```python
import torch

def _softmax(x, axis=-1):
    return torch.softmax(x, dim=axis)
def _gelu(x):
    return torch.nn.functional.gelu(x, approximate="tanh")
def _silu(x):
    return torch.nn.functional.silu(x)
def _sigmoid(x):
    return torch.sigmoid(x)
def _layernorm(x, axis=-1, eps=1e-5):
    m = x.mean(dim=axis, keepdim=True)
    v = x.var(dim=axis, keepdim=True, unbiased=False)
    return (x - m) / torch.sqrt(v + eps)
def _scatter_add(tgt, idx, src, axis=0):
    return tgt.clone().index_add_(axis, idx, src)
def _segment_sum(src, seg, n):
    out = torch.zeros((n,) + src.shape[1:], dtype=src.dtype)
    return out.index_add_(0, seg, src)
def _pad(x, pw):
    flat = tuple(v for pair in reversed(pw) for v in pair)
    return torch.nn.functional.pad(x, flat)

kernel_name = 'standalone__mha_block_cached__near_ridge'

def setup_inputs():

    _w = (lambda a: (lambda t: t.to(torch.bfloat16) if t.is_floating_point() else t)(torch.as_tensor(a)))
    B, Sq, D = 32, 192, 512
    H, Sk, Dh = 32, 512, 128
    return {
        "x": _w((lambda *s: torch.randn(*s, dtype=torch.bfloat16) * 0.8)(B, Sq, D)),
        "k_cache": _w((lambda *s: torch.randn(*s, dtype=torch.bfloat16) * 0.8)(B, H, Sk, Dh)),
        "v_cache": _w((lambda *s: torch.randn(*s, dtype=torch.bfloat16) * 0.05)(B, H, Sk, Dh)),
        "wq": _w((lambda *s: torch.randn(*s, dtype=torch.bfloat16) * 0.8)(D, H * Dh) * (D ** -0.5)),
        "wo": _w((lambda *s: torch.randn(*s, dtype=torch.bfloat16) * 0.05)(H * Dh, D) * ((H * Dh) ** -0.5)),
    }

def reference(x, k_cache, v_cache, wq, wo):
    B, Sq, D = x.shape
    H, Dh = 32, 128
    q = (lambda x, *d: x.permute(*d))((x @ wq).reshape(B, Sq, H, Dh), 0, 2, 1, 3)
    scores = torch.einsum("bhqd,bhkd->bhqk", q, k_cache) * (Dh ** -0.5)
    p = _softmax(scores, axis=-1)
    o = torch.einsum("bhqk,bhkd->bhqd", p, v_cache)
    return (lambda x, *d: x.permute(*d))(o, 0, 2, 1, 3).reshape(B, Sq, H * Dh) @ wo
```

```asm
; @launch grid=(256,1,1) block=(256,1,1) lds=163840
.amdgcn_target "amdgcn-amd-amdhsa--gfx950"
.text
.macro mm d, a, b, c
v_mfma_f32_16x16x32_bf16 \d, \a, \b, \c
.endm
.macro tr d, a, o
ds_read_b64_tr_b16 \d, \a offset:\o
.endm
.macro lq d, a, o
ds_read_b128 \d, \a offset:\o
.endm
.macro cv d, a, b
v_cvt_pk_bf16_f32 \d, \a, \b
.endm
.globl standalone__mha_block_cached__near_ridge_kernel
.p2align 8
.type standalone__mha_block_cached__near_ridge_kernel,@function
standalone__mha_block_cached__near_ridge_kernel:
s_cmp_ge_u32 s2, 256
s_cbranch_scc1 L_end
s_load_dwordx16 s[60:75], s[0:1], 0
s_getpc_b64 s[76:77]
v_lshrrev_b32 v14, 6, v0
s_and_b32 s53, s2, 7
v_readfirstlane_b32 s42, v14
s_lshr_b32 s54, s2, 3
s_and_b32 s41, s54, 1
s_and_b32 s55, s53, 3
s_lshl_b32 s55, s55, 1
s_add_u32 s41, s41, s55
s_lshr_b32 s53, s53, 2
s_lshr_b32 s54, s54, 1
s_lshl_b32 s55, s54, 0
s_add_u32 s55, s55, s41
s_and_b32 s59, s55, 7
s_lshl_b32 s54, s54, 1
s_add_u32 s40, s53, s54
v_and_b32 v0, 63, v0
s_lshl_b32 s43, s42, 12
s_add_u32 s44, s43, 16384
v_bfe_u32 v80, v0, 2, 2
v_bfe_u32 v81, v0, 4, 1
v_lshrrev_b32 v82, 5, v0
v_and_b32 v83, 3, v0
v_xor_b32 v84, v83, v81
v_lshl_add_u32 v84, v82, 2, v84
v_lshlrev_b32 v84, 4, v84
v_lshl_add_u32 v85, v81, 2, v80
v_lshlrev_b32 v91, 1, v81
v_xor_b32 v91, v91, v83
v_lshl_add_u32 v91, v82, 2, v91
v_lshlrev_b32 v91, 4, v91
s_mul_i32 s53, s42, 48
v_add_u32 v86, s53, v85
v_lshl_add_u32 v100, v86, 10, v91
v_add_u32 v101, 7168, v100
v_add_u32 v102, 14336, v100
v_add_u32 v103, 21504, v100
v_lshl_add_u32 v86, v81, 3, v80
v_lshl_add_u32 v1, v86, 13, v84
s_lshr_b32 s53, s42, 1
s_lshl_b32 s53, s53, 5
s_and_b32 s56, s42, 1
s_lshl_b32 s56, s56, 2
s_add_u32 s53, s53, s56
s_lshl_b32 s53, s53, 13
v_add_u32 v104, s53, v1
v_add_u32 v105, 130048, v104
s_mul_i32 s92, s42, 6144
s_lshl_b32 s93, s42, 11
s_add_u32 s93, s93, 24576
s_lshr_b32 s53, s2, 3
s_lshl_b32 s53, s53, 2
s_add_u32 s53, s53, s42
s_mul_i32 s56, s53, 2048
s_lshr_b32 s56, s56, 16
s_mul_i32 s56, s56, 32
s_sub_u32 s53, s53, s56
s_lshl_b32 s53, s53, 12
v_lshl_add_u32 v87, v0, 6, s53
global_load_dword v14, v87, s[76:77]
s_waitcnt lgkmcnt(0)
s_lshl_b32 s53, s41, 10
s_add_u32 s16, s66, s53
s_addc_u32 s17, s67, 0
s_sub_u32 s18, 4194304, s53
s_mov_b32 s19, 0x20000
s_mul_i32 s53, s40, 196608
s_add_u32 s4, s60, s53
s_addc_u32 s5, s61, 0
s_sub_u32 s6, 6291456, s53
s_mov_b32 s7, 0x20000
s_add_u32 s3, s59, 0
s_and_b32 s3, s3, 7
s_lshl_b32 s3, s3, 7
s_add_u32 m0, s92, 0
s_add_u32 s50, s3, 32768
buffer_load_dwordx4 v100, s[4:7], s3 offen offset:0 lds
buffer_load_dwordx4 v101, s[4:7], s3 offen offset:1024 lds
buffer_load_dwordx4 v102, s[4:7], s3 offen offset:2048 lds
buffer_load_dwordx4 v103, s[4:7], s3 offen offset:3072 lds
s_add_u32 m0, s92, 4096
s_lshl_b32 s51, s3, 12
buffer_load_dwordx4 v100, s[4:7], s50 offen offset:0 lds
buffer_load_dwordx4 v101, s[4:7], s50 offen offset:1024 lds
s_add_u32 m0, s93, 0
s_nop 0
buffer_load_dwordx4 v104, s[16:19], s51 offen offset:0 lds
buffer_load_dwordx4 v105, s[16:19], s51 offen offset:1024 lds
s_add_u32 s3, s59, 1
s_and_b32 s3, s3, 7
s_lshl_b32 s3, s3, 7
s_add_u32 m0, s92, 32768
s_add_u32 s50, s3, 32768
buffer_load_dwordx4 v100, s[4:7], s3 offen offset:0 lds
buffer_load_dwordx4 v101, s[4:7], s3 offen offset:1024 lds
buffer_load_dwordx4 v102, s[4:7], s3 offen offset:2048 lds
buffer_load_dwordx4 v103, s[4:7], s3 offen offset:3072 lds
s_add_u32 m0, s92, 36864
s_lshl_b32 s51, s3, 12
buffer_load_dwordx4 v100, s[4:7], s50 offen offset:0 lds
buffer_load_dwordx4 v101, s[4:7], s50 offen offset:1024 lds
s_add_u32 m0, s93, 32768
s_nop 0
buffer_load_dwordx4 v104, s[16:19], s51 offen offset:0 lds
buffer_load_dwordx4 v105, s[16:19], s51 offen offset:1024 lds
v_lshlrev_b32 v88, 10, v82
v_lshl_add_u32 v88, v80, 6, v88
v_lshl_add_u32 v88, v81, 8, v88
v_and_b32 v90, 1, v83
v_lshl_add_u32 v88, v90, 3, v88
v_lshrrev_b32 v89, 1, v83
v_xor_b32 v86, 0, v81
v_lshl_add_u32 v87, v89, 1, v86
v_lshl_add_u32 v9, v87, 4, v88
v_lshl_add_u32 v87, v86, 1, v89
v_lshl_add_u32 v12, v87, 4, v88
v_add_u32 v12, 65536, v12
v_xor_b32 v86, 1, v81
v_lshl_add_u32 v87, v89, 1, v86
v_lshl_add_u32 v10, v87, 4, v88
v_lshl_add_u32 v87, v86, 1, v89
v_lshl_add_u32 v13, v87, 4, v88
v_add_u32 v13, 65536, v13
v_bfe_u32 v86, v0, 2, 1
v_lshlrev_b32 v87, 1, v86
v_lshrrev_b32 v90, 4, v0
v_xor_b32 v87, v87, v90
v_lshl_add_u32 v87, v83, 2, v87
v_lshl_add_u32 v87, v86, 4, v87
v_lshlrev_b32 v87, 4, v87
v_bfe_u32 v86, v0, 3, 1
v_lshl_add_u32 v11, v86, 10, v87
v_add_u32 v106, s92, v11
v_add_u32 v107, 65536, v106
v_add_u32 v108, 131072, v106
v_add_u32 v11, 65536, v11
s_mov_b64 exec, 0
s_cmp_eq_u32 s42, 1
s_cbranch_scc1 L_pg1
s_cmp_eq_u32 s42, 2
s_cbranch_scc1 L_pg2
s_cmp_eq_u32 s42, 3
s_cbranch_scc1 L_pg3
s_branch L_pg0
L_tret0:
s_mov_b64 exec, -1
s_add_u32 s3, s59, 2
s_and_b32 s3, s3, 7
s_lshl_b32 s3, s3, 7
s_add_u32 m0, s92, 65536
s_add_u32 s50, s3, 32768
buffer_load_dwordx4 v100, s[4:7], s3 offen offset:0 lds
buffer_load_dwordx4 v101, s[4:7], s3 offen offset:1024 lds
buffer_load_dwordx4 v102, s[4:7], s3 offen offset:2048 lds
buffer_load_dwordx4 v103, s[4:7], s3 offen offset:3072 lds
s_add_u32 m0, s92, 69632
s_lshl_b32 s51, s3, 12
buffer_load_dwordx4 v100, s[4:7], s50 offen offset:0 lds
buffer_load_dwordx4 v101, s[4:7], s50 offen offset:1024 lds
s_add_u32 m0, s93, 65536
s_nop 0
buffer_load_dwordx4 v104, s[16:19], s51 offen offset:0 lds
buffer_load_dwordx4 v105, s[16:19], s51 offen offset:1024 lds
s_waitcnt vmcnt(16)
s_barrier
s_branch L_main
.p2align 12
L_main:
L_pg0:
s_cbranch_execz L_pg4
lq v[112:115],v106,0
lq v[116:119],v106,2048
lq v[120:123],v106,4096
lq v[124:127],v106,512
lq v[128:131],v106,2560
lq v[132:135],v106,4608
tr a[216:217],v9,24576
tr a[218:219],v9,26624
tr a[220:221],v9,28672
tr a[222:223],v9,30720
tr a[224:225],v10,24576
tr a[226:227],v10,26624
tr a[228:229],v10,28672
tr a[230:231],v10,30720
tr a[232:233],v9,25088
tr a[234:235],v9,27136
tr a[236:237],v9,29184
tr a[238:239],v9,31232
tr a[240:241],v10,25088
tr a[242:243],v10,27136
tr a[244:245],v10,29184
tr a[246:247],v10,31232
s_waitcnt lgkmcnt(8)
mm v[16:19],a[216:219],v[112:115],0
s_waitcnt vmcnt(8)
s_add_u32 s3, s59, 3
s_and_b32 s3, s3, 7
mm v[16:19],a[220:223],v[124:127],v[16:19]
s_barrier
s_lshl_b32 s3, s3, 7
s_add_u32 m0, s92, 98304
mm v[20:23],a[220:223],v[128:131],0
s_add_u32 s50, s3, 32768
buffer_load_dwordx4 v100, s[4:7], s3 offen offset:0 lds
buffer_load_dwordx4 v101, s[4:7], s3 offen offset:1024 lds
mm v[20:23],a[216:219],v[116:119],v[20:23]
buffer_load_dwordx4 v102, s[4:7], s3 offen offset:2048 lds
buffer_load_dwordx4 v103, s[4:7], s3 offen offset:3072 lds
s_add_u32 m0, s92, 102400
mm v[24:27],a[216:219],v[120:123],0
s_lshl_b32 s51, s3, 12
buffer_load_dwordx4 v100, s[4:7], s50 offen offset:0 lds
buffer_load_dwordx4 v101, s[4:7], s50 offen offset:1024 lds
mm v[24:27],a[220:223],v[132:135],v[24:27]
s_add_u32 m0, s93, 98304
s_nop 0
buffer_load_dwordx4 v104, s[16:19], s51 offen offset:0 lds
mm v[36:39],a[228:231],v[132:135],0
buffer_load_dwordx4 v105, s[16:19], s51 offen offset:1024 lds
lq v[136:139],v106,32768
s_add_u32 s3, s59, 4
mm v[36:39],a[224:227],v[120:123],v[36:39]
lq v[140:143],v106,34816
s_and_b32 s3, s3, 7
s_lshl_b32 s3, s3, 7
mm v[32:35],a[224:227],v[116:119],0
lq v[144:147],v106,36864
s_add_u32 m0, s92, 131072
v_add_u32 v4, 160768, v1
mm v[32:35],a[228:231],v[128:131],v[32:35]
lq v[148:151],v106,33280
s_add_u32 s50, s3, 32768
v_add_u32 v3, 30720, v1
mm v[28:31],a[228:231],v[124:127],0
s_waitcnt lgkmcnt(4)
lq v[152:155],v106,35328
buffer_load_dwordx4 v100, s[4:7], s3 offen offset:0 lds
mm v[28:31],a[224:227],v[112:115],v[28:31]
lq v[156:159],v106,37376
buffer_load_dwordx4 v101, s[4:7], s3 offen offset:1024 lds
buffer_load_dwordx4 v102, s[4:7], s3 offen offset:2048 lds
mm v[40:43],a[232:235],v[112:115],0
tr a[216:217],v9,57344
tr a[218:219],v9,59392
tr a[220:221],v9,61440
tr a[222:223],v9,63488
mm v[40:43],a[236:239],v[124:127],v[40:43]
tr a[224:225],v10,57344
buffer_load_dwordx4 v103, s[4:7], s3 offen offset:3072 lds
s_add_u32 m0, s92, 135168
mm v[44:47],a[236:239],v[128:131],0
tr a[226:227],v10,59392
s_lshl_b32 s51, s3, 12
v_add_u32 v2, 130048, v1
mm v[44:47],a[232:235],v[116:119],v[44:47]
tr a[228:229],v10,61440
buffer_load_dwordx4 v100, s[4:7], s50 offen offset:0 lds
buffer_load_dwordx4 v101, s[4:7], s50 offen offset:1024 lds
mm v[48:51],a[232:235],v[120:123],0
tr a[230:231],v10,63488
s_add_u32 m0, s93, 131072
s_lshr_b32 s53, s42, 1
mm v[48:51],a[236:239],v[132:135],v[48:51]
s_nop 0
tr a[232:233],v9,57856
s_add_u32 s53, s53, s59
mm v[60:63],a[244:247],v[132:135],0
buffer_load_dwordx4 v104, s[16:19], s51 offen offset:0 lds
tr a[234:235],v9,59904
s_add_u32 s53, s53, 0
mm v[60:63],a[240:243],v[120:123],v[60:63]
buffer_load_dwordx4 v105, s[16:19], s51 offen offset:1024 lds
tr a[236:237],v9,61952
s_and_b32 s53, s53, 7
mm v[56:59],a[240:243],v[116:119],0
tr a[238:239],v9,64000
s_lshl_b32 s53, s53, 1
s_and_b32 s56, s42, 1
mm v[56:59],a[244:247],v[128:131],v[56:59]
mm v[52:55],a[244:247],v[124:127],0
s_waitcnt vmcnt(16)
s_waitcnt lgkmcnt(4)
mm v[52:55],a[240:243],v[112:115],v[52:55]
tr a[240:241],v10,57856
s_add_u32 s53, s53, s56
mm v[16:19],a[216:219],v[136:139],v[16:19]
s_barrier
tr a[242:243],v10,59904
mm v[16:19],a[220:223],v[148:151],v[16:19]
tr a[244:245],v10,61952
s_add_u32 s3, s59, 5
s_lshl_b32 s94, s53, 18
mm v[20:23],a[220:223],v[152:155],v[20:23]
tr a[246:247],v10,64000
v_add_u32 v9, 65536, v9
v_add_u32 v10, 65536, v10
mm v[20:23],a[216:219],v[140:143],v[20:23]
lq v[160:163],v107,0
s_and_b32 s3, s3, 7
s_lshl_b32 s3, s3, 7
mm v[24:27],a[216:219],v[144:147],v[24:27]
lq v[164:167],v107,2048
s_add_u32 m0, s92, 0
s_lshr_b32 s53, s42, 1
mm v[24:27],a[220:223],v[156:159],v[24:27]
lq v[168:171],v107,4096
s_add_u32 s50, s3, 32768
mm v[36:39],a[228:231],v[156:159],v[36:39]
lq v[172:175],v107,512
buffer_load_dwordx4 v100, s[4:7], s3 offen offset:0 lds
s_add_u32 s53, s53, s59
mm v[36:39],a[224:227],v[144:147],v[36:39]
lq v[176:179],v107,2560
mm v[32:35],a[224:227],v[140:143],v[32:35]
lq v[180:183],v107,4608
buffer_load_dwordx4 v101, s[4:7], s3 offen offset:1024 lds
mm v[32:35],a[228:231],v[152:155],v[32:35]
tr a[216:217],v9,24576
buffer_load_dwordx4 v102, s[4:7], s3 offen offset:2048 lds
s_add_u32 s53, s53, 2
mm v[28:31],a[228:231],v[148:151],v[28:31]
s_waitcnt lgkmcnt(7)
tr a[218:219],v9,26624
buffer_load_dwordx4 v103, s[4:7], s3 offen offset:3072 lds
mm v[28:31],a[224:227],v[136:139],v[28:31]
tr a[220:221],v9,28672
s_add_u32 m0, s92, 4096
mm v[40:43],a[232:235],v[136:139],v[40:43]
tr a[222:223],v9,30720
s_lshl_b32 s51, s3, 12
s_and_b32 s53, s53, 7
mm v[40:43],a[236:239],v[148:151],v[40:43]
tr a[224:225],v10,24576
buffer_load_dwordx4 v100, s[4:7], s50 offen offset:0 lds
mm v[44:47],a[236:239],v[152:155],v[44:47]
tr a[226:227],v10,26624
s_lshl_b32 s53, s53, 1
mm v[44:47],a[232:235],v[140:143],v[44:47]
tr a[228:229],v10,28672
buffer_load_dwordx4 v101, s[4:7], s50 offen offset:1024 lds
mm v[48:51],a[232:235],v[144:147],v[48:51]
tr a[230:231],v10,30720
s_add_u32 m0, s93, 0
mm v[48:51],a[236:239],v[156:159],v[48:51]
s_nop 0
tr a[232:233],v9,25088
s_and_b32 s56, s42, 1
mm v[60:63],a[244:247],v[156:159],v[60:63]
buffer_load_dwordx4 v104, s[16:19], s51 offen offset:0 lds
tr a[234:235],v9,27136
mm v[60:63],a[240:243],v[144:147],v[60:63]
buffer_load_dwordx4 v105, s[16:19], s51 offen offset:1024 lds
tr a[236:237],v9,29184
s_add_u32 s53, s53, s56
mm v[56:59],a[240:243],v[140:143],v[56:59]
tr a[238:239],v9,31232
mm v[56:59],a[244:247],v[152:155],v[56:59]
mm v[52:55],a[244:247],v[148:151],v[52:55]
s_waitcnt vmcnt(16)
s_waitcnt lgkmcnt(4)
s_lshl_b32 s95, s53, 18
mm v[52:55],a[240:243],v[136:139],v[52:55]
tr a[240:241],v10,25088
mm v[16:19],a[216:219],v[160:163],v[16:19]
s_barrier
tr a[242:243],v10,27136
s_lshr_b32 s53, s42, 1
mm v[16:19],a[220:223],v[172:175],v[16:19]
tr a[244:245],v10,29184
s_add_u32 s3, s59, 6
mm v[20:23],a[220:223],v[176:179],v[20:23]
tr a[246:247],v10,31232
s_and_b32 s3, s3, 7
mm v[20:23],a[216:219],v[164:167],v[20:23]
lq v[184:187],v107,32768
s_lshl_b32 s3, s3, 7
s_add_u32 s53, s53, s59
mm v[24:27],a[216:219],v[168:171],v[24:27]
lq v[188:191],v107,34816
s_add_u32 m0, s92, 32768
mm v[24:27],a[220:223],v[180:183],v[24:27]
lq v[192:195],v107,36864
s_add_u32 s50, s3, 32768
mm v[36:39],a[228:231],v[180:183],v[36:39]
lq v[196:199],v107,33280
buffer_load_dwordx4 v100, s[4:7], s3 offen offset:0 lds
s_add_u32 s53, s53, 4
mm v[36:39],a[224:227],v[168:171],v[36:39]
lq v[200:203],v107,35328
mm v[32:35],a[224:227],v[164:167],v[32:35]
lq v[204:207],v107,37376
buffer_load_dwordx4 v101, s[4:7], s3 offen offset:1024 lds
s_and_b32 s53, s53, 7
mm v[32:35],a[228:231],v[176:179],v[32:35]
tr a[216:217],v9,57344
buffer_load_dwordx4 v102, s[4:7], s3 offen offset:2048 lds
mm v[28:31],a[228:231],v[172:175],v[28:31]
s_waitcnt lgkmcnt(7)
tr a[218:219],v9,59392
buffer_load_dwordx4 v103, s[4:7], s3 offen offset:3072 lds
mm v[28:31],a[224:227],v[160:163],v[28:31]
tr a[220:221],v9,61440
s_add_u32 m0, s92, 36864
s_lshl_b32 s53, s53, 1
mm v[40:43],a[232:235],v[160:163],v[40:43]
tr a[222:223],v9,63488
s_lshl_b32 s51, s3, 12
mm v[40:43],a[236:239],v[172:175],v[40:43]
tr a[224:225],v10,57344
buffer_load_dwordx4 v100, s[4:7], s50 offen offset:0 lds
s_and_b32 s56, s42, 1
mm v[44:47],a[236:239],v[176:179],v[44:47]
tr a[226:227],v10,59392
mm v[44:47],a[232:235],v[164:167],v[44:47]
tr a[228:229],v10,61440
buffer_load_dwordx4 v101, s[4:7], s50 offen offset:1024 lds
mm v[48:51],a[232:235],v[168:171],v[48:51]
tr a[230:231],v10,63488
s_add_u32 m0, s93, 32768
s_add_u32 s53, s53, s56
mm v[48:51],a[236:239],v[180:183],v[48:51]
s_nop 0
tr a[232:233],v9,57856
mm v[60:63],a[244:247],v[180:183],v[60:63]
buffer_load_dwordx4 v104, s[16:19], s51 offen offset:0 lds
tr a[234:235],v9,59904
s_lshl_b32 s96, s53, 18
mm v[60:63],a[240:243],v[168:171],v[60:63]
buffer_load_dwordx4 v105, s[16:19], s51 offen offset:1024 lds
tr a[236:237],v9,61952
mm v[56:59],a[240:243],v[164:167],v[56:59]
tr a[238:239],v9,64000
mm v[56:59],a[244:247],v[176:179],v[56:59]
s_lshr_b32 s53, s42, 1
mm v[52:55],a[244:247],v[172:175],v[52:55]
s_waitcnt vmcnt(16)
s_waitcnt lgkmcnt(4)
mm v[52:55],a[240:243],v[160:163],v[52:55]
tr a[240:241],v10,57856
mm v[16:19],a[216:219],v[184:187],v[16:19]
s_barrier
tr a[242:243],v10,59904
s_add_u32 s53, s53, s59
mm v[16:19],a[220:223],v[196:199],v[16:19]
tr a[244:245],v10,61952
s_add_u32 s3, s59, 7
mm v[20:23],a[220:223],v[200:203],v[20:23]
tr a[246:247],v10,64000
v_add_u32 v9, 65536, v9
v_add_u32 v10, 65536, v10
mm v[20:23],a[216:219],v[188:191],v[20:23]
lq v[208:211],v108,0
s_add_u32 s53, s53, 6
s_and_b32 s3, s3, 7
mm v[24:27],a[216:219],v[192:195],v[24:27]
lq v[212:215],v108,2048
s_lshl_b32 s3, s3, 7
s_add_u32 m0, s92, 65536
mm v[24:27],a[220:223],v[204:207],v[24:27]
lq v[216:219],v108,4096
s_and_b32 s53, s53, 7
s_add_u32 s50, s3, 32768
mm v[36:39],a[228:231],v[204:207],v[36:39]
lq v[220:223],v108,512
buffer_load_dwordx4 v100, s[4:7], s3 offen offset:0 lds
mm v[36:39],a[224:227],v[192:195],v[36:39]
lq v[224:227],v108,2560
s_lshl_b32 s53, s53, 1
mm v[32:35],a[224:227],v[188:191],v[32:35]
lq v[228:231],v108,4608
buffer_load_dwordx4 v101, s[4:7], s3 offen offset:1024 lds
mm v[32:35],a[228:231],v[200:203],v[32:35]
tr a[216:217],v9,24576
buffer_load_dwordx4 v102, s[4:7], s3 offen offset:2048 lds
mm v[28:31],a[228:231],v[196:199],v[28:31]
s_waitcnt lgkmcnt(7)
tr a[218:219],v9,26624
s_and_b32 s56, s42, 1
mm v[28:31],a[224:227],v[184:187],v[28:31]
tr a[220:221],v9,28672
buffer_load_dwordx4 v103, s[4:7], s3 offen offset:3072 lds
s_add_u32 m0, s92, 69632
mm v[40:43],a[232:235],v[184:187],v[40:43]
tr a[222:223],v9,30720
s_add_u32 s53, s53, s56
s_lshl_b32 s51, s3, 12
mm v[40:43],a[236:239],v[196:199],v[40:43]
tr a[224:225],v10,24576
buffer_load_dwordx4 v100, s[4:7], s50 offen offset:0 lds
mm v[44:47],a[236:239],v[200:203],v[44:47]
tr a[226:227],v10,26624
mm v[44:47],a[232:235],v[188:191],v[44:47]
tr a[228:229],v10,28672
s_lshl_b32 s97, s53, 18
buffer_load_dwordx4 v101, s[4:7], s50 offen offset:1024 lds
mm v[48:51],a[232:235],v[192:195],v[48:51]
tr a[230:231],v10,30720
s_add_u32 m0, s93, 65536
mm v[48:51],a[236:239],v[204:207],v[48:51]
s_nop 0
tr a[232:233],v9,25088
mm v[60:63],a[244:247],v[204:207],v[60:63]
buffer_load_dwordx4 v104, s[16:19], s51 offen offset:0 lds
tr a[234:235],v9,27136
mm v[60:63],a[240:243],v[192:195],v[60:63]
buffer_load_dwordx4 v105, s[16:19], s51 offen offset:1024 lds
tr a[236:237],v9,29184
mm v[56:59],a[240:243],v[188:191],v[56:59]
tr a[238:239],v9,31232
v_lshl_add_u32 v86, v85, 8, v91
mm v[56:59],a[244:247],v[200:203],v[56:59]
mm v[52:55],a[244:247],v[196:199],v[52:55]
s_waitcnt vmcnt(16)
s_waitcnt lgkmcnt(4)
mm v[52:55],a[240:243],v[184:187],v[52:55]
tr a[240:241],v10,25088
s_lshr_b32 s53, s42, 1
mm v[16:19],a[216:219],v[208:211],v[16:19]
s_barrier
tr a[242:243],v10,27136
mm v[16:19],a[220:223],v[220:223],v[16:19]
s_add_u32 s50, s94, 128
s_add_u32 s51, s95, 128
tr a[244:245],v10,29184
mm v[20:23],a[220:223],v[224:227],v[20:23]
tr a[246:247],v10,31232
v_add_u32 v9, 4294836224, v9
v_add_u32 v10, 4294836224, v10
mm v[20:23],a[216:219],v[212:215],v[20:23]
lq v[232:235],v106,0
s_add_u32 m0, s43, 98304
s_lshl_b32 s53, s53, 13
mm v[24:27],a[216:219],v[216:219],v[24:27]
buffer_load_dwordx4 v1, s[16:19], s50 offen offset:0 lds
lq v[236:239],v106,2048
buffer_load_dwordx4 v2, s[16:19], s50 offen offset:1024 lds
mm v[24:27],a[220:223],v[228:231],v[24:27]
lq v[240:243],v106,4096
mm v[36:39],a[228:231],v[228:231],v[36:39]
lq v[244:247],v106,512
buffer_load_dwordx4 v3, s[16:19], s50 offen offset:2048 lds
mm v[36:39],a[224:227],v[216:219],v[36:39]
lq v[248:251],v106,2560
s_and_b32 s56, s42, 1
mm v[32:35],a[224:227],v[212:215],v[32:35]
lq v[252:255],v106,4608
mm v[32:35],a[228:231],v[224:227],v[32:35]
tr a[216:217],v9,24576
buffer_load_dwordx4 v4, s[16:19], s50 offen offset:3072 lds
mm v[28:31],a[228:231],v[220:223],v[28:31]
s_waitcnt lgkmcnt(7)
tr a[218:219],v9,26624
s_lshl_b32 s56, s56, 7
mm v[28:31],a[224:227],v[208:211],v[28:31]
tr a[220:221],v9,28672
s_add_u32 m0, s44, 98304
mm v[40:43],a[232:235],v[208:211],v[40:43]
tr a[222:223],v9,30720
buffer_load_dwordx4 v1, s[16:19], s51 offen offset:0 lds
mm v[40:43],a[236:239],v[220:223],v[40:43]
tr a[224:225],v10,24576
buffer_load_dwordx4 v2, s[16:19], s51 offen offset:1024 lds
mm v[44:47],a[236:239],v[224:227],v[44:47]
tr a[226:227],v10,26624
s_add_u32 s53, s53, s56
mm v[44:47],a[232:235],v[212:215],v[44:47]
tr a[228:229],v10,28672
mm v[48:51],a[232:235],v[216:219],v[48:51]
tr a[230:231],v10,30720
buffer_load_dwordx4 v3, s[16:19], s51 offen offset:2048 lds
mm v[48:51],a[236:239],v[228:231],v[48:51]
tr a[232:233],v9,25088
mm v[60:63],a[244:247],v[228:231],v[60:63]
buffer_load_dwordx4 v4, s[16:19], s51 offen offset:3072 lds
tr a[234:235],v9,27136
v_add_u32 v5, s53, v86
mm v[60:63],a[240:243],v[216:219],v[60:63]
tr a[236:237],v9,29184
mm v[56:59],a[240:243],v[212:215],v[56:59]
tr a[238:239],v9,31232
mm v[56:59],a[244:247],v[224:227],v[56:59]
mm v[52:55],a[244:247],v[220:223],v[52:55]
s_waitcnt vmcnt(16)
s_waitcnt lgkmcnt(4)
v_add_u32 v6, 1024, v5
mm v[52:55],a[240:243],v[208:211],v[52:55]
tr a[240:241],v10,25088
mm v[16:19],a[216:219],v[232:235],v[16:19]
s_barrier
tr a[242:243],v10,27136
mm v[16:19],a[220:223],v[244:247],v[16:19]
s_add_u32 s50, s96, 128
s_add_u32 s51, s97, 128
tr a[244:245],v10,29184
mm v[20:23],a[220:223],v[248:251],v[20:23]
tr a[246:247],v10,31232
s_add_u32 m0, s43, 131072
v_add_u32 v7, 2048, v5
mm v[20:23],a[216:219],v[236:239],v[20:23]
lq a[168:171],v106,32768
buffer_load_dwordx4 v1, s[16:19], s50 offen offset:0 lds
mm v[24:27],a[216:219],v[240:243],v[24:27]
lq a[172:175],v106,34816
buffer_load_dwordx4 v2, s[16:19], s50 offen offset:1024 lds
mm v[24:27],a[220:223],v[252:255],v[24:27]
lq a[176:179],v106,36864
v_add_u32 v8, 3072, v5
mm v[36:39],a[228:231],v[252:255],v[36:39]
lq a[180:183],v106,33280
buffer_load_dwordx4 v3, s[16:19], s50 offen offset:2048 lds
mm v[36:39],a[224:227],v[240:243],v[36:39]
lq a[184:187],v106,35328
mm v[32:35],a[224:227],v[236:239],v[32:35]
lq a[188:191],v106,37376
mm v[32:35],a[228:231],v[248:251],v[32:35]
tr a[216:217],v9,57344
buffer_load_dwordx4 v4, s[16:19], s50 offen offset:3072 lds
s_lshl_b32 s53, s42, 5
mm v[28:31],a[228:231],v[244:247],v[28:31]
s_waitcnt lgkmcnt(7)
tr a[218:219],v9,59392
mm v[28:31],a[224:227],v[232:235],v[28:31]
tr a[220:221],v9,61440
s_add_u32 m0, s44, 131072
mm v[40:43],a[232:235],v[232:235],v[40:43]
tr a[222:223],v9,63488
buffer_load_dwordx4 v1, s[16:19], s51 offen offset:0 lds
mm v[40:43],a[236:239],v[244:247],v[40:43]
tr a[224:225],v10,57344
buffer_load_dwordx4 v2, s[16:19], s51 offen offset:1024 lds
v_add_u32 v86, s53, v85
mm v[44:47],a[236:239],v[248:251],v[44:47]
tr a[226:227],v10,59392
mm v[44:47],a[232:235],v[236:239],v[44:47]
tr a[228:229],v10,61440
mm v[48:51],a[232:235],v[240:243],v[48:51]
tr a[230:231],v10,63488
buffer_load_dwordx4 v3, s[16:19], s51 offen offset:2048 lds
v_lshl_add_u32 v86, v86, 10, v84
mm v[48:51],a[236:239],v[252:255],v[48:51]
tr a[232:233],v9,57856
mm v[60:63],a[244:247],v[252:255],v[60:63]
buffer_load_dwordx4 v4, s[16:19], s51 offen offset:3072 lds
tr a[234:235],v9,59904
mm v[60:63],a[240:243],v[240:243],v[60:63]
tr a[236:237],v9,61952
mm v[56:59],a[240:243],v[236:239],v[56:59]
tr a[238:239],v9,64000
v_accvgpr_write_b32 a248, v86
mm v[56:59],a[244:247],v[248:251],v[56:59]
mm v[52:55],a[244:247],v[244:247],v[52:55]
s_waitcnt vmcnt(16)
s_waitcnt lgkmcnt(4)
mm v[52:55],a[240:243],v[232:235],v[52:55]
tr a[240:241],v10,57856
mm v[16:19],a[216:219],a[168:171],v[16:19]
s_barrier
s_mov_b32 s52, 0x3e0293ee
tr a[242:243],v10,59904
mm v[16:19],a[220:223],a[180:183],v[16:19]
s_add_u32 s50, s94, 256
s_add_u32 s51, s95, 256
tr a[244:245],v10,61952
mm v[20:23],a[220:223],a[184:187],v[20:23]
tr a[246:247],v10,64000
v_add_u32 v9, 65536, v9
v_add_u32 v10, 65536, v10
mm v[20:23],a[216:219],a[172:175],v[20:23]
lq a[192:195],v107,0
s_add_u32 m0, s43, 0
mm v[24:27],a[216:219],a[176:179],v[24:27]
buffer_load_dwordx4 v1, s[16:19], s50 offen offset:0 lds
lq a[196:199],v107,2048
buffer_load_dwordx4 v2, s[16:19], s50 offen offset:1024 lds
mm v[24:27],a[220:223],a[188:191],v[24:27]
lq a[200:203],v107,4096
mm v[36:39],a[228:231],a[188:191],v[36:39]
lq a[204:207],v107,512
buffer_load_dwordx4 v3, s[16:19], s50 offen offset:2048 lds
s_mov_b32 s53, 67108864
mm v[36:39],a[224:227],a[176:179],v[36:39]
lq a[208:211],v107,2560
mm v[32:35],a[224:227],a[172:175],v[32:35]
lq a[212:215],v107,4608
s_add_u32 s28, s74, s53
s_addc_u32 s29, s75, 0
mm v[32:35],a[228:231],a[184:187],v[32:35]
tr a[216:217],v9,24576
buffer_load_dwordx4 v4, s[16:19], s50 offen offset:3072 lds
mm v[28:31],a[228:231],a[180:183],v[28:31]
s_waitcnt lgkmcnt(7)
tr a[218:219],v9,26624
s_sub_u32 s30, 92274688, s53
mm v[28:31],a[224:227],a[168:171],v[28:31]
tr a[220:221],v9,28672
s_add_u32 m0, s44, 0
mm v[40:43],a[232:235],a[168:171],v[40:43]
tr a[222:223],v9,30720
buffer_load_dwordx4 v1, s[16:19], s51 offen offset:0 lds
s_mov_b32 s31, 0x20000
mm v[40:43],a[236:239],a[180:183],v[40:43]
tr a[224:225],v10,24576
buffer_load_dwordx4 v2, s[16:19], s51 offen offset:1024 lds
mm v[44:47],a[236:239],a[184:187],v[44:47]
tr a[226:227],v10,26624
s_lshl_b32 s56, s40, 3
mm v[44:47],a[232:235],a[172:175],v[44:47]
tr a[228:229],v10,28672
mm v[48:51],a[232:235],a[176:179],v[48:51]
tr a[230:231],v10,30720
buffer_load_dwordx4 v3, s[16:19], s51 offen offset:2048 lds
mm v[48:51],a[236:239],a[188:191],v[48:51]
tr a[232:233],v9,25088
s_add_u32 s56, s56, s41
mm v[60:63],a[244:247],a[188:191],v[60:63]
buffer_load_dwordx4 v4, s[16:19], s51 offen offset:3072 lds
tr a[234:235],v9,27136
mm v[60:63],a[240:243],a[176:179],v[60:63]
tr a[236:237],v9,29184
s_lshl_b32 s53, s56, 2
mm v[56:59],a[240:243],a[172:175],v[56:59]
tr a[238:239],v9,31232
mm v[56:59],a[244:247],a[184:187],v[56:59]
s_add_u32 s53, s53, s42
mm v[52:55],a[244:247],a[180:183],v[52:55]
s_waitcnt vmcnt(16)
s_waitcnt lgkmcnt(4)
mm v[52:55],a[240:243],a[168:171],v[52:55]
s_lshl_b32 s91, s53, 7
tr a[240:241],v10,25088
mm v[16:19],a[216:219],a[192:195],v[16:19]
s_barrier
tr a[242:243],v10,27136
mm v[16:19],a[220:223],a[204:207],v[16:19]
s_add_u32 s50, s96, 256
L_pg1:
s_cbranch_execz L_pg5
s_add_u32 s51, s97, 256
tr a[244:245],v10,29184
mm v[20:23],a[220:223],a[208:211],v[20:23]
tr a[246:247],v10,31232
s_add_u32 m0, s43, 32768
s_mov_b32 s53, 0
mm v[20:23],a[216:219],a[196:199],v[20:23]
buffer_load_dwordx4 v1, s[16:19], s50 offen offset:0 lds
s_add_u32 s32, s72, s53
s_addc_u32 s33, s73, 0
mm v[24:27],a[216:219],a[200:203],v[24:27]
tr a[216:217],v9,32768
mm v[24:27],a[220:223],a[212:215],v[24:27]
tr a[218:219],v9,34816
s_sub_u32 s34, 256, s53
mm v[36:39],a[228:231],a[212:215],v[36:39]
tr a[220:221],v9,36864
mm v[36:39],a[224:227],a[200:203],v[36:39]
tr a[222:223],v9,38912
s_mov_b32 s35, 0x20000
mm v[32:35],a[224:227],a[196:199],v[32:35]
buffer_load_dwordx4 v2, s[16:19], s50 offen offset:1024 lds
mm v[32:35],a[228:231],a[208:211],v[32:35]
s_add_u32 s24, s74, s53
s_addc_u32 s25, s75, 0
mm v[28:31],a[228:231],a[204:207],v[28:31]
s_waitcnt lgkmcnt(4)
mm v[28:31],a[224:227],a[192:195],v[28:31]
tr a[224:225],v10,32768
s_sub_u32 s26, 58720256, s53
mm v[40:43],a[232:235],a[192:195],v[40:43]
tr a[226:227],v10,34816
s_mov_b32 s27, 0x20000
mm v[40:43],a[236:239],a[204:207],v[40:43]
tr a[228:229],v10,36864
mm v[44:47],a[236:239],a[208:211],v[44:47]
tr a[230:231],v10,38912
s_lshl_b32 s53, s41, 19
mm v[44:47],a[232:235],a[196:199],v[44:47]
buffer_load_dwordx4 v3, s[16:19], s50 offen offset:2048 lds
mm v[48:51],a[232:235],a[200:203],v[48:51]
tr a[232:233],v9,33280
s_add_u32 s20, s68, s53
s_addc_u32 s21, s69, 0
mm v[48:51],a[236:239],a[212:215],v[48:51]
tr a[234:235],v9,35328
mm v[60:63],a[244:247],a[212:215],v[60:63]
s_sub_u32 s22, 4194304, s53
tr a[236:237],v9,37376
mm v[60:63],a[240:243],a[200:203],v[60:63]
tr a[238:239],v9,39424
mm v[56:59],a[240:243],a[196:199],v[56:59]
s_mov_b32 s23, 0x20000
mm v[56:59],a[244:247],a[208:211],v[56:59]
mm v[52:55],a[244:247],a[204:207],v[52:55]
s_waitcnt lgkmcnt(4)
buffer_load_dwordx4 v4, s[16:19], s50 offen offset:3072 lds
mm v[52:55],a[240:243],a[192:195],v[52:55]
tr a[240:241],v10,33280
s_lshl_b32 s53, s40, 5
mm v[64:67],a[216:219],v[112:115],0
tr a[242:243],v10,35328
s_lshl_b32 s55, s41, 2
mm v[64:67],a[220:223],v[124:127],v[64:67]
tr a[244:245],v10,37376
s_add_u32 s53, s53, s55
mm v[68:71],a[220:223],v[128:131],0
tr a[246:247],v10,39424
s_lshl_b32 s53, s53, 17
mm v[68:71],a[216:219],v[116:119],v[68:71]
mm v[72:75],a[216:219],v[120:123],0
tr a[216:217],v9,40960
v_mul_f32 v16, s52, v16
mm v[72:75],a[220:223],v[132:135],v[72:75]
tr a[218:219],v9,43008
s_add_u32 m0, s44, 32768
mm v[84:87],a[228:231],v[132:135],0
buffer_load_dwordx4 v1, s[16:19], s51 offen offset:0 lds
tr a[220:221],v9,45056
mm v[84:87],a[224:227],v[120:123],v[84:87]
tr a[222:223],v9,47104
v_mul_f32 v17, s52, v17
mm v[80:83],a[224:227],v[116:119],0
s_add_u32 s8, s62, s53
s_addc_u32 s9, s63, 0
mm v[80:83],a[228:231],v[128:131],v[80:83]
s_sub_u32 s10, 134217728, s53
s_mov_b32 s11, 0x20000
mm v[76:79],a[228:231],v[124:127],0
s_waitcnt lgkmcnt(4)
v_mul_f32 v18, s52, v18
mm v[76:79],a[224:227],v[112:115],v[76:79]
tr a[224:225],v10,40960
v_mul_f32 v19, s52, v19
mm v[88:91],a[232:235],v[112:115],0
tr a[226:227],v10,43008
buffer_load_dwordx4 v2, s[16:19], s51 offen offset:1024 lds
mm v[88:91],a[236:239],v[124:127],v[88:91]
tr a[228:229],v10,45056
v_mul_f32 v28, s52, v28
mm v[92:95],a[236:239],v[128:131],0
tr a[230:231],v10,47104
v_mul_f32 v29, s52, v29
mm v[92:95],a[232:235],v[116:119],v[92:95]
s_add_u32 s12, s64, s53
s_addc_u32 s13, s65, 0
mm v[96:99],a[232:235],v[120:123],0
tr a[232:233],v9,41472
s_sub_u32 s14, 134217728, s53
mm v[96:99],a[236:239],v[132:135],v[96:99]
tr a[234:235],v9,43520
s_mov_b32 s15, 0x20000
mm v[108:111],a[244:247],v[132:135],0
tr a[236:237],v9,45568
s_mul_i32 s53, s40, 196608
mm v[108:111],a[240:243],v[120:123],v[108:111]
tr a[238:239],v9,47616
buffer_load_dwordx4 v3, s[16:19], s51 offen offset:2048 lds
mm v[104:107],a[240:243],v[116:119],0
s_add_u32 s36, s70, s53
s_addc_u32 s37, s71, 0
mm v[104:107],a[244:247],v[128:131],v[104:107]
s_sub_u32 s38, 6291456, s53
s_mov_b32 s39, 0x20000
mm v[100:103],a[244:247],v[124:127],0
s_waitcnt lgkmcnt(4)
s_mov_b32 s57, 0x33800000
mm v[100:103],a[240:243],v[112:115],v[100:103]
s_mov_b32 s58, 0x4f800000
tr a[240:241],v10,41472
mm v[64:67],a[216:219],v[136:139],v[64:67]
s_mov_b32 s45, 0
tr a[242:243],v10,43520
mm v[64:67],a[220:223],v[148:151],v[64:67]
tr a[244:245],v10,45568
v_mul_f32 v30, s52, v30
mm v[68:71],a[220:223],v[152:155],v[68:71]
tr a[246:247],v10,47616
buffer_load_dwordx4 v4, s[16:19], s51 offen offset:3072 lds
mm v[68:71],a[216:219],v[140:143],v[68:71]
v_mul_f32 v31, s52, v31
cv v16,v16,v17
mm v[72:75],a[216:219],v[144:147],v[72:75]
tr a[216:217],v9,49152
cv v17,v18,v19
mm v[72:75],a[220:223],v[156:159],v[72:75]
tr a[218:219],v9,51200
cv v28,v28,v29
mm v[84:87],a[228:231],v[156:159],v[84:87]
tr a[220:221],v9,53248
cv v29,v30,v31
mm v[84:87],a[224:227],v[144:147],v[84:87]
tr a[222:223],v9,55296
mm v[80:83],a[224:227],v[140:143],v[80:83]
v_permlane16_swap_b32 v16, v28
mm v[80:83],a[228:231],v[152:155],v[80:83]
v_permlane16_swap_b32 v17, v29
mm v[76:79],a[228:231],v[148:151],v[76:79]
s_waitcnt lgkmcnt(4)
v_accvgpr_write_b32 a0, v16
mm v[76:79],a[224:227],v[136:139],v[76:79]
tr a[224:225],v10,49152
v_accvgpr_write_b32 a1, v17
s_cmp_lt_u32 s42, 2
s_cselect_b32 s4, s8, s12
s_cselect_b32 s5, s9, s13
s_mov_b32 s6, s10
s_and_b32 s46, s42, 1
s_lshl_b32 s46, s46, 12
v_and_b32 v14, 62, v0
v_lshlrev_b32 v14, 6, v14
mm v[88:91],a[232:235],v[136:139],v[88:91]
s_add_u32 s47, s46, 98304
tr a[226:227],v10,51200
mm v[88:91],a[236:239],v[148:151],v[88:91]
tr a[228:229],v10,53248
buffer_load_dword a249, v14, s[4:7], s47 offen
mm v[92:95],a[236:239],v[152:155],v[92:95]
tr a[230:231],v10,55296
v_accvgpr_write_b32 a2, v28
mm v[92:95],a[232:235],v[140:143],v[92:95]
v_accvgpr_write_b32 a3, v29
v_mul_f32 v20, s52, v20
mm v[96:99],a[232:235],v[144:147],v[96:99]
tr a[232:233],v9,49664
v_mul_f32 v21, s52, v21
mm v[96:99],a[236:239],v[156:159],v[96:99]
tr a[234:235],v9,51712
v_mul_f32 v22, s52, v22
mm v[108:111],a[244:247],v[156:159],v[108:111]
tr a[236:237],v9,53760
v_mul_f32 v23, s52, v23
mm v[108:111],a[240:243],v[144:147],v[108:111]
tr a[238:239],v9,55808
v_mul_f32 v32, s52, v32
mm v[104:107],a[240:243],v[140:143],v[104:107]
v_mul_f32 v33, s52, v33
v_mul_f32 v34, s52, v34
mm v[104:107],a[244:247],v[152:155],v[104:107]
v_mul_f32 v35, s52, v35
cv v20,v20,v21
mm v[100:103],a[244:247],v[148:151],v[100:103]
s_waitcnt lgkmcnt(4)
cv v21,v22,v23
mm v[100:103],a[240:243],v[136:139],v[100:103]
tr a[240:241],v10,49664
cv v32,v32,v33
mm v[64:67],a[216:219],v[160:163],v[64:67]
tr a[242:243],v10,51712
cv v33,v34,v35
mm v[64:67],a[220:223],v[172:175],v[64:67]
tr a[244:245],v10,53760
mm v[68:71],a[220:223],v[176:179],v[68:71]
tr a[246:247],v10,55808
mm v[68:71],a[216:219],v[164:167],v[68:71]
v_permlane16_swap_b32 v20, v32
mm v[72:75],a[216:219],v[168:171],v[72:75]
tr a[216:217],v9,57344
mm v[72:75],a[220:223],v[180:183],v[72:75]
tr a[218:219],v9,59392
mm v[84:87],a[228:231],v[180:183],v[84:87]
tr a[220:221],v9,61440
mm v[84:87],a[224:227],v[168:171],v[84:87]
tr a[222:223],v9,63488
mm v[80:83],a[224:227],v[164:167],v[80:83]
v_permlane16_swap_b32 v21, v33
mm v[80:83],a[228:231],v[176:179],v[80:83]
v_accvgpr_write_b32 a4, v20
v_accvgpr_write_b32 a5, v21
mm v[76:79],a[228:231],v[172:175],v[76:79]
s_waitcnt lgkmcnt(4)
v_accvgpr_write_b32 a6, v32
mm v[76:79],a[224:227],v[160:163],v[76:79]
tr a[224:225],v10,57344
v_accvgpr_write_b32 a7, v33
mm v[88:91],a[232:235],v[160:163],v[88:91]
tr a[226:227],v10,59392
v_mul_f32 v24, s52, v24
mm v[88:91],a[236:239],v[172:175],v[88:91]
tr a[228:229],v10,61440
v_mul_f32 v25, s52, v25
mm v[92:95],a[236:239],v[176:179],v[92:95]
tr a[230:231],v10,63488
v_mul_f32 v26, s52, v26
mm v[92:95],a[232:235],v[164:167],v[92:95]
v_mul_f32 v27, s52, v27
v_mul_f32 v36, s52, v36
mm v[96:99],a[232:235],v[168:171],v[96:99]
tr a[232:233],v9,57856
v_mul_f32 v37, s52, v37
mm v[96:99],a[236:239],v[180:183],v[96:99]
tr a[234:235],v9,59904
v_mul_f32 v38, s52, v38
mm v[108:111],a[244:247],v[180:183],v[108:111]
tr a[236:237],v9,61952
v_mul_f32 v39, s52, v39
mm v[108:111],a[240:243],v[168:171],v[108:111]
tr a[238:239],v9,64000
cv v24,v24,v25
mm v[104:107],a[240:243],v[164:167],v[104:107]
cv v25,v26,v27
cv v36,v36,v37
mm v[104:107],a[244:247],v[176:179],v[104:107]
cv v37,v38,v39
mm v[100:103],a[244:247],v[172:175],v[100:103]
s_waitcnt vmcnt(17)
s_waitcnt lgkmcnt(4)
mm v[100:103],a[240:243],v[160:163],v[100:103]
tr a[240:241],v10,57856
mm v[64:67],a[216:219],v[184:187],v[64:67]
s_barrier
tr a[242:243],v10,59904
mm v[64:67],a[220:223],v[196:199],v[64:67]
s_add_u32 s50, s94, 384
s_add_u32 s51, s95, 384
mm v[68:71],a[220:223],v[200:203],v[68:71]
tr a[244:245],v10,61952
s_add_u32 m0, s43, 65536
mm v[68:71],a[216:219],v[188:191],v[68:71]
tr a[246:247],v10,64000
v_add_u32 v9, 65536, v9
mm v[72:75],a[216:219],v[192:195],v[72:75]
buffer_load_dwordx4 v1, s[16:19], s50 offen offset:0 lds
v_add_u32 v10, 65536, v10
mm v[72:75],a[220:223],v[204:207],v[72:75]
tr a[216:217],v9,0
mm v[84:87],a[228:231],v[204:207],v[84:87]
tr a[218:219],v9,2048
mm v[84:87],a[224:227],v[192:195],v[84:87]
tr a[220:221],v9,4096
mm v[80:83],a[224:227],v[188:191],v[80:83]
tr a[222:223],v9,6144
buffer_load_dwordx4 v2, s[16:19], s50 offen offset:1024 lds
mm v[80:83],a[228:231],v[200:203],v[80:83]
v_permlane16_swap_b32 v24, v36
mm v[76:79],a[228:231],v[196:199],v[76:79]
s_waitcnt lgkmcnt(4)
mm v[76:79],a[224:227],v[184:187],v[76:79]
tr a[224:225],v10,0
mm v[88:91],a[232:235],v[184:187],v[88:91]
tr a[226:227],v10,2048
mm v[88:91],a[236:239],v[196:199],v[88:91]
tr a[228:229],v10,4096
mm v[92:95],a[236:239],v[200:203],v[92:95]
tr a[230:231],v10,6144
mm v[92:95],a[232:235],v[188:191],v[92:95]
buffer_load_dwordx4 v3, s[16:19], s50 offen offset:2048 lds
mm v[96:99],a[232:235],v[192:195],v[96:99]
tr a[232:233],v9,512
mm v[96:99],a[236:239],v[204:207],v[96:99]
tr a[234:235],v9,2560
mm v[108:111],a[244:247],v[204:207],v[108:111]
tr a[236:237],v9,4608
mm v[108:111],a[240:243],v[192:195],v[108:111]
tr a[238:239],v9,6656
mm v[104:107],a[240:243],v[188:191],v[104:107]
v_permlane16_swap_b32 v25, v37
mm v[104:107],a[244:247],v[200:203],v[104:107]
v_accvgpr_write_b32 a8, v24
v_accvgpr_write_b32 a9, v25
mm v[100:103],a[244:247],v[196:199],v[100:103]
s_waitcnt lgkmcnt(4)
buffer_load_dwordx4 v4, s[16:19], s50 offen offset:3072 lds
mm v[100:103],a[240:243],v[184:187],v[100:103]
tr a[240:241],v10,512
v_accvgpr_write_b32 a10, v36
mm v[64:67],a[216:219],v[208:211],v[64:67]
tr a[242:243],v10,2560
v_accvgpr_write_b32 a11, v37
mm v[64:67],a[220:223],v[220:223],v[64:67]
tr a[244:245],v10,4608
v_mul_f32 v40, s52, v40
mm v[68:71],a[220:223],v[224:227],v[68:71]
tr a[246:247],v10,6656
v_mul_f32 v41, s52, v41
mm v[68:71],a[216:219],v[212:215],v[68:71]
v_mul_f32 v42, s52, v42
v_mul_f32 v43, s52, v43
mm v[72:75],a[216:219],v[216:219],v[72:75]
tr a[216:217],v9,8192
v_mul_f32 v52, s52, v52
mm v[72:75],a[220:223],v[228:231],v[72:75]
tr a[218:219],v9,10240
s_add_u32 m0, s44, 65536
mm v[84:87],a[228:231],v[228:231],v[84:87]
buffer_load_dwordx4 v1, s[16:19], s51 offen offset:0 lds
tr a[220:221],v9,12288
mm v[84:87],a[224:227],v[216:219],v[84:87]
tr a[222:223],v9,14336
v_mul_f32 v53, s52, v53
mm v[80:83],a[224:227],v[212:215],v[80:83]
v_mul_f32 v54, s52, v54
v_mul_f32 v55, s52, v55
mm v[80:83],a[228:231],v[224:227],v[80:83]
cv v40,v40,v41
cv v41,v42,v43
mm v[76:79],a[228:231],v[220:223],v[76:79]
s_waitcnt lgkmcnt(4)
cv v52,v52,v53
mm v[76:79],a[224:227],v[208:211],v[76:79]
tr a[224:225],v10,8192
cv v53,v54,v55
mm v[88:91],a[232:235],v[208:211],v[88:91]
tr a[226:227],v10,10240
buffer_load_dwordx4 v2, s[16:19], s51 offen offset:1024 lds
mm v[88:91],a[236:239],v[220:223],v[88:91]
tr a[228:229],v10,12288
mm v[92:95],a[236:239],v[224:227],v[92:95]
tr a[230:231],v10,14336
mm v[92:95],a[232:235],v[212:215],v[92:95]
v_permlane16_swap_b32 v40, v52
mm v[96:99],a[232:235],v[216:219],v[96:99]
tr a[232:233],v9,8704
mm v[96:99],a[236:239],v[228:231],v[96:99]
tr a[234:235],v9,10752
mm v[108:111],a[244:247],v[228:231],v[108:111]
tr a[236:237],v9,12800
mm v[108:111],a[240:243],v[216:219],v[108:111]
tr a[238:239],v9,14848
buffer_load_dwordx4 v3, s[16:19], s51 offen offset:2048 lds
mm v[104:107],a[240:243],v[212:215],v[104:107]
v_permlane16_swap_b32 v41, v53
mm v[104:107],a[244:247],v[224:227],v[104:107]
v_accvgpr_write_b32 a12, v40
v_accvgpr_write_b32 a13, v41
mm v[100:103],a[244:247],v[220:223],v[100:103]
s_waitcnt lgkmcnt(4)
v_accvgpr_write_b32 a14, v52
mm v[100:103],a[240:243],v[208:211],v[100:103]
tr a[240:241],v10,8704
v_accvgpr_write_b32 a15, v53
mm v[64:67],a[216:219],v[232:235],v[64:67]
tr a[242:243],v10,10752
v_mul_f32 v44, s52, v44
mm v[64:67],a[220:223],v[244:247],v[64:67]
tr a[244:245],v10,12800
v_mul_f32 v45, s52, v45
mm v[68:71],a[220:223],v[248:251],v[68:71]
tr a[246:247],v10,14848
buffer_load_dwordx4 v4, s[16:19], s51 offen offset:3072 lds
mm v[68:71],a[216:219],v[236:239],v[68:71]
v_mul_f32 v46, s52, v46
v_mul_f32 v47, s52, v47
mm v[72:75],a[216:219],v[240:243],v[72:75]
tr a[216:217],v9,16384
v_mul_f32 v56, s52, v56
mm v[72:75],a[220:223],v[252:255],v[72:75]
tr a[218:219],v9,18432
v_mul_f32 v57, s52, v57
mm v[84:87],a[228:231],v[252:255],v[84:87]
tr a[220:221],v9,20480
v_mul_f32 v58, s52, v58
mm v[84:87],a[224:227],v[240:243],v[84:87]
tr a[222:223],v9,22528
v_mul_f32 v59, s52, v59
mm v[80:83],a[224:227],v[236:239],v[80:83]
cv v44,v44,v45
cv v45,v46,v47
mm v[80:83],a[228:231],v[248:251],v[80:83]
cv v56,v56,v57
cv v57,v58,v59
mm v[76:79],a[228:231],v[244:247],v[76:79]
s_waitcnt lgkmcnt(4)
mm v[76:79],a[224:227],v[232:235],v[76:79]
tr a[224:225],v10,16384
mm v[88:91],a[232:235],v[232:235],v[88:91]
s_add_u32 s47, s46, 106496
tr a[226:227],v10,18432
mm v[88:91],a[236:239],v[244:247],v[88:91]
tr a[228:229],v10,20480
buffer_load_dword a249, v14, s[4:7], s47 offen
mm v[92:95],a[236:239],v[248:251],v[92:95]
tr a[230:231],v10,22528
mm v[92:95],a[232:235],v[236:239],v[92:95]
v_permlane16_swap_b32 v44, v56
mm v[96:99],a[232:235],v[240:243],v[96:99]
tr a[232:233],v9,16896
mm v[96:99],a[236:239],v[252:255],v[96:99]
tr a[234:235],v9,18944
mm v[108:111],a[244:247],v[252:255],v[108:111]
tr a[236:237],v9,20992
mm v[108:111],a[240:243],v[240:243],v[108:111]
tr a[238:239],v9,23040
mm v[104:107],a[240:243],v[236:239],v[104:107]
v_permlane16_swap_b32 v45, v57
mm v[104:107],a[244:247],v[248:251],v[104:107]
v_accvgpr_write_b32 a16, v44
v_accvgpr_write_b32 a17, v45
mm v[100:103],a[244:247],v[244:247],v[100:103]
s_waitcnt lgkmcnt(4)
v_accvgpr_write_b32 a18, v56
mm v[100:103],a[240:243],v[232:235],v[100:103]
tr a[240:241],v10,16896
v_accvgpr_write_b32 a19, v57
mm v[64:67],a[216:219],a[168:171],v[64:67]
tr a[242:243],v10,18944
v_mul_f32 v48, s52, v48
mm v[64:67],a[220:223],a[180:183],v[64:67]
tr a[244:245],v10,20992
v_mul_f32 v49, s52, v49
mm v[68:71],a[220:223],a[184:187],v[68:71]
tr a[246:247],v10,23040
v_mul_f32 v50, s52, v50
mm v[68:71],a[216:219],a[172:175],v[68:71]
v_mul_f32 v51, s52, v51
v_mul_f32 v60, s52, v60
mm v[72:75],a[216:219],a[176:179],v[72:75]
tr a[216:217],v9,24576
v_mul_f32 v61, s52, v61
mm v[72:75],a[220:223],a[188:191],v[72:75]
tr a[218:219],v9,26624
v_mul_f32 v62, s52, v62
mm v[84:87],a[228:231],a[188:191],v[84:87]
tr a[220:221],v9,28672
v_mul_f32 v63, s52, v63
mm v[84:87],a[224:227],a[176:179],v[84:87]
tr a[222:223],v9,30720
cv v48,v48,v49
mm v[80:83],a[224:227],a[172:175],v[80:83]
cv v49,v50,v51
cv v60,v60,v61
mm v[80:83],a[228:231],a[184:187],v[80:83]
cv v61,v62,v63
mm v[76:79],a[228:231],a[180:183],v[76:79]
s_waitcnt lgkmcnt(4)
mm v[76:79],a[224:227],a[168:171],v[76:79]
tr a[224:225],v10,24576
mm v[88:91],a[232:235],a[168:171],v[88:91]
tr a[226:227],v10,26624
mm v[88:91],a[236:239],a[180:183],v[88:91]
tr a[228:229],v10,28672
mm v[92:95],a[236:239],a[184:187],v[92:95]
tr a[230:231],v10,30720
mm v[92:95],a[232:235],a[172:175],v[92:95]
v_permlane16_swap_b32 v48, v60
mm v[96:99],a[232:235],a[176:179],v[96:99]
v_permlane16_swap_b32 v49, v61
mm v[96:99],a[236:239],a[188:191],v[96:99]
tr a[232:233],v9,25088
v_accvgpr_write_b32 a20, v48
mm v[108:111],a[244:247],a[188:191],v[108:111]
tr a[234:235],v9,27136
v_accvgpr_write_b32 a21, v49
v_accvgpr_write_b32 a22, v60
v_accvgpr_write_b32 a23, v61
mm v[108:111],a[240:243],a[176:179],v[108:111]
tr a[236:237],v9,29184
v_lshlrev_b32 v16, 2, v0
mm v[104:107],a[240:243],a[172:175],v[104:107]
tr a[238:239],v9,31232
mm v[104:107],a[244:247],a[184:187],v[104:107]
mm v[100:103],a[244:247],a[180:183],v[100:103]
s_waitcnt vmcnt(18)
s_waitcnt lgkmcnt(4)
mm v[100:103],a[240:243],a[168:171],v[100:103]
tr a[240:241],v10,25088
v_cmp_gt_u32 vcc, 8, v0
mm v[64:67],a[216:219],a[192:195],v[64:67]
s_barrier
tr a[242:243],v10,27136
mm v[64:67],a[220:223],a[204:207],v[64:67]
s_add_u32 s50, s96, 384
s_add_u32 s51, s97, 384
mm v[68:71],a[220:223],a[208:211],v[68:71]
tr a[244:245],v10,29184
s_add_u32 m0, s43, 98304
mm v[68:71],a[216:219],a[196:199],v[68:71]
tr a[246:247],v10,31232
v_add_u32 v9, 4294836224, v9
mm v[72:75],a[216:219],a[200:203],v[72:75]
buffer_load_dwordx4 v1, s[16:19], s50 offen offset:0 lds
v_add_u32 v10, 4294836224, v10
mm v[72:75],a[220:223],a[212:215],v[72:75]
tr a[216:217],v9,0
v_mov_b32 v17, 0x7fff0000
mm v[84:87],a[228:231],a[212:215],v[84:87]
tr a[218:219],v9,2048
mm v[84:87],a[224:227],a[200:203],v[84:87]
tr a[220:221],v9,4096
v_mov_b32 v18, 0
mm v[80:83],a[224:227],a[196:199],v[80:83]
tr a[222:223],v9,6144
buffer_load_dwordx4 v2, s[16:19], s50 offen offset:1024 lds
mm v[80:83],a[228:231],a[208:211],v[80:83]
mm v[76:79],a[228:231],a[204:207],v[76:79]
s_waitcnt lgkmcnt(4)
mm v[76:79],a[224:227],a[192:195],v[76:79]
tr a[224:225],v10,0
v_cndmask_b32 v16, v17, v16, vcc
mm v[88:91],a[232:235],a[192:195],v[88:91]
tr a[226:227],v10,2048
mm v[88:91],a[236:239],a[204:207],v[88:91]
tr a[228:229],v10,4096
mm v[92:95],a[236:239],a[208:211],v[92:95]
tr a[230:231],v10,6144
mm v[92:95],a[232:235],a[196:199],v[92:95]
buffer_load_dwordx4 v3, s[16:19], s50 offen offset:2048 lds
buffer_store_dword v18, v16, s[28:31], s91 offen offset:0 sc1
mm v[96:99],a[232:235],a[200:203],v[96:99]
tr a[232:233],v9,512
mm v[96:99],a[236:239],a[212:215],v[96:99]
tr a[234:235],v9,2560
mm v[108:111],a[244:247],a[212:215],v[108:111]
tr a[236:237],v9,4608
mm v[108:111],a[240:243],a[200:203],v[108:111]
tr a[238:239],v9,6656
mm v[104:107],a[240:243],a[196:199],v[104:107]
mm v[104:107],a[244:247],a[208:211],v[104:107]
L_pg2:
s_cbranch_execz L_pg6
mm v[100:103],a[244:247],a[204:207],v[100:103]
s_waitcnt lgkmcnt(4)
buffer_load_dwordx4 v4, s[16:19], s50 offen offset:3072 lds
mm v[100:103],a[240:243],a[192:195],v[100:103]
tr a[240:241],v10,512
mm v[16:19],a[216:219],v[112:115],0
tr a[242:243],v10,2560
mm v[16:19],a[220:223],v[124:127],v[16:19]
tr a[244:245],v10,4608
mm v[20:23],a[220:223],v[128:131],0
tr a[246:247],v10,6656
mm v[20:23],a[216:219],v[116:119],v[20:23]
mm v[24:27],a[216:219],v[120:123],0
tr a[216:217],v9,8192
v_mul_f32 v64, s52, v64
mm v[24:27],a[220:223],v[132:135],v[24:27]
tr a[218:219],v9,10240
s_add_u32 m0, s44, 98304
mm v[36:39],a[228:231],v[132:135],0
buffer_load_dwordx4 v1, s[16:19], s51 offen offset:0 lds
tr a[220:221],v9,12288
mm v[36:39],a[224:227],v[120:123],v[36:39]
tr a[222:223],v9,14336
v_mul_f32 v65, s52, v65
mm v[32:35],a[224:227],v[116:119],0
v_mul_f32 v66, s52, v66
v_mul_f32 v67, s52, v67
mm v[32:35],a[228:231],v[128:131],v[32:35]
v_mul_f32 v76, s52, v76
mm v[28:31],a[228:231],v[124:127],0
s_waitcnt lgkmcnt(4)
v_mul_f32 v77, s52, v77
mm v[28:31],a[224:227],v[112:115],v[28:31]
tr a[224:225],v10,8192
v_mul_f32 v78, s52, v78
mm v[40:43],a[232:235],v[112:115],0
tr a[226:227],v10,10240
buffer_load_dwordx4 v2, s[16:19], s51 offen offset:1024 lds
mm v[40:43],a[236:239],v[124:127],v[40:43]
tr a[228:229],v10,12288
v_mul_f32 v79, s52, v79
mm v[44:47],a[236:239],v[128:131],0
tr a[230:231],v10,14336
cv v64,v64,v65
mm v[44:47],a[232:235],v[116:119],v[44:47]
cv v65,v66,v67
mm v[48:51],a[232:235],v[120:123],0
tr a[232:233],v9,8704
mm v[48:51],a[236:239],v[132:135],v[48:51]
tr a[234:235],v9,10752
cv v76,v76,v77
mm v[60:63],a[244:247],v[132:135],0
tr a[236:237],v9,12800
cv v77,v78,v79
mm v[60:63],a[240:243],v[120:123],v[60:63]
tr a[238:239],v9,14848
buffer_load_dwordx4 v3, s[16:19], s51 offen offset:2048 lds
mm v[56:59],a[240:243],v[116:119],0
v_permlane16_swap_b32 v64, v76
mm v[56:59],a[244:247],v[128:131],v[56:59]
v_permlane16_swap_b32 v65, v77
mm v[52:55],a[244:247],v[124:127],0
s_waitcnt lgkmcnt(4)
v_accvgpr_write_b32 a24, v64
mm v[52:55],a[240:243],v[112:115],v[52:55]
tr a[240:241],v10,8704
v_accvgpr_write_b32 a25, v65
mm v[16:19],a[216:219],v[136:139],v[16:19]
tr a[242:243],v10,10752
v_accvgpr_write_b32 a26, v76
mm v[16:19],a[220:223],v[148:151],v[16:19]
tr a[244:245],v10,12800
mm v[20:23],a[220:223],v[152:155],v[20:23]
tr a[246:247],v10,14848
buffer_load_dwordx4 v4, s[16:19], s51 offen offset:3072 lds
mm v[20:23],a[216:219],v[140:143],v[20:23]
v_accvgpr_write_b32 a27, v77
v_mul_f32 v68, s52, v68
mm v[24:27],a[216:219],v[144:147],v[24:27]
tr a[216:217],v9,16384
v_mul_f32 v69, s52, v69
mm v[24:27],a[220:223],v[156:159],v[24:27]
tr a[218:219],v9,18432
mm v[36:39],a[228:231],v[156:159],v[36:39]
tr a[220:221],v9,20480
v_mul_f32 v70, s52, v70
mm v[36:39],a[224:227],v[144:147],v[36:39]
tr a[222:223],v9,22528
v_mul_f32 v71, s52, v71
mm v[32:35],a[224:227],v[140:143],v[32:35]
v_mul_f32 v80, s52, v80
mm v[32:35],a[228:231],v[152:155],v[32:35]
mm v[28:31],a[228:231],v[148:151],v[28:31]
s_waitcnt lgkmcnt(4)
v_mul_f32 v81, s52, v81
mm v[28:31],a[224:227],v[136:139],v[28:31]
tr a[224:225],v10,16384
v_mul_f32 v82, s52, v82
mm v[40:43],a[232:235],v[136:139],v[40:43]
s_add_u32 s47, s46, 229376
tr a[226:227],v10,18432
mm v[40:43],a[236:239],v[148:151],v[40:43]
tr a[228:229],v10,20480
buffer_load_dword a249, v14, s[4:7], s47 offen
mm v[44:47],a[236:239],v[152:155],v[44:47]
tr a[230:231],v10,22528
v_mul_f32 v83, s52, v83
mm v[44:47],a[232:235],v[140:143],v[44:47]
cv v68,v68,v69
cv v69,v70,v71
mm v[48:51],a[232:235],v[144:147],v[48:51]
tr a[232:233],v9,16896
cv v80,v80,v81
mm v[48:51],a[236:239],v[156:159],v[48:51]
tr a[234:235],v9,18944
cv v81,v82,v83
mm v[60:63],a[244:247],v[156:159],v[60:63]
tr a[236:237],v9,20992
mm v[60:63],a[240:243],v[144:147],v[60:63]
tr a[238:239],v9,23040
mm v[56:59],a[240:243],v[140:143],v[56:59]
v_permlane16_swap_b32 v68, v80
mm v[56:59],a[244:247],v[152:155],v[56:59]
v_permlane16_swap_b32 v69, v81
mm v[52:55],a[244:247],v[148:151],v[52:55]
s_waitcnt lgkmcnt(4)
v_accvgpr_write_b32 a28, v68
mm v[52:55],a[240:243],v[136:139],v[52:55]
tr a[240:241],v10,16896
v_accvgpr_write_b32 a29, v69
mm v[16:19],a[216:219],v[160:163],v[16:19]
tr a[242:243],v10,18944
v_accvgpr_write_b32 a30, v80
mm v[16:19],a[220:223],v[172:175],v[16:19]
tr a[244:245],v10,20992
v_accvgpr_write_b32 a31, v81
mm v[20:23],a[220:223],v[176:179],v[20:23]
tr a[246:247],v10,23040
mm v[20:23],a[216:219],v[164:167],v[20:23]
v_mul_f32 v72, s52, v72
mm v[24:27],a[216:219],v[168:171],v[24:27]
tr a[216:217],v9,24576
v_mul_f32 v73, s52, v73
mm v[24:27],a[220:223],v[180:183],v[24:27]
tr a[218:219],v9,26624
v_mul_f32 v74, s52, v74
mm v[36:39],a[228:231],v[180:183],v[36:39]
tr a[220:221],v9,28672
v_mul_f32 v75, s52, v75
mm v[36:39],a[224:227],v[168:171],v[36:39]
tr a[222:223],v9,30720
mm v[32:35],a[224:227],v[164:167],v[32:35]
v_mul_f32 v84, s52, v84
mm v[32:35],a[228:231],v[176:179],v[32:35]
v_mul_f32 v85, s52, v85
mm v[28:31],a[228:231],v[172:175],v[28:31]
s_waitcnt lgkmcnt(4)
v_mul_f32 v86, s52, v86
mm v[28:31],a[224:227],v[160:163],v[28:31]
tr a[224:225],v10,24576
mm v[40:43],a[232:235],v[160:163],v[40:43]
tr a[226:227],v10,26624
v_mul_f32 v87, s52, v87
mm v[40:43],a[236:239],v[172:175],v[40:43]
tr a[228:229],v10,28672
cv v72,v72,v73
mm v[44:47],a[236:239],v[176:179],v[44:47]
tr a[230:231],v10,30720
cv v73,v74,v75
mm v[44:47],a[232:235],v[164:167],v[44:47]
mm v[48:51],a[232:235],v[168:171],v[48:51]
tr a[232:233],v9,25088
cv v84,v84,v85
mm v[48:51],a[236:239],v[180:183],v[48:51]
tr a[234:235],v9,27136
cv v85,v86,v87
mm v[60:63],a[244:247],v[180:183],v[60:63]
tr a[236:237],v9,29184
mm v[60:63],a[240:243],v[168:171],v[60:63]
tr a[238:239],v9,31232
mm v[56:59],a[240:243],v[164:167],v[56:59]
v_permlane16_swap_b32 v72, v84
mm v[56:59],a[244:247],v[176:179],v[56:59]
v_permlane16_swap_b32 v73, v85
mm v[52:55],a[244:247],v[172:175],v[52:55]
s_waitcnt vmcnt(20)
s_waitcnt lgkmcnt(4)
mm v[52:55],a[240:243],v[160:163],v[52:55]
tr a[240:241],v10,25088
v_accvgpr_write_b32 a32, v72
mm v[16:19],a[216:219],v[184:187],v[16:19]
s_barrier
tr a[242:243],v10,27136
mm v[16:19],a[220:223],v[196:199],v[16:19]
s_add_u32 s50, s94, 512
s_add_u32 s51, s95, 512
mm v[20:23],a[220:223],v[200:203],v[20:23]
tr a[244:245],v10,29184
s_add_u32 m0, s43, 131072
mm v[20:23],a[216:219],v[188:191],v[20:23]
tr a[246:247],v10,31232
buffer_load_dwordx4 v1, s[16:19], s50 offen offset:0 lds
mm v[24:27],a[216:219],v[192:195],v[24:27]
tr a[216:217],v9,32768
v_accvgpr_write_b32 a33, v73
mm v[24:27],a[220:223],v[204:207],v[24:27]
tr a[218:219],v9,34816
v_accvgpr_write_b32 a34, v84
mm v[36:39],a[228:231],v[204:207],v[36:39]
tr a[220:221],v9,36864
v_accvgpr_write_b32 a35, v85
mm v[36:39],a[224:227],v[192:195],v[36:39]
tr a[222:223],v9,38912
v_mul_f32 v88, s52, v88
mm v[32:35],a[224:227],v[188:191],v[32:35]
buffer_load_dwordx4 v2, s[16:19], s50 offen offset:1024 lds
v_mul_f32 v89, s52, v89
mm v[32:35],a[228:231],v[200:203],v[32:35]
v_mul_f32 v90, s52, v90
v_mul_f32 v91, s52, v91
mm v[28:31],a[228:231],v[196:199],v[28:31]
s_waitcnt lgkmcnt(4)
v_mul_f32 v100, s52, v100
mm v[28:31],a[224:227],v[184:187],v[28:31]
tr a[224:225],v10,32768
v_mul_f32 v101, s52, v101
mm v[40:43],a[232:235],v[184:187],v[40:43]
tr a[226:227],v10,34816
v_mul_f32 v102, s52, v102
mm v[40:43],a[236:239],v[196:199],v[40:43]
tr a[228:229],v10,36864
v_mul_f32 v103, s52, v103
mm v[44:47],a[236:239],v[200:203],v[44:47]
tr a[230:231],v10,38912
cv v88,v88,v89
mm v[44:47],a[232:235],v[188:191],v[44:47]
buffer_load_dwordx4 v3, s[16:19], s50 offen offset:2048 lds
cv v89,v90,v91
mm v[48:51],a[232:235],v[192:195],v[48:51]
tr a[232:233],v9,33280
cv v100,v100,v101
mm v[48:51],a[236:239],v[204:207],v[48:51]
tr a[234:235],v9,35328
cv v101,v102,v103
mm v[60:63],a[244:247],v[204:207],v[60:63]
tr a[236:237],v9,37376
mm v[60:63],a[240:243],v[192:195],v[60:63]
tr a[238:239],v9,39424
mm v[56:59],a[240:243],v[188:191],v[56:59]
v_permlane16_swap_b32 v88, v100
mm v[56:59],a[244:247],v[200:203],v[56:59]
v_permlane16_swap_b32 v89, v101
mm v[52:55],a[244:247],v[196:199],v[52:55]
s_waitcnt lgkmcnt(4)
buffer_load_dwordx4 v4, s[16:19], s50 offen offset:3072 lds
mm v[52:55],a[240:243],v[184:187],v[52:55]
tr a[240:241],v10,33280
v_accvgpr_write_b32 a36, v88
mm v[16:19],a[216:219],v[208:211],v[16:19]
tr a[242:243],v10,35328
v_accvgpr_write_b32 a37, v89
mm v[16:19],a[220:223],v[220:223],v[16:19]
tr a[244:245],v10,37376
v_accvgpr_write_b32 a38, v100
mm v[20:23],a[220:223],v[224:227],v[20:23]
tr a[246:247],v10,39424
v_accvgpr_write_b32 a39, v101
mm v[20:23],a[216:219],v[212:215],v[20:23]
v_mul_f32 v92, s52, v92
v_mul_f32 v93, s52, v93
mm v[24:27],a[216:219],v[216:219],v[24:27]
tr a[216:217],v9,40960
v_mul_f32 v94, s52, v94
mm v[24:27],a[220:223],v[228:231],v[24:27]
tr a[218:219],v9,43008
s_add_u32 m0, s44, 131072
mm v[36:39],a[228:231],v[228:231],v[36:39]
buffer_load_dwordx4 v1, s[16:19], s51 offen offset:0 lds
tr a[220:221],v9,45056
mm v[36:39],a[224:227],v[216:219],v[36:39]
tr a[222:223],v9,47104
v_mul_f32 v95, s52, v95
mm v[32:35],a[224:227],v[212:215],v[32:35]
v_mul_f32 v104, s52, v104
v_mul_f32 v105, s52, v105
mm v[32:35],a[228:231],v[224:227],v[32:35]
v_mul_f32 v106, s52, v106
mm v[28:31],a[228:231],v[220:223],v[28:31]
s_waitcnt lgkmcnt(4)
mm v[28:31],a[224:227],v[208:211],v[28:31]
tr a[224:225],v10,40960
v_mul_f32 v107, s52, v107
mm v[40:43],a[232:235],v[208:211],v[40:43]
tr a[226:227],v10,43008
buffer_load_dwordx4 v2, s[16:19], s51 offen offset:1024 lds
mm v[40:43],a[236:239],v[220:223],v[40:43]
tr a[228:229],v10,45056
cv v92,v92,v93
mm v[44:47],a[236:239],v[224:227],v[44:47]
tr a[230:231],v10,47104
cv v93,v94,v95
mm v[44:47],a[232:235],v[212:215],v[44:47]
cv v104,v104,v105
mm v[48:51],a[232:235],v[216:219],v[48:51]
tr a[232:233],v9,41472
cv v105,v106,v107
mm v[48:51],a[236:239],v[228:231],v[48:51]
tr a[234:235],v9,43520
mm v[60:63],a[244:247],v[228:231],v[60:63]
tr a[236:237],v9,45568
mm v[60:63],a[240:243],v[216:219],v[60:63]
tr a[238:239],v9,47616
buffer_load_dwordx4 v3, s[16:19], s51 offen offset:2048 lds
mm v[56:59],a[240:243],v[212:215],v[56:59]
v_permlane16_swap_b32 v92, v104
mm v[56:59],a[244:247],v[224:227],v[56:59]
v_permlane16_swap_b32 v93, v105
mm v[52:55],a[244:247],v[220:223],v[52:55]
s_waitcnt lgkmcnt(4)
v_accvgpr_write_b32 a40, v92
mm v[52:55],a[240:243],v[208:211],v[52:55]
tr a[240:241],v10,41472
v_accvgpr_write_b32 a41, v93
mm v[16:19],a[216:219],v[232:235],v[16:19]
tr a[242:243],v10,43520
v_accvgpr_write_b32 a42, v104
mm v[16:19],a[220:223],v[244:247],v[16:19]
tr a[244:245],v10,45568
v_accvgpr_write_b32 a43, v105
mm v[20:23],a[220:223],v[248:251],v[20:23]
tr a[246:247],v10,47616
buffer_load_dwordx4 v4, s[16:19], s51 offen offset:3072 lds
mm v[20:23],a[216:219],v[236:239],v[20:23]
v_mul_f32 v96, s52, v96
v_mul_f32 v97, s52, v97
mm v[24:27],a[216:219],v[240:243],v[24:27]
tr a[216:217],v9,49152
v_mul_f32 v98, s52, v98
mm v[24:27],a[220:223],v[252:255],v[24:27]
tr a[218:219],v9,51200
v_mul_f32 v99, s52, v99
mm v[36:39],a[228:231],v[252:255],v[36:39]
tr a[220:221],v9,53248
v_mul_f32 v108, s52, v108
mm v[36:39],a[224:227],v[240:243],v[36:39]
tr a[222:223],v9,55296
mm v[32:35],a[224:227],v[236:239],v[32:35]
v_mul_f32 v109, s52, v109
mm v[32:35],a[228:231],v[248:251],v[32:35]
v_mul_f32 v110, s52, v110
mm v[28:31],a[228:231],v[244:247],v[28:31]
s_waitcnt lgkmcnt(4)
v_mul_f32 v111, s52, v111
mm v[28:31],a[224:227],v[232:235],v[28:31]
tr a[224:225],v10,49152
cv v96,v96,v97
mm v[40:43],a[232:235],v[232:235],v[40:43]
tr a[226:227],v10,51200
mm v[40:43],a[236:239],v[244:247],v[40:43]
tr a[228:229],v10,53248
cv v97,v98,v99
mm v[44:47],a[236:239],v[248:251],v[44:47]
tr a[230:231],v10,55296
cv v108,v108,v109
mm v[44:47],a[232:235],v[236:239],v[44:47]
cv v109,v110,v111
mm v[48:51],a[232:235],v[240:243],v[48:51]
tr a[232:233],v9,49664
mm v[48:51],a[236:239],v[252:255],v[48:51]
tr a[234:235],v9,51712
mm v[60:63],a[244:247],v[252:255],v[60:63]
tr a[236:237],v9,53760
mm v[60:63],a[240:243],v[240:243],v[60:63]
tr a[238:239],v9,55808
mm v[56:59],a[240:243],v[236:239],v[56:59]
v_permlane16_swap_b32 v96, v108
mm v[56:59],a[244:247],v[248:251],v[56:59]
v_permlane16_swap_b32 v97, v109
mm v[52:55],a[244:247],v[244:247],v[52:55]
s_waitcnt lgkmcnt(4)
v_accvgpr_write_b32 a44, v96
mm v[52:55],a[240:243],v[232:235],v[52:55]
tr a[240:241],v10,49664
v_accvgpr_write_b32 a45, v97
mm v[16:19],a[216:219],a[168:171],v[16:19]
tr a[242:243],v10,51712
v_accvgpr_write_b32 a46, v108
mm v[16:19],a[220:223],a[180:183],v[16:19]
tr a[244:245],v10,53760
v_accvgpr_write_b32 a47, v109
mm v[20:23],a[220:223],a[184:187],v[20:23]
tr a[246:247],v10,55808
mm v[20:23],a[216:219],a[172:175],v[20:23]
mm v[24:27],a[216:219],a[176:179],v[24:27]
tr a[216:217],v9,57344
mm v[24:27],a[220:223],a[188:191],v[24:27]
tr a[218:219],v9,59392
mm v[36:39],a[228:231],a[188:191],v[36:39]
tr a[220:221],v9,61440
mm v[36:39],a[224:227],a[176:179],v[36:39]
tr a[222:223],v9,63488
mm v[32:35],a[224:227],a[172:175],v[32:35]
mm v[32:35],a[228:231],a[184:187],v[32:35]
mm v[28:31],a[228:231],a[180:183],v[28:31]
s_waitcnt lgkmcnt(4)
mm v[28:31],a[224:227],a[168:171],v[28:31]
tr a[224:225],v10,57344
mm v[40:43],a[232:235],a[168:171],v[40:43]
tr a[226:227],v10,59392
mm v[40:43],a[236:239],a[180:183],v[40:43]
tr a[228:229],v10,61440
mm v[44:47],a[236:239],a[184:187],v[44:47]
tr a[230:231],v10,63488
mm v[44:47],a[232:235],a[172:175],v[44:47]
mm v[48:51],a[232:235],a[176:179],v[48:51]
tr a[232:233],v9,57856
mm v[48:51],a[236:239],a[188:191],v[48:51]
tr a[234:235],v9,59904
mm v[60:63],a[244:247],a[188:191],v[60:63]
tr a[236:237],v9,61952
mm v[60:63],a[240:243],a[176:179],v[60:63]
tr a[238:239],v9,64000
s_lshl_b32 s48, s40, 2
mm v[56:59],a[240:243],a[172:175],v[56:59]
mm v[56:59],a[244:247],a[184:187],v[56:59]
mm v[52:55],a[244:247],a[180:183],v[52:55]
s_waitcnt vmcnt(19)
s_waitcnt lgkmcnt(4)
mm v[52:55],a[240:243],a[168:171],v[52:55]
tr a[240:241],v10,57856
s_add_u32 s48, s48, s42
mm v[16:19],a[216:219],a[192:195],v[16:19]
s_barrier
tr a[242:243],v10,59904
mm v[16:19],a[220:223],a[204:207],v[16:19]
s_add_u32 s50, s96, 512
s_add_u32 s51, s97, 512
mm v[20:23],a[220:223],a[208:211],v[20:23]
tr a[244:245],v10,61952
s_add_u32 m0, s43, 0
mm v[20:23],a[216:219],a[196:199],v[20:23]
tr a[246:247],v10,64000
v_add_u32 v9, 65536, v9
mm v[24:27],a[216:219],a[200:203],v[24:27]
buffer_load_dwordx4 v1, s[16:19], s50 offen offset:0 lds
v_add_u32 v10, 65536, v10
mm v[24:27],a[220:223],a[212:215],v[24:27]
tr a[216:217],v9,0
s_lshl_b32 s48, s48, 12
mm v[36:39],a[228:231],a[212:215],v[36:39]
tr a[218:219],v9,2048
mm v[36:39],a[224:227],a[200:203],v[36:39]
tr a[220:221],v9,4096
v_and_b32 v14, 62, v0
mm v[32:35],a[224:227],a[196:199],v[32:35]
tr a[222:223],v9,6144
buffer_load_dwordx4 v2, s[16:19], s50 offen offset:1024 lds
mm v[32:35],a[228:231],a[208:211],v[32:35]
mm v[28:31],a[228:231],a[204:207],v[28:31]
s_waitcnt lgkmcnt(4)
mm v[28:31],a[224:227],a[192:195],v[28:31]
tr a[224:225],v10,0
v_lshlrev_b32 v14, 6, v14
mm v[40:43],a[232:235],a[192:195],v[40:43]
tr a[226:227],v10,2048
mm v[40:43],a[236:239],a[204:207],v[40:43]
tr a[228:229],v10,4096
mm v[44:47],a[236:239],a[208:211],v[44:47]
tr a[230:231],v10,6144
mm v[44:47],a[232:235],a[196:199],v[44:47]
buffer_load_dwordx4 v3, s[16:19], s50 offen offset:2048 lds
buffer_load_dword a249, v14, s[20:23], s48 offen
mm v[48:51],a[232:235],a[200:203],v[48:51]
tr a[232:233],v9,512
mm v[48:51],a[236:239],a[212:215],v[48:51]
tr a[234:235],v9,2560
mm v[60:63],a[244:247],a[212:215],v[60:63]
tr a[236:237],v9,4608
mm v[60:63],a[240:243],a[200:203],v[60:63]
tr a[238:239],v9,6656
mm v[56:59],a[240:243],a[196:199],v[56:59]
mm v[56:59],a[244:247],a[208:211],v[56:59]
mm v[52:55],a[244:247],a[204:207],v[52:55]
s_waitcnt lgkmcnt(4)
buffer_load_dwordx4 v4, s[16:19], s50 offen offset:3072 lds
mm v[52:55],a[240:243],a[192:195],v[52:55]
tr a[240:241],v10,512
mm v[64:67],a[216:219],v[112:115],0
tr a[242:243],v10,2560
mm v[64:67],a[220:223],v[124:127],v[64:67]
tr a[244:245],v10,4608
mm v[68:71],a[220:223],v[128:131],0
tr a[246:247],v10,6656
mm v[68:71],a[216:219],v[116:119],v[68:71]
mm v[72:75],a[216:219],v[120:123],0
tr a[216:217],v9,8192
v_mul_f32 v16, s52, v16
mm v[72:75],a[220:223],v[132:135],v[72:75]
tr a[218:219],v9,10240
s_add_u32 m0, s44, 0
mm v[84:87],a[228:231],v[132:135],0
buffer_load_dwordx4 v1, s[16:19], s51 offen offset:0 lds
tr a[220:221],v9,12288
mm v[84:87],a[224:227],v[120:123],v[84:87]
tr a[222:223],v9,14336
v_mul_f32 v17, s52, v17
mm v[80:83],a[224:227],v[116:119],0
v_mul_f32 v18, s52, v18
v_mul_f32 v19, s52, v19
mm v[80:83],a[228:231],v[128:131],v[80:83]
v_mul_f32 v28, s52, v28
mm v[76:79],a[228:231],v[124:127],0
s_waitcnt lgkmcnt(4)
v_mul_f32 v29, s52, v29
mm v[76:79],a[224:227],v[112:115],v[76:79]
tr a[224:225],v10,8192
v_mul_f32 v30, s52, v30
mm v[88:91],a[232:235],v[112:115],0
tr a[226:227],v10,10240
buffer_load_dwordx4 v2, s[16:19], s51 offen offset:1024 lds
mm v[88:91],a[236:239],v[124:127],v[88:91]
tr a[228:229],v10,12288
v_mul_f32 v31, s52, v31
mm v[92:95],a[236:239],v[128:131],0
tr a[230:231],v10,14336
cv v16,v16,v17
mm v[92:95],a[232:235],v[116:119],v[92:95]
cv v17,v18,v19
mm v[96:99],a[232:235],v[120:123],0
tr a[232:233],v9,8704
mm v[96:99],a[236:239],v[132:135],v[96:99]
tr a[234:235],v9,10752
cv v28,v28,v29
mm v[108:111],a[244:247],v[132:135],0
tr a[236:237],v9,12800
cv v29,v30,v31
mm v[108:111],a[240:243],v[120:123],v[108:111]
tr a[238:239],v9,14848
buffer_load_dwordx4 v3, s[16:19], s51 offen offset:2048 lds
mm v[104:107],a[240:243],v[116:119],0
v_permlane16_swap_b32 v16, v28
mm v[104:107],a[244:247],v[128:131],v[104:107]
v_permlane16_swap_b32 v17, v29
mm v[100:103],a[244:247],v[124:127],0
s_waitcnt lgkmcnt(4)
v_accvgpr_write_b32 a48, v16
mm v[100:103],a[240:243],v[112:115],v[100:103]
tr a[240:241],v10,8704
v_accvgpr_write_b32 a49, v17
mm v[64:67],a[216:219],v[136:139],v[64:67]
tr a[242:243],v10,10752
v_accvgpr_write_b32 a50, v28
mm v[64:67],a[220:223],v[148:151],v[64:67]
tr a[244:245],v10,12800
mm v[68:71],a[220:223],v[152:155],v[68:71]
tr a[246:247],v10,14848
buffer_load_dwordx4 v4, s[16:19], s51 offen offset:3072 lds
mm v[68:71],a[216:219],v[140:143],v[68:71]
v_accvgpr_write_b32 a51, v29
v_mul_f32 v20, s52, v20
mm v[72:75],a[216:219],v[144:147],v[72:75]
tr a[216:217],v9,16384
L_pg3:
s_cbranch_execz L_pg7
v_mul_f32 v21, s52, v21
mm v[72:75],a[220:223],v[156:159],v[72:75]
tr a[218:219],v9,18432
mm v[84:87],a[228:231],v[156:159],v[84:87]
tr a[220:221],v9,20480
v_mul_f32 v22, s52, v22
mm v[84:87],a[224:227],v[144:147],v[84:87]
tr a[222:223],v9,22528
v_mul_f32 v23, s52, v23
mm v[80:83],a[224:227],v[140:143],v[80:83]
v_mul_f32 v32, s52, v32
mm v[80:83],a[228:231],v[152:155],v[80:83]
mm v[76:79],a[228:231],v[148:151],v[76:79]
s_waitcnt lgkmcnt(4)
v_mul_f32 v33, s52, v33
mm v[76:79],a[224:227],v[136:139],v[76:79]
tr a[224:225],v10,16384
v_mul_f32 v34, s52, v34
mm v[88:91],a[232:235],v[136:139],v[88:91]
s_add_u32 s47, s46, 237568
tr a[226:227],v10,18432
mm v[88:91],a[236:239],v[148:151],v[88:91]
tr a[228:229],v10,20480
buffer_load_dword a249, v14, s[4:7], s47 offen
mm v[92:95],a[236:239],v[152:155],v[92:95]
tr a[230:231],v10,22528
v_mul_f32 v35, s52, v35
mm v[92:95],a[232:235],v[140:143],v[92:95]
cv v20,v20,v21
cv v21,v22,v23
mm v[96:99],a[232:235],v[144:147],v[96:99]
tr a[232:233],v9,16896
cv v32,v32,v33
mm v[96:99],a[236:239],v[156:159],v[96:99]
tr a[234:235],v9,18944
cv v33,v34,v35
mm v[108:111],a[244:247],v[156:159],v[108:111]
tr a[236:237],v9,20992
mm v[108:111],a[240:243],v[144:147],v[108:111]
tr a[238:239],v9,23040
mm v[104:107],a[240:243],v[140:143],v[104:107]
v_permlane16_swap_b32 v20, v32
mm v[104:107],a[244:247],v[152:155],v[104:107]
v_permlane16_swap_b32 v21, v33
mm v[100:103],a[244:247],v[148:151],v[100:103]
s_waitcnt lgkmcnt(4)
v_accvgpr_write_b32 a52, v20
mm v[100:103],a[240:243],v[136:139],v[100:103]
tr a[240:241],v10,16896
v_accvgpr_write_b32 a53, v21
mm v[64:67],a[216:219],v[160:163],v[64:67]
tr a[242:243],v10,18944
v_accvgpr_write_b32 a54, v32
mm v[64:67],a[220:223],v[172:175],v[64:67]
tr a[244:245],v10,20992
v_accvgpr_write_b32 a55, v33
mm v[68:71],a[220:223],v[176:179],v[68:71]
tr a[246:247],v10,23040
mm v[68:71],a[216:219],v[164:167],v[68:71]
v_mul_f32 v24, s52, v24
mm v[72:75],a[216:219],v[168:171],v[72:75]
tr a[216:217],v9,24576
v_mul_f32 v25, s52, v25
mm v[72:75],a[220:223],v[180:183],v[72:75]
tr a[218:219],v9,26624
v_mul_f32 v26, s52, v26
mm v[84:87],a[228:231],v[180:183],v[84:87]
tr a[220:221],v9,28672
v_mul_f32 v27, s52, v27
mm v[84:87],a[224:227],v[168:171],v[84:87]
tr a[222:223],v9,30720
mm v[80:83],a[224:227],v[164:167],v[80:83]
v_mul_f32 v36, s52, v36
mm v[80:83],a[228:231],v[176:179],v[80:83]
v_mul_f32 v37, s52, v37
mm v[76:79],a[228:231],v[172:175],v[76:79]
s_waitcnt lgkmcnt(4)
v_mul_f32 v38, s52, v38
mm v[76:79],a[224:227],v[160:163],v[76:79]
tr a[224:225],v10,24576
mm v[88:91],a[232:235],v[160:163],v[88:91]
tr a[226:227],v10,26624
v_mul_f32 v39, s52, v39
mm v[88:91],a[236:239],v[172:175],v[88:91]
tr a[228:229],v10,28672
cv v24,v24,v25
mm v[92:95],a[236:239],v[176:179],v[92:95]
tr a[230:231],v10,30720
cv v25,v26,v27
mm v[92:95],a[232:235],v[164:167],v[92:95]
mm v[96:99],a[232:235],v[168:171],v[96:99]
tr a[232:233],v9,25088
cv v36,v36,v37
mm v[96:99],a[236:239],v[180:183],v[96:99]
tr a[234:235],v9,27136
cv v37,v38,v39
mm v[108:111],a[244:247],v[180:183],v[108:111]
tr a[236:237],v9,29184
mm v[108:111],a[240:243],v[168:171],v[108:111]
tr a[238:239],v9,31232
mm v[104:107],a[240:243],v[164:167],v[104:107]
v_permlane16_swap_b32 v24, v36
mm v[104:107],a[244:247],v[176:179],v[104:107]
v_permlane16_swap_b32 v25, v37
mm v[100:103],a[244:247],v[172:175],v[100:103]
s_waitcnt vmcnt(19)
s_waitcnt lgkmcnt(4)
mm v[100:103],a[240:243],v[160:163],v[100:103]
tr a[240:241],v10,25088
v_accvgpr_write_b32 a56, v24
mm v[64:67],a[216:219],v[184:187],v[64:67]
s_barrier
tr a[242:243],v10,27136
mm v[64:67],a[220:223],v[196:199],v[64:67]
s_add_u32 s50, s94, 640
s_add_u32 s51, s95, 640
mm v[68:71],a[220:223],v[200:203],v[68:71]
tr a[244:245],v10,29184
s_add_u32 m0, s43, 32768
mm v[68:71],a[216:219],v[188:191],v[68:71]
tr a[246:247],v10,31232
buffer_load_dwordx4 v1, s[16:19], s50 offen offset:0 lds
mm v[72:75],a[216:219],v[192:195],v[72:75]
tr a[216:217],v9,32768
v_accvgpr_write_b32 a57, v25
mm v[72:75],a[220:223],v[204:207],v[72:75]
tr a[218:219],v9,34816
v_accvgpr_write_b32 a58, v36
mm v[84:87],a[228:231],v[204:207],v[84:87]
tr a[220:221],v9,36864
v_accvgpr_write_b32 a59, v37
mm v[84:87],a[224:227],v[192:195],v[84:87]
tr a[222:223],v9,38912
v_mul_f32 v40, s52, v40
mm v[80:83],a[224:227],v[188:191],v[80:83]
buffer_load_dwordx4 v2, s[16:19], s50 offen offset:1024 lds
v_mul_f32 v41, s52, v41
mm v[80:83],a[228:231],v[200:203],v[80:83]
v_mul_f32 v42, s52, v42
v_mul_f32 v43, s52, v43
mm v[76:79],a[228:231],v[196:199],v[76:79]
s_waitcnt lgkmcnt(4)
v_mul_f32 v52, s52, v52
mm v[76:79],a[224:227],v[184:187],v[76:79]
tr a[224:225],v10,32768
v_mul_f32 v53, s52, v53
mm v[88:91],a[232:235],v[184:187],v[88:91]
tr a[226:227],v10,34816
v_mul_f32 v54, s52, v54
mm v[88:91],a[236:239],v[196:199],v[88:91]
tr a[228:229],v10,36864
v_mul_f32 v55, s52, v55
mm v[92:95],a[236:239],v[200:203],v[92:95]
tr a[230:231],v10,38912
cv v40,v40,v41
mm v[92:95],a[232:235],v[188:191],v[92:95]
buffer_load_dwordx4 v3, s[16:19], s50 offen offset:2048 lds
cv v41,v42,v43
mm v[96:99],a[232:235],v[192:195],v[96:99]
tr a[232:233],v9,33280
cv v52,v52,v53
mm v[96:99],a[236:239],v[204:207],v[96:99]
tr a[234:235],v9,35328
cv v53,v54,v55
mm v[108:111],a[244:247],v[204:207],v[108:111]
tr a[236:237],v9,37376
mm v[108:111],a[240:243],v[192:195],v[108:111]
tr a[238:239],v9,39424
mm v[104:107],a[240:243],v[188:191],v[104:107]
v_permlane16_swap_b32 v40, v52
mm v[104:107],a[244:247],v[200:203],v[104:107]
v_permlane16_swap_b32 v41, v53
mm v[100:103],a[244:247],v[196:199],v[100:103]
s_waitcnt lgkmcnt(4)
buffer_load_dwordx4 v4, s[16:19], s50 offen offset:3072 lds
mm v[100:103],a[240:243],v[184:187],v[100:103]
tr a[240:241],v10,33280
v_accvgpr_write_b32 a60, v40
mm v[64:67],a[216:219],v[208:211],v[64:67]
tr a[242:243],v10,35328
v_accvgpr_write_b32 a61, v41
mm v[64:67],a[220:223],v[220:223],v[64:67]
tr a[244:245],v10,37376
v_accvgpr_write_b32 a62, v52
mm v[68:71],a[220:223],v[224:227],v[68:71]
tr a[246:247],v10,39424
v_accvgpr_write_b32 a63, v53
mm v[68:71],a[216:219],v[212:215],v[68:71]
v_mul_f32 v44, s52, v44
v_mul_f32 v45, s52, v45
mm v[72:75],a[216:219],v[216:219],v[72:75]
tr a[216:217],v9,40960
v_mul_f32 v46, s52, v46
mm v[72:75],a[220:223],v[228:231],v[72:75]
tr a[218:219],v9,43008
s_add_u32 m0, s44, 32768
mm v[84:87],a[228:231],v[228:231],v[84:87]
buffer_load_dwordx4 v1, s[16:19], s51 offen offset:0 lds
tr a[220:221],v9,45056
mm v[84:87],a[224:227],v[216:219],v[84:87]
tr a[222:223],v9,47104
v_mul_f32 v47, s52, v47
mm v[80:83],a[224:227],v[212:215],v[80:83]
v_mul_f32 v56, s52, v56
v_mul_f32 v57, s52, v57
mm v[80:83],a[228:231],v[224:227],v[80:83]
v_mul_f32 v58, s52, v58
mm v[76:79],a[228:231],v[220:223],v[76:79]
s_waitcnt lgkmcnt(4)
mm v[76:79],a[224:227],v[208:211],v[76:79]
tr a[224:225],v10,40960
v_mul_f32 v59, s52, v59
mm v[88:91],a[232:235],v[208:211],v[88:91]
tr a[226:227],v10,43008
buffer_load_dwordx4 v2, s[16:19], s51 offen offset:1024 lds
mm v[88:91],a[236:239],v[220:223],v[88:91]
tr a[228:229],v10,45056
cv v44,v44,v45
mm v[92:95],a[236:239],v[224:227],v[92:95]
tr a[230:231],v10,47104
cv v45,v46,v47
mm v[92:95],a[232:235],v[212:215],v[92:95]
cv v56,v56,v57
mm v[96:99],a[232:235],v[216:219],v[96:99]
tr a[232:233],v9,41472
cv v57,v58,v59
mm v[96:99],a[236:239],v[228:231],v[96:99]
tr a[234:235],v9,43520
mm v[108:111],a[244:247],v[228:231],v[108:111]
tr a[236:237],v9,45568
mm v[108:111],a[240:243],v[216:219],v[108:111]
tr a[238:239],v9,47616
buffer_load_dwordx4 v3, s[16:19], s51 offen offset:2048 lds
mm v[104:107],a[240:243],v[212:215],v[104:107]
v_permlane16_swap_b32 v44, v56
mm v[104:107],a[244:247],v[224:227],v[104:107]
v_permlane16_swap_b32 v45, v57
mm v[100:103],a[244:247],v[220:223],v[100:103]
s_waitcnt lgkmcnt(4)
v_accvgpr_write_b32 a64, v44
mm v[100:103],a[240:243],v[208:211],v[100:103]
tr a[240:241],v10,41472
v_accvgpr_write_b32 a65, v45
mm v[64:67],a[216:219],v[232:235],v[64:67]
tr a[242:243],v10,43520
v_accvgpr_write_b32 a66, v56
mm v[64:67],a[220:223],v[244:247],v[64:67]
tr a[244:245],v10,45568
v_accvgpr_write_b32 a67, v57
mm v[68:71],a[220:223],v[248:251],v[68:71]
tr a[246:247],v10,47616
buffer_load_dwordx4 v4, s[16:19], s51 offen offset:3072 lds
mm v[68:71],a[216:219],v[236:239],v[68:71]
v_mul_f32 v48, s52, v48
v_mul_f32 v49, s52, v49
mm v[72:75],a[216:219],v[240:243],v[72:75]
tr a[216:217],v9,49152
v_mul_f32 v50, s52, v50
mm v[72:75],a[220:223],v[252:255],v[72:75]
tr a[218:219],v9,51200
v_mul_f32 v51, s52, v51
mm v[84:87],a[228:231],v[252:255],v[84:87]
tr a[220:221],v9,53248
v_mul_f32 v60, s52, v60
mm v[84:87],a[224:227],v[240:243],v[84:87]
tr a[222:223],v9,55296
mm v[80:83],a[224:227],v[236:239],v[80:83]
v_mul_f32 v61, s52, v61
mm v[80:83],a[228:231],v[248:251],v[80:83]
v_mul_f32 v62, s52, v62
mm v[76:79],a[228:231],v[244:247],v[76:79]
s_waitcnt lgkmcnt(4)
v_mul_f32 v63, s52, v63
mm v[76:79],a[224:227],v[232:235],v[76:79]
tr a[224:225],v10,49152
cv v48,v48,v49
mm v[88:91],a[232:235],v[232:235],v[88:91]
s_add_u32 s47, s46, 360448
tr a[226:227],v10,51200
mm v[88:91],a[236:239],v[244:247],v[88:91]
tr a[228:229],v10,53248
buffer_load_dword a249, v14, s[4:7], s47 offen
mm v[92:95],a[236:239],v[248:251],v[92:95]
tr a[230:231],v10,55296
cv v49,v50,v51
mm v[92:95],a[232:235],v[236:239],v[92:95]
cv v60,v60,v61
cv v61,v62,v63
mm v[96:99],a[232:235],v[240:243],v[96:99]
tr a[232:233],v9,49664
mm v[96:99],a[236:239],v[252:255],v[96:99]
tr a[234:235],v9,51712
mm v[108:111],a[244:247],v[252:255],v[108:111]
tr a[236:237],v9,53760
mm v[108:111],a[240:243],v[240:243],v[108:111]
tr a[238:239],v9,55808
mm v[104:107],a[240:243],v[236:239],v[104:107]
v_permlane16_swap_b32 v48, v60
mm v[104:107],a[244:247],v[248:251],v[104:107]
v_permlane16_swap_b32 v49, v61
mm v[100:103],a[244:247],v[244:247],v[100:103]
s_waitcnt lgkmcnt(4)
v_accvgpr_write_b32 a68, v48
mm v[100:103],a[240:243],v[232:235],v[100:103]
tr a[240:241],v10,49664
v_accvgpr_write_b32 a69, v49
mm v[64:67],a[216:219],a[168:171],v[64:67]
tr a[242:243],v10,51712
v_accvgpr_write_b32 a70, v60
mm v[64:67],a[220:223],a[180:183],v[64:67]
tr a[244:245],v10,53760
v_accvgpr_write_b32 a71, v61
mm v[68:71],a[220:223],a[184:187],v[68:71]
tr a[246:247],v10,55808
mm v[68:71],a[216:219],a[172:175],v[68:71]
mm v[72:75],a[216:219],a[176:179],v[72:75]
tr a[216:217],v9,57344
mm v[72:75],a[220:223],a[188:191],v[72:75]
tr a[218:219],v9,59392
mm v[84:87],a[228:231],a[188:191],v[84:87]
tr a[220:221],v9,61440
mm v[84:87],a[224:227],a[176:179],v[84:87]
tr a[222:223],v9,63488
mm v[80:83],a[224:227],a[172:175],v[80:83]
mm v[80:83],a[228:231],a[184:187],v[80:83]
mm v[76:79],a[228:231],a[180:183],v[76:79]
s_waitcnt lgkmcnt(4)
mm v[76:79],a[224:227],a[168:171],v[76:79]
tr a[224:225],v10,57344
mm v[88:91],a[232:235],a[168:171],v[88:91]
tr a[226:227],v10,59392
mm v[88:91],a[236:239],a[180:183],v[88:91]
tr a[228:229],v10,61440
mm v[92:95],a[236:239],a[184:187],v[92:95]
tr a[230:231],v10,63488
mm v[92:95],a[232:235],a[172:175],v[92:95]
mm v[96:99],a[232:235],a[176:179],v[96:99]
tr a[232:233],v9,57856
mm v[96:99],a[236:239],a[188:191],v[96:99]
tr a[234:235],v9,59904
mm v[108:111],a[244:247],a[188:191],v[108:111]
tr a[236:237],v9,61952
mm v[108:111],a[240:243],a[176:179],v[108:111]
tr a[238:239],v9,64000
s_mul_i32 s48, s41, 3
mm v[104:107],a[240:243],a[172:175],v[104:107]
mm v[104:107],a[244:247],a[184:187],v[104:107]
s_lshr_b32 s48, s48, 3
mm v[100:103],a[244:247],a[180:183],v[100:103]
s_waitcnt vmcnt(19)
s_waitcnt lgkmcnt(4)
mm v[100:103],a[240:243],a[168:171],v[100:103]
tr a[240:241],v10,57856
s_xor_b32 s48, s48, 0
mm v[64:67],a[216:219],a[192:195],v[64:67]
s_barrier
tr a[242:243],v10,59904
mm v[64:67],a[220:223],a[204:207],v[64:67]
tr a[244:245],v10,61952
s_or_b32 s48, s48, s42
mm v[68:71],a[220:223],a[208:211],v[68:71]
tr a[246:247],v10,64000
v_add_u32 v9, 65536, v9
mm v[68:71],a[216:219],a[196:199],v[68:71]
v_add_u32 v10, 65536, v10
v_or_b32 v16, s48, v0
mm v[72:75],a[216:219],a[200:203],v[72:75]
s_add_u32 s47, s46, 368640
tr a[216:217],v9,0
mm v[72:75],a[220:223],a[212:215],v[72:75]
tr a[218:219],v9,2048
buffer_load_dword a249, v14, s[4:7], s47 offen
mm v[84:87],a[228:231],a[212:215],v[84:87]
tr a[220:221],v9,4096
s_lshl_b32 s49, 1, s41
mm v[84:87],a[224:227],a[200:203],v[84:87]
tr a[222:223],v9,6144
v_cmp_eq_u32 vcc, 0, v16
mm v[80:83],a[224:227],a[196:199],v[80:83]
mm v[80:83],a[228:231],a[208:211],v[80:83]
v_mov_b32 v17, s49
mm v[76:79],a[228:231],a[204:207],v[76:79]
s_waitcnt lgkmcnt(4)
mm v[76:79],a[224:227],a[192:195],v[76:79]
tr a[224:225],v10,0
v_mov_b32 v16, 0x7fff0000
mm v[88:91],a[232:235],a[192:195],v[88:91]
tr a[226:227],v10,2048
mm v[88:91],a[236:239],a[204:207],v[88:91]
tr a[228:229],v10,4096
s_lshl_b32 s49, s40, 3
mm v[92:95],a[236:239],a[208:211],v[92:95]
tr a[230:231],v10,6144
mm v[92:95],a[232:235],a[196:199],v[92:95]
v_cndmask_b32_e64 v16, v16, 0, vcc
mm v[96:99],a[232:235],a[200:203],v[96:99]
tr a[232:233],v9,512
s_mul_i32 s55, s42, 6144
mm v[96:99],a[236:239],a[212:215],v[96:99]
buffer_atomic_or v17, v16, s[32:35], s49 offen offset:4
tr a[234:235],v9,2560
mm v[108:111],a[244:247],a[212:215],v[108:111]
tr a[236:237],v9,4608
mm v[108:111],a[240:243],a[200:203],v[108:111]
tr a[238:239],v9,6656
mm v[104:107],a[240:243],a[196:199],v[104:107]
mm v[104:107],a[244:247],a[208:211],v[104:107]
s_mul_i32 s53, s56, 24576
mm v[100:103],a[244:247],a[204:207],v[100:103]
s_waitcnt lgkmcnt(4)
mm v[100:103],a[240:243],a[192:195],v[100:103]
tr a[240:241],v10,512
mm v[16:19],a[216:219],v[112:115],0
tr a[242:243],v10,2560
mm v[16:19],a[220:223],v[124:127],v[16:19]
tr a[244:245],v10,4608
mm v[20:23],a[220:223],v[128:131],0
tr a[246:247],v10,6656
mm v[20:23],a[216:219],v[116:119],v[20:23]
s_add_u32 s76, s53, s55
mm v[24:27],a[216:219],v[120:123],0
tr a[216:217],v9,8192
v_mul_f32 v64, s52, v64
mm v[24:27],a[220:223],v[132:135],v[24:27]
tr a[218:219],v9,10240
v_mul_f32 v65, s52, v65
mm v[36:39],a[228:231],v[132:135],0
tr a[220:221],v9,12288
v_mul_f32 v66, s52, v66
mm v[36:39],a[224:227],v[120:123],v[36:39]
tr a[222:223],v9,14336
v_mul_f32 v67, s52, v67
mm v[32:35],a[224:227],v[116:119],0
mm v[32:35],a[228:231],v[128:131],v[32:35]
v_mul_f32 v76, s52, v76
s_add_u32 s77, s76, 6291456
mm v[28:31],a[228:231],v[124:127],0
s_waitcnt lgkmcnt(4)
v_mul_f32 v77, s52, v77
mm v[28:31],a[224:227],v[112:115],v[28:31]
tr a[224:225],v10,8192
v_mul_f32 v78, s52, v78
mm v[40:43],a[232:235],v[112:115],0
tr a[226:227],v10,10240
mm v[40:43],a[236:239],v[124:127],v[40:43]
tr a[228:229],v10,12288
v_mul_f32 v79, s52, v79
mm v[44:47],a[236:239],v[128:131],0
tr a[230:231],v10,14336
cv v64,v64,v65
mm v[44:47],a[232:235],v[116:119],v[44:47]
cv v65,v66,v67
s_add_u32 s78, s76, 12582912
mm v[48:51],a[232:235],v[120:123],0
tr a[232:233],v9,8704
mm v[48:51],a[236:239],v[132:135],v[48:51]
tr a[234:235],v9,10752
cv v76,v76,v77
mm v[60:63],a[244:247],v[132:135],0
tr a[236:237],v9,12800
cv v77,v78,v79
mm v[60:63],a[240:243],v[120:123],v[60:63]
tr a[238:239],v9,14848
mm v[56:59],a[240:243],v[116:119],0
v_permlane16_swap_b32 v64, v76
mm v[56:59],a[244:247],v[128:131],v[56:59]
v_permlane16_swap_b32 v65, v77
mm v[52:55],a[244:247],v[124:127],0
s_waitcnt lgkmcnt(4)
v_accvgpr_write_b32 a72, v64
mm v[52:55],a[240:243],v[112:115],v[52:55]
tr a[240:241],v10,8704
v_accvgpr_write_b32 a73, v65
mm v[16:19],a[216:219],v[136:139],v[16:19]
tr a[242:243],v10,10752
v_accvgpr_write_b32 a74, v76
mm v[16:19],a[220:223],v[148:151],v[16:19]
tr a[244:245],v10,12800
s_add_u32 s79, s76, 18874368
mm v[20:23],a[220:223],v[152:155],v[20:23]
tr a[246:247],v10,14848
v_accvgpr_write_b32 a75, v77
mm v[20:23],a[216:219],v[140:143],v[20:23]
v_mul_f32 v68, s52, v68
s_add_u32 s80, s76, 25165824
mm v[24:27],a[216:219],v[144:147],v[24:27]
tr a[216:217],v9,16384
v_mul_f32 v69, s52, v69
mm v[24:27],a[220:223],v[156:159],v[24:27]
tr a[218:219],v9,18432
mm v[36:39],a[228:231],v[156:159],v[36:39]
tr a[220:221],v9,20480
v_mul_f32 v70, s52, v70
mm v[36:39],a[224:227],v[144:147],v[36:39]
tr a[222:223],v9,22528
v_mul_f32 v71, s52, v71
mm v[32:35],a[224:227],v[140:143],v[32:35]
v_mul_f32 v80, s52, v80
mm v[32:35],a[228:231],v[152:155],v[32:35]
s_add_u32 s81, s76, 31457280
mm v[28:31],a[228:231],v[148:151],v[28:31]
s_waitcnt lgkmcnt(4)
v_mul_f32 v81, s52, v81
mm v[28:31],a[224:227],v[136:139],v[28:31]
tr a[224:225],v10,16384
v_mul_f32 v82, s52, v82
mm v[40:43],a[232:235],v[136:139],v[40:43]
s_add_u32 s47, s46, 491520
tr a[226:227],v10,18432
mm v[40:43],a[236:239],v[148:151],v[40:43]
tr a[228:229],v10,20480
buffer_load_dword a249, v14, s[4:7], s47 offen
mm v[44:47],a[236:239],v[152:155],v[44:47]
tr a[230:231],v10,22528
v_mul_f32 v83, s52, v83
mm v[44:47],a[232:235],v[140:143],v[44:47]
cv v68,v68,v69
cv v69,v70,v71
mm v[48:51],a[232:235],v[144:147],v[48:51]
tr a[232:233],v9,16896
cv v80,v80,v81
mm v[48:51],a[236:239],v[156:159],v[48:51]
tr a[234:235],v9,18944
cv v81,v82,v83
mm v[60:63],a[244:247],v[156:159],v[60:63]
tr a[236:237],v9,20992
s_add_u32 s82, s76, 37748736
mm v[60:63],a[240:243],v[144:147],v[60:63]
tr a[238:239],v9,23040
mm v[56:59],a[240:243],v[140:143],v[56:59]
v_permlane16_swap_b32 v68, v80
mm v[56:59],a[244:247],v[152:155],v[56:59]
v_permlane16_swap_b32 v69, v81
mm v[52:55],a[244:247],v[148:151],v[52:55]
s_waitcnt lgkmcnt(4)
v_accvgpr_write_b32 a76, v68
mm v[52:55],a[240:243],v[136:139],v[52:55]
tr a[240:241],v10,16896
v_accvgpr_write_b32 a77, v69
mm v[16:19],a[216:219],v[160:163],v[16:19]
tr a[242:243],v10,18944
v_accvgpr_write_b32 a78, v80
mm v[16:19],a[220:223],v[172:175],v[16:19]
tr a[244:245],v10,20992
v_accvgpr_write_b32 a79, v81
mm v[20:23],a[220:223],v[176:179],v[20:23]
tr a[246:247],v10,23040
s_add_u32 s53, s41, 1
mm v[20:23],a[216:219],v[164:167],v[20:23]
v_mul_f32 v72, s52, v72
s_and_b32 s53, s53, 7
mm v[24:27],a[216:219],v[168:171],v[24:27]
tr a[216:217],v9,24576
v_mul_f32 v73, s52, v73
mm v[24:27],a[220:223],v[180:183],v[24:27]
tr a[218:219],v9,26624
v_mul_f32 v74, s52, v74
mm v[36:39],a[228:231],v[180:183],v[36:39]
tr a[220:221],v9,28672
v_mul_f32 v75, s52, v75
mm v[36:39],a[224:227],v[168:171],v[36:39]
tr a[222:223],v9,30720
mm v[32:35],a[224:227],v[164:167],v[32:35]
v_mul_f32 v84, s52, v84
mm v[32:35],a[228:231],v[176:179],v[32:35]
L_pg4:
s_cbranch_execz L_pg8
v_mul_f32 v85, s52, v85
s_lshl_b32 s60, s53, 7
mm v[28:31],a[228:231],v[172:175],v[28:31]
s_waitcnt lgkmcnt(4)
v_mul_f32 v86, s52, v86
mm v[28:31],a[224:227],v[160:163],v[28:31]
tr a[224:225],v10,24576
mm v[40:43],a[232:235],v[160:163],v[40:43]
tr a[226:227],v10,26624
v_mul_f32 v87, s52, v87
mm v[40:43],a[236:239],v[172:175],v[40:43]
tr a[228:229],v10,28672
cv v72,v72,v73
mm v[44:47],a[236:239],v[176:179],v[44:47]
tr a[230:231],v10,30720
cv v73,v74,v75
mm v[44:47],a[232:235],v[164:167],v[44:47]
s_lshl_b32 s56, s40, 3
mm v[48:51],a[232:235],v[168:171],v[48:51]
tr a[232:233],v9,25088
cv v84,v84,v85
mm v[48:51],a[236:239],v[180:183],v[48:51]
tr a[234:235],v9,27136
cv v85,v86,v87
mm v[60:63],a[244:247],v[180:183],v[60:63]
tr a[236:237],v9,29184
mm v[60:63],a[240:243],v[168:171],v[60:63]
tr a[238:239],v9,31232
mm v[56:59],a[240:243],v[164:167],v[56:59]
v_permlane16_swap_b32 v72, v84
mm v[56:59],a[244:247],v[176:179],v[56:59]
v_permlane16_swap_b32 v73, v85
mm v[52:55],a[244:247],v[172:175],v[52:55]
s_waitcnt vmcnt(13)
s_waitcnt lgkmcnt(4)
mm v[52:55],a[240:243],v[160:163],v[52:55]
tr a[240:241],v10,25088
v_accvgpr_write_b32 a80, v72
mm v[16:19],a[216:219],v[184:187],v[16:19]
s_barrier
tr a[242:243],v10,27136
mm v[16:19],a[220:223],v[196:199],v[16:19]
tr a[244:245],v10,29184
v_accvgpr_write_b32 a81, v73
mm v[20:23],a[220:223],v[200:203],v[20:23]
tr a[246:247],v10,31232
v_add_u32 v9, 4294836224, v9
mm v[20:23],a[216:219],v[188:191],v[20:23]
v_add_u32 v10, 4294836224, v10
v_accvgpr_write_b32 a82, v84
mm v[24:27],a[216:219],v[192:195],v[24:27]
tr a[216:217],v9,0
v_accvgpr_write_b32 a83, v85
mm v[24:27],a[220:223],v[204:207],v[24:27]
tr a[218:219],v9,2048
v_mul_f32 v88, s52, v88
mm v[36:39],a[228:231],v[204:207],v[36:39]
tr a[220:221],v9,4096
v_mul_f32 v89, s52, v89
mm v[36:39],a[224:227],v[192:195],v[36:39]
tr a[222:223],v9,6144
v_mul_f32 v90, s52, v90
mm v[32:35],a[224:227],v[188:191],v[32:35]
v_mul_f32 v91, s52, v91
v_mul_f32 v100, s52, v100
mm v[32:35],a[228:231],v[200:203],v[32:35]
v_mul_f32 v101, s52, v101
s_add_u32 s56, s56, s53
mm v[28:31],a[228:231],v[196:199],v[28:31]
s_waitcnt lgkmcnt(4)
v_mul_f32 v102, s52, v102
mm v[28:31],a[224:227],v[184:187],v[28:31]
tr a[224:225],v10,0
v_mul_f32 v103, s52, v103
mm v[40:43],a[232:235],v[184:187],v[40:43]
tr a[226:227],v10,2048
cv v88,v88,v89
mm v[40:43],a[236:239],v[196:199],v[40:43]
tr a[228:229],v10,4096
s_lshl_b32 s53, s56, 2
mm v[44:47],a[236:239],v[200:203],v[44:47]
tr a[230:231],v10,6144
cv v89,v90,v91
mm v[44:47],a[232:235],v[188:191],v[44:47]
cv v100,v100,v101
s_add_u32 s53, s53, s42
mm v[48:51],a[232:235],v[192:195],v[48:51]
tr a[232:233],v9,512
cv v101,v102,v103
mm v[48:51],a[236:239],v[204:207],v[48:51]
tr a[234:235],v9,2560
s_lshl_b32 s53, s53, 7
mm v[60:63],a[244:247],v[204:207],v[60:63]
tr a[236:237],v9,4608
mm v[60:63],a[240:243],v[192:195],v[60:63]
tr a[238:239],v9,6656
mm v[56:59],a[240:243],v[188:191],v[56:59]
v_permlane16_swap_b32 v88, v100
mm v[56:59],a[244:247],v[200:203],v[56:59]
v_permlane16_swap_b32 v89, v101
mm v[52:55],a[244:247],v[196:199],v[52:55]
s_waitcnt lgkmcnt(4)
v_accvgpr_write_b32 a84, v88
mm v[52:55],a[240:243],v[184:187],v[52:55]
tr a[240:241],v10,512
v_accvgpr_write_b32 a85, v89
mm v[16:19],a[216:219],v[208:211],v[16:19]
tr a[242:243],v10,2560
v_accvgpr_write_b32 a86, v100
mm v[16:19],a[220:223],v[220:223],v[16:19]
s_barrier
tr a[244:245],v10,4608
mm v[20:23],a[220:223],v[224:227],v[20:23]
tr a[246:247],v10,6656
v_accvgpr_write_b32 a87, v101
mm v[20:23],a[216:219],v[212:215],v[20:23]
s_add_u32 s50, s96, 640
s_add_u32 s51, s97, 640
mm v[24:27],a[216:219],v[216:219],v[24:27]
s_add_u32 m0, s43, 131072
tr a[216:217],v9,8192
mm v[24:27],a[220:223],v[228:231],v[24:27]
buffer_load_dwordx4 v1, s[16:19], s50 offen offset:0 lds
tr a[218:219],v9,10240
mm v[36:39],a[228:231],v[228:231],v[36:39]
tr a[220:221],v9,12288
v_mul_f32 v92, s52, v92
mm v[36:39],a[224:227],v[216:219],v[36:39]
tr a[222:223],v9,14336
buffer_load_dwordx4 v2, s[16:19], s50 offen offset:1024 lds
mm v[32:35],a[224:227],v[212:215],v[32:35]
v_mul_f32 v93, s52, v93
v_mul_f32 v94, s52, v94
mm v[32:35],a[228:231],v[224:227],v[32:35]
v_mul_f32 v95, s52, v95
v_mul_f32 v104, s52, v104
mm v[28:31],a[228:231],v[220:223],v[28:31]
s_waitcnt lgkmcnt(4)
buffer_load_dwordx4 v3, s[16:19], s50 offen offset:2048 lds
mm v[28:31],a[224:227],v[208:211],v[28:31]
tr a[224:225],v10,8192
v_mul_f32 v105, s52, v105
mm v[40:43],a[232:235],v[208:211],v[40:43]
tr a[226:227],v10,10240
v_mul_f32 v106, s52, v106
mm v[40:43],a[236:239],v[220:223],v[40:43]
tr a[228:229],v10,12288
v_mul_f32 v107, s52, v107
mm v[44:47],a[236:239],v[224:227],v[44:47]
tr a[230:231],v10,14336
buffer_load_dwordx4 v4, s[16:19], s50 offen offset:3072 lds
mm v[44:47],a[232:235],v[212:215],v[44:47]
cv v92,v92,v93
cv v93,v94,v95
mm v[48:51],a[232:235],v[216:219],v[48:51]
tr a[232:233],v9,8704
cv v104,v104,v105
mm v[48:51],a[236:239],v[228:231],v[48:51]
tr a[234:235],v9,10752
s_add_u32 m0, s44, 131072
mm v[60:63],a[244:247],v[228:231],v[60:63]
buffer_load_dwordx4 v1, s[16:19], s51 offen offset:0 lds
tr a[236:237],v9,12800
mm v[60:63],a[240:243],v[216:219],v[60:63]
tr a[238:239],v9,14848
cv v105,v106,v107
mm v[56:59],a[240:243],v[212:215],v[56:59]
buffer_load_dwordx4 v2, s[16:19], s51 offen offset:1024 lds
s_add_u32 s84, s53, 0
mm v[56:59],a[244:247],v[224:227],v[56:59]
v_permlane16_swap_b32 v92, v104
mm v[52:55],a[244:247],v[220:223],v[52:55]
s_waitcnt lgkmcnt(4)
s_mul_i32 s56, s56, 24576
mm v[52:55],a[240:243],v[208:211],v[52:55]
tr a[240:241],v10,8704
s_add_u32 s56, s56, s55
mm v[16:19],a[216:219],v[232:235],v[16:19]
tr a[242:243],v10,10752
buffer_load_dwordx4 v3, s[16:19], s51 offen offset:2048 lds
mm v[16:19],a[220:223],v[244:247],v[16:19]
tr a[244:245],v10,12800
s_add_u32 s68, s56, 0
mm v[20:23],a[220:223],v[248:251],v[20:23]
tr a[246:247],v10,14848
s_add_u32 s53, s41, 2
mm v[20:23],a[216:219],v[236:239],v[20:23]
buffer_load_dwordx4 v4, s[16:19], s51 offen offset:3072 lds
s_and_b32 s53, s53, 7
mm v[24:27],a[216:219],v[240:243],v[24:27]
tr a[216:217],v9,16384
mm v[24:27],a[220:223],v[252:255],v[24:27]
tr a[218:219],v9,18432
mm v[36:39],a[228:231],v[252:255],v[36:39]
tr a[220:221],v9,20480
mm v[36:39],a[224:227],v[240:243],v[36:39]
tr a[222:223],v9,22528
mm v[32:35],a[224:227],v[236:239],v[32:35]
v_permlane16_swap_b32 v93, v105
mm v[32:35],a[228:231],v[248:251],v[32:35]
v_accvgpr_write_b32 a88, v92
v_accvgpr_write_b32 a89, v93
mm v[28:31],a[228:231],v[244:247],v[28:31]
s_waitcnt lgkmcnt(4)
v_accvgpr_write_b32 a90, v104
mm v[28:31],a[224:227],v[232:235],v[28:31]
tr a[224:225],v10,16384
v_accvgpr_write_b32 a91, v105
mm v[40:43],a[232:235],v[232:235],v[40:43]
tr a[226:227],v10,18432
v_mul_f32 v96, s52, v96
mm v[40:43],a[236:239],v[244:247],v[40:43]
tr a[228:229],v10,20480
v_mul_f32 v97, s52, v97
mm v[44:47],a[236:239],v[248:251],v[44:47]
tr a[230:231],v10,22528
v_mul_f32 v98, s52, v98
mm v[44:47],a[232:235],v[236:239],v[44:47]
v_mul_f32 v99, s52, v99
v_mul_f32 v108, s52, v108
mm v[48:51],a[232:235],v[240:243],v[48:51]
tr a[232:233],v9,16896
v_mul_f32 v109, s52, v109
mm v[48:51],a[236:239],v[252:255],v[48:51]
tr a[234:235],v9,18944
v_mul_f32 v110, s52, v110
mm v[60:63],a[244:247],v[252:255],v[60:63]
tr a[236:237],v9,20992
v_mul_f32 v111, s52, v111
mm v[60:63],a[240:243],v[240:243],v[60:63]
tr a[238:239],v9,23040
cv v96,v96,v97
mm v[56:59],a[240:243],v[236:239],v[56:59]
cv v97,v98,v99
cv v108,v108,v109
mm v[56:59],a[244:247],v[248:251],v[56:59]
cv v109,v110,v111
s_lshl_b32 s61, s53, 7
mm v[52:55],a[244:247],v[244:247],v[52:55]
s_waitcnt lgkmcnt(4)
s_lshl_b32 s56, s40, 3
mm v[52:55],a[240:243],v[232:235],v[52:55]
tr a[240:241],v10,16896
s_add_u32 s56, s56, s53
mm v[16:19],a[216:219],a[168:171],v[16:19]
tr a[242:243],v10,18944
mm v[16:19],a[220:223],a[180:183],v[16:19]
tr a[244:245],v10,20992
mm v[20:23],a[220:223],a[184:187],v[20:23]
tr a[246:247],v10,23040
s_lshl_b32 s53, s56, 2
mm v[20:23],a[216:219],a[172:175],v[20:23]
v_permlane16_swap_b32 v96, v108
mm v[24:27],a[216:219],a[176:179],v[24:27]
tr a[216:217],v9,24576
mm v[24:27],a[220:223],a[188:191],v[24:27]
tr a[218:219],v9,26624
mm v[36:39],a[228:231],a[188:191],v[36:39]
tr a[220:221],v9,28672
mm v[36:39],a[224:227],a[176:179],v[36:39]
tr a[222:223],v9,30720
mm v[32:35],a[224:227],a[172:175],v[32:35]
v_permlane16_swap_b32 v97, v109
mm v[32:35],a[228:231],a[184:187],v[32:35]
v_accvgpr_write_b32 a92, v96
v_accvgpr_write_b32 a93, v97
mm v[28:31],a[228:231],a[180:183],v[28:31]
s_waitcnt lgkmcnt(4)
v_accvgpr_write_b32 a94, v108
mm v[28:31],a[224:227],a[168:171],v[28:31]
tr a[224:225],v10,24576
v_accvgpr_write_b32 a95, v109
mm v[40:43],a[232:235],a[168:171],v[40:43]
tr a[226:227],v10,26624
s_add_u32 s53, s53, s42
mm v[40:43],a[236:239],a[180:183],v[40:43]
tr a[228:229],v10,28672
mm v[44:47],a[236:239],a[184:187],v[44:47]
tr a[230:231],v10,30720
s_lshl_b32 s53, s53, 7
mm v[44:47],a[232:235],a[172:175],v[44:47]
s_add_u32 m0, s43, 65536
mm v[48:51],a[232:235],a[176:179],v[48:51]
buffer_load_dwordx4 v5, s[8:11], s45 offen offset:0 nt lds
tr a[232:233],v9,25088
mm v[48:51],a[236:239],a[188:191],v[48:51]
tr a[234:235],v9,27136
mm v[60:63],a[244:247],a[188:191],v[60:63]
tr a[236:237],v9,29184
mm v[60:63],a[240:243],a[176:179],v[60:63]
tr a[238:239],v9,31232
s_mul_i32 s48, s41, 3
mm v[56:59],a[240:243],a[172:175],v[56:59]
s_add_u32 s85, s53, 4
mm v[56:59],a[244:247],a[184:187],v[56:59]
s_lshr_b32 s48, s48, 3
mm v[52:55],a[244:247],a[180:183],v[52:55]
s_waitcnt vmcnt(13)
s_waitcnt lgkmcnt(4)
mm v[52:55],a[240:243],a[168:171],v[52:55]
buffer_load_dwordx4 v6, s[8:11], s45 offen offset:1024 nt lds
tr a[240:241],v10,25088
mm v[16:19],a[216:219],a[192:195],v[16:19]
s_barrier
tr a[242:243],v10,27136
mm v[16:19],a[220:223],a[204:207],v[16:19]
tr a[244:245],v10,29184
s_xor_b32 s48, s48, 1
mm v[20:23],a[220:223],a[208:211],v[20:23]
tr a[246:247],v10,31232
s_or_b32 s48, s48, s42
mm v[20:23],a[216:219],a[196:199],v[20:23]
v_or_b32 v64, s48, v0
s_mul_i32 s56, s56, 24576
mm v[24:27],a[216:219],a[200:203],v[24:27]
tr a[216:217],v9,32768
mm v[24:27],a[220:223],a[212:215],v[24:27]
tr a[218:219],v9,34816
s_lshl_b32 s49, 1, s41
mm v[36:39],a[228:231],a[212:215],v[36:39]
buffer_load_dwordx4 v7, s[8:11], s45 offen offset:2048 nt lds
tr a[220:221],v9,36864
mm v[36:39],a[224:227],a[200:203],v[36:39]
tr a[222:223],v9,38912
v_cmp_eq_u32 vcc, 0, v64
mm v[32:35],a[224:227],a[196:199],v[32:35]
s_add_u32 s56, s56, s55
mm v[32:35],a[228:231],a[208:211],v[32:35]
v_mov_b32 v65, s49
mm v[28:31],a[228:231],a[204:207],v[28:31]
s_waitcnt lgkmcnt(4)
mm v[28:31],a[224:227],a[192:195],v[28:31]
tr a[224:225],v10,32768
v_mov_b32 v64, 0x7fff0000
mm v[40:43],a[232:235],a[192:195],v[40:43]
tr a[226:227],v10,34816
mm v[40:43],a[236:239],a[204:207],v[40:43]
tr a[228:229],v10,36864
buffer_load_dwordx4 v8, s[8:11], s45 offen offset:3072 nt lds
mm v[44:47],a[236:239],a[208:211],v[44:47]
tr a[230:231],v10,38912
s_lshl_b32 s49, s40, 3
mm v[44:47],a[232:235],a[196:199],v[44:47]
v_cndmask_b32_e64 v64, v64, 0, vcc
s_add_u32 s69, s56, 6291456
mm v[48:51],a[232:235],a[200:203],v[48:51]
tr a[232:233],v9,33280
mm v[48:51],a[236:239],a[212:215],v[48:51]
buffer_atomic_or v65, v64, s[32:35], s49 offen offset:4
tr a[234:235],v9,35328
mm v[60:63],a[244:247],a[212:215],v[60:63]
tr a[236:237],v9,37376
mm v[60:63],a[240:243],a[200:203],v[60:63]
tr a[238:239],v9,39424
s_add_u32 s53, s41, 3
mm v[56:59],a[240:243],a[196:199],v[56:59]
mm v[56:59],a[244:247],a[208:211],v[56:59]
mm v[52:55],a[244:247],a[204:207],v[52:55]
s_waitcnt lgkmcnt(4)
mm v[52:55],a[240:243],a[192:195],v[52:55]
tr a[240:241],v10,33280
mm v[64:67],a[216:219],v[112:115],0
tr a[242:243],v10,35328
mm v[64:67],a[220:223],v[124:127],v[64:67]
s_barrier
tr a[244:245],v10,37376
mm v[68:71],a[220:223],v[128:131],0
tr a[246:247],v10,39424
s_and_b32 s53, s53, 7
mm v[68:71],a[216:219],v[116:119],v[68:71]
s_add_u32 s50, s94, 768
s_add_u32 s51, s95, 768
mm v[72:75],a[216:219],v[120:123],0
s_add_u32 m0, s43, 0
tr a[216:217],v9,40960
mm v[72:75],a[220:223],v[132:135],v[72:75]
buffer_load_dwordx4 v1, s[16:19], s50 offen offset:0 lds
tr a[218:219],v9,43008
mm v[84:87],a[228:231],v[132:135],0
tr a[220:221],v9,45056
v_mul_f32 v16, s52, v16
mm v[84:87],a[224:227],v[120:123],v[84:87]
tr a[222:223],v9,47104
buffer_load_dwordx4 v2, s[16:19], s50 offen offset:1024 lds
mm v[80:83],a[224:227],v[116:119],0
v_mul_f32 v17, s52, v17
v_mul_f32 v18, s52, v18
mm v[80:83],a[228:231],v[128:131],v[80:83]
v_mul_f32 v19, s52, v19
v_mul_f32 v28, s52, v28
mm v[76:79],a[228:231],v[124:127],0
s_waitcnt lgkmcnt(4)
buffer_load_dwordx4 v3, s[16:19], s50 offen offset:2048 lds
mm v[76:79],a[224:227],v[112:115],v[76:79]
tr a[224:225],v10,40960
v_mul_f32 v29, s52, v29
mm v[88:91],a[232:235],v[112:115],0
tr a[226:227],v10,43008
v_mul_f32 v30, s52, v30
mm v[88:91],a[236:239],v[124:127],v[88:91]
tr a[228:229],v10,45056
v_mul_f32 v31, s52, v31
mm v[92:95],a[236:239],v[128:131],0
tr a[230:231],v10,47104
buffer_load_dwordx4 v4, s[16:19], s50 offen offset:3072 lds
mm v[92:95],a[232:235],v[116:119],v[92:95]
cv v16,v16,v17
cv v17,v18,v19
mm v[96:99],a[232:235],v[120:123],0
tr a[232:233],v9,41472
s_lshl_b32 s62, s53, 7
mm v[96:99],a[236:239],v[132:135],v[96:99]
tr a[234:235],v9,43520
s_add_u32 m0, s44, 0
mm v[108:111],a[244:247],v[132:135],0
buffer_load_dwordx4 v1, s[16:19], s51 offen offset:0 lds
tr a[236:237],v9,45568
mm v[108:111],a[240:243],v[120:123],v[108:111]
tr a[238:239],v9,47616
cv v28,v28,v29
mm v[104:107],a[240:243],v[116:119],0
buffer_load_dwordx4 v2, s[16:19], s51 offen offset:1024 lds
cv v29,v30,v31
mm v[104:107],a[244:247],v[128:131],v[104:107]
v_permlane16_swap_b32 v16, v28
mm v[100:103],a[244:247],v[124:127],0
s_waitcnt lgkmcnt(4)
s_lshl_b32 s56, s40, 3
mm v[100:103],a[240:243],v[112:115],v[100:103]
tr a[240:241],v10,41472
s_add_u32 s56, s56, s53
mm v[64:67],a[216:219],v[136:139],v[64:67]
tr a[242:243],v10,43520
buffer_load_dwordx4 v3, s[16:19], s51 offen offset:2048 lds
mm v[64:67],a[220:223],v[148:151],v[64:67]
tr a[244:245],v10,45568
s_lshl_b32 s53, s56, 2
mm v[68:71],a[220:223],v[152:155],v[68:71]
tr a[246:247],v10,47616
mm v[68:71],a[216:219],v[140:143],v[68:71]
buffer_load_dwordx4 v4, s[16:19], s51 offen offset:3072 lds
mm v[72:75],a[216:219],v[144:147],v[72:75]
tr a[216:217],v9,49152
mm v[72:75],a[220:223],v[156:159],v[72:75]
tr a[218:219],v9,51200
mm v[84:87],a[228:231],v[156:159],v[84:87]
tr a[220:221],v9,53248
mm v[84:87],a[224:227],v[144:147],v[84:87]
tr a[222:223],v9,55296
s_add_u32 s53, s53, s42
mm v[80:83],a[224:227],v[140:143],v[80:83]
v_permlane16_swap_b32 v17, v29
mm v[80:83],a[228:231],v[152:155],v[80:83]
v_accvgpr_write_b32 a96, v16
v_accvgpr_write_b32 a97, v17
mm v[76:79],a[228:231],v[148:151],v[76:79]
s_waitcnt lgkmcnt(4)
v_accvgpr_write_b32 a98, v28
mm v[76:79],a[224:227],v[136:139],v[76:79]
tr a[224:225],v10,49152
v_accvgpr_write_b32 a99, v29
mm v[88:91],a[232:235],v[136:139],v[88:91]
tr a[226:227],v10,51200
v_mul_f32 v20, s52, v20
mm v[88:91],a[236:239],v[148:151],v[88:91]
tr a[228:229],v10,53248
v_mul_f32 v21, s52, v21
mm v[92:95],a[236:239],v[152:155],v[92:95]
tr a[230:231],v10,55296
v_mul_f32 v22, s52, v22
mm v[92:95],a[232:235],v[140:143],v[92:95]
v_mul_f32 v23, s52, v23
v_mul_f32 v32, s52, v32
mm v[96:99],a[232:235],v[144:147],v[96:99]
tr a[232:233],v9,49664
v_mul_f32 v33, s52, v33
mm v[96:99],a[236:239],v[156:159],v[96:99]
tr a[234:235],v9,51712
v_mul_f32 v34, s52, v34
mm v[108:111],a[244:247],v[156:159],v[108:111]
tr a[236:237],v9,53760
v_mul_f32 v35, s52, v35
mm v[108:111],a[240:243],v[144:147],v[108:111]
tr a[238:239],v9,55808
cv v20,v20,v21
mm v[104:107],a[240:243],v[140:143],v[104:107]
cv v21,v22,v23
cv v32,v32,v33
mm v[104:107],a[244:247],v[152:155],v[104:107]
cv v33,v34,v35
s_lshl_b32 s53, s53, 7
mm v[100:103],a[244:247],v[148:151],v[100:103]
s_waitcnt lgkmcnt(4)
s_add_u32 s86, s53, 8
mm v[100:103],a[240:243],v[136:139],v[100:103]
tr a[240:241],v10,49664
mm v[64:67],a[216:219],v[160:163],v[64:67]
tr a[242:243],v10,51712
mm v[64:67],a[220:223],v[172:175],v[64:67]
tr a[244:245],v10,53760
s_mul_i32 s56, s56, 24576
mm v[68:71],a[220:223],v[176:179],v[68:71]
tr a[246:247],v10,55808
mm v[68:71],a[216:219],v[164:167],v[68:71]
v_permlane16_swap_b32 v20, v32
mm v[72:75],a[216:219],v[168:171],v[72:75]
tr a[216:217],v9,57344
mm v[72:75],a[220:223],v[180:183],v[72:75]
tr a[218:219],v9,59392
mm v[84:87],a[228:231],v[180:183],v[84:87]
tr a[220:221],v9,61440
mm v[84:87],a[224:227],v[168:171],v[84:87]
tr a[222:223],v9,63488
s_add_u32 s56, s56, s55
mm v[80:83],a[224:227],v[164:167],v[80:83]
v_permlane16_swap_b32 v21, v33
mm v[80:83],a[228:231],v[176:179],v[80:83]
v_accvgpr_write_b32 a100, v20
v_accvgpr_write_b32 a101, v21
mm v[76:79],a[228:231],v[172:175],v[76:79]
s_waitcnt lgkmcnt(4)
v_accvgpr_write_b32 a102, v32
mm v[76:79],a[224:227],v[160:163],v[76:79]
tr a[224:225],v10,57344
v_accvgpr_write_b32 a103, v33
mm v[88:91],a[232:235],v[160:163],v[88:91]
tr a[226:227],v10,59392
v_mul_f32 v24, s52, v24
mm v[88:91],a[236:239],v[172:175],v[88:91]
tr a[228:229],v10,61440
v_mul_f32 v25, s52, v25
mm v[92:95],a[236:239],v[176:179],v[92:95]
tr a[230:231],v10,63488
v_mul_f32 v26, s52, v26
mm v[92:95],a[232:235],v[164:167],v[92:95]
s_add_u32 m0, s44, 65536
v_mul_f32 v27, s52, v27
mm v[96:99],a[232:235],v[168:171],v[96:99]
buffer_load_dwordx4 v5, s[12:15], s45 offen offset:0 nt lds
tr a[232:233],v9,57856
mm v[96:99],a[236:239],v[180:183],v[96:99]
tr a[234:235],v9,59904
v_mul_f32 v36, s52, v36
mm v[108:111],a[244:247],v[180:183],v[108:111]
tr a[236:237],v9,61952
v_mul_f32 v37, s52, v37
mm v[108:111],a[240:243],v[168:171],v[108:111]
tr a[238:239],v9,64000
v_mul_f32 v38, s52, v38
mm v[104:107],a[240:243],v[164:167],v[104:107]
v_mul_f32 v39, s52, v39
cv v24,v24,v25
mm v[104:107],a[244:247],v[176:179],v[104:107]
cv v25,v26,v27
cv v36,v36,v37
mm v[100:103],a[244:247],v[172:175],v[100:103]
s_waitcnt vmcnt(14)
s_waitcnt lgkmcnt(4)
mm v[100:103],a[240:243],v[160:163],v[100:103]
buffer_load_dwordx4 v6, s[12:15], s45 offen offset:1024 nt lds
tr a[240:241],v10,57856
mm v[64:67],a[216:219],v[184:187],v[64:67]
s_barrier
tr a[242:243],v10,59904
mm v[64:67],a[220:223],v[196:199],v[64:67]
tr a[244:245],v10,61952
cv v37,v38,v39
mm v[68:71],a[220:223],v[200:203],v[68:71]
tr a[246:247],v10,64000
v_add_u32 v9, 131072, v9
mm v[68:71],a[216:219],v[188:191],v[68:71]
v_add_u32 v10, 131072, v10
s_add_u32 s70, s56, 12582912
mm v[72:75],a[216:219],v[192:195],v[72:75]
tr a[216:217],v9,0
s_add_u32 s53, s41, 4
mm v[72:75],a[220:223],v[204:207],v[72:75]
L_pg5:
s_cbranch_execz L_pg9
tr a[218:219],v9,2048
s_and_b32 s53, s53, 7
mm v[84:87],a[228:231],v[204:207],v[84:87]
buffer_load_dwordx4 v7, s[12:15], s45 offen offset:2048 nt lds
tr a[220:221],v9,4096
mm v[84:87],a[224:227],v[192:195],v[84:87]
tr a[222:223],v9,6144
s_lshl_b32 s63, s53, 7
mm v[80:83],a[224:227],v[188:191],v[80:83]
v_permlane16_swap_b32 v24, v36
mm v[80:83],a[228:231],v[200:203],v[80:83]
v_permlane16_swap_b32 v25, v37
mm v[76:79],a[228:231],v[196:199],v[76:79]
s_waitcnt lgkmcnt(4)
v_accvgpr_write_b32 a104, v24
mm v[76:79],a[224:227],v[184:187],v[76:79]
tr a[224:225],v10,0
v_accvgpr_write_b32 a105, v25
mm v[88:91],a[232:235],v[184:187],v[88:91]
tr a[226:227],v10,2048
v_accvgpr_write_b32 a106, v36
mm v[88:91],a[236:239],v[196:199],v[88:91]
tr a[228:229],v10,4096
buffer_load_dwordx4 v8, s[12:15], s45 offen offset:3072 nt lds
mm v[92:95],a[236:239],v[200:203],v[92:95]
tr a[230:231],v10,6144
v_accvgpr_write_b32 a107, v37
mm v[92:95],a[232:235],v[188:191],v[92:95]
v_mul_f32 v40, s52, v40
v_mul_f32 v41, s52, v41
mm v[96:99],a[232:235],v[192:195],v[96:99]
tr a[232:233],v9,512
v_mul_f32 v42, s52, v42
mm v[96:99],a[236:239],v[204:207],v[96:99]
tr a[234:235],v9,2560
v_mul_f32 v43, s52, v43
mm v[108:111],a[244:247],v[204:207],v[108:111]
tr a[236:237],v9,4608
v_mul_f32 v52, s52, v52
mm v[108:111],a[240:243],v[192:195],v[108:111]
tr a[238:239],v9,6656
v_mul_f32 v53, s52, v53
mm v[104:107],a[240:243],v[188:191],v[104:107]
v_mul_f32 v54, s52, v54
v_mul_f32 v55, s52, v55
mm v[104:107],a[244:247],v[200:203],v[104:107]
cv v40,v40,v41
cv v41,v42,v43
mm v[100:103],a[244:247],v[196:199],v[100:103]
s_waitcnt lgkmcnt(4)
cv v52,v52,v53
mm v[100:103],a[240:243],v[184:187],v[100:103]
tr a[240:241],v10,512
cv v53,v54,v55
mm v[64:67],a[216:219],v[208:211],v[64:67]
tr a[242:243],v10,2560
s_lshl_b32 s56, s40, 3
mm v[64:67],a[220:223],v[220:223],v[64:67]
s_barrier
tr a[244:245],v10,4608
mm v[68:71],a[220:223],v[224:227],v[68:71]
tr a[246:247],v10,6656
s_add_u32 s56, s56, s53
mm v[68:71],a[216:219],v[212:215],v[68:71]
s_add_u32 s50, s96, 768
s_add_u32 s51, s97, 768
mm v[72:75],a[216:219],v[216:219],v[72:75]
s_add_u32 m0, s43, 32768
tr a[216:217],v9,8192
mm v[72:75],a[220:223],v[228:231],v[72:75]
buffer_load_dwordx4 v1, s[16:19], s50 offen offset:0 lds
tr a[218:219],v9,10240
mm v[84:87],a[228:231],v[228:231],v[84:87]
tr a[220:221],v9,12288
s_lshl_b32 s53, s56, 2
mm v[84:87],a[224:227],v[216:219],v[84:87]
tr a[222:223],v9,14336
buffer_load_dwordx4 v2, s[16:19], s50 offen offset:1024 lds
mm v[80:83],a[224:227],v[212:215],v[80:83]
v_permlane16_swap_b32 v40, v52
mm v[80:83],a[228:231],v[224:227],v[80:83]
v_permlane16_swap_b32 v41, v53
mm v[76:79],a[228:231],v[220:223],v[76:79]
s_waitcnt lgkmcnt(4)
buffer_load_dwordx4 v3, s[16:19], s50 offen offset:2048 lds
mm v[76:79],a[224:227],v[208:211],v[76:79]
tr a[224:225],v10,8192
v_accvgpr_write_b32 a108, v40
mm v[88:91],a[232:235],v[208:211],v[88:91]
tr a[226:227],v10,10240
v_accvgpr_write_b32 a109, v41
mm v[88:91],a[236:239],v[220:223],v[88:91]
tr a[228:229],v10,12288
v_accvgpr_write_b32 a110, v52
mm v[92:95],a[236:239],v[224:227],v[92:95]
tr a[230:231],v10,14336
buffer_load_dwordx4 v4, s[16:19], s50 offen offset:3072 lds
mm v[92:95],a[232:235],v[212:215],v[92:95]
v_accvgpr_write_b32 a111, v53
v_mul_f32 v44, s52, v44
mm v[96:99],a[232:235],v[216:219],v[96:99]
tr a[232:233],v9,8704
v_mul_f32 v45, s52, v45
mm v[96:99],a[236:239],v[228:231],v[96:99]
tr a[234:235],v9,10752
s_add_u32 m0, s44, 32768
mm v[108:111],a[244:247],v[228:231],v[108:111]
buffer_load_dwordx4 v1, s[16:19], s51 offen offset:0 lds
tr a[236:237],v9,12800
mm v[108:111],a[240:243],v[216:219],v[108:111]
tr a[238:239],v9,14848
v_mul_f32 v46, s52, v46
mm v[104:107],a[240:243],v[212:215],v[104:107]
buffer_load_dwordx4 v2, s[16:19], s51 offen offset:1024 lds
v_mul_f32 v47, s52, v47
mm v[104:107],a[244:247],v[224:227],v[104:107]
v_mul_f32 v56, s52, v56
v_mul_f32 v57, s52, v57
mm v[100:103],a[244:247],v[220:223],v[100:103]
s_waitcnt lgkmcnt(4)
v_mul_f32 v58, s52, v58
mm v[100:103],a[240:243],v[208:211],v[100:103]
tr a[240:241],v10,8704
v_mul_f32 v59, s52, v59
mm v[64:67],a[216:219],v[232:235],v[64:67]
tr a[242:243],v10,10752
buffer_load_dwordx4 v3, s[16:19], s51 offen offset:2048 lds
mm v[64:67],a[220:223],v[244:247],v[64:67]
tr a[244:245],v10,12800
cv v44,v44,v45
mm v[68:71],a[220:223],v[248:251],v[68:71]
tr a[246:247],v10,14848
cv v45,v46,v47
mm v[68:71],a[216:219],v[236:239],v[68:71]
buffer_load_dwordx4 v4, s[16:19], s51 offen offset:3072 lds
cv v56,v56,v57
mm v[72:75],a[216:219],v[240:243],v[72:75]
tr a[216:217],v9,16384
cv v57,v58,v59
mm v[72:75],a[220:223],v[252:255],v[72:75]
tr a[218:219],v9,18432
s_add_u32 s53, s53, s42
mm v[84:87],a[228:231],v[252:255],v[84:87]
tr a[220:221],v9,20480
s_lshl_b32 s53, s53, 7
mm v[84:87],a[224:227],v[240:243],v[84:87]
tr a[222:223],v9,22528
s_add_u32 s87, s53, 12
mm v[80:83],a[224:227],v[236:239],v[80:83]
v_permlane16_swap_b32 v44, v56
mm v[80:83],a[228:231],v[248:251],v[80:83]
v_permlane16_swap_b32 v45, v57
mm v[76:79],a[228:231],v[244:247],v[76:79]
s_waitcnt lgkmcnt(4)
v_accvgpr_write_b32 a112, v44
mm v[76:79],a[224:227],v[232:235],v[76:79]
tr a[224:225],v10,16384
v_accvgpr_write_b32 a113, v45
mm v[88:91],a[232:235],v[232:235],v[88:91]
tr a[226:227],v10,18432
v_accvgpr_write_b32 a114, v56
mm v[88:91],a[236:239],v[244:247],v[88:91]
tr a[228:229],v10,20480
v_accvgpr_write_b32 a115, v57
mm v[92:95],a[236:239],v[248:251],v[92:95]
tr a[230:231],v10,22528
v_mul_f32 v48, s52, v48
mm v[92:95],a[232:235],v[236:239],v[92:95]
v_mul_f32 v49, s52, v49
v_mul_f32 v50, s52, v50
mm v[96:99],a[232:235],v[240:243],v[96:99]
tr a[232:233],v9,16896
v_mul_f32 v51, s52, v51
mm v[96:99],a[236:239],v[252:255],v[96:99]
tr a[234:235],v9,18944
v_mul_f32 v60, s52, v60
mm v[108:111],a[244:247],v[252:255],v[108:111]
tr a[236:237],v9,20992
v_mul_f32 v61, s52, v61
mm v[108:111],a[240:243],v[240:243],v[108:111]
tr a[238:239],v9,23040
v_mul_f32 v62, s52, v62
mm v[104:107],a[240:243],v[236:239],v[104:107]
v_mul_f32 v63, s52, v63
cv v48,v48,v49
mm v[104:107],a[244:247],v[248:251],v[104:107]
cv v49,v50,v51
cv v60,v60,v61
mm v[100:103],a[244:247],v[244:247],v[100:103]
s_waitcnt lgkmcnt(4)
cv v61,v62,v63
mm v[100:103],a[240:243],v[232:235],v[100:103]
tr a[240:241],v10,16896
s_mul_i32 s56, s56, 24576
mm v[64:67],a[216:219],a[168:171],v[64:67]
tr a[242:243],v10,18944
s_add_u32 s56, s56, s55
mm v[64:67],a[220:223],a[180:183],v[64:67]
tr a[244:245],v10,20992
s_add_u32 s71, s56, 18874368
mm v[68:71],a[220:223],a[184:187],v[68:71]
tr a[246:247],v10,23040
s_add_u32 s53, s41, 5
mm v[68:71],a[216:219],a[172:175],v[68:71]
v_permlane16_swap_b32 v48, v60
mm v[72:75],a[216:219],a[176:179],v[72:75]
tr a[216:217],v9,24576
s_and_b32 s53, s53, 7
mm v[72:75],a[220:223],a[188:191],v[72:75]
tr a[218:219],v9,26624
mm v[84:87],a[228:231],a[188:191],v[84:87]
tr a[220:221],v9,28672
s_lshl_b32 s64, s53, 7
mm v[84:87],a[224:227],a[176:179],v[84:87]
tr a[222:223],v9,30720
mm v[80:83],a[224:227],a[172:175],v[80:83]
v_permlane16_swap_b32 v49, v61
mm v[80:83],a[228:231],a[184:187],v[80:83]
v_accvgpr_write_b32 a116, v48
v_accvgpr_write_b32 a117, v49
mm v[76:79],a[228:231],a[180:183],v[76:79]
s_waitcnt lgkmcnt(4)
v_accvgpr_write_b32 a118, v60
mm v[76:79],a[224:227],a[168:171],v[76:79]
tr a[224:225],v10,24576
v_accvgpr_write_b32 a119, v61
mm v[88:91],a[232:235],a[168:171],v[88:91]
tr a[226:227],v10,26624
s_lshl_b32 s56, s40, 3
mm v[88:91],a[236:239],a[180:183],v[88:91]
tr a[228:229],v10,28672
mm v[92:95],a[236:239],a[184:187],v[92:95]
tr a[230:231],v10,30720
s_add_u32 s45, s45, 16384
mm v[92:95],a[232:235],a[172:175],v[92:95]
s_add_u32 m0, s43, 98304
mm v[96:99],a[232:235],a[176:179],v[96:99]
buffer_load_dwordx4 v5, s[8:11], s45 offen offset:0 nt lds
tr a[232:233],v9,25088
mm v[96:99],a[236:239],a[188:191],v[96:99]
tr a[234:235],v9,27136
mm v[108:111],a[244:247],a[188:191],v[108:111]
tr a[236:237],v9,29184
s_add_u32 s56, s56, s53
mm v[108:111],a[240:243],a[176:179],v[108:111]
tr a[238:239],v9,31232
s_mul_i32 s48, s41, 3
mm v[104:107],a[240:243],a[172:175],v[104:107]
mm v[104:107],a[244:247],a[184:187],v[104:107]
s_lshr_b32 s48, s48, 3
mm v[100:103],a[244:247],a[180:183],v[100:103]
s_waitcnt vmcnt(13)
s_waitcnt lgkmcnt(4)
mm v[100:103],a[240:243],a[168:171],v[100:103]
buffer_load_dwordx4 v6, s[8:11], s45 offen offset:1024 nt lds
tr a[240:241],v10,25088
mm v[64:67],a[216:219],a[192:195],v[64:67]
s_barrier
tr a[242:243],v10,27136
mm v[64:67],a[220:223],a[204:207],v[64:67]
tr a[244:245],v10,29184
s_xor_b32 s48, s48, 2
mm v[68:71],a[220:223],a[208:211],v[68:71]
tr a[246:247],v10,31232
v_add_u32 v9, 4294836224, v9
mm v[68:71],a[216:219],a[196:199],v[68:71]
v_add_u32 v10, 4294836224, v10
s_or_b32 s48, s48, s42
mm v[72:75],a[216:219],a[200:203],v[72:75]
tr a[216:217],v9,0
v_or_b32 v16, s48, v0
mm v[72:75],a[220:223],a[212:215],v[72:75]
tr a[218:219],v9,2048
s_lshl_b32 s49, 1, s41
mm v[84:87],a[228:231],a[212:215],v[84:87]
buffer_load_dwordx4 v7, s[8:11], s45 offen offset:2048 nt lds
tr a[220:221],v9,4096
mm v[84:87],a[224:227],a[200:203],v[84:87]
tr a[222:223],v9,6144
v_cmp_eq_u32 vcc, 0, v16
mm v[80:83],a[224:227],a[196:199],v[80:83]
s_lshl_b32 s53, s56, 2
s_add_u32 s53, s53, s42
mm v[80:83],a[228:231],a[208:211],v[80:83]
v_mov_b32 v17, s49
mm v[76:79],a[228:231],a[204:207],v[76:79]
s_waitcnt lgkmcnt(4)
mm v[76:79],a[224:227],a[192:195],v[76:79]
tr a[224:225],v10,0
v_mov_b32 v16, 0x7fff0000
mm v[88:91],a[232:235],a[192:195],v[88:91]
tr a[226:227],v10,2048
s_lshl_b32 s53, s53, 7
mm v[88:91],a[236:239],a[204:207],v[88:91]
tr a[228:229],v10,4096
buffer_load_dwordx4 v8, s[8:11], s45 offen offset:3072 nt lds
mm v[92:95],a[236:239],a[208:211],v[92:95]
tr a[230:231],v10,6144
s_lshl_b32 s49, s40, 3
mm v[92:95],a[232:235],a[196:199],v[92:95]
v_cndmask_b32_e64 v16, v16, 0, vcc
mm v[96:99],a[232:235],a[200:203],v[96:99]
tr a[232:233],v9,512
mm v[96:99],a[236:239],a[212:215],v[96:99]
buffer_atomic_or v17, v16, s[32:35], s49 offen offset:4
tr a[234:235],v9,2560
mm v[108:111],a[244:247],a[212:215],v[108:111]
tr a[236:237],v9,4608
s_add_u32 s88, s53, 16
mm v[108:111],a[240:243],a[200:203],v[108:111]
tr a[238:239],v9,6656
mm v[104:107],a[240:243],a[196:199],v[104:107]
mm v[104:107],a[244:247],a[208:211],v[104:107]
mm v[100:103],a[244:247],a[204:207],v[100:103]
s_waitcnt lgkmcnt(4)
mm v[100:103],a[240:243],a[192:195],v[100:103]
tr a[240:241],v10,512
s_mul_i32 s56, s56, 24576
mm v[16:19],a[216:219],v[112:115],0
tr a[242:243],v10,2560
mm v[16:19],a[220:223],v[124:127],v[16:19]
s_barrier
tr a[244:245],v10,4608
mm v[20:23],a[220:223],v[128:131],0
tr a[246:247],v10,6656
mm v[20:23],a[216:219],v[116:119],v[20:23]
s_add_u32 s50, s94, 896
s_add_u32 s51, s95, 896
mm v[24:27],a[216:219],v[120:123],0
s_add_u32 m0, s43, 131072
tr a[216:217],v9,8192
mm v[24:27],a[220:223],v[132:135],v[24:27]
buffer_load_dwordx4 v1, s[16:19], s50 offen offset:0 lds
tr a[218:219],v9,10240
mm v[36:39],a[228:231],v[132:135],0
tr a[220:221],v9,12288
s_add_u32 s56, s56, s55
mm v[36:39],a[224:227],v[120:123],v[36:39]
tr a[222:223],v9,14336
buffer_load_dwordx4 v2, s[16:19], s50 offen offset:1024 lds
mm v[32:35],a[224:227],v[116:119],0
v_mul_f32 v64, s52, v64
v_mul_f32 v65, s52, v65
mm v[32:35],a[228:231],v[128:131],v[32:35]
v_mul_f32 v66, s52, v66
v_mul_f32 v67, s52, v67
mm v[28:31],a[228:231],v[124:127],0
s_waitcnt lgkmcnt(4)
buffer_load_dwordx4 v3, s[16:19], s50 offen offset:2048 lds
mm v[28:31],a[224:227],v[112:115],v[28:31]
tr a[224:225],v10,8192
s_add_u32 s72, s56, 25165824
mm v[40:43],a[232:235],v[112:115],0
tr a[226:227],v10,10240
v_mul_f32 v76, s52, v76
mm v[40:43],a[236:239],v[124:127],v[40:43]
tr a[228:229],v10,12288
v_mul_f32 v77, s52, v77
mm v[44:47],a[236:239],v[128:131],0
tr a[230:231],v10,14336
buffer_load_dwordx4 v4, s[16:19], s50 offen offset:3072 lds
mm v[44:47],a[232:235],v[116:119],v[44:47]
v_mul_f32 v78, s52, v78
v_mul_f32 v79, s52, v79
mm v[48:51],a[232:235],v[120:123],0
tr a[232:233],v9,8704
cv v64,v64,v65
mm v[48:51],a[236:239],v[132:135],v[48:51]
tr a[234:235],v9,10752
s_add_u32 m0, s44, 131072
mm v[60:63],a[244:247],v[132:135],0
buffer_load_dwordx4 v1, s[16:19], s51 offen offset:0 lds
tr a[236:237],v9,12800
mm v[60:63],a[240:243],v[120:123],v[60:63]
tr a[238:239],v9,14848
s_add_u32 s53, s41, 6
mm v[56:59],a[240:243],v[116:119],0
buffer_load_dwordx4 v2, s[16:19], s51 offen offset:1024 lds
cv v65,v66,v67
mm v[56:59],a[244:247],v[128:131],v[56:59]
cv v76,v76,v77
cv v77,v78,v79
mm v[52:55],a[244:247],v[124:127],0
s_waitcnt lgkmcnt(4)
mm v[52:55],a[240:243],v[112:115],v[52:55]
tr a[240:241],v10,8704
s_and_b32 s53, s53, 7
mm v[16:19],a[216:219],v[136:139],v[16:19]
tr a[242:243],v10,10752
buffer_load_dwordx4 v3, s[16:19], s51 offen offset:2048 lds
mm v[16:19],a[220:223],v[148:151],v[16:19]
tr a[244:245],v10,12800
mm v[20:23],a[220:223],v[152:155],v[20:23]
tr a[246:247],v10,14848
mm v[20:23],a[216:219],v[140:143],v[20:23]
buffer_load_dwordx4 v4, s[16:19], s51 offen offset:3072 lds
mm v[24:27],a[216:219],v[144:147],v[24:27]
tr a[216:217],v9,16384
mm v[24:27],a[220:223],v[156:159],v[24:27]
tr a[218:219],v9,18432
s_lshl_b32 s65, s53, 7
mm v[36:39],a[228:231],v[156:159],v[36:39]
tr a[220:221],v9,20480
mm v[36:39],a[224:227],v[144:147],v[36:39]
tr a[222:223],v9,22528
mm v[32:35],a[224:227],v[140:143],v[32:35]
v_permlane16_swap_b32 v64, v76
mm v[32:35],a[228:231],v[152:155],v[32:35]
v_permlane16_swap_b32 v65, v77
mm v[28:31],a[228:231],v[148:151],v[28:31]
s_waitcnt lgkmcnt(4)
v_accvgpr_write_b32 a120, v64
mm v[28:31],a[224:227],v[136:139],v[28:31]
tr a[224:225],v10,16384
s_lshl_b32 s56, s40, 3
mm v[40:43],a[232:235],v[136:139],v[40:43]
tr a[226:227],v10,18432
v_accvgpr_write_b32 a121, v65
mm v[40:43],a[236:239],v[148:151],v[40:43]
tr a[228:229],v10,20480
v_accvgpr_write_b32 a122, v76
mm v[44:47],a[236:239],v[152:155],v[44:47]
tr a[230:231],v10,22528
v_accvgpr_write_b32 a123, v77
mm v[44:47],a[232:235],v[140:143],v[44:47]
v_mul_f32 v68, s52, v68
v_mul_f32 v69, s52, v69
mm v[48:51],a[232:235],v[144:147],v[48:51]
tr a[232:233],v9,16896
v_mul_f32 v70, s52, v70
mm v[48:51],a[236:239],v[156:159],v[48:51]
tr a[234:235],v9,18944
s_add_u32 s56, s56, s53
mm v[60:63],a[244:247],v[156:159],v[60:63]
tr a[236:237],v9,20992
v_mul_f32 v71, s52, v71
mm v[60:63],a[240:243],v[144:147],v[60:63]
tr a[238:239],v9,23040
v_mul_f32 v80, s52, v80
mm v[56:59],a[240:243],v[140:143],v[56:59]
v_mul_f32 v81, s52, v81
v_mul_f32 v82, s52, v82
mm v[56:59],a[244:247],v[152:155],v[56:59]
v_mul_f32 v83, s52, v83
cv v68,v68,v69
mm v[52:55],a[244:247],v[148:151],v[52:55]
s_waitcnt lgkmcnt(4)
cv v69,v70,v71
mm v[52:55],a[240:243],v[136:139],v[52:55]
tr a[240:241],v10,16896
s_lshl_b32 s53, s56, 2
mm v[16:19],a[216:219],v[160:163],v[16:19]
tr a[242:243],v10,18944
cv v80,v80,v81
mm v[16:19],a[220:223],v[172:175],v[16:19]
tr a[244:245],v10,20992
cv v81,v82,v83
mm v[20:23],a[220:223],v[176:179],v[20:23]
tr a[246:247],v10,23040
mm v[20:23],a[216:219],v[164:167],v[20:23]
v_permlane16_swap_b32 v68, v80
mm v[24:27],a[216:219],v[168:171],v[24:27]
tr a[216:217],v9,24576
mm v[24:27],a[220:223],v[180:183],v[24:27]
tr a[218:219],v9,26624
s_add_u32 s53, s53, s42
mm v[36:39],a[228:231],v[180:183],v[36:39]
tr a[220:221],v9,28672
mm v[36:39],a[224:227],v[168:171],v[36:39]
tr a[222:223],v9,30720
mm v[32:35],a[224:227],v[164:167],v[32:35]
v_permlane16_swap_b32 v69, v81
mm v[32:35],a[228:231],v[176:179],v[32:35]
v_accvgpr_write_b32 a124, v68
v_accvgpr_write_b32 a125, v69
mm v[28:31],a[228:231],v[172:175],v[28:31]
s_waitcnt lgkmcnt(4)
v_accvgpr_write_b32 a126, v80
mm v[28:31],a[224:227],v[160:163],v[28:31]
tr a[224:225],v10,24576
s_lshl_b32 s53, s53, 7
mm v[40:43],a[232:235],v[160:163],v[40:43]
tr a[226:227],v10,26624
v_accvgpr_write_b32 a127, v81
mm v[40:43],a[236:239],v[172:175],v[40:43]
tr a[228:229],v10,28672
v_mul_f32 v72, s52, v72
mm v[44:47],a[236:239],v[176:179],v[44:47]
tr a[230:231],v10,30720
v_mul_f32 v73, s52, v73
mm v[44:47],a[232:235],v[164:167],v[44:47]
s_add_u32 m0, s44, 98304
v_mul_f32 v74, s52, v74
mm v[48:51],a[232:235],v[168:171],v[48:51]
buffer_load_dwordx4 v5, s[12:15], s45 offen offset:0 nt lds
tr a[232:233],v9,25088
mm v[48:51],a[236:239],v[180:183],v[48:51]
tr a[234:235],v9,27136
s_add_u32 s89, s53, 20
mm v[60:63],a[244:247],v[180:183],v[60:63]
tr a[236:237],v9,29184
v_mul_f32 v75, s52, v75
mm v[60:63],a[240:243],v[168:171],v[60:63]
tr a[238:239],v9,31232
v_mul_f32 v84, s52, v84
mm v[56:59],a[240:243],v[164:167],v[56:59]
v_mul_f32 v85, s52, v85
v_mul_f32 v86, s52, v86
mm v[56:59],a[244:247],v[176:179],v[56:59]
v_mul_f32 v87, s52, v87
cv v72,v72,v73
mm v[52:55],a[244:247],v[172:175],v[52:55]
s_waitcnt vmcnt(14)
s_waitcnt lgkmcnt(4)
mm v[52:55],a[240:243],v[160:163],v[52:55]
buffer_load_dwordx4 v6, s[12:15], s45 offen offset:1024 nt lds
tr a[240:241],v10,25088
mm v[16:19],a[216:219],v[184:187],v[16:19]
s_barrier
tr a[242:243],v10,27136
mm v[16:19],a[220:223],v[196:199],v[16:19]
tr a[244:245],v10,29184
s_mul_i32 s56, s56, 24576
mm v[20:23],a[220:223],v[200:203],v[20:23]
tr a[246:247],v10,31232
cv v73,v74,v75
mm v[20:23],a[216:219],v[188:191],v[20:23]
cv v84,v84,v85
cv v85,v86,v87
mm v[24:27],a[216:219],v[192:195],v[24:27]
tr a[216:217],v9,32768
mm v[24:27],a[220:223],v[204:207],v[24:27]
tr a[218:219],v9,34816
s_add_u32 s56, s56, s55
mm v[36:39],a[228:231],v[204:207],v[36:39]
buffer_load_dwordx4 v7, s[12:15], s45 offen offset:2048 nt lds
tr a[220:221],v9,36864
mm v[36:39],a[224:227],v[192:195],v[36:39]
tr a[222:223],v9,38912
mm v[32:35],a[224:227],v[188:191],v[32:35]
v_permlane16_swap_b32 v72, v84
mm v[32:35],a[228:231],v[200:203],v[32:35]
v_permlane16_swap_b32 v73, v85
mm v[28:31],a[228:231],v[196:199],v[28:31]
s_waitcnt lgkmcnt(4)
v_accvgpr_write_b32 a128, v72
mm v[28:31],a[224:227],v[184:187],v[28:31]
tr a[224:225],v10,32768
s_add_u32 s73, s56, 31457280
mm v[40:43],a[232:235],v[184:187],v[40:43]
tr a[226:227],v10,34816
v_accvgpr_write_b32 a129, v73
mm v[40:43],a[236:239],v[196:199],v[40:43]
tr a[228:229],v10,36864
buffer_load_dwordx4 v8, s[12:15], s45 offen offset:3072 nt lds
mm v[44:47],a[236:239],v[200:203],v[44:47]
tr a[230:231],v10,38912
v_accvgpr_write_b32 a130, v84
mm v[44:47],a[232:235],v[188:191],v[44:47]
v_accvgpr_write_b32 a131, v85
v_mul_f32 v88, s52, v88
mm v[48:51],a[232:235],v[192:195],v[48:51]
tr a[232:233],v9,33280
s_add_u32 s53, s41, 7
mm v[48:51],a[236:239],v[204:207],v[48:51]
tr a[234:235],v9,35328
v_mul_f32 v89, s52, v89
mm v[60:63],a[244:247],v[204:207],v[60:63]
tr a[236:237],v9,37376
v_mul_f32 v90, s52, v90
mm v[60:63],a[240:243],v[192:195],v[60:63]
tr a[238:239],v9,39424
v_mul_f32 v91, s52, v91
mm v[56:59],a[240:243],v[188:191],v[56:59]
v_mul_f32 v100, s52, v100
v_mul_f32 v101, s52, v101
L_pg6:
s_cbranch_execz L_pg10
mm v[56:59],a[244:247],v[200:203],v[56:59]
v_mul_f32 v102, s52, v102
mm v[52:55],a[244:247],v[196:199],v[52:55]
s_waitcnt lgkmcnt(4)
s_and_b32 s53, s53, 7
mm v[52:55],a[240:243],v[184:187],v[52:55]
tr a[240:241],v10,33280
v_mul_f32 v103, s52, v103
mm v[16:19],a[216:219],v[208:211],v[16:19]
tr a[242:243],v10,35328
cv v88,v88,v89
mm v[16:19],a[220:223],v[220:223],v[16:19]
s_barrier
tr a[244:245],v10,37376
mm v[20:23],a[220:223],v[224:227],v[20:23]
tr a[246:247],v10,39424
cv v89,v90,v91
mm v[20:23],a[216:219],v[212:215],v[20:23]
s_add_u32 s50, s96, 896
s_add_u32 s51, s97, 896
mm v[24:27],a[216:219],v[216:219],v[24:27]
s_add_u32 m0, s43, 0
tr a[216:217],v9,40960
mm v[24:27],a[220:223],v[228:231],v[24:27]
buffer_load_dwordx4 v1, s[16:19], s50 offen offset:0 lds
tr a[218:219],v9,43008
mm v[36:39],a[228:231],v[228:231],v[36:39]
tr a[220:221],v9,45056
s_lshl_b32 s66, s53, 7
mm v[36:39],a[224:227],v[216:219],v[36:39]
tr a[222:223],v9,47104
buffer_load_dwordx4 v2, s[16:19], s50 offen offset:1024 lds
mm v[32:35],a[224:227],v[212:215],v[32:35]
cv v100,v100,v101
cv v101,v102,v103
mm v[32:35],a[228:231],v[224:227],v[32:35]
v_permlane16_swap_b32 v88, v100
mm v[28:31],a[228:231],v[220:223],v[28:31]
s_waitcnt lgkmcnt(4)
buffer_load_dwordx4 v3, s[16:19], s50 offen offset:2048 lds
mm v[28:31],a[224:227],v[208:211],v[28:31]
tr a[224:225],v10,40960
s_lshl_b32 s56, s40, 3
mm v[40:43],a[232:235],v[208:211],v[40:43]
tr a[226:227],v10,43008
mm v[40:43],a[236:239],v[220:223],v[40:43]
tr a[228:229],v10,45056
mm v[44:47],a[236:239],v[224:227],v[44:47]
tr a[230:231],v10,47104
buffer_load_dwordx4 v4, s[16:19], s50 offen offset:3072 lds
mm v[44:47],a[232:235],v[212:215],v[44:47]
v_permlane16_swap_b32 v89, v101
mm v[48:51],a[232:235],v[216:219],v[48:51]
tr a[232:233],v9,41472
s_add_u32 s56, s56, s53
mm v[48:51],a[236:239],v[228:231],v[48:51]
tr a[234:235],v9,43520
s_add_u32 m0, s44, 0
mm v[60:63],a[244:247],v[228:231],v[60:63]
buffer_load_dwordx4 v1, s[16:19], s51 offen offset:0 lds
tr a[236:237],v9,45568
mm v[60:63],a[240:243],v[216:219],v[60:63]
tr a[238:239],v9,47616
v_accvgpr_write_b32 a132, v88
mm v[56:59],a[240:243],v[212:215],v[56:59]
buffer_load_dwordx4 v2, s[16:19], s51 offen offset:1024 lds
v_accvgpr_write_b32 a133, v89
mm v[56:59],a[244:247],v[224:227],v[56:59]
v_accvgpr_write_b32 a134, v100
v_accvgpr_write_b32 a135, v101
mm v[52:55],a[244:247],v[220:223],v[52:55]
s_waitcnt lgkmcnt(4)
s_lshl_b32 s53, s56, 2
mm v[52:55],a[240:243],v[208:211],v[52:55]
tr a[240:241],v10,41472
v_mul_f32 v92, s52, v92
mm v[16:19],a[216:219],v[232:235],v[16:19]
tr a[242:243],v10,43520
buffer_load_dwordx4 v3, s[16:19], s51 offen offset:2048 lds
mm v[16:19],a[220:223],v[244:247],v[16:19]
tr a[244:245],v10,45568
v_mul_f32 v93, s52, v93
mm v[20:23],a[220:223],v[248:251],v[20:23]
tr a[246:247],v10,47616
v_mul_f32 v94, s52, v94
mm v[20:23],a[216:219],v[236:239],v[20:23]
buffer_load_dwordx4 v4, s[16:19], s51 offen offset:3072 lds
v_mul_f32 v95, s52, v95
mm v[24:27],a[216:219],v[240:243],v[24:27]
tr a[216:217],v9,49152
s_add_u32 s53, s53, s42
mm v[24:27],a[220:223],v[252:255],v[24:27]
tr a[218:219],v9,51200
v_mul_f32 v104, s52, v104
mm v[36:39],a[228:231],v[252:255],v[36:39]
tr a[220:221],v9,53248
v_mul_f32 v105, s52, v105
mm v[36:39],a[224:227],v[240:243],v[36:39]
tr a[222:223],v9,55296
v_mul_f32 v106, s52, v106
mm v[32:35],a[224:227],v[236:239],v[32:35]
v_mul_f32 v107, s52, v107
cv v92,v92,v93
mm v[32:35],a[228:231],v[248:251],v[32:35]
cv v93,v94,v95
cv v104,v104,v105
mm v[28:31],a[228:231],v[244:247],v[28:31]
s_waitcnt lgkmcnt(4)
s_lshl_b32 s53, s53, 7
mm v[28:31],a[224:227],v[232:235],v[28:31]
tr a[224:225],v10,49152
cv v105,v106,v107
mm v[40:43],a[232:235],v[232:235],v[40:43]
s_add_u32 s47, s46, 499712
tr a[226:227],v10,51200
mm v[40:43],a[236:239],v[244:247],v[40:43]
tr a[228:229],v10,53248
buffer_load_dword a249, v14, s[4:7], s47 offen
mm v[44:47],a[236:239],v[248:251],v[44:47]
tr a[230:231],v10,55296
mm v[44:47],a[232:235],v[236:239],v[44:47]
v_permlane16_swap_b32 v92, v104
mm v[48:51],a[232:235],v[240:243],v[48:51]
tr a[232:233],v9,49664
s_add_u32 s90, s53, 24
mm v[48:51],a[236:239],v[252:255],v[48:51]
tr a[234:235],v9,51712
mm v[60:63],a[244:247],v[252:255],v[60:63]
tr a[236:237],v9,53760
mm v[60:63],a[240:243],v[240:243],v[60:63]
tr a[238:239],v9,55808
mm v[56:59],a[240:243],v[236:239],v[56:59]
v_permlane16_swap_b32 v93, v105
mm v[56:59],a[244:247],v[248:251],v[56:59]
v_accvgpr_write_b32 a136, v92
v_accvgpr_write_b32 a137, v93
mm v[52:55],a[244:247],v[244:247],v[52:55]
s_waitcnt lgkmcnt(4)
s_mul_i32 s56, s56, 24576
mm v[52:55],a[240:243],v[232:235],v[52:55]
tr a[240:241],v10,49664
v_accvgpr_write_b32 a138, v104
mm v[16:19],a[216:219],a[168:171],v[16:19]
tr a[242:243],v10,51712
v_accvgpr_write_b32 a139, v105
mm v[16:19],a[220:223],a[180:183],v[16:19]
tr a[244:245],v10,53760
v_mul_f32 v96, s52, v96
mm v[20:23],a[220:223],a[184:187],v[20:23]
tr a[246:247],v10,55808
v_mul_f32 v97, s52, v97
mm v[20:23],a[216:219],a[172:175],v[20:23]
v_mul_f32 v98, s52, v98
v_mul_f32 v99, s52, v99
mm v[24:27],a[216:219],a[176:179],v[24:27]
tr a[216:217],v9,57344
s_add_u32 s56, s56, s55
mm v[24:27],a[220:223],a[188:191],v[24:27]
tr a[218:219],v9,59392
v_mul_f32 v108, s52, v108
mm v[36:39],a[228:231],a[188:191],v[36:39]
tr a[220:221],v9,61440
v_mul_f32 v109, s52, v109
mm v[36:39],a[224:227],a[176:179],v[36:39]
tr a[222:223],v9,63488
v_mul_f32 v110, s52, v110
mm v[32:35],a[224:227],a[172:175],v[32:35]
v_mul_f32 v111, s52, v111
cv v96,v96,v97
mm v[32:35],a[228:231],a[184:187],v[32:35]
cv v97,v98,v99
cv v108,v108,v109
mm v[28:31],a[228:231],a[180:183],v[28:31]
s_waitcnt lgkmcnt(4)
s_add_u32 s74, s56, 37748736
mm v[28:31],a[224:227],a[168:171],v[28:31]
tr a[224:225],v10,57344
cv v109,v110,v111
mm v[40:43],a[232:235],a[168:171],v[40:43]
tr a[226:227],v10,59392
mm v[40:43],a[236:239],a[180:183],v[40:43]
tr a[228:229],v10,61440
mm v[44:47],a[236:239],a[184:187],v[44:47]
tr a[230:231],v10,63488
mm v[44:47],a[232:235],a[172:175],v[44:47]
v_permlane16_swap_b32 v96, v108
mm v[48:51],a[232:235],a[176:179],v[48:51]
tr a[232:233],v9,57856
s_add_u32 s53, s41, 8
mm v[48:51],a[236:239],a[188:191],v[48:51]
tr a[234:235],v9,59904
mm v[60:63],a[244:247],a[188:191],v[60:63]
tr a[236:237],v9,61952
mm v[60:63],a[240:243],a[176:179],v[60:63]
tr a[238:239],v9,64000
mm v[56:59],a[240:243],a[172:175],v[56:59]
v_permlane16_swap_b32 v97, v109
mm v[56:59],a[244:247],a[184:187],v[56:59]
v_accvgpr_write_b32 a140, v96
v_accvgpr_write_b32 a141, v97
mm v[52:55],a[244:247],a[180:183],v[52:55]
s_waitcnt vmcnt(13)
s_waitcnt lgkmcnt(4)
mm v[52:55],a[240:243],a[168:171],v[52:55]
tr a[240:241],v10,57856
s_and_b32 s53, s53, 7
mm v[16:19],a[216:219],a[192:195],v[16:19]
s_barrier
tr a[242:243],v10,59904
mm v[16:19],a[220:223],a[204:207],v[16:19]
tr a[244:245],v10,61952
v_accvgpr_write_b32 a142, v108
mm v[20:23],a[220:223],a[208:211],v[20:23]
tr a[246:247],v10,64000
v_add_u32 v9, 131072, v9
mm v[20:23],a[216:219],a[196:199],v[20:23]
v_add_u32 v10, 131072, v10
v_accvgpr_write_b32 a143, v109
mm v[24:27],a[216:219],a[200:203],v[24:27]
tr a[216:217],v9,0
s_lshl_b32 s67, s53, 7
mm v[24:27],a[220:223],a[212:215],v[24:27]
tr a[218:219],v9,2048
mm v[36:39],a[228:231],a[212:215],v[36:39]
tr a[220:221],v9,4096
mm v[36:39],a[224:227],a[200:203],v[36:39]
tr a[222:223],v9,6144
mm v[32:35],a[224:227],a[196:199],v[32:35]
mm v[32:35],a[228:231],a[208:211],v[32:35]
mm v[28:31],a[228:231],a[204:207],v[28:31]
s_waitcnt lgkmcnt(4)
mm v[28:31],a[224:227],a[192:195],v[28:31]
tr a[224:225],v10,0
mm v[40:43],a[232:235],a[192:195],v[40:43]
tr a[226:227],v10,2048
mm v[40:43],a[236:239],a[204:207],v[40:43]
tr a[228:229],v10,4096
mm v[44:47],a[236:239],a[208:211],v[44:47]
tr a[230:231],v10,6144
mm v[44:47],a[232:235],a[196:199],v[44:47]
mm v[48:51],a[232:235],a[200:203],v[48:51]
tr a[232:233],v9,512
v_accvgpr_read_b32 v1, a248
mm v[48:51],a[236:239],a[212:215],v[48:51]
tr a[234:235],v9,2560
mm v[60:63],a[244:247],a[212:215],v[60:63]
tr a[236:237],v9,4608
mm v[60:63],a[240:243],a[200:203],v[60:63]
tr a[238:239],v9,6656
mm v[56:59],a[240:243],a[196:199],v[56:59]
mm v[56:59],a[244:247],a[208:211],v[56:59]
v_add_u32 v2, 7168, v1
mm v[52:55],a[244:247],a[204:207],v[52:55]
s_waitcnt lgkmcnt(4)
mm v[52:55],a[240:243],a[192:195],v[52:55]
tr a[240:241],v10,512
mm v[64:67],a[216:219],v[112:115],0
tr a[242:243],v10,2560
mm v[64:67],a[220:223],v[124:127],v[64:67]
s_barrier
tr a[244:245],v10,4608
mm v[68:71],a[220:223],v[128:131],0
tr a[246:247],v10,6656
v_add_u32 v3, 14336, v1
mm v[68:71],a[216:219],v[116:119],v[68:71]
mm v[72:75],a[216:219],v[120:123],0
s_add_u32 s45, s45, 16384
tr a[216:217],v9,8192
mm v[72:75],a[220:223],v[132:135],v[72:75]
s_add_u32 m0, s43, 32768
s_waitcnt vmcnt(12)
mm v[84:87],a[228:231],v[132:135],0
tr a[218:219],v9,10240
buffer_load_dwordx4 v5, s[8:11], s45 offen offset:0 nt lds
mm v[84:87],a[224:227],v[120:123],v[84:87]
tr a[220:221],v9,12288
v_add_u32 v4, 21504, v1
mm v[80:83],a[224:227],v[116:119],0
tr a[222:223],v9,14336
v_mul_f32 v16, s52, v16
mm v[80:83],a[228:231],v[128:131],v[80:83]
v_mul_f32 v17, s52, v17
v_mul_f32 v18, s52, v18
mm v[76:79],a[228:231],v[124:127],0
s_waitcnt lgkmcnt(4)
v_mul_f32 v19, s52, v19
mm v[76:79],a[224:227],v[112:115],v[76:79]
tr a[224:225],v10,8192
v_mul_f32 v28, s52, v28
mm v[88:91],a[232:235],v[112:115],0
tr a[226:227],v10,10240
v_mul_f32 v29, s52, v29
mm v[88:91],a[236:239],v[124:127],v[88:91]
tr a[228:229],v10,12288
v_mul_f32 v30, s52, v30
mm v[92:95],a[236:239],v[128:131],0
tr a[230:231],v10,14336
v_mul_f32 v31, s52, v31
mm v[92:95],a[232:235],v[116:119],v[92:95]
cv v16,v16,v17
mm v[96:99],a[232:235],v[120:123],0
tr a[232:233],v9,8704
mm v[96:99],a[236:239],v[132:135],v[96:99]
tr a[234:235],v9,10752
cv v17,v18,v19
mm v[108:111],a[244:247],v[132:135],0
tr a[236:237],v9,12800
cv v28,v28,v29
mm v[108:111],a[240:243],v[120:123],v[108:111]
tr a[238:239],v9,14848
mm v[104:107],a[240:243],v[116:119],0
cv v29,v30,v31
mm v[104:107],a[244:247],v[128:131],v[104:107]
s_waitcnt vmcnt(12)
mm v[100:103],a[244:247],v[124:127],0
s_waitcnt lgkmcnt(4)
buffer_load_dwordx4 v6, s[8:11], s45 offen offset:1024 nt lds
mm v[100:103],a[240:243],v[112:115],v[100:103]
tr a[240:241],v10,8704
mm v[64:67],a[216:219],v[136:139],v[64:67]
tr a[242:243],v10,10752
mm v[64:67],a[220:223],v[148:151],v[64:67]
tr a[244:245],v10,12800
mm v[68:71],a[220:223],v[152:155],v[68:71]
tr a[246:247],v10,14848
mm v[68:71],a[216:219],v[140:143],v[68:71]
v_permlane16_swap_b32 v16, v28
mm v[72:75],a[216:219],v[144:147],v[72:75]
tr a[216:217],v9,16384
mm v[72:75],a[220:223],v[156:159],v[72:75]
tr a[218:219],v9,18432
mm v[84:87],a[228:231],v[156:159],v[84:87]
tr a[220:221],v9,20480
mm v[84:87],a[224:227],v[144:147],v[84:87]
tr a[222:223],v9,22528
mm v[80:83],a[224:227],v[140:143],v[80:83]
v_permlane16_swap_b32 v17, v29
mm v[80:83],a[228:231],v[152:155],v[80:83]
v_accvgpr_write_b32 a144, v16
v_accvgpr_write_b32 a145, v17
mm v[76:79],a[228:231],v[148:151],v[76:79]
s_waitcnt lgkmcnt(4)
v_accvgpr_write_b32 a146, v28
mm v[76:79],a[224:227],v[136:139],v[76:79]
tr a[224:225],v10,16384
v_accvgpr_write_b32 a147, v29
mm v[88:91],a[232:235],v[136:139],v[88:91]
s_waitcnt vmcnt(12)
tr a[226:227],v10,18432
mm v[88:91],a[236:239],v[148:151],v[88:91]
tr a[228:229],v10,20480
buffer_load_dwordx4 v7, s[8:11], s45 offen offset:2048 nt lds
mm v[92:95],a[236:239],v[152:155],v[92:95]
tr a[230:231],v10,22528
v_mul_f32 v20, s52, v20
mm v[92:95],a[232:235],v[140:143],v[92:95]
v_mul_f32 v21, s52, v21
v_mul_f32 v22, s52, v22
mm v[96:99],a[232:235],v[144:147],v[96:99]
tr a[232:233],v9,16896
v_mul_f32 v23, s52, v23
mm v[96:99],a[236:239],v[156:159],v[96:99]
tr a[234:235],v9,18944
v_mul_f32 v32, s52, v32
mm v[108:111],a[244:247],v[156:159],v[108:111]
tr a[236:237],v9,20992
v_mul_f32 v33, s52, v33
mm v[108:111],a[240:243],v[144:147],v[108:111]
tr a[238:239],v9,23040
v_mul_f32 v34, s52, v34
mm v[104:107],a[240:243],v[140:143],v[104:107]
v_mul_f32 v35, s52, v35
cv v20,v20,v21
mm v[104:107],a[244:247],v[152:155],v[104:107]
cv v21,v22,v23
cv v32,v32,v33
mm v[100:103],a[244:247],v[148:151],v[100:103]
s_waitcnt lgkmcnt(4)
mm v[100:103],a[240:243],v[136:139],v[100:103]
tr a[240:241],v10,16896
cv v33,v34,v35
mm v[64:67],a[216:219],v[160:163],v[64:67]
tr a[242:243],v10,18944
mm v[64:67],a[220:223],v[172:175],v[64:67]
tr a[244:245],v10,20992
mm v[68:71],a[220:223],v[176:179],v[68:71]
tr a[246:247],v10,23040
mm v[68:71],a[216:219],v[164:167],v[68:71]
s_waitcnt vmcnt(12)
mm v[72:75],a[216:219],v[168:171],v[72:75]
buffer_load_dwordx4 v8, s[8:11], s45 offen offset:3072 nt lds
tr a[216:217],v9,24576
mm v[72:75],a[220:223],v[180:183],v[72:75]
tr a[218:219],v9,26624
mm v[84:87],a[228:231],v[180:183],v[84:87]
tr a[220:221],v9,28672
mm v[84:87],a[224:227],v[168:171],v[84:87]
tr a[222:223],v9,30720
mm v[80:83],a[224:227],v[164:167],v[80:83]
v_permlane16_swap_b32 v20, v32
mm v[80:83],a[228:231],v[176:179],v[80:83]
v_permlane16_swap_b32 v21, v33
mm v[76:79],a[228:231],v[172:175],v[76:79]
s_waitcnt lgkmcnt(4)
v_accvgpr_write_b32 a148, v20
mm v[76:79],a[224:227],v[160:163],v[76:79]
tr a[224:225],v10,24576
v_accvgpr_write_b32 a149, v21
mm v[88:91],a[232:235],v[160:163],v[88:91]
tr a[226:227],v10,26624
v_accvgpr_write_b32 a150, v32
mm v[88:91],a[236:239],v[172:175],v[88:91]
tr a[228:229],v10,28672
v_accvgpr_write_b32 a151, v33
mm v[92:95],a[236:239],v[176:179],v[92:95]
tr a[230:231],v10,30720
v_mul_f32 v24, s52, v24
mm v[92:95],a[232:235],v[164:167],v[92:95]
v_mul_f32 v25, s52, v25
v_mul_f32 v26, s52, v26
mm v[96:99],a[232:235],v[168:171],v[96:99]
tr a[232:233],v9,25088
v_mul_f32 v27, s52, v27
mm v[96:99],a[236:239],v[180:183],v[96:99]
tr a[234:235],v9,27136
v_mul_f32 v36, s52, v36
mm v[108:111],a[244:247],v[180:183],v[108:111]
s_add_u32 m0, s44, 32768
s_waitcnt vmcnt(3)
mm v[108:111],a[240:243],v[168:171],v[108:111]
tr a[236:237],v9,29184
buffer_load_dwordx4 v5, s[12:15], s45 offen offset:0 nt lds
mm v[104:107],a[240:243],v[164:167],v[104:107]
tr a[238:239],v9,31232
v_mul_f32 v37, s52, v37
mm v[104:107],a[244:247],v[176:179],v[104:107]
v_mul_f32 v38, s52, v38
v_mul_f32 v39, s52, v39
mm v[100:103],a[244:247],v[172:175],v[100:103]
s_waitcnt vmcnt(63)
s_waitcnt lgkmcnt(4)
mm v[100:103],a[240:243],v[160:163],v[100:103]
tr a[240:241],v10,25088
cv v24,v24,v25
mm v[64:67],a[216:219],v[184:187],v[64:67]
s_barrier
tr a[242:243],v10,27136
mm v[64:67],a[220:223],v[196:199],v[64:67]
tr a[244:245],v10,29184
cv v25,v26,v27
mm v[68:71],a[220:223],v[200:203],v[68:71]
tr a[246:247],v10,31232
v_add_u32 v9, 4294836224, v9
mm v[68:71],a[216:219],v[188:191],v[68:71]
v_add_u32 v10, 4294836224, v10
cv v36,v36,v37
mm v[72:75],a[216:219],v[192:195],v[72:75]
tr a[216:217],v9,0
cv v37,v38,v39
mm v[72:75],a[220:223],v[204:207],v[72:75]
tr a[218:219],v9,2048
mm v[84:87],a[228:231],v[204:207],v[84:87]
tr a[220:221],v9,4096
mm v[84:87],a[224:227],v[192:195],v[84:87]
tr a[222:223],v9,6144
mm v[80:83],a[224:227],v[188:191],v[80:83]
v_permlane16_swap_b32 v24, v36
mm v[80:83],a[228:231],v[200:203],v[80:83]
s_waitcnt vmcnt(3)
mm v[76:79],a[228:231],v[196:199],v[76:79]
s_waitcnt lgkmcnt(4)
buffer_load_dwordx4 v6, s[12:15], s45 offen offset:1024 nt lds
mm v[76:79],a[224:227],v[184:187],v[76:79]
tr a[224:225],v10,0
mm v[88:91],a[232:235],v[184:187],v[88:91]
tr a[226:227],v10,2048
mm v[88:91],a[236:239],v[196:199],v[88:91]
tr a[228:229],v10,4096
mm v[92:95],a[236:239],v[200:203],v[92:95]
tr a[230:231],v10,6144
mm v[92:95],a[232:235],v[188:191],v[92:95]
v_permlane16_swap_b32 v25, v37
mm v[96:99],a[232:235],v[192:195],v[96:99]
tr a[232:233],v9,512
v_accvgpr_write_b32 a152, v24
mm v[96:99],a[236:239],v[204:207],v[96:99]
tr a[234:235],v9,2560
v_accvgpr_write_b32 a153, v25
mm v[108:111],a[244:247],v[204:207],v[108:111]
tr a[236:237],v9,4608
v_accvgpr_write_b32 a154, v36
mm v[108:111],a[240:243],v[192:195],v[108:111]
tr a[238:239],v9,6656
v_accvgpr_write_b32 a155, v37
mm v[104:107],a[240:243],v[188:191],v[104:107]
v_mul_f32 v40, s52, v40
v_mul_f32 v41, s52, v41
mm v[104:107],a[244:247],v[200:203],v[104:107]
v_mul_f32 v42, s52, v42
v_mul_f32 v43, s52, v43
mm v[100:103],a[244:247],v[196:199],v[100:103]
s_waitcnt lgkmcnt(4)
v_mul_f32 v52, s52, v52
mm v[100:103],a[240:243],v[184:187],v[100:103]
tr a[240:241],v10,512
v_mul_f32 v53, s52, v53
mm v[64:67],a[216:219],v[208:211],v[64:67]
s_waitcnt vmcnt(3)
tr a[242:243],v10,2560
mm v[64:67],a[220:223],v[220:223],v[64:67]
s_barrier
tr a[244:245],v10,4608
mm v[68:71],a[220:223],v[224:227],v[68:71]
tr a[246:247],v10,6656
buffer_load_dwordx4 v7, s[12:15], s45 offen offset:2048 nt lds
mm v[68:71],a[216:219],v[212:215],v[68:71]
v_mul_f32 v54, s52, v54
v_mul_f32 v55, s52, v55
mm v[72:75],a[216:219],v[216:219],v[72:75]
tr a[216:217],v9,8192
cv v40,v40,v41
mm v[72:75],a[220:223],v[228:231],v[72:75]
tr a[218:219],v9,10240
cv v41,v42,v43
mm v[84:87],a[228:231],v[228:231],v[84:87]
tr a[220:221],v9,12288
cv v52,v52,v53
mm v[84:87],a[224:227],v[216:219],v[84:87]
tr a[222:223],v9,14336
cv v53,v54,v55
mm v[80:83],a[224:227],v[212:215],v[80:83]
v_permlane16_swap_b32 v40, v52
mm v[80:83],a[228:231],v[224:227],v[80:83]
v_permlane16_swap_b32 v41, v53
mm v[76:79],a[228:231],v[220:223],v[76:79]
s_waitcnt lgkmcnt(4)
v_accvgpr_write_b32 a156, v40
mm v[76:79],a[224:227],v[208:211],v[76:79]
tr a[224:225],v10,8192
v_accvgpr_write_b32 a157, v41
mm v[88:91],a[232:235],v[208:211],v[88:91]
tr a[226:227],v10,10240
v_accvgpr_write_b32 a158, v52
mm v[88:91],a[236:239],v[220:223],v[88:91]
tr a[228:229],v10,12288
v_accvgpr_write_b32 a159, v53
mm v[92:95],a[236:239],v[224:227],v[92:95]
tr a[230:231],v10,14336
mm v[92:95],a[232:235],v[212:215],v[92:95]
s_waitcnt vmcnt(3)
v_mul_f32 v44, s52, v44
mm v[96:99],a[232:235],v[216:219],v[96:99]
buffer_load_dwordx4 v8, s[12:15], s45 offen offset:3072 nt lds
tr a[232:233],v9,8704
mm v[96:99],a[236:239],v[228:231],v[96:99]
tr a[234:235],v9,10752
v_mul_f32 v45, s52, v45
mm v[108:111],a[244:247],v[228:231],v[108:111]
tr a[236:237],v9,12800
v_mul_f32 v46, s52, v46
mm v[108:111],a[240:243],v[216:219],v[108:111]
tr a[238:239],v9,14848
v_mul_f32 v47, s52, v47
mm v[104:107],a[240:243],v[212:215],v[104:107]
mm v[104:107],a[244:247],v[224:227],v[104:107]
v_mul_f32 v56, s52, v56
mm v[100:103],a[244:247],v[220:223],v[100:103]
s_waitcnt lgkmcnt(4)
v_mul_f32 v57, s52, v57
mm v[100:103],a[240:243],v[208:211],v[100:103]
tr a[240:241],v10,8704
L_pg7:
s_cbranch_execz L_pg11
mm v[64:67],a[216:219],v[232:235],v[64:67]
tr a[242:243],v10,10752
v_mul_f32 v58, s52, v58
mm v[64:67],a[220:223],v[244:247],v[64:67]
tr a[244:245],v10,12800
v_mul_f32 v59, s52, v59
mm v[68:71],a[220:223],v[248:251],v[68:71]
tr a[246:247],v10,14848
mm v[68:71],a[216:219],v[236:239],v[68:71]
cv v44,v44,v45
mm v[72:75],a[216:219],v[240:243],v[72:75]
tr a[216:217],v9,16384
cv v45,v46,v47
mm v[72:75],a[220:223],v[252:255],v[72:75]
s_add_u32 s45, s45, 16384
tr a[218:219],v9,18432
mm v[84:87],a[228:231],v[252:255],v[84:87]
s_add_u32 m0, s43, 131072
s_waitcnt vmcnt(3)
mm v[84:87],a[224:227],v[240:243],v[84:87]
tr a[220:221],v9,20480
buffer_load_dwordx4 v5, s[8:11], s45 offen offset:0 nt lds
mm v[80:83],a[224:227],v[236:239],v[80:83]
tr a[222:223],v9,22528
cv v56,v56,v57
mm v[80:83],a[228:231],v[248:251],v[80:83]
cv v57,v58,v59
mm v[76:79],a[228:231],v[244:247],v[76:79]
s_waitcnt lgkmcnt(4)
mm v[76:79],a[224:227],v[232:235],v[76:79]
tr a[224:225],v10,16384
mm v[88:91],a[232:235],v[232:235],v[88:91]
tr a[226:227],v10,18432
mm v[88:91],a[236:239],v[244:247],v[88:91]
tr a[228:229],v10,20480
mm v[92:95],a[236:239],v[248:251],v[92:95]
tr a[230:231],v10,22528
mm v[92:95],a[232:235],v[236:239],v[92:95]
v_permlane16_swap_b32 v44, v56
mm v[96:99],a[232:235],v[240:243],v[96:99]
tr a[232:233],v9,16896
mm v[96:99],a[236:239],v[252:255],v[96:99]
tr a[234:235],v9,18944
mm v[108:111],a[244:247],v[252:255],v[108:111]
tr a[236:237],v9,20992
mm v[108:111],a[240:243],v[240:243],v[108:111]
tr a[238:239],v9,23040
mm v[104:107],a[240:243],v[236:239],v[104:107]
v_permlane16_swap_b32 v45, v57
mm v[104:107],a[244:247],v[248:251],v[104:107]
s_waitcnt vmcnt(3)
v_accvgpr_write_b32 a160, v44
mm v[100:103],a[244:247],v[244:247],v[100:103]
s_waitcnt lgkmcnt(4)
buffer_load_dwordx4 v6, s[8:11], s45 offen offset:1024 nt lds
mm v[100:103],a[240:243],v[232:235],v[100:103]
tr a[240:241],v10,16896
v_accvgpr_write_b32 a161, v45
mm v[64:67],a[216:219],a[168:171],v[64:67]
tr a[242:243],v10,18944
v_accvgpr_write_b32 a162, v56
mm v[64:67],a[220:223],a[180:183],v[64:67]
tr a[244:245],v10,20992
v_accvgpr_write_b32 a163, v57
mm v[68:71],a[220:223],a[184:187],v[68:71]
tr a[246:247],v10,23040
v_mul_f32 v48, s52, v48
mm v[68:71],a[216:219],a[172:175],v[68:71]
v_mul_f32 v49, s52, v49
v_mul_f32 v50, s52, v50
mm v[72:75],a[216:219],a[176:179],v[72:75]
tr a[216:217],v9,24576
v_mul_f32 v51, s52, v51
mm v[72:75],a[220:223],a[188:191],v[72:75]
tr a[218:219],v9,26624
v_mul_f32 v60, s52, v60
mm v[84:87],a[228:231],a[188:191],v[84:87]
tr a[220:221],v9,28672
v_mul_f32 v61, s52, v61
mm v[84:87],a[224:227],a[176:179],v[84:87]
tr a[222:223],v9,30720
v_mul_f32 v62, s52, v62
mm v[80:83],a[224:227],a[172:175],v[80:83]
v_mul_f32 v63, s52, v63
cv v48,v48,v49
mm v[80:83],a[228:231],a[184:187],v[80:83]
cv v49,v50,v51
cv v60,v60,v61
mm v[76:79],a[228:231],a[180:183],v[76:79]
s_waitcnt lgkmcnt(4)
cv v61,v62,v63
mm v[76:79],a[224:227],a[168:171],v[76:79]
tr a[224:225],v10,24576
mm v[88:91],a[232:235],a[168:171],v[88:91]
s_waitcnt vmcnt(3)
tr a[226:227],v10,26624
mm v[88:91],a[236:239],a[180:183],v[88:91]
tr a[228:229],v10,28672
buffer_load_dwordx4 v7, s[8:11], s45 offen offset:2048 nt lds
mm v[92:95],a[236:239],a[184:187],v[92:95]
tr a[230:231],v10,30720
mm v[92:95],a[232:235],a[172:175],v[92:95]
v_permlane16_swap_b32 v48, v60
mm v[96:99],a[232:235],a[176:179],v[96:99]
tr a[232:233],v9,25088
mm v[96:99],a[236:239],a[188:191],v[96:99]
tr a[234:235],v9,27136
mm v[108:111],a[244:247],a[188:191],v[108:111]
tr a[236:237],v9,29184
mm v[108:111],a[240:243],a[176:179],v[108:111]
tr a[238:239],v9,31232
mm v[104:107],a[240:243],a[172:175],v[104:107]
v_permlane16_swap_b32 v49, v61
mm v[104:107],a[244:247],a[184:187],v[104:107]
v_accvgpr_write_b32 a164, v48
v_accvgpr_write_b32 a165, v49
mm v[100:103],a[244:247],a[180:183],v[100:103]
s_waitcnt vmcnt(63)
s_waitcnt lgkmcnt(4)
mm v[100:103],a[240:243],a[168:171],v[100:103]
tr a[240:241],v10,25088
v_accvgpr_write_b32 a166, v60
mm v[64:67],a[216:219],a[192:195],v[64:67]
s_barrier
tr a[242:243],v10,27136
mm v[64:67],a[220:223],a[204:207],v[64:67]
tr a[244:245],v10,29184
v_accvgpr_write_b32 a167, v61
mm v[68:71],a[220:223],a[208:211],v[68:71]
tr a[246:247],v10,31232
mm v[68:71],a[216:219],a[196:199],v[68:71]
s_waitcnt vmcnt(3)
mm v[72:75],a[216:219],a[200:203],v[72:75]
buffer_load_dwordx4 v8, s[8:11], s45 offen offset:3072 nt lds
mm v[72:75],a[220:223],a[212:215],v[72:75]
lq v[224:227],v11,0
mm v[84:87],a[228:231],a[212:215],v[84:87]
mm v[84:87],a[224:227],a[200:203],v[84:87]
lq v[228:231],v11,512
mm v[80:83],a[224:227],a[196:199],v[80:83]
mm v[80:83],a[228:231],a[208:211],v[80:83]
mm v[76:79],a[228:231],a[204:207],v[76:79]
s_waitcnt lgkmcnt(2)
lq v[232:235],v11,4096
mm v[76:79],a[224:227],a[192:195],v[76:79]
mm v[88:91],a[232:235],a[192:195],v[88:91]
mm v[88:91],a[236:239],a[204:207],v[88:91]
lq v[236:239],v11,4608
mm v[92:95],a[236:239],a[208:211],v[92:95]
mm v[92:95],a[232:235],a[196:199],v[92:95]
mm v[96:99],a[232:235],a[200:203],v[96:99]
mm v[96:99],a[236:239],a[212:215],v[96:99]
mm v[108:111],a[244:247],a[212:215],v[108:111]
s_add_u32 m0, s44, 131072
s_waitcnt vmcnt(3)
mm v[108:111],a[240:243],a[200:203],v[108:111]
buffer_load_dwordx4 v5, s[12:15], s45 offen offset:0 nt lds
mm v[104:107],a[240:243],a[196:199],v[104:107]
mm v[104:107],a[244:247],a[208:211],v[104:107]
mm v[100:103],a[244:247],a[204:207],v[100:103]
mm v[100:103],a[240:243],a[192:195],v[100:103]
s_waitcnt lgkmcnt(0)
mm v[112:115],v[224:227],a[0:3],0
lq a[208:211],v11,2048
mm v[112:115],v[228:231],a[12:15],v[112:115]
lq a[212:215],v11,2560
s_barrier
mm v[112:115],v[232:235],a[24:27],v[112:115]
lq a[216:219],v11,6144
mm v[112:115],v[236:239],a[36:39],v[112:115]
lq a[220:223],v11,6656
mm v[116:119],v[236:239],a[40:43],0
lq a[224:227],v11,8192
v_mul_f32 v64, s52, v64
mm v[116:119],v[232:235],a[28:31],v[116:119]
s_waitcnt vmcnt(3)
v_mul_f32 v65, s52, v65
mm v[116:119],v[228:231],a[16:19],v[116:119]
lq a[228:231],v11,8704
buffer_load_dwordx4 v6, s[12:15], s45 offen offset:1024 nt lds
v_mul_f32 v66, s52, v66
mm v[116:119],v[224:227],a[4:7],v[116:119]
v_mul_f32 v67, s52, v67
mm v[120:123],v[224:227],a[8:11],0
v_exp_f32 v112, v112
v_mul_f32 v76, s52, v76
mm v[120:123],v[228:231],a[20:23],v[120:123]
lq a[232:235],v11,12288
v_mul_f32 v77, s52, v77
mm v[120:123],v[232:235],a[32:35],v[120:123]
v_exp_f32 v113, v113
s_waitcnt lgkmcnt(3)
cv v160,v112,v113
mm v[120:123],v[236:239],a[44:47],v[120:123]
lq a[236:239],v11,12800
v_mul_f32 v78, s52, v78
mm v[132:135],a[220:223],a[44:47],0
v_exp_f32 v114, v114
v_mul_f32 v79, s52, v79
mm v[132:135],a[216:219],a[32:35],v[132:135]
lq a[240:243],v11,10240
cv v64,v64,v65
mm v[132:135],a[212:215],a[20:23],v[132:135]
v_exp_f32 v115, v115
cv v65,v66,v67
cv v161,v114,v115
mm v[132:135],a[208:211],a[8:11],v[132:135]
lq a[244:247],v11,10752
s_waitcnt vmcnt(3)
cv v76,v76,v77
mm v[128:131],a[208:211],a[4:7],0
v_exp_f32 v116, v116
cv v77,v78,v79
mm v[128:131],a[212:215],a[16:19],v[128:131]
buffer_load_dwordx4 v7, s[12:15], s45 offen offset:2048 nt lds
mm v[128:131],a[216:219],a[28:31],v[128:131]
v_exp_f32 v117, v117
v_permlane16_swap_b32 v64, v76
mm v[128:131],a[220:223],a[40:43],v[128:131]
lq a[248:251],v11,14336
v_permlane16_swap_b32 v65, v77
cv v164,v116,v117
mm v[124:127],a[220:223],a[36:39],0
v_exp_f32 v118, v118
v_accvgpr_write_b32 a168, v64
mm v[124:127],a[216:219],a[24:27],v[124:127]
lq a[252:255],v11,14848
v_accvgpr_write_b32 a169, v65
mm v[124:127],a[212:215],a[12:15],v[124:127]
v_exp_f32 v119, v119
s_waitcnt lgkmcnt(4)
v_accvgpr_write_b32 a170, v76
mm v[124:127],a[208:211],a[0:3],v[124:127]
v_accvgpr_write_b32 a171, v77
cv v165,v118,v119
mm v[136:139],a[224:227],a[0:3],0
v_exp_f32 v120, v120
v_exp_f32 v121, v121
mm v[136:139],a[228:231],a[12:15],v[136:139]
s_waitcnt vmcnt(3)
v_mul_f32 v68, s52, v68
cv v168,v120,v121
mm v[136:139],a[232:235],a[24:27],v[136:139]
v_exp_f32 v122, v122
v_mul_f32 v69, s52, v69
mm v[136:139],a[236:239],a[36:39],v[136:139]
buffer_load_dwordx4 v8, s[12:15], s45 offen offset:3072 nt lds
v_mul_f32 v70, s52, v70
mm v[140:143],a[236:239],a[40:43],0
v_exp_f32 v123, v123
v_mul_f32 v71, s52, v71
cv v169,v122,v123
mm v[140:143],a[232:235],a[28:31],v[140:143]
v_mul_f32 v80, s52, v80
mm v[140:143],a[228:231],a[16:19],v[140:143]
v_exp_f32 v132, v132
v_mul_f32 v81, s52, v81
mm v[140:143],a[224:227],a[4:7],v[140:143]
v_exp_f32 v133, v133
mm v[144:147],a[224:227],a[8:11],0
v_exp_f32 v134, v134
v_mul_f32 v82, s52, v82
cv v170,v132,v133
mm v[144:147],a[228:231],a[20:23],v[144:147]
v_mul_f32 v83, s52, v83
mm v[144:147],a[232:235],a[32:35],v[144:147]
v_exp_f32 v135, v135
s_waitcnt lgkmcnt(0)
s_add_u32 s45, s45, 16384
mm v[144:147],a[236:239],a[44:47],v[144:147]
s_add_u32 m0, s43, 0
s_waitcnt vmcnt(3)
cv v68,v68,v69
cv v69,v70,v71
mm v[156:159],a[252:255],a[44:47],0
s_barrier
buffer_load_dwordx4 v5, s[8:11], s45 offen offset:0 nt lds
cv v80,v80,v81
cv v171,v134,v135
mm v[156:159],a[248:251],a[32:35],v[156:159]
lq a[192:195],v11,32768
cv v81,v82,v83
mm v[156:159],a[244:247],a[20:23],v[156:159]
v_exp_f32 v128, v128
v_exp_f32 v129, v129
mm v[156:159],a[240:243],a[8:11],v[156:159]
lq a[196:199],v11,33280
v_permlane16_swap_b32 v68, v80
cv v166,v128,v129
mm v[152:155],a[240:243],a[4:7],0
lq a[200:203],v11,36864
v_permlane16_swap_b32 v69, v81
mm v[152:155],a[244:247],a[16:19],v[152:155]
lq a[204:207],v11,37376
v_accvgpr_write_b32 a172, v68
mm v[152:155],a[248:251],a[28:31],v[152:155]
v_exp_f32 v130, v130
v_accvgpr_write_b32 a173, v69
mm v[152:155],a[252:255],a[40:43],v[152:155]
lq a[208:211],v11,34816
v_accvgpr_write_b32 a174, v80
mm v[148:151],a[252:255],a[36:39],0
v_exp_f32 v131, v131
v_accvgpr_write_b32 a175, v81
cv v167,v130,v131
mm v[148:151],a[248:251],a[24:27],v[148:151]
lq a[212:215],v11,35328
v_exp_f32 v124, v124
s_waitcnt vmcnt(3)
mm v[148:151],a[244:247],a[12:15],v[148:151]
v_exp_f32 v125, v125
v_exp_f32 v126, v126
mm v[148:151],a[240:243],a[0:3],v[148:151]
s_waitcnt lgkmcnt(2)
buffer_load_dwordx4 v6, s[8:11], s45 offen offset:1024 nt lds
v_exp_f32 v127, v127
cv v162,v124,v125
cv v163,v126,v127
v_exp_f32 v136, v136
v_exp_f32 v137, v137
v_exp_f32 v138, v138
v_exp_f32 v139, v139
cv v172,v136,v137
cv v173,v138,v139
v_exp_f32 v140, v140
v_exp_f32 v141, v141
v_exp_f32 v142, v142
v_exp_f32 v143, v143
cv v176,v140,v141
cv v177,v142,v143
v_exp_f32 v144, v144
v_exp_f32 v145, v145
v_exp_f32 v146, v146
v_exp_f32 v147, v147
cv v180,v144,v145
cv v181,v146,v147
L_mk_b0:
mm v[112:115],a[192:195],a[0:3],0
v_exp_f32 v156, v156
v_mov_b32 v220, 0x3f803f80
mm v[112:115],a[196:199],a[12:15],v[112:115]
lq a[216:219],v11,38912
v_mov_b32 v221, 0x3f803f80
v_mov_b32 v222, 0x3f803f80
mm v[112:115],a[200:203],a[24:27],v[112:115]
v_exp_f32 v157, v157
v_mov_b32 v223, 0x3f803f80
mm v[112:115],a[204:207],a[36:39],v[112:115]
lq a[220:223],v11,39424
cv v182,v156,v157
v_mul_f32 v72, s52, v72
mm v[116:119],a[204:207],a[40:43],0
v_exp_f32 v158, v158
v_mul_f32 v73, s52, v73
mm v[116:119],a[200:203],a[28:31],v[116:119]
lq a[224:227],v11,40960
v_mul_f32 v74, s52, v74
v_mul_f32 v75, s52, v75
mm v[116:119],a[196:199],a[16:19],v[116:119]
v_exp_f32 v159, v159
v_mul_f32 v84, s52, v84
mm v[116:119],a[192:195],a[4:7],v[116:119]
lq a[228:231],v11,41472
cv v183,v158,v159
v_mul_f32 v85, s52, v85
mm v[120:123],a[192:195],a[8:11],0
v_exp_f32 v152, v152
v_mul_f32 v86, s52, v86
mm v[120:123],a[196:199],a[20:23],v[120:123]
lq a[232:235],v11,45056
v_mul_f32 v87, s52, v87
cv v72,v72,v73
mm v[120:123],a[200:203],a[32:35],v[120:123]
v_exp_f32 v153, v153
s_waitcnt lgkmcnt(3)
mm v[120:123],a[204:207],a[44:47],v[120:123]
lq a[236:239],v11,45568
s_waitcnt vmcnt(3)
cv v178,v152,v153
mm v[132:135],a[220:223],a[44:47],0
v_exp_f32 v154, v154
cv v73,v74,v75
mm v[132:135],a[216:219],a[32:35],v[132:135]
buffer_load_dwordx4 v7, s[8:11], s45 offen offset:2048 nt lds
lq a[240:243],v11,43008
cv v84,v84,v85
mm v[132:135],a[212:215],a[20:23],v[132:135]
v_exp_f32 v155, v155
cv v85,v86,v87
mm v[132:135],a[208:211],a[8:11],v[132:135]
lq a[244:247],v11,43520
cv v179,v154,v155
v_mov_b32 v243, s58
mm v[128:131],a[208:211],a[4:7],0
v_exp_f32 v148, v148
mm v[128:131],a[212:215],a[16:19],v[128:131]
lq a[248:251],v11,47104
v_permlane16_swap_b32 v72, v84
mm v[128:131],a[216:219],a[28:31],v[128:131]
v_exp_f32 v149, v149
mm v[128:131],a[220:223],a[40:43],v[128:131]
lq a[252:255],v11,47616
cv v174,v148,v149
mm v[124:127],a[220:223],a[36:39],0
v_exp_f32 v150, v150
mm v[124:127],a[216:219],a[24:27],v[124:127]
tr a[192:193],v12,16384
v_permlane16_swap_b32 v73, v85
mm v[124:127],a[212:215],a[12:15],v[124:127]
v_exp_f32 v151, v151
s_waitcnt lgkmcnt(5)
mm v[124:127],a[208:211],a[0:3],v[124:127]
tr a[194:195],v12,18432
cv v175,v150,v151
v_accvgpr_write_b32 a176, v72
mm v[136:139],a[224:227],a[0:3],0
v_exp_f32 v112, v112
v_accvgpr_write_b32 a177, v73
mm v[136:139],a[228:231],a[12:15],v[136:139]
tr a[196:197],v12,24576
v_accvgpr_write_b32 a178, v84
v_accvgpr_write_b32 a179, v85
mm v[136:139],a[232:235],a[24:27],v[136:139]
v_exp_f32 v113, v113
s_waitcnt vmcnt(3)
mm v[136:139],a[236:239],a[36:39],v[136:139]
tr a[198:199],v12,26624
buffer_load_dwordx4 v8, s[8:11], s45 offen offset:3072 nt lds
v_mul_f32 v88, s52, v88
mm v[140:143],a[236:239],a[40:43],0
v_exp_f32 v114, v114
v_mul_f32 v89, s52, v89
mm v[140:143],a[232:235],a[28:31],v[140:143]
tr a[200:201],v13,16384
v_mul_f32 v90, s52, v90
v_mul_f32 v91, s52, v91
mm v[140:143],a[228:231],a[16:19],v[140:143]
v_exp_f32 v115, v115
v_mul_f32 v100, s52, v100
mm v[140:143],a[224:227],a[4:7],v[140:143]
tr a[202:203],v13,18432
v_mul_f32 v101, s52, v101
v_mul_f32 v102, s52, v102
mm v[144:147],a[224:227],a[8:11],0
v_exp_f32 v116, v116
v_mul_f32 v103, s52, v103
mm v[144:147],a[228:231],a[20:23],v[144:147]
tr a[204:205],v13,24576
cv v88,v88,v89
cv v89,v90,v91
mm v[144:147],a[232:235],a[32:35],v[144:147]
v_exp_f32 v117, v117
s_waitcnt lgkmcnt(7)
mm v[144:147],a[236:239],a[44:47],v[144:147]
tr a[206:207],v13,26624
cv v100,v100,v101
cv v101,v102,v103
mm v[156:159],a[252:255],a[44:47],0
v_exp_f32 v118, v118
cv v184,v112,v113
mm v[156:159],a[248:251],a[32:35],v[156:159]
tr a[208:209],v12,16896
v_permlane16_swap_b32 v88, v100
mm v[156:159],a[244:247],a[20:23],v[156:159]
v_exp_f32 v119, v119
cv v185,v114,v115
mm v[156:159],a[240:243],a[8:11],v[156:159]
tr a[210:211],v12,18944
v_permlane16_swap_b32 v89, v101
mm v[152:155],a[240:243],a[4:7],0
v_exp_f32 v120, v120
v_accvgpr_write_b32 a180, v88
mm v[152:155],a[244:247],a[16:19],v[152:155]
tr a[212:213],v12,25088
s_add_u32 m0, s44, 0
s_waitcnt vmcnt(3)
mm v[152:155],a[248:251],a[28:31],v[152:155]
v_exp_f32 v121, v121
v_accvgpr_write_b32 a181, v89
mm v[152:155],a[252:255],a[40:43],v[152:155]
tr a[214:215],v12,27136
buffer_load_dwordx4 v5, s[12:15], s45 offen offset:0 nt lds
v_accvgpr_write_b32 a182, v100
mm v[148:151],a[252:255],a[36:39],0
v_exp_f32 v122, v122
v_accvgpr_write_b32 a183, v101
mm v[148:151],a[248:251],a[24:27],v[148:151]
tr a[216:217],v13,16896
v_mul_f32 v92, s52, v92
v_mul_f32 v93, s52, v93
mm v[148:151],a[244:247],a[12:15],v[148:151]
v_exp_f32 v123, v123
v_mul_f32 v94, s52, v94
mm v[148:151],a[240:243],a[0:3],v[148:151]
tr a[218:219],v13,18944
v_mul_f32 v95, s52, v95
v_mul_f32 v104, s52, v104
mm v[216:219],v[220:223],v[180:183],0
v_exp_f32 v132, v132
v_mul_f32 v105, s52, v105
mm v[216:219],v[220:223],v[168:171],v[216:219]
tr a[220:221],v13,25088
v_mul_f32 v106, s52, v106
v_mul_f32 v107, s52, v107
mm v[212:215],v[220:223],v[176:179],0
v_exp_f32 v133, v133
cv v92,v92,v93
mm v[212:215],v[220:223],v[164:167],v[212:215]
tr a[222:223],v13,27136
cv v93,v94,v95
cv v104,v104,v105
mm v[208:211],v[220:223],v[172:175],0
v_exp_f32 v134, v134
s_waitcnt lgkmcnt(8)
mm v[208:211],v[220:223],v[160:163],v[208:211]
tr a[224:225],v12,20480
cv v105,v106,v107
cv v188,v116,v117
mm v[16:19],a[192:195],v[160:163],0
v_exp_f32 v135, v135
cv v189,v118,v119
mm v[16:19],a[196:199],v[172:175],v[16:19]
tr a[226:227],v12,22528
v_permlane16_swap_b32 v92, v104
mm v[20:23],a[196:199],v[176:179],0
v_exp_f32 v128, v128
s_waitcnt vmcnt(3)
mm v[20:23],a[192:195],v[164:167],v[20:23]
tr a[228:229],v12,28672
buffer_load_dwordx4 v6, s[12:15], s45 offen offset:1024 nt lds
cv v192,v120,v121
mm v[24:27],a[192:195],v[168:171],0
v_exp_f32 v129, v129
cv v193,v122,v123
mm v[24:27],a[196:199],v[180:183],v[24:27]
tr a[230:231],v12,30720
v_permlane16_swap_b32 v93, v105
mm v[36:39],a[204:207],v[180:183],0
v_exp_f32 v130, v130
v_accvgpr_write_b32 a184, v92
mm v[36:39],a[200:203],v[168:171],v[36:39]
tr a[232:233],v13,20480
v_accvgpr_write_b32 a185, v93
v_accvgpr_write_b32 a186, v104
mm v[32:35],a[200:203],v[164:167],0
v_exp_f32 v131, v131
v_accvgpr_write_b32 a187, v105
mm v[32:35],a[204:207],v[176:179],v[32:35]
tr a[234:235],v13,22528
v_mul_f32 v96, s52, v96
v_mul_f32 v97, s52, v97
mm v[28:31],a[204:207],v[172:175],0
v_exp_f32 v124, v124
s_waitcnt lgkmcnt(6)
mm v[28:31],a[200:203],v[160:163],v[28:31]
tr a[236:237],v13,28672
v_mul_f32 v98, s52, v98
v_mul_f32 v99, s52, v99
mm v[40:43],a[208:211],v[160:163],0
tr a[238:239],v13,30720
v_mul_f32 v108, s52, v108
v_mul_f32 v109, s52, v109
mm v[40:43],a[212:215],v[172:175],v[40:43]
tr a[240:241],v12,20992
v_mul_f32 v110, s52, v110
v_mul_f32 v111, s52, v111
mm v[44:47],a[212:215],v[176:179],0
v_exp_f32 v125, v125
cv v96,v96,v97
mm v[44:47],a[208:211],v[164:167],v[44:47]
tr a[242:243],v12,23040
cv v97,v98,v99
cv v108,v108,v109
mm v[48:51],a[208:211],v[168:171],0
v_exp_f32 v126, v126
cv v109,v110,v111
mm v[48:51],a[212:215],v[180:183],v[48:51]
tr a[244:245],v12,29184
v_permlane16_swap_b32 v96, v108
mm v[60:63],a[220:223],v[180:183],0
tr a[246:247],v12,31232
v_permlane16_swap_b32 v97, v109
v_accvgpr_write_b32 a188, v96
v_accvgpr_write_b32 a189, v97
v_accvgpr_write_b32 a190, v108
v_accvgpr_write_b32 a191, v109
mm v[60:63],a[216:219],v[168:171],v[60:63]
tr a[248:249],v13,20992
s_waitcnt vmcnt(3)
buffer_load_dwordx4 v7, s[12:15], s45 offen offset:2048 nt lds
mm v[56:59],a[216:219],v[164:167],0
v_exp_f32 v127, v127
cv v194,v132,v133
mm v[56:59],a[220:223],v[176:179],v[56:59]
tr a[250:251],v13,23040
cv v195,v134,v135
cv v190,v128,v129
mm v[52:55],a[220:223],v[172:175],0
v_exp_f32 v136, v136
mm v[52:55],a[216:219],v[160:163],v[52:55]
s_waitcnt lgkmcnt(6)
tr a[252:253],v13,29184
mm v[64:67],a[224:227],v[160:163],0
v_exp_f32 v137, v137
mm v[64:67],a[228:231],v[172:175],v[64:67]
L_pg8:
s_cbranch_execz L_tret0
tr a[254:255],v13,31232
v_add_u32 v11, 4294934528, v11
mm v[68:71],a[228:231],v[176:179],0
v_exp_f32 v138, v138
mm v[68:71],a[224:227],v[164:167],v[68:71]
cv v191,v130,v131
cv v186,v124,v125
mm v[72:75],a[224:227],v[168:171],0
v_exp_f32 v139, v139
mm v[72:75],a[228:231],v[180:183],v[72:75]
cv v187,v126,v127
cv v196,v136,v137
mm v[84:87],a[236:239],v[180:183],0
v_exp_f32 v140, v140
mm v[84:87],a[232:235],v[168:171],v[84:87]
cv v197,v138,v139
mm v[80:83],a[232:235],v[164:167],0
v_exp_f32 v141, v141
mm v[80:83],a[236:239],v[176:179],v[80:83]
s_waitcnt vmcnt(3)
mm v[76:79],a[236:239],v[172:175],0
v_exp_f32 v142, v142
mm v[76:79],a[232:235],v[160:163],v[76:79]
s_waitcnt lgkmcnt(0)
buffer_load_dwordx4 v8, s[12:15], s45 offen offset:3072 nt lds
mm v[88:91],a[240:243],v[160:163],0
s_barrier
cv v200,v140,v141
mm v[88:91],a[244:247],v[172:175],v[88:91]
lq a[192:195],v11,0
mm v[92:95],a[244:247],v[176:179],0
v_exp_f32 v143, v143
mm v[92:95],a[240:243],v[164:167],v[92:95]
lq a[196:199],v11,512
cv v201,v142,v143
mm v[96:99],a[240:243],v[168:171],0
lq a[200:203],v11,4096
mm v[96:99],a[244:247],v[180:183],v[96:99]
lq a[204:207],v11,4608
mm v[108:111],a[252:255],v[180:183],0
v_exp_f32 v144, v144
mm v[108:111],a[248:251],v[168:171],v[108:111]
lq a[208:211],v11,2048
mm v[104:107],a[248:251],v[164:167],0
v_exp_f32 v145, v145
mm v[104:107],a[252:255],v[176:179],v[104:107]
lq a[212:215],v11,2560
cv v204,v144,v145
mm v[100:103],a[252:255],v[172:175],0
v_exp_f32 v146, v146
mm v[100:103],a[248:251],v[160:163],v[100:103]
s_waitcnt lgkmcnt(2)
s_add_u32 s45, s45, 16384
v_exp_f32 v147, v147
v_exp_f32 v156, v156
cv v205,v146,v147
v_exp_f32 v157, v157
v_exp_f32 v158, v158
v_exp_f32 v159, v159
cv v206,v156,v157
cv v207,v158,v159
v_exp_f32 v152, v152
v_exp_f32 v153, v153
v_exp_f32 v154, v154
v_exp_f32 v155, v155
cv v202,v152,v153
cv v203,v154,v155
s_add_u32 m0, s43, 65536
s_waitcnt vmcnt(3)
mm v[112:115],a[192:195],a[0:3],0
v_exp_f32 v148, v148
mm v[112:115],a[196:199],a[12:15],v[112:115]
lq a[216:219],v11,6144
buffer_load_dwordx4 v5, s[8:11], s45 offen offset:0 nt lds
mm v[112:115],a[200:203],a[24:27],v[112:115]
v_exp_f32 v149, v149
mm v[112:115],a[204:207],a[36:39],v[112:115]
lq a[220:223],v11,6656
cv v198,v148,v149
mm v[116:119],a[204:207],a[40:43],0
v_exp_f32 v150, v150
mm v[116:119],a[200:203],a[28:31],v[116:119]
lq a[224:227],v11,8192
mm v[116:119],a[196:199],a[16:19],v[116:119]
v_exp_f32 v151, v151
mm v[116:119],a[192:195],a[4:7],v[116:119]
lq a[228:231],v11,8704
cv v199,v150,v151
mm v[120:123],a[192:195],a[8:11],0
v_exp_f32 v112, v112
mm v[120:123],a[196:199],a[20:23],v[120:123]
lq a[232:235],v11,12288
mm v[120:123],a[200:203],a[32:35],v[120:123]
v_exp_f32 v113, v113
mm v[120:123],a[204:207],a[44:47],v[120:123]
s_waitcnt lgkmcnt(3)
lq a[236:239],v11,12800
mm v[132:135],a[220:223],a[44:47],0
v_exp_f32 v114, v114
mm v[132:135],a[216:219],a[32:35],v[132:135]
lq a[240:243],v11,10240
cv v160,v112,v113
mm v[132:135],a[212:215],a[20:23],v[132:135]
v_exp_f32 v115, v115
mm v[132:135],a[208:211],a[8:11],v[132:135]
s_waitcnt vmcnt(3)
buffer_load_dwordx4 v6, s[8:11], s45 offen offset:1024 nt lds
mm v[128:131],a[208:211],a[4:7],0
v_exp_f32 v116, v116
mm v[128:131],a[212:215],a[16:19],v[128:131]
lq a[244:247],v11,10752
cv v161,v114,v115
mm v[128:131],a[216:219],a[28:31],v[128:131]
v_exp_f32 v117, v117
mm v[128:131],a[220:223],a[40:43],v[128:131]
lq a[248:251],v11,14336
cv v164,v116,v117
mm v[124:127],a[220:223],a[36:39],0
lq a[252:255],v11,14848
mm v[124:127],a[216:219],a[24:27],v[124:127]
tr a[192:193],v12,49152
mm v[124:127],a[212:215],a[12:15],v[124:127]
v_exp_f32 v118, v118
mm v[124:127],a[208:211],a[0:3],v[124:127]
s_waitcnt lgkmcnt(5)
tr a[194:195],v12,51200
mm v[136:139],a[224:227],a[0:3],0
v_exp_f32 v119, v119
mm v[136:139],a[228:231],a[12:15],v[136:139]
tr a[196:197],v12,57344
cv v165,v118,v119
mm v[136:139],a[232:235],a[24:27],v[136:139]
v_exp_f32 v120, v120
mm v[136:139],a[236:239],a[36:39],v[136:139]
tr a[198:199],v12,59392
mm v[140:143],a[236:239],a[40:43],0
v_exp_f32 v121, v121
mm v[140:143],a[232:235],a[28:31],v[140:143]
tr a[200:201],v13,49152
s_waitcnt vmcnt(3)
mm v[140:143],a[228:231],a[16:19],v[140:143]
v_exp_f32 v122, v122
mm v[140:143],a[224:227],a[4:7],v[140:143]
buffer_load_dwordx4 v7, s[8:11], s45 offen offset:2048 nt lds
tr a[202:203],v13,51200
mm v[144:147],a[224:227],a[8:11],0
v_exp_f32 v123, v123
mm v[144:147],a[228:231],a[20:23],v[144:147]
tr a[204:205],v13,57344
cv v168,v120,v121
mm v[144:147],a[232:235],a[32:35],v[144:147]
v_exp_f32 v132, v132
mm v[144:147],a[236:239],a[44:47],v[144:147]
s_waitcnt lgkmcnt(7)
tr a[206:207],v13,59392
mm v[156:159],a[252:255],a[44:47],0
v_exp_f32 v133, v133
mm v[156:159],a[248:251],a[32:35],v[156:159]
tr a[208:209],v12,49664
cv v169,v122,v123
mm v[156:159],a[244:247],a[20:23],v[156:159]
v_exp_f32 v134, v134
mm v[156:159],a[240:243],a[8:11],v[156:159]
tr a[210:211],v12,51712
cv v170,v132,v133
mm v[152:155],a[240:243],a[4:7],0
v_exp_f32 v135, v135
mm v[152:155],a[244:247],a[16:19],v[152:155]
tr a[212:213],v12,57856
cv v171,v134,v135
mm v[152:155],a[248:251],a[28:31],v[152:155]
v_exp_f32 v128, v128
mm v[152:155],a[252:255],a[40:43],v[152:155]
tr a[214:215],v12,59904
mm v[148:151],a[252:255],a[36:39],0
v_exp_f32 v129, v129
mm v[148:151],a[248:251],a[24:27],v[148:151]
tr a[216:217],v13,49664
s_waitcnt vmcnt(3)
mm v[148:151],a[244:247],a[12:15],v[148:151]
v_exp_f32 v130, v130
mm v[148:151],a[240:243],a[0:3],v[148:151]
buffer_load_dwordx4 v8, s[8:11], s45 offen offset:3072 nt lds
tr a[218:219],v13,51712
mm v[216:219],v[220:223],v[204:207],v[216:219]
v_exp_f32 v131, v131
mm v[216:219],v[220:223],v[192:195],v[216:219]
tr a[220:221],v13,57856
cv v166,v128,v129
mm v[212:215],v[220:223],v[200:203],v[212:215]
v_exp_f32 v124, v124
mm v[212:215],v[220:223],v[188:191],v[212:215]
tr a[222:223],v13,59904
cv v167,v130,v131
mm v[208:211],v[220:223],v[196:199],v[208:211]
v_exp_f32 v125, v125
mm v[208:211],v[220:223],v[184:187],v[208:211]
s_waitcnt lgkmcnt(8)
tr a[224:225],v12,53248
mm v[16:19],a[192:195],v[184:187],v[16:19]
v_exp_f32 v126, v126
mm v[16:19],a[196:199],v[196:199],v[16:19]
tr a[226:227],v12,55296
cv v162,v124,v125
mm v[20:23],a[196:199],v[200:203],v[20:23]
v_exp_f32 v127, v127
mm v[20:23],a[192:195],v[188:191],v[20:23]
tr a[228:229],v12,61440
cv v163,v126,v127
mm v[24:27],a[192:195],v[192:195],v[24:27]
v_exp_f32 v136, v136
mm v[24:27],a[196:199],v[204:207],v[24:27]
tr a[230:231],v12,63488
s_add_u32 m0, s44, 65536
mm v[36:39],a[204:207],v[204:207],v[36:39]
v_exp_f32 v137, v137
mm v[36:39],a[200:203],v[192:195],v[36:39]
tr a[232:233],v13,53248
s_waitcnt vmcnt(3)
mm v[32:35],a[200:203],v[188:191],v[32:35]
v_exp_f32 v138, v138
mm v[32:35],a[204:207],v[200:203],v[32:35]
buffer_load_dwordx4 v5, s[12:15], s45 offen offset:0 nt lds
tr a[234:235],v13,55296
mm v[28:31],a[204:207],v[196:199],v[28:31]
v_exp_f32 v139, v139
mm v[28:31],a[200:203],v[184:187],v[28:31]
s_waitcnt lgkmcnt(6)
tr a[236:237],v13,61440
mm v[40:43],a[208:211],v[184:187],v[40:43]
tr a[238:239],v13,63488
cv v172,v136,v137
mm v[40:43],a[212:215],v[196:199],v[40:43]
tr a[240:241],v12,53760
cv v173,v138,v139
mm v[44:47],a[212:215],v[200:203],v[44:47]
v_exp_f32 v140, v140
mm v[44:47],a[208:211],v[188:191],v[44:47]
tr a[242:243],v12,55808
mm v[48:51],a[208:211],v[192:195],v[48:51]
v_exp_f32 v141, v141
mm v[48:51],a[212:215],v[204:207],v[48:51]
tr a[244:245],v12,61952
cv v176,v140,v141
mm v[60:63],a[220:223],v[204:207],v[60:63]
v_exp_f32 v142, v142
mm v[60:63],a[216:219],v[192:195],v[60:63]
tr a[246:247],v12,64000
mm v[56:59],a[216:219],v[188:191],v[56:59]
v_exp_f32 v143, v143
mm v[56:59],a[220:223],v[200:203],v[56:59]
tr a[248:249],v13,53760
s_waitcnt vmcnt(3)
mm v[52:55],a[220:223],v[196:199],v[52:55]
v_exp_f32 v144, v144
mm v[52:55],a[216:219],v[184:187],v[52:55]
s_waitcnt lgkmcnt(5)
tr a[250:251],v13,55808
mm v[64:67],a[224:227],v[184:187],v[64:67]
v_exp_f32 v145, v145
mm v[64:67],a[228:231],v[196:199],v[64:67]
tr a[252:253],v13,61952
buffer_load_dwordx4 v6, s[12:15], s45 offen offset:1024 nt lds
mm v[68:71],a[228:231],v[200:203],v[68:71]
v_exp_f32 v146, v146
mm v[68:71],a[224:227],v[188:191],v[68:71]
tr a[254:255],v13,64000
cv v177,v142,v143
mm v[72:75],a[224:227],v[192:195],v[72:75]
v_exp_f32 v147, v147
mm v[72:75],a[228:231],v[204:207],v[72:75]
v_add_u32 v11, 98304, v11
cv v180,v144,v145
mm v[84:87],a[236:239],v[204:207],v[84:87]
v_exp_f32 v156, v156
mm v[84:87],a[232:235],v[192:195],v[84:87]
cv v181,v146,v147
mm v[80:83],a[232:235],v[188:191],v[80:83]
v_exp_f32 v157, v157
mm v[80:83],a[236:239],v[200:203],v[80:83]
cv v182,v156,v157
mm v[76:79],a[236:239],v[196:199],v[76:79]
v_exp_f32 v158, v158
mm v[76:79],a[232:235],v[184:187],v[76:79]
s_waitcnt lgkmcnt(0)
s_waitcnt vmcnt(3)
mm v[88:91],a[240:243],v[184:187],v[88:91]
s_barrier
buffer_load_dwordx4 v7, s[12:15], s45 offen offset:2048 nt lds
v_exp_f32 v159, v159
mm v[88:91],a[244:247],v[196:199],v[88:91]
lq a[192:195],v11,0
cv v183,v158,v159
mm v[92:95],a[244:247],v[200:203],v[92:95]
v_exp_f32 v152, v152
mm v[92:95],a[240:243],v[188:191],v[92:95]
lq a[196:199],v11,512
mm v[96:99],a[240:243],v[192:195],v[96:99]
lq a[200:203],v11,4096
mm v[96:99],a[244:247],v[204:207],v[96:99]
lq a[204:207],v11,4608
mm v[108:111],a[252:255],v[204:207],v[108:111]
v_exp_f32 v153, v153
mm v[108:111],a[248:251],v[192:195],v[108:111]
v_exp_f32 v154, v154
mm v[104:107],a[248:251],v[188:191],v[104:107]
v_exp_f32 v155, v155
mm v[104:107],a[252:255],v[200:203],v[104:107]
lq a[208:211],v11,2048
cv v178,v152,v153
mm v[100:103],a[252:255],v[196:199],v[100:103]
lq a[212:215],v11,2560
cv v179,v154,v155
mm v[100:103],a[248:251],v[184:187],v[100:103]
s_waitcnt lgkmcnt(2)
mm v[112:115],a[192:195],a[0:3],0
v_exp_f32 v148, v148
mm v[112:115],a[196:199],a[12:15],v[112:115]
lq a[216:219],v11,6144
mm v[112:115],a[200:203],a[24:27],v[112:115]
v_exp_f32 v149, v149
mm v[112:115],a[204:207],a[36:39],v[112:115]
lq a[220:223],v11,6656
s_waitcnt vmcnt(3)
mm v[116:119],a[204:207],a[40:43],0
v_exp_f32 v150, v150
mm v[116:119],a[200:203],a[28:31],v[116:119]
buffer_load_dwordx4 v8, s[12:15], s45 offen offset:3072 nt lds
lq a[224:227],v11,8192
mm v[116:119],a[196:199],a[16:19],v[116:119]
v_exp_f32 v151, v151
mm v[116:119],a[192:195],a[4:7],v[116:119]
lq a[228:231],v11,8704
cv v174,v148,v149
mm v[120:123],a[192:195],a[8:11],0
v_exp_f32 v112, v112
mm v[120:123],a[196:199],a[20:23],v[120:123]
lq a[232:235],v11,12288
v_add_u32 v12, 4294934528, v12
mm v[120:123],a[200:203],a[32:35],v[120:123]
v_exp_f32 v113, v113
mm v[120:123],a[204:207],a[44:47],v[120:123]
s_waitcnt lgkmcnt(3)
lq a[236:239],v11,12800
mm v[132:135],a[220:223],a[44:47],0
v_exp_f32 v114, v114
mm v[132:135],a[216:219],a[32:35],v[132:135]
lq a[240:243],v11,10240
v_add_u32 v13, 4294934528, v13
mm v[132:135],a[212:215],a[20:23],v[132:135]
v_exp_f32 v115, v115
mm v[132:135],a[208:211],a[8:11],v[132:135]
lq a[244:247],v11,10752
cv v184,v112,v113
mm v[128:131],a[208:211],a[4:7],0
v_exp_f32 v116, v116
mm v[128:131],a[212:215],a[16:19],v[128:131]
lq a[248:251],v11,14336
s_add_u32 s45, s45, 16384
mm v[128:131],a[216:219],a[28:31],v[128:131]
v_exp_f32 v117, v117
mm v[128:131],a[220:223],a[40:43],v[128:131]
lq a[252:255],v11,14848
s_add_u32 m0, s43, 98304
mm v[124:127],a[220:223],a[36:39],0
v_exp_f32 v118, v118
mm v[124:127],a[216:219],a[24:27],v[124:127]
s_waitcnt vmcnt(3)
buffer_load_dwordx4 v5, s[8:11], s45 offen offset:0 nt lds
mm v[124:127],a[212:215],a[12:15],v[124:127]
v_exp_f32 v119, v119
mm v[124:127],a[208:211],a[0:3],v[124:127]
s_waitcnt lgkmcnt(4)
tr a[192:193],v12,16384
mm v[136:139],a[224:227],a[0:3],0
v_exp_f32 v120, v120
mm v[136:139],a[228:231],a[12:15],v[136:139]
tr a[194:195],v12,18432
cv v185,v114,v115
mm v[136:139],a[232:235],a[24:27],v[136:139]
v_exp_f32 v121, v121
mm v[136:139],a[236:239],a[36:39],v[136:139]
tr a[196:197],v12,24576
cv v188,v116,v117
mm v[140:143],a[236:239],a[40:43],0
v_exp_f32 v122, v122
mm v[140:143],a[232:235],a[28:31],v[140:143]
tr a[198:199],v12,26624
cv v189,v118,v119
mm v[140:143],a[228:231],a[16:19],v[140:143]
v_exp_f32 v123, v123
mm v[140:143],a[224:227],a[4:7],v[140:143]
tr a[200:201],v13,16384
s_waitcnt vmcnt(3)
mm v[144:147],a[224:227],a[8:11],0
v_exp_f32 v132, v132
mm v[144:147],a[228:231],a[20:23],v[144:147]
tr a[202:203],v13,18432
buffer_load_dwordx4 v6, s[8:11], s45 offen offset:1024 nt lds
mm v[144:147],a[232:235],a[32:35],v[144:147]
v_exp_f32 v133, v133
mm v[144:147],a[236:239],a[44:47],v[144:147]
s_waitcnt lgkmcnt(6)
tr a[204:205],v13,24576
mm v[156:159],a[252:255],a[44:47],0
tr a[206:207],v13,26624
cv v175,v150,v151
mm v[156:159],a[248:251],a[32:35],v[156:159]
tr a[208:209],v12,16896
cv v192,v120,v121
mm v[156:159],a[244:247],a[20:23],v[156:159]
v_exp_f32 v134, v134
mm v[156:159],a[240:243],a[8:11],v[156:159]
tr a[210:211],v12,18944
cv v193,v122,v123
mm v[152:155],a[240:243],a[4:7],0
v_exp_f32 v135, v135
mm v[152:155],a[244:247],a[16:19],v[152:155]
tr a[212:213],v12,25088
cv v194,v132,v133
mm v[152:155],a[248:251],a[28:31],v[152:155]
v_exp_f32 v128, v128
mm v[152:155],a[252:255],a[40:43],v[152:155]
tr a[214:215],v12,27136
cv v195,v134,v135
mm v[148:151],a[252:255],a[36:39],0
v_exp_f32 v129, v129
mm v[148:151],a[248:251],a[24:27],v[148:151]
tr a[216:217],v13,16896
s_waitcnt vmcnt(3)
mm v[148:151],a[244:247],a[12:15],v[148:151]
v_exp_f32 v130, v130
mm v[148:151],a[240:243],a[0:3],v[148:151]
tr a[218:219],v13,18944
buffer_load_dwordx4 v7, s[8:11], s45 offen offset:2048 nt lds
mm v[216:219],v[220:223],v[180:183],v[216:219]
v_exp_f32 v131, v131
mm v[216:219],v[220:223],v[168:171],v[216:219]
tr a[220:221],v13,25088
cv v190,v128,v129
mm v[212:215],v[220:223],v[176:179],v[212:215]
v_exp_f32 v124, v124
mm v[212:215],v[220:223],v[164:167],v[212:215]
tr a[222:223],v13,27136
cv v191,v130,v131
mm v[208:211],v[220:223],v[172:175],v[208:211]
v_exp_f32 v125, v125
mm v[208:211],v[220:223],v[160:163],v[208:211]
s_waitcnt lgkmcnt(8)
tr a[224:225],v12,20480
mm v[16:19],a[192:195],v[160:163],v[16:19]
v_exp_f32 v126, v126
mm v[16:19],a[196:199],v[172:175],v[16:19]
tr a[226:227],v12,22528
cv v186,v124,v125
mm v[20:23],a[196:199],v[176:179],v[20:23]
v_exp_f32 v127, v127
mm v[20:23],a[192:195],v[164:167],v[20:23]
tr a[228:229],v12,28672
cv v187,v126,v127
mm v[24:27],a[192:195],v[168:171],v[24:27]
v_exp_f32 v136, v136
mm v[24:27],a[196:199],v[180:183],v[24:27]
tr a[230:231],v12,30720
s_waitcnt vmcnt(3)
mm v[36:39],a[204:207],v[180:183],v[36:39]
v_exp_f32 v137, v137
mm v[36:39],a[200:203],v[168:171],v[36:39]
tr a[232:233],v13,20480
buffer_load_dwordx4 v8, s[8:11], s45 offen offset:3072 nt lds
mm v[32:35],a[200:203],v[164:167],v[32:35]
v_exp_f32 v138, v138
mm v[32:35],a[204:207],v[176:179],v[32:35]
tr a[234:235],v13,22528
cv v196,v136,v137
mm v[28:31],a[204:207],v[172:175],v[28:31]
v_exp_f32 v139, v139
mm v[28:31],a[200:203],v[160:163],v[28:31]
s_waitcnt lgkmcnt(6)
tr a[236:237],v13,28672
mm v[40:43],a[208:211],v[160:163],v[40:43]
tr a[238:239],v13,30720
cv v197,v138,v139
mm v[40:43],a[212:215],v[172:175],v[40:43]
tr a[240:241],v12,20992
mm v[44:47],a[212:215],v[176:179],v[44:47]
v_exp_f32 v140, v140
mm v[44:47],a[208:211],v[164:167],v[44:47]
tr a[242:243],v12,23040
mm v[48:51],a[208:211],v[168:171],v[48:51]
v_exp_f32 v141, v141
mm v[48:51],a[212:215],v[180:183],v[48:51]
tr a[244:245],v12,29184
cv v200,v140,v141
mm v[60:63],a[220:223],v[180:183],v[60:63]
v_exp_f32 v142, v142
mm v[60:63],a[216:219],v[168:171],v[60:63]
tr a[246:247],v12,31232
s_add_u32 m0, s44, 98304
mm v[56:59],a[216:219],v[164:167],v[56:59]
v_exp_f32 v143, v143
mm v[56:59],a[220:223],v[176:179],v[56:59]
tr a[248:249],v13,20992
s_waitcnt vmcnt(3)
mm v[52:55],a[220:223],v[172:175],v[52:55]
v_exp_f32 v144, v144
mm v[52:55],a[216:219],v[160:163],v[52:55]
s_waitcnt lgkmcnt(5)
tr a[250:251],v13,23040
buffer_load_dwordx4 v5, s[12:15], s45 offen offset:0 nt lds
mm v[64:67],a[224:227],v[160:163],v[64:67]
v_exp_f32 v145, v145
mm v[64:67],a[228:231],v[172:175],v[64:67]
tr a[252:253],v13,29184
cv v201,v142,v143
mm v[68:71],a[228:231],v[176:179],v[68:71]
v_exp_f32 v146, v146
mm v[68:71],a[224:227],v[164:167],v[68:71]
tr a[254:255],v13,31232
v_add_u32 v11, 4294836224, v11
mm v[72:75],a[224:227],v[168:171],v[72:75]
v_exp_f32 v147, v147
mm v[72:75],a[228:231],v[180:183],v[72:75]
s_waitcnt vmcnt(3)
cv v204,v144,v145
mm v[84:87],a[236:239],v[180:183],v[84:87]
v_exp_f32 v156, v156
mm v[84:87],a[232:235],v[168:171],v[84:87]
buffer_load_dwordx4 v6, s[12:15], s45 offen offset:1024 nt lds
cv v205,v146,v147
mm v[80:83],a[232:235],v[164:167],v[80:83]
v_exp_f32 v157, v157
mm v[80:83],a[236:239],v[176:179],v[80:83]
cv v206,v156,v157
mm v[76:79],a[236:239],v[172:175],v[76:79]
v_exp_f32 v158, v158
mm v[76:79],a[232:235],v[160:163],v[76:79]
s_waitcnt lgkmcnt(0)
mm v[88:91],a[240:243],v[160:163],v[88:91]
s_barrier
v_exp_f32 v159, v159
mm v[88:91],a[244:247],v[172:175],v[88:91]
lq a[192:195],v11,0
cv v207,v158,v159
mm v[92:95],a[244:247],v[176:179],v[92:95]
v_exp_f32 v152, v152
mm v[92:95],a[240:243],v[164:167],v[92:95]
lq a[196:199],v11,512
mm v[96:99],a[240:243],v[168:171],v[96:99]
lq a[200:203],v11,4096
s_waitcnt vmcnt(3)
mm v[96:99],a[244:247],v[180:183],v[96:99]
lq a[204:207],v11,4608
buffer_load_dwordx4 v7, s[12:15], s45 offen offset:2048 nt lds
mm v[108:111],a[252:255],v[180:183],v[108:111]
v_exp_f32 v153, v153
mm v[108:111],a[248:251],v[168:171],v[108:111]
v_exp_f32 v154, v154
mm v[104:107],a[248:251],v[164:167],v[104:107]
v_exp_f32 v155, v155
mm v[104:107],a[252:255],v[176:179],v[104:107]
lq a[208:211],v11,2048
cv v202,v152,v153
mm v[100:103],a[252:255],v[172:175],v[100:103]
lq a[212:215],v11,2560
cv v203,v154,v155
mm v[100:103],a[248:251],v[160:163],v[100:103]
s_waitcnt lgkmcnt(2)
mm v[112:115],a[192:195],a[0:3],0
v_exp_f32 v148, v148
mm v[112:115],a[196:199],a[12:15],v[112:115]
lq a[216:219],v11,6144
mm v[112:115],a[200:203],a[24:27],v[112:115]
v_exp_f32 v149, v149
mm v[112:115],a[204:207],a[36:39],v[112:115]
lq a[220:223],v11,6656
s_waitcnt vmcnt(3)
mm v[116:119],a[204:207],a[40:43],0
v_exp_f32 v150, v150
mm v[116:119],a[200:203],a[28:31],v[116:119]
buffer_load_dwordx4 v8, s[12:15], s45 offen offset:3072 nt lds
lq a[224:227],v11,8192
mm v[116:119],a[196:199],a[16:19],v[116:119]
v_exp_f32 v151, v151
mm v[116:119],a[192:195],a[4:7],v[116:119]
lq a[228:231],v11,8704
cv v198,v148,v149
mm v[120:123],a[192:195],a[8:11],0
v_exp_f32 v112, v112
mm v[120:123],a[196:199],a[20:23],v[120:123]
L_pg9:
s_cbranch_execz L_tret0
lq a[232:235],v11,12288
v_add_u32 v12, 98304, v12
mm v[120:123],a[200:203],a[32:35],v[120:123]
v_exp_f32 v113, v113
mm v[120:123],a[204:207],a[44:47],v[120:123]
s_waitcnt lgkmcnt(3)
lq a[236:239],v11,12800
mm v[132:135],a[220:223],a[44:47],0
v_exp_f32 v114, v114
mm v[132:135],a[216:219],a[32:35],v[132:135]
s_add_u32 s45, s45, 16384
s_add_u32 m0, s43, 32768
mm v[132:135],a[212:215],a[20:23],v[132:135]
v_exp_f32 v115, v115
mm v[132:135],a[208:211],a[8:11],v[132:135]
s_waitcnt vmcnt(3)
lq a[240:243],v11,10240
mm v[128:131],a[208:211],a[4:7],0
v_exp_f32 v116, v116
mm v[128:131],a[212:215],a[16:19],v[128:131]
buffer_load_dwordx4 v5, s[8:11], s45 offen offset:0 nt lds
lq a[244:247],v11,10752
mm v[128:131],a[216:219],a[28:31],v[128:131]
v_exp_f32 v117, v117
mm v[128:131],a[220:223],a[40:43],v[128:131]
lq a[248:251],v11,14336
v_add_u32 v13, 98304, v13
mm v[124:127],a[220:223],a[36:39],0
lq a[252:255],v11,14848
cv v160,v112,v113
mm v[124:127],a[216:219],a[24:27],v[124:127]
tr a[192:193],v12,16384
cv v161,v114,v115
mm v[124:127],a[212:215],a[12:15],v[124:127]
v_exp_f32 v118, v118
mm v[124:127],a[208:211],a[0:3],v[124:127]
s_waitcnt lgkmcnt(5)
tr a[194:195],v12,18432
mm v[136:139],a[224:227],a[0:3],0
v_exp_f32 v119, v119
mm v[136:139],a[228:231],a[12:15],v[136:139]
s_waitcnt vmcnt(3)
buffer_load_dwordx4 v6, s[8:11], s45 offen offset:1024 nt lds
mm v[136:139],a[232:235],a[24:27],v[136:139]
v_exp_f32 v120, v120
mm v[136:139],a[236:239],a[36:39],v[136:139]
tr a[196:197],v12,24576
cv v164,v116,v117
mm v[140:143],a[236:239],a[40:43],0
v_exp_f32 v121, v121
mm v[140:143],a[232:235],a[28:31],v[140:143]
tr a[198:199],v12,26624
cv v165,v118,v119
mm v[140:143],a[228:231],a[16:19],v[140:143]
v_exp_f32 v122, v122
mm v[140:143],a[224:227],a[4:7],v[140:143]
tr a[200:201],v13,16384
cv v199,v150,v151
mm v[144:147],a[224:227],a[8:11],0
v_exp_f32 v123, v123
mm v[144:147],a[228:231],a[20:23],v[144:147]
tr a[202:203],v13,18432
cv v168,v120,v121
mm v[144:147],a[232:235],a[32:35],v[144:147]
v_exp_f32 v132, v132
mm v[144:147],a[236:239],a[44:47],v[144:147]
s_waitcnt lgkmcnt(6)
tr a[204:205],v13,24576
mm v[156:159],a[252:255],a[44:47],0
tr a[206:207],v13,26624
s_waitcnt vmcnt(3)
mm v[156:159],a[248:251],a[32:35],v[156:159]
buffer_load_dwordx4 v7, s[8:11], s45 offen offset:2048 nt lds
tr a[208:209],v12,16896
mm v[156:159],a[244:247],a[20:23],v[156:159]
v_exp_f32 v133, v133
mm v[156:159],a[240:243],a[8:11],v[156:159]
tr a[210:211],v12,18944
cv v169,v122,v123
mm v[152:155],a[240:243],a[4:7],0
v_exp_f32 v134, v134
mm v[152:155],a[244:247],a[16:19],v[152:155]
v_exp_f32 v135, v135
mm v[152:155],a[248:251],a[28:31],v[152:155]
v_exp_f32 v128, v128
mm v[152:155],a[252:255],a[40:43],v[152:155]
tr a[212:213],v12,25088
cv v170,v132,v133
mm v[148:151],a[252:255],a[36:39],0
v_exp_f32 v129, v129
mm v[148:151],a[248:251],a[24:27],v[148:151]
tr a[214:215],v12,27136
s_waitcnt vmcnt(3)
mm v[148:151],a[244:247],a[12:15],v[148:151]
v_exp_f32 v130, v130
mm v[148:151],a[240:243],a[0:3],v[148:151]
tr a[216:217],v13,16896
buffer_load_dwordx4 v8, s[8:11], s45 offen offset:3072 nt lds
mm v[216:219],v[220:223],v[204:207],v[216:219]
v_exp_f32 v131, v131
mm v[216:219],v[220:223],v[192:195],v[216:219]
tr a[218:219],v13,18944
cv v171,v134,v135
mm v[212:215],v[220:223],v[200:203],v[212:215]
v_exp_f32 v124, v124
mm v[212:215],v[220:223],v[188:191],v[212:215]
tr a[220:221],v13,25088
tr a[222:223],v13,27136
mm v[208:211],v[220:223],v[196:199],v[208:211]
v_exp_f32 v125, v125
mm v[208:211],v[220:223],v[184:187],v[208:211]
s_waitcnt lgkmcnt(8)
tr a[224:225],v12,20480
mm v[16:19],a[192:195],v[184:187],v[16:19]
v_exp_f32 v126, v126
mm v[16:19],a[196:199],v[196:199],v[16:19]
tr a[226:227],v12,22528
cv v166,v128,v129
mm v[20:23],a[196:199],v[200:203],v[20:23]
v_exp_f32 v127, v127
mm v[20:23],a[192:195],v[188:191],v[20:23]
tr a[228:229],v12,28672
cv v167,v130,v131
mm v[24:27],a[192:195],v[192:195],v[24:27]
v_exp_f32 v136, v136
mm v[24:27],a[196:199],v[204:207],v[24:27]
tr a[230:231],v12,30720
s_add_u32 m0, s44, 32768
mm v[36:39],a[204:207],v[204:207],v[36:39]
v_exp_f32 v137, v137
mm v[36:39],a[200:203],v[192:195],v[36:39]
tr a[232:233],v13,20480
s_waitcnt vmcnt(3)
mm v[32:35],a[200:203],v[188:191],v[32:35]
v_exp_f32 v138, v138
mm v[32:35],a[204:207],v[200:203],v[32:35]
buffer_load_dwordx4 v5, s[12:15], s45 offen offset:0 nt lds
tr a[234:235],v13,22528
mm v[28:31],a[204:207],v[196:199],v[28:31]
v_exp_f32 v139, v139
mm v[28:31],a[200:203],v[184:187],v[28:31]
s_waitcnt lgkmcnt(6)
tr a[236:237],v13,28672
mm v[40:43],a[208:211],v[184:187],v[40:43]
tr a[238:239],v13,30720
cv v162,v124,v125
mm v[40:43],a[212:215],v[196:199],v[40:43]
tr a[240:241],v12,20992
cv v163,v126,v127
mm v[44:47],a[212:215],v[200:203],v[44:47]
v_exp_f32 v140, v140
mm v[44:47],a[208:211],v[188:191],v[44:47]
tr a[242:243],v12,23040
cv v172,v136,v137
mm v[48:51],a[208:211],v[192:195],v[48:51]
v_exp_f32 v141, v141
mm v[48:51],a[212:215],v[204:207],v[48:51]
tr a[244:245],v12,29184
cv v173,v138,v139
mm v[60:63],a[220:223],v[204:207],v[60:63]
v_exp_f32 v142, v142
mm v[60:63],a[216:219],v[192:195],v[60:63]
tr a[246:247],v12,31232
cv v176,v140,v141
mm v[56:59],a[216:219],v[188:191],v[56:59]
v_exp_f32 v143, v143
mm v[56:59],a[220:223],v[200:203],v[56:59]
tr a[248:249],v13,20992
s_waitcnt vmcnt(3)
mm v[52:55],a[220:223],v[196:199],v[52:55]
v_exp_f32 v144, v144
mm v[52:55],a[216:219],v[184:187],v[52:55]
s_waitcnt lgkmcnt(5)
tr a[250:251],v13,23040
mm v[64:67],a[224:227],v[184:187],v[64:67]
v_exp_f32 v145, v145
mm v[64:67],a[228:231],v[196:199],v[64:67]
tr a[252:253],v13,29184
buffer_load_dwordx4 v6, s[12:15], s45 offen offset:1024 nt lds
mm v[68:71],a[228:231],v[200:203],v[68:71]
v_exp_f32 v146, v146
mm v[68:71],a[224:227],v[188:191],v[68:71]
tr a[254:255],v13,31232
cv v177,v142,v143
mm v[72:75],a[224:227],v[192:195],v[72:75]
v_exp_f32 v147, v147
mm v[72:75],a[228:231],v[204:207],v[72:75]
v_add_u32 v11, 65536, v11
cv v180,v144,v145
mm v[84:87],a[236:239],v[204:207],v[84:87]
v_exp_f32 v156, v156
mm v[84:87],a[232:235],v[192:195],v[84:87]
cv v181,v146,v147
mm v[80:83],a[232:235],v[188:191],v[80:83]
v_exp_f32 v157, v157
mm v[80:83],a[236:239],v[200:203],v[80:83]
cv v182,v156,v157
mm v[76:79],a[236:239],v[196:199],v[76:79]
v_exp_f32 v158, v158
mm v[76:79],a[232:235],v[184:187],v[76:79]
s_waitcnt lgkmcnt(0)
s_waitcnt vmcnt(3)
mm v[88:91],a[240:243],v[184:187],v[88:91]
s_barrier
buffer_load_dwordx4 v7, s[12:15], s45 offen offset:2048 nt lds
v_exp_f32 v159, v159
mm v[88:91],a[244:247],v[196:199],v[88:91]
lq a[192:195],v11,0
cv v183,v158,v159
mm v[92:95],a[244:247],v[200:203],v[92:95]
v_exp_f32 v152, v152
mm v[92:95],a[240:243],v[188:191],v[92:95]
lq a[196:199],v11,512
mm v[96:99],a[240:243],v[192:195],v[96:99]
lq a[200:203],v11,4096
mm v[96:99],a[244:247],v[204:207],v[96:99]
lq a[204:207],v11,4608
mm v[108:111],a[252:255],v[204:207],v[108:111]
v_exp_f32 v153, v153
mm v[108:111],a[248:251],v[192:195],v[108:111]
v_exp_f32 v154, v154
mm v[104:107],a[248:251],v[188:191],v[104:107]
v_exp_f32 v155, v155
mm v[104:107],a[252:255],v[200:203],v[104:107]
lq a[208:211],v11,2048
cv v178,v152,v153
mm v[100:103],a[252:255],v[196:199],v[100:103]
lq a[212:215],v11,2560
cv v179,v154,v155
mm v[100:103],a[248:251],v[184:187],v[100:103]
s_waitcnt lgkmcnt(2)
mm v[112:115],a[192:195],a[0:3],0
v_exp_f32 v148, v148
mm v[112:115],a[196:199],a[12:15],v[112:115]
lq a[216:219],v11,6144
mm v[112:115],a[200:203],a[24:27],v[112:115]
v_exp_f32 v149, v149
mm v[112:115],a[204:207],a[36:39],v[112:115]
lq a[220:223],v11,6656
s_waitcnt vmcnt(3)
mm v[116:119],a[204:207],a[40:43],0
v_exp_f32 v150, v150
mm v[116:119],a[200:203],a[28:31],v[116:119]
buffer_load_dwordx4 v8, s[12:15], s45 offen offset:3072 nt lds
lq a[224:227],v11,8192
mm v[116:119],a[196:199],a[16:19],v[116:119]
v_exp_f32 v151, v151
mm v[116:119],a[192:195],a[4:7],v[116:119]
lq a[228:231],v11,8704
cv v174,v148,v149
mm v[120:123],a[192:195],a[8:11],0
v_exp_f32 v112, v112
mm v[120:123],a[196:199],a[20:23],v[120:123]
lq a[232:235],v11,12288
v_add_u32 v12, 4294836224, v12
mm v[120:123],a[200:203],a[32:35],v[120:123]
v_exp_f32 v113, v113
mm v[120:123],a[204:207],a[44:47],v[120:123]
s_waitcnt lgkmcnt(3)
lq a[236:239],v11,12800
mm v[132:135],a[220:223],a[44:47],0
v_exp_f32 v114, v114
mm v[132:135],a[216:219],a[32:35],v[132:135]
lq a[240:243],v11,10240
v_add_u32 v13, 4294836224, v13
mm v[132:135],a[212:215],a[20:23],v[132:135]
v_exp_f32 v115, v115
mm v[132:135],a[208:211],a[8:11],v[132:135]
lq a[244:247],v11,10752
cv v184,v112,v113
mm v[128:131],a[208:211],a[4:7],0
v_exp_f32 v116, v116
mm v[128:131],a[212:215],a[16:19],v[128:131]
lq a[248:251],v11,14336
s_add_u32 s45, s45, 16384
mm v[128:131],a[216:219],a[28:31],v[128:131]
v_exp_f32 v117, v117
mm v[128:131],a[220:223],a[40:43],v[128:131]
lq a[252:255],v11,14848
s_add_u32 m0, s43, 131072
mm v[124:127],a[220:223],a[36:39],0
v_exp_f32 v118, v118
mm v[124:127],a[216:219],a[24:27],v[124:127]
s_waitcnt vmcnt(3)
buffer_load_dwordx4 v5, s[8:11], s45 offen offset:0 nt lds
mm v[124:127],a[212:215],a[12:15],v[124:127]
v_exp_f32 v119, v119
mm v[124:127],a[208:211],a[0:3],v[124:127]
s_waitcnt lgkmcnt(4)
tr a[192:193],v12,16384
mm v[136:139],a[224:227],a[0:3],0
v_exp_f32 v120, v120
mm v[136:139],a[228:231],a[12:15],v[136:139]
tr a[194:195],v12,18432
cv v185,v114,v115
mm v[136:139],a[232:235],a[24:27],v[136:139]
v_exp_f32 v121, v121
mm v[136:139],a[236:239],a[36:39],v[136:139]
tr a[196:197],v12,24576
cv v188,v116,v117
mm v[140:143],a[236:239],a[40:43],0
v_exp_f32 v122, v122
mm v[140:143],a[232:235],a[28:31],v[140:143]
tr a[198:199],v12,26624
cv v189,v118,v119
mm v[140:143],a[228:231],a[16:19],v[140:143]
v_exp_f32 v123, v123
mm v[140:143],a[224:227],a[4:7],v[140:143]
tr a[200:201],v13,16384
cv v175,v150,v151
mm v[144:147],a[224:227],a[8:11],0
v_exp_f32 v132, v132
mm v[144:147],a[228:231],a[20:23],v[144:147]
tr a[202:203],v13,18432
s_waitcnt vmcnt(3)
mm v[144:147],a[232:235],a[32:35],v[144:147]
v_exp_f32 v133, v133
mm v[144:147],a[236:239],a[44:47],v[144:147]
s_waitcnt lgkmcnt(6)
tr a[204:205],v13,24576
mm v[156:159],a[252:255],a[44:47],0
tr a[206:207],v13,26624
buffer_load_dwordx4 v6, s[8:11], s45 offen offset:1024 nt lds
mm v[156:159],a[248:251],a[32:35],v[156:159]
tr a[208:209],v12,16896
cv v192,v120,v121
mm v[156:159],a[244:247],a[20:23],v[156:159]
v_exp_f32 v134, v134
mm v[156:159],a[240:243],a[8:11],v[156:159]
tr a[210:211],v12,18944
cv v193,v122,v123
mm v[152:155],a[240:243],a[4:7],0
v_exp_f32 v135, v135
mm v[152:155],a[244:247],a[16:19],v[152:155]
tr a[212:213],v12,25088
cv v194,v132,v133
mm v[152:155],a[248:251],a[28:31],v[152:155]
v_exp_f32 v128, v128
mm v[152:155],a[252:255],a[40:43],v[152:155]
tr a[214:215],v12,27136
cv v195,v134,v135
mm v[148:151],a[252:255],a[36:39],0
v_exp_f32 v129, v129
mm v[148:151],a[248:251],a[24:27],v[148:151]
tr a[216:217],v13,16896
cv v190,v128,v129
mm v[148:151],a[244:247],a[12:15],v[148:151]
v_exp_f32 v130, v130
mm v[148:151],a[240:243],a[0:3],v[148:151]
tr a[218:219],v13,18944
s_waitcnt vmcnt(3)
mm v[216:219],v[220:223],v[180:183],v[216:219]
v_exp_f32 v131, v131
mm v[216:219],v[220:223],v[168:171],v[216:219]
tr a[220:221],v13,25088
buffer_load_dwordx4 v7, s[8:11], s45 offen offset:2048 nt lds
mm v[212:215],v[220:223],v[176:179],v[212:215]
v_exp_f32 v124, v124
mm v[212:215],v[220:223],v[164:167],v[212:215]
tr a[222:223],v13,27136
cv v191,v130,v131
mm v[208:211],v[220:223],v[172:175],v[208:211]
v_exp_f32 v125, v125
mm v[208:211],v[220:223],v[160:163],v[208:211]
s_waitcnt lgkmcnt(8)
tr a[224:225],v12,20480
mm v[16:19],a[192:195],v[160:163],v[16:19]
v_exp_f32 v126, v126
mm v[16:19],a[196:199],v[172:175],v[16:19]
tr a[226:227],v12,22528
cv v186,v124,v125
mm v[20:23],a[196:199],v[176:179],v[20:23]
v_exp_f32 v127, v127
mm v[20:23],a[192:195],v[164:167],v[20:23]
tr a[228:229],v12,28672
cv v187,v126,v127
mm v[24:27],a[192:195],v[168:171],v[24:27]
v_exp_f32 v136, v136
mm v[24:27],a[196:199],v[180:183],v[24:27]
tr a[230:231],v12,30720
mm v[36:39],a[204:207],v[180:183],v[36:39]
v_exp_f32 v137, v137
mm v[36:39],a[200:203],v[168:171],v[36:39]
tr a[232:233],v13,20480
cv v196,v136,v137
mm v[32:35],a[200:203],v[164:167],v[32:35]
v_exp_f32 v138, v138
mm v[32:35],a[204:207],v[176:179],v[32:35]
tr a[234:235],v13,22528
s_waitcnt vmcnt(3)
mm v[28:31],a[204:207],v[172:175],v[28:31]
v_exp_f32 v139, v139
mm v[28:31],a[200:203],v[160:163],v[28:31]
s_waitcnt lgkmcnt(6)
tr a[236:237],v13,28672
mm v[40:43],a[208:211],v[160:163],v[40:43]
tr a[238:239],v13,30720
buffer_load_dwordx4 v8, s[8:11], s45 offen offset:3072 nt lds
mm v[40:43],a[212:215],v[172:175],v[40:43]
tr a[240:241],v12,20992
cv v197,v138,v139
mm v[44:47],a[212:215],v[176:179],v[44:47]
v_exp_f32 v140, v140
mm v[44:47],a[208:211],v[164:167],v[44:47]
tr a[242:243],v12,23040
mm v[48:51],a[208:211],v[168:171],v[48:51]
v_exp_f32 v141, v141
mm v[48:51],a[212:215],v[180:183],v[48:51]
tr a[244:245],v12,29184
cv v200,v140,v141
mm v[60:63],a[220:223],v[180:183],v[60:63]
v_exp_f32 v142, v142
mm v[60:63],a[216:219],v[168:171],v[60:63]
tr a[246:247],v12,31232
mm v[56:59],a[216:219],v[164:167],v[56:59]
v_exp_f32 v143, v143
mm v[56:59],a[220:223],v[176:179],v[56:59]
tr a[248:249],v13,20992
cv v201,v142,v143
mm v[52:55],a[220:223],v[172:175],v[52:55]
v_exp_f32 v144, v144
mm v[52:55],a[216:219],v[160:163],v[52:55]
s_waitcnt lgkmcnt(5)
tr a[250:251],v13,23040
mm v[64:67],a[224:227],v[160:163],v[64:67]
v_exp_f32 v145, v145
mm v[64:67],a[228:231],v[172:175],v[64:67]
tr a[252:253],v13,29184
s_add_u32 m0, s44, 131072
mm v[68:71],a[228:231],v[176:179],v[68:71]
v_exp_f32 v146, v146
mm v[68:71],a[224:227],v[164:167],v[68:71]
tr a[254:255],v13,31232
s_waitcnt vmcnt(3)
mm v[72:75],a[224:227],v[168:171],v[72:75]
v_exp_f32 v147, v147
buffer_load_dwordx4 v5, s[12:15], s45 offen offset:0 nt lds
mm v[72:75],a[228:231],v[180:183],v[72:75]
cv v204,v144,v145
cv v205,v146,v147
mm v[84:87],a[236:239],v[180:183],v[84:87]
v_exp_f32 v156, v156
mm v[84:87],a[232:235],v[168:171],v[84:87]
v_exp_f32 v157, v157
mm v[80:83],a[232:235],v[164:167],v[80:83]
v_exp_f32 v158, v158
mm v[80:83],a[236:239],v[176:179],v[80:83]
cv v206,v156,v157
mm v[76:79],a[236:239],v[172:175],v[76:79]
v_exp_f32 v159, v159
mm v[76:79],a[232:235],v[160:163],v[76:79]
s_waitcnt lgkmcnt(0)
cv v207,v158,v159
mm v[88:91],a[240:243],v[160:163],v[88:91]
s_barrier
mm v[88:91],a[244:247],v[172:175],v[88:91]
lq a[192:195],v11,32768
mm v[92:95],a[244:247],v[176:179],v[92:95]
v_exp_f32 v152, v152
mm v[92:95],a[240:243],v[164:167],v[92:95]
lq a[196:199],v11,33280
s_waitcnt vmcnt(3)
mm v[96:99],a[240:243],v[168:171],v[96:99]
lq a[200:203],v11,36864
buffer_load_dwordx4 v6, s[12:15], s45 offen offset:1024 nt lds
mm v[96:99],a[244:247],v[180:183],v[96:99]
lq a[204:207],v11,37376
mm v[108:111],a[252:255],v[180:183],v[108:111]
v_exp_f32 v153, v153
mm v[108:111],a[248:251],v[168:171],v[108:111]
v_exp_f32 v154, v154
mm v[104:107],a[248:251],v[164:167],v[104:107]
v_exp_f32 v155, v155
mm v[104:107],a[252:255],v[176:179],v[104:107]
lq a[208:211],v11,34816
cv v202,v152,v153
mm v[100:103],a[252:255],v[172:175],v[100:103]
lq a[212:215],v11,35328
cv v203,v154,v155
mm v[100:103],a[248:251],v[160:163],v[100:103]
s_waitcnt lgkmcnt(2)
mm v[112:115],a[192:195],a[0:3],0
v_exp_f32 v148, v148
mm v[112:115],a[196:199],a[12:15],v[112:115]
lq a[216:219],v11,38912
mm v[112:115],a[200:203],a[24:27],v[112:115]
v_exp_f32 v149, v149
mm v[112:115],a[204:207],a[36:39],v[112:115]
lq a[220:223],v11,39424
cv v198,v148,v149
mm v[116:119],a[204:207],a[40:43],0
v_exp_f32 v150, v150
mm v[116:119],a[200:203],a[28:31],v[116:119]
lq a[224:227],v11,40960
s_waitcnt vmcnt(3)
mm v[116:119],a[196:199],a[16:19],v[116:119]
v_exp_f32 v151, v151
mm v[116:119],a[192:195],a[4:7],v[116:119]
buffer_load_dwordx4 v7, s[12:15], s45 offen offset:2048 nt lds
lq a[228:231],v11,41472
mm v[120:123],a[192:195],a[8:11],0
v_exp_f32 v112, v112
mm v[120:123],a[196:199],a[20:23],v[120:123]
lq a[232:235],v11,45056
v_add_u32 v12, 65536, v12
mm v[120:123],a[200:203],a[32:35],v[120:123]
v_exp_f32 v113, v113
mm v[120:123],a[204:207],a[44:47],v[120:123]
s_waitcnt lgkmcnt(3)
lq a[236:239],v11,45568
mm v[132:135],a[220:223],a[44:47],0
v_exp_f32 v114, v114
mm v[132:135],a[216:219],a[32:35],v[132:135]
lq a[240:243],v11,43008
v_add_u32 v13, 65536, v13
mm v[132:135],a[212:215],a[20:23],v[132:135]
v_exp_f32 v115, v115
mm v[132:135],a[208:211],a[8:11],v[132:135]
lq a[244:247],v11,43520
cv v160,v112,v113
mm v[128:131],a[208:211],a[4:7],0
v_exp_f32 v116, v116
mm v[128:131],a[212:215],a[16:19],v[128:131]
lq a[248:251],v11,47104
cv v161,v114,v115
mm v[128:131],a[216:219],a[28:31],v[128:131]
v_exp_f32 v117, v117
mm v[128:131],a[220:223],a[40:43],v[128:131]
lq a[252:255],v11,47616
cv v164,v116,v117
mm v[124:127],a[220:223],a[36:39],0
v_exp_f32 v118, v118
mm v[124:127],a[216:219],a[24:27],v[124:127]
s_waitcnt vmcnt(3)
buffer_load_dwordx4 v8, s[12:15], s45 offen offset:3072 nt lds
mm v[124:127],a[212:215],a[12:15],v[124:127]
v_exp_f32 v119, v119
mm v[124:127],a[208:211],a[0:3],v[124:127]
s_waitcnt lgkmcnt(4)
tr a[192:193],v12,16384
mm v[136:139],a[224:227],a[0:3],0
v_exp_f32 v120, v120
mm v[136:139],a[228:231],a[12:15],v[136:139]
tr a[194:195],v12,18432
cv v165,v118,v119
mm v[136:139],a[232:235],a[24:27],v[136:139]
v_exp_f32 v121, v121
mm v[136:139],a[236:239],a[36:39],v[136:139]
tr a[196:197],v12,24576
cv v199,v150,v151
mm v[140:143],a[236:239],a[40:43],0
v_exp_f32 v122, v122
mm v[140:143],a[232:235],a[28:31],v[140:143]
tr a[198:199],v12,26624
cv v168,v120,v121
mm v[140:143],a[228:231],a[16:19],v[140:143]
v_exp_f32 v123, v123
mm v[140:143],a[224:227],a[4:7],v[140:143]
tr a[200:201],v13,16384
cv v169,v122,v123
mm v[144:147],a[224:227],a[8:11],0
v_exp_f32 v132, v132
mm v[144:147],a[228:231],a[20:23],v[144:147]
tr a[202:203],v13,18432
mm v[144:147],a[232:235],a[32:35],v[144:147]
v_exp_f32 v133, v133
mm v[144:147],a[236:239],a[44:47],v[144:147]
s_waitcnt lgkmcnt(6)
tr a[204:205],v13,24576
mm v[156:159],a[252:255],a[44:47],0
tr a[206:207],v13,26624
s_add_u32 s45, s45, 16384
mm v[156:159],a[248:251],a[32:35],v[156:159]
s_add_u32 m0, s43, 0
s_waitcnt vmcnt(3)
mm v[156:159],a[244:247],a[20:23],v[156:159]
v_exp_f32 v134, v134
mm v[156:159],a[240:243],a[8:11],v[156:159]
buffer_load_dwordx4 v5, s[8:11], s45 offen offset:0 nt lds
tr a[208:209],v12,16896
mm v[152:155],a[240:243],a[4:7],0
v_exp_f32 v135, v135
mm v[152:155],a[244:247],a[16:19],v[152:155]
tr a[210:211],v12,18944
cv v170,v132,v133
mm v[152:155],a[248:251],a[28:31],v[152:155]
v_exp_f32 v128, v128
L_pg10:
s_cbranch_execz L_tret0
mm v[152:155],a[252:255],a[40:43],v[152:155]
tr a[212:213],v12,25088
cv v171,v134,v135
mm v[148:151],a[252:255],a[36:39],0
v_exp_f32 v129, v129
mm v[148:151],a[248:251],a[24:27],v[148:151]
tr a[214:215],v12,27136
cv v166,v128,v129
mm v[148:151],a[244:247],a[12:15],v[148:151]
v_exp_f32 v130, v130
mm v[148:151],a[240:243],a[0:3],v[148:151]
tr a[216:217],v13,16896
mm v[216:219],v[220:223],v[204:207],v[216:219]
v_exp_f32 v131, v131
mm v[216:219],v[220:223],v[192:195],v[216:219]
tr a[218:219],v13,18944
cv v167,v130,v131
mm v[212:215],v[220:223],v[200:203],v[212:215]
v_exp_f32 v124, v124
mm v[212:215],v[220:223],v[188:191],v[212:215]
tr a[220:221],v13,25088
tr a[222:223],v13,27136
mm v[208:211],v[220:223],v[196:199],v[208:211]
v_exp_f32 v125, v125
mm v[208:211],v[220:223],v[184:187],v[208:211]
s_waitcnt lgkmcnt(8)
s_waitcnt vmcnt(3)
mm v[16:19],a[192:195],v[184:187],v[16:19]
v_exp_f32 v126, v126
mm v[16:19],a[196:199],v[196:199],v[16:19]
buffer_load_dwordx4 v6, s[8:11], s45 offen offset:1024 nt lds
tr a[224:225],v12,20480
mm v[20:23],a[196:199],v[200:203],v[20:23]
v_exp_f32 v127, v127
mm v[20:23],a[192:195],v[188:191],v[20:23]
tr a[226:227],v12,22528
cv v162,v124,v125
mm v[24:27],a[192:195],v[192:195],v[24:27]
v_exp_f32 v136, v136
mm v[24:27],a[196:199],v[204:207],v[24:27]
tr a[228:229],v12,28672
cv v163,v126,v127
mm v[36:39],a[204:207],v[204:207],v[36:39]
v_exp_f32 v137, v137
mm v[36:39],a[200:203],v[192:195],v[36:39]
tr a[230:231],v12,30720
cv v172,v136,v137
mm v[32:35],a[200:203],v[188:191],v[32:35]
v_exp_f32 v138, v138
mm v[32:35],a[204:207],v[200:203],v[32:35]
tr a[232:233],v13,20480
mm v[28:31],a[204:207],v[196:199],v[28:31]
v_exp_f32 v139, v139
mm v[28:31],a[200:203],v[184:187],v[28:31]
s_waitcnt lgkmcnt(5)
tr a[234:235],v13,22528
mm v[40:43],a[208:211],v[184:187],v[40:43]
tr a[236:237],v13,28672
tr a[238:239],v13,30720
mm v[40:43],a[212:215],v[196:199],v[40:43]
tr a[240:241],v12,20992
s_waitcnt vmcnt(3)
mm v[44:47],a[212:215],v[200:203],v[44:47]
v_exp_f32 v140, v140
mm v[44:47],a[208:211],v[188:191],v[44:47]
tr a[242:243],v12,23040
buffer_load_dwordx4 v7, s[8:11], s45 offen offset:2048 nt lds
mm v[48:51],a[208:211],v[192:195],v[48:51]
v_exp_f32 v141, v141
mm v[48:51],a[212:215],v[204:207],v[48:51]
tr a[244:245],v12,29184
cv v173,v138,v139
mm v[60:63],a[220:223],v[204:207],v[60:63]
v_exp_f32 v142, v142
mm v[60:63],a[216:219],v[192:195],v[60:63]
tr a[246:247],v12,31232
cv v176,v140,v141
mm v[56:59],a[216:219],v[188:191],v[56:59]
v_exp_f32 v143, v143
mm v[56:59],a[220:223],v[200:203],v[56:59]
tr a[248:249],v13,20992
cv v177,v142,v143
mm v[52:55],a[220:223],v[196:199],v[52:55]
v_exp_f32 v144, v144
mm v[52:55],a[216:219],v[184:187],v[52:55]
s_waitcnt lgkmcnt(5)
tr a[250:251],v13,23040
mm v[64:67],a[224:227],v[184:187],v[64:67]
v_exp_f32 v145, v145
mm v[64:67],a[228:231],v[196:199],v[64:67]
tr a[252:253],v13,29184
v_add_u32 v11, 4294934528, v11
mm v[68:71],a[228:231],v[200:203],v[68:71]
v_exp_f32 v146, v146
mm v[68:71],a[224:227],v[188:191],v[68:71]
tr a[254:255],v13,31232
s_waitcnt vmcnt(3)
mm v[72:75],a[224:227],v[192:195],v[72:75]
v_exp_f32 v147, v147
mm v[72:75],a[228:231],v[204:207],v[72:75]
buffer_load_dwordx4 v8, s[8:11], s45 offen offset:3072 nt lds
cv v180,v144,v145
mm v[84:87],a[236:239],v[204:207],v[84:87]
v_exp_f32 v156, v156
mm v[84:87],a[232:235],v[192:195],v[84:87]
cv v181,v146,v147
mm v[80:83],a[232:235],v[188:191],v[80:83]
v_exp_f32 v157, v157
mm v[80:83],a[236:239],v[200:203],v[80:83]
cv v182,v156,v157
mm v[76:79],a[236:239],v[196:199],v[76:79]
v_exp_f32 v158, v158
mm v[76:79],a[232:235],v[184:187],v[76:79]
s_waitcnt lgkmcnt(0)
mm v[88:91],a[240:243],v[184:187],v[88:91]
s_barrier
v_exp_f32 v159, v159
mm v[88:91],a[244:247],v[196:199],v[88:91]
lq a[192:195],v11,0
cv v183,v158,v159
mm v[92:95],a[244:247],v[200:203],v[92:95]
v_exp_f32 v152, v152
mm v[92:95],a[240:243],v[188:191],v[92:95]
lq a[196:199],v11,512
mm v[96:99],a[240:243],v[192:195],v[96:99]
lq a[200:203],v11,4096
mm v[96:99],a[244:247],v[204:207],v[96:99]
lq a[204:207],v11,4608
s_add_u32 m0, s44, 0
mm v[108:111],a[252:255],v[204:207],v[108:111]
v_exp_f32 v153, v153
mm v[108:111],a[248:251],v[192:195],v[108:111]
v_exp_f32 v154, v154
mm v[104:107],a[248:251],v[188:191],v[104:107]
v_exp_f32 v155, v155
mm v[104:107],a[252:255],v[200:203],v[104:107]
lq a[208:211],v11,2048
s_waitcnt vmcnt(3)
mm v[100:103],a[252:255],v[196:199],v[100:103]
buffer_load_dwordx4 v5, s[12:15], s45 offen offset:0 nt lds
lq a[212:215],v11,2560
mm v[100:103],a[248:251],v[184:187],v[100:103]
s_waitcnt lgkmcnt(2)
cv v178,v152,v153
cv v179,v154,v155
mm v[112:115],a[192:195],a[0:3],0
v_exp_f32 v148, v148
mm v[112:115],a[196:199],a[12:15],v[112:115]
lq a[216:219],v11,6144
mm v[112:115],a[200:203],a[24:27],v[112:115]
v_exp_f32 v149, v149
mm v[112:115],a[204:207],a[36:39],v[112:115]
lq a[220:223],v11,6656
cv v174,v148,v149
mm v[116:119],a[204:207],a[40:43],0
v_exp_f32 v150, v150
mm v[116:119],a[200:203],a[28:31],v[116:119]
lq a[224:227],v11,8192
mm v[116:119],a[196:199],a[16:19],v[116:119]
v_exp_f32 v151, v151
mm v[116:119],a[192:195],a[4:7],v[116:119]
lq a[228:231],v11,8704
cv v175,v150,v151
mm v[120:123],a[192:195],a[8:11],0
v_exp_f32 v112, v112
mm v[120:123],a[196:199],a[20:23],v[120:123]
lq a[232:235],v11,12288
s_waitcnt vmcnt(3)
mm v[120:123],a[200:203],a[32:35],v[120:123]
v_exp_f32 v113, v113
mm v[120:123],a[204:207],a[44:47],v[120:123]
s_waitcnt lgkmcnt(3)
lq a[236:239],v11,12800
mm v[132:135],a[220:223],a[44:47],0
v_exp_f32 v114, v114
mm v[132:135],a[216:219],a[32:35],v[132:135]
buffer_load_dwordx4 v6, s[12:15], s45 offen offset:1024 nt lds
lq a[240:243],v11,10240
mm v[132:135],a[212:215],a[20:23],v[132:135]
v_exp_f32 v115, v115
mm v[132:135],a[208:211],a[8:11],v[132:135]
lq a[244:247],v11,10752
cv v184,v112,v113
mm v[128:131],a[208:211],a[4:7],0
v_exp_f32 v116, v116
mm v[128:131],a[212:215],a[16:19],v[128:131]
lq a[248:251],v11,14336
cv v185,v114,v115
mm v[128:131],a[216:219],a[28:31],v[128:131]
v_exp_f32 v117, v117
mm v[128:131],a[220:223],a[40:43],v[128:131]
lq a[252:255],v11,14848
cv v188,v116,v117
mm v[124:127],a[220:223],a[36:39],0
v_exp_f32 v118, v118
mm v[124:127],a[216:219],a[24:27],v[124:127]
tr a[192:193],v12,49152
mm v[124:127],a[212:215],a[12:15],v[124:127]
v_exp_f32 v119, v119
mm v[124:127],a[208:211],a[0:3],v[124:127]
s_waitcnt lgkmcnt(5)
tr a[194:195],v12,51200
mm v[136:139],a[224:227],a[0:3],0
v_exp_f32 v120, v120
mm v[136:139],a[228:231],a[12:15],v[136:139]
s_waitcnt vmcnt(3)
buffer_load_dwordx4 v7, s[12:15], s45 offen offset:2048 nt lds
mm v[136:139],a[232:235],a[24:27],v[136:139]
v_exp_f32 v121, v121
mm v[136:139],a[236:239],a[36:39],v[136:139]
tr a[196:197],v12,57344
cv v189,v118,v119
mm v[140:143],a[236:239],a[40:43],0
v_exp_f32 v122, v122
mm v[140:143],a[232:235],a[28:31],v[140:143]
tr a[198:199],v12,59392
cv v192,v120,v121
mm v[140:143],a[228:231],a[16:19],v[140:143]
v_exp_f32 v123, v123
mm v[140:143],a[224:227],a[4:7],v[140:143]
tr a[200:201],v13,49152
cv v193,v122,v123
mm v[144:147],a[224:227],a[8:11],0
v_exp_f32 v132, v132
mm v[144:147],a[228:231],a[20:23],v[144:147]
tr a[202:203],v13,51200
mm v[144:147],a[232:235],a[32:35],v[144:147]
v_exp_f32 v133, v133
mm v[144:147],a[236:239],a[44:47],v[144:147]
s_waitcnt lgkmcnt(6)
tr a[204:205],v13,57344
mm v[156:159],a[252:255],a[44:47],0
tr a[206:207],v13,59392
cv v194,v132,v133
mm v[156:159],a[248:251],a[32:35],v[156:159]
tr a[208:209],v12,49664
mm v[156:159],a[244:247],a[20:23],v[156:159]
v_exp_f32 v134, v134
mm v[156:159],a[240:243],a[8:11],v[156:159]
tr a[210:211],v12,51712
s_waitcnt vmcnt(3)
mm v[152:155],a[240:243],a[4:7],0
v_exp_f32 v135, v135
mm v[152:155],a[244:247],a[16:19],v[152:155]
buffer_load_dwordx4 v8, s[12:15], s45 offen offset:3072 nt lds
tr a[212:213],v12,57856
mm v[152:155],a[248:251],a[28:31],v[152:155]
v_exp_f32 v128, v128
mm v[152:155],a[252:255],a[40:43],v[152:155]
tr a[214:215],v12,59904
cv v195,v134,v135
mm v[148:151],a[252:255],a[36:39],0
v_exp_f32 v129, v129
mm v[148:151],a[248:251],a[24:27],v[148:151]
tr a[216:217],v13,49664
cv v190,v128,v129
mm v[148:151],a[244:247],a[12:15],v[148:151]
v_exp_f32 v130, v130
mm v[148:151],a[240:243],a[0:3],v[148:151]
tr a[218:219],v13,51712
mm v[216:219],v[220:223],v[180:183],v[216:219]
v_exp_f32 v131, v131
mm v[216:219],v[220:223],v[168:171],v[216:219]
tr a[220:221],v13,57856
cv v191,v130,v131
mm v[212:215],v[220:223],v[176:179],v[212:215]
v_exp_f32 v124, v124
mm v[212:215],v[220:223],v[164:167],v[212:215]
tr a[222:223],v13,59904
mm v[208:211],v[220:223],v[172:175],v[208:211]
v_exp_f32 v125, v125
mm v[208:211],v[220:223],v[160:163],v[208:211]
s_waitcnt lgkmcnt(8)
tr a[224:225],v12,53248
mm v[16:19],a[192:195],v[160:163],v[16:19]
v_exp_f32 v126, v126
mm v[16:19],a[196:199],v[172:175],v[16:19]
s_add_u32 s45, s45, 16384
tr a[226:227],v12,55296
mm v[20:23],a[196:199],v[176:179],v[20:23]
v_exp_f32 v127, v127
mm v[20:23],a[192:195],v[164:167],v[20:23]
s_add_u32 m0, s43, 65536
s_waitcnt vmcnt(3)
mm v[24:27],a[192:195],v[168:171],v[24:27]
buffer_load_dwordx4 v5, s[8:11], s45 offen offset:0 nt lds
tr a[228:229],v12,61440
mm v[24:27],a[196:199],v[180:183],v[24:27]
tr a[230:231],v12,63488
cv v186,v124,v125
mm v[36:39],a[204:207],v[180:183],v[36:39]
v_exp_f32 v136, v136
mm v[36:39],a[200:203],v[168:171],v[36:39]
tr a[232:233],v13,53248
cv v187,v126,v127
mm v[32:35],a[200:203],v[164:167],v[32:35]
v_exp_f32 v137, v137
mm v[32:35],a[204:207],v[176:179],v[32:35]
tr a[234:235],v13,55296
cv v196,v136,v137
mm v[28:31],a[204:207],v[172:175],v[28:31]
v_exp_f32 v138, v138
mm v[28:31],a[200:203],v[160:163],v[28:31]
s_waitcnt lgkmcnt(6)
tr a[236:237],v13,61440
mm v[40:43],a[208:211],v[160:163],v[40:43]
tr a[238:239],v13,63488
v_exp_f32 v139, v139
mm v[40:43],a[212:215],v[172:175],v[40:43]
tr a[240:241],v12,53760
cv v197,v138,v139
mm v[44:47],a[212:215],v[176:179],v[44:47]
v_exp_f32 v140, v140
mm v[44:47],a[208:211],v[164:167],v[44:47]
tr a[242:243],v12,55808
s_waitcnt vmcnt(3)
mm v[48:51],a[208:211],v[168:171],v[48:51]
v_exp_f32 v141, v141
mm v[48:51],a[212:215],v[180:183],v[48:51]
tr a[244:245],v12,61952
buffer_load_dwordx4 v6, s[8:11], s45 offen offset:1024 nt lds
mm v[60:63],a[220:223],v[180:183],v[60:63]
v_exp_f32 v142, v142
mm v[60:63],a[216:219],v[168:171],v[60:63]
tr a[246:247],v12,64000
cv v200,v140,v141
mm v[56:59],a[216:219],v[164:167],v[56:59]
v_exp_f32 v143, v143
mm v[56:59],a[220:223],v[176:179],v[56:59]
tr a[248:249],v13,53760
cv v201,v142,v143
mm v[52:55],a[220:223],v[172:175],v[52:55]
v_exp_f32 v144, v144
mm v[52:55],a[216:219],v[160:163],v[52:55]
s_waitcnt lgkmcnt(5)
tr a[250:251],v13,55808
mm v[64:67],a[224:227],v[160:163],v[64:67]
v_exp_f32 v145, v145
mm v[64:67],a[228:231],v[172:175],v[64:67]
tr a[252:253],v13,61952
v_add_u32 v11, 98304, v11
mm v[68:71],a[228:231],v[176:179],v[68:71]
v_exp_f32 v146, v146
mm v[68:71],a[224:227],v[164:167],v[68:71]
tr a[254:255],v13,64000
cv v204,v144,v145
mm v[72:75],a[224:227],v[168:171],v[72:75]
v_exp_f32 v147, v147
mm v[72:75],a[228:231],v[180:183],v[72:75]
s_waitcnt vmcnt(3)
cv v205,v146,v147
mm v[84:87],a[236:239],v[180:183],v[84:87]
v_exp_f32 v156, v156
mm v[84:87],a[232:235],v[168:171],v[84:87]
buffer_load_dwordx4 v7, s[8:11], s45 offen offset:2048 nt lds
mm v[80:83],a[232:235],v[164:167],v[80:83]
v_exp_f32 v157, v157
mm v[80:83],a[236:239],v[176:179],v[80:83]
cv v206,v156,v157
mm v[76:79],a[236:239],v[172:175],v[76:79]
v_exp_f32 v158, v158
mm v[76:79],a[232:235],v[160:163],v[76:79]
s_waitcnt lgkmcnt(0)
mm v[88:91],a[240:243],v[160:163],v[88:91]
s_barrier
v_exp_f32 v159, v159
mm v[88:91],a[244:247],v[172:175],v[88:91]
lq a[192:195],v11,0
cv v207,v158,v159
mm v[92:95],a[244:247],v[176:179],v[92:95]
v_exp_f32 v152, v152
mm v[92:95],a[240:243],v[164:167],v[92:95]
lq a[196:199],v11,512
mm v[96:99],a[240:243],v[168:171],v[96:99]
lq a[200:203],v11,4096
mm v[96:99],a[244:247],v[180:183],v[96:99]
lq a[204:207],v11,4608
mm v[108:111],a[252:255],v[180:183],v[108:111]
v_exp_f32 v153, v153
mm v[108:111],a[248:251],v[168:171],v[108:111]
v_exp_f32 v154, v154
mm v[104:107],a[248:251],v[164:167],v[104:107]
v_exp_f32 v155, v155
mm v[104:107],a[252:255],v[176:179],v[104:107]
lq a[208:211],v11,2048
cv v202,v152,v153
mm v[100:103],a[252:255],v[172:175],v[100:103]
lq a[212:215],v11,2560
cv v203,v154,v155
mm v[100:103],a[248:251],v[160:163],v[100:103]
s_waitcnt lgkmcnt(2)
s_waitcnt vmcnt(3)
buffer_load_dwordx4 v8, s[8:11], s45 offen offset:3072 nt lds
mm v[112:115],a[192:195],a[48:51],0
v_exp_f32 v148, v148
mm v[112:115],a[196:199],a[60:63],v[112:115]
lq a[216:219],v11,6144
mm v[112:115],a[200:203],a[72:75],v[112:115]
v_exp_f32 v149, v149
mm v[112:115],a[204:207],a[84:87],v[112:115]
lq a[220:223],v11,6656
cv v198,v148,v149
mm v[116:119],a[204:207],a[88:91],0
v_exp_f32 v150, v150
mm v[116:119],a[200:203],a[76:79],v[116:119]
lq a[224:227],v11,8192
mm v[116:119],a[196:199],a[64:67],v[116:119]
v_exp_f32 v151, v151
mm v[116:119],a[192:195],a[52:55],v[116:119]
lq a[228:231],v11,8704
cv v199,v150,v151
mm v[120:123],a[192:195],a[56:59],0
v_exp_f32 v112, v112
mm v[120:123],a[196:199],a[68:71],v[120:123]
lq a[232:235],v11,12288
v_add_u32 v12, 4294934528, v12
mm v[120:123],a[200:203],a[80:83],v[120:123]
v_exp_f32 v113, v113
mm v[120:123],a[204:207],a[92:95],v[120:123]
s_waitcnt lgkmcnt(3)
lq a[236:239],v11,12800
mm v[132:135],a[220:223],a[92:95],0
v_exp_f32 v114, v114
mm v[132:135],a[216:219],a[80:83],v[132:135]
s_add_u32 m0, s44, 65536
s_waitcnt vmcnt(3)
mm v[132:135],a[212:215],a[68:71],v[132:135]
v_exp_f32 v115, v115
mm v[132:135],a[208:211],a[56:59],v[132:135]
buffer_load_dwordx4 v5, s[12:15], s45 offen offset:0 nt lds
lq a[240:243],v11,10240
mm v[128:131],a[208:211],a[52:55],0
v_exp_f32 v116, v116
mm v[128:131],a[212:215],a[64:67],v[128:131]
lq a[244:247],v11,10752
v_add_u32 v13, 4294934528, v13
mm v[128:131],a[216:219],a[76:79],v[128:131]
v_exp_f32 v117, v117
mm v[128:131],a[220:223],a[88:91],v[128:131]
lq a[248:251],v11,14336
cv v160,v112,v113
mm v[124:127],a[220:223],a[84:87],0
lq a[252:255],v11,14848
cv v161,v114,v115
mm v[124:127],a[216:219],a[72:75],v[124:127]
tr a[192:193],v12,16384
cv v164,v116,v117
mm v[124:127],a[212:215],a[60:63],v[124:127]
v_exp_f32 v118, v118
mm v[124:127],a[208:211],a[48:51],v[124:127]
s_waitcnt lgkmcnt(5)
tr a[194:195],v12,18432
mm v[136:139],a[224:227],a[48:51],0
v_exp_f32 v119, v119
mm v[136:139],a[228:231],a[60:63],v[136:139]
tr a[196:197],v12,24576
cv v165,v118,v119
mm v[136:139],a[232:235],a[72:75],v[136:139]
v_exp_f32 v120, v120
mm v[136:139],a[236:239],a[84:87],v[136:139]
s_waitcnt vmcnt(3)
tr a[198:199],v12,26624
mm v[140:143],a[236:239],a[88:91],0
v_exp_f32 v121, v121
mm v[140:143],a[232:235],a[76:79],v[140:143]
buffer_load_dwordx4 v6, s[12:15], s45 offen offset:1024 nt lds
tr a[200:201],v13,16384
mm v[140:143],a[228:231],a[64:67],v[140:143]
v_exp_f32 v122, v122
mm v[140:143],a[224:227],a[52:55],v[140:143]
tr a[202:203],v13,18432
cv v168,v120,v121
mm v[144:147],a[224:227],a[56:59],0
v_exp_f32 v123, v123
mm v[144:147],a[228:231],a[68:71],v[144:147]
tr a[204:205],v13,24576
cv v169,v122,v123
mm v[144:147],a[232:235],a[80:83],v[144:147]
v_exp_f32 v132, v132
mm v[144:147],a[236:239],a[92:95],v[144:147]
s_waitcnt lgkmcnt(7)
tr a[206:207],v13,26624
mm v[156:159],a[252:255],a[92:95],0
v_exp_f32 v133, v133
mm v[156:159],a[248:251],a[80:83],v[156:159]
tr a[208:209],v12,16896
cv v170,v132,v133
mm v[156:159],a[244:247],a[68:71],v[156:159]
v_exp_f32 v134, v134
mm v[156:159],a[240:243],a[56:59],v[156:159]
tr a[210:211],v12,18944
mm v[152:155],a[240:243],a[52:55],0
v_exp_f32 v135, v135
mm v[152:155],a[244:247],a[64:67],v[152:155]
tr a[212:213],v12,25088
s_waitcnt vmcnt(3)
mm v[152:155],a[248:251],a[76:79],v[152:155]
v_exp_f32 v128, v128
mm v[152:155],a[252:255],a[88:91],v[152:155]
tr a[214:215],v12,27136
buffer_load_dwordx4 v7, s[12:15], s45 offen offset:2048 nt lds
mm v[148:151],a[252:255],a[84:87],0
v_exp_f32 v129, v129
mm v[148:151],a[248:251],a[72:75],v[148:151]
tr a[216:217],v13,16896
cv v171,v134,v135
mm v[148:151],a[244:247],a[60:63],v[148:151]
v_exp_f32 v130, v130
mm v[148:151],a[240:243],a[48:51],v[148:151]
tr a[218:219],v13,18944
cv v166,v128,v129
mm v[216:219],v[220:223],v[204:207],v[216:219]
v_exp_f32 v131, v131
mm v[216:219],v[220:223],v[192:195],v[216:219]
tr a[220:221],v13,25088
cv v167,v130,v131
mm v[212:215],v[220:223],v[200:203],v[212:215]
v_exp_f32 v124, v124
mm v[212:215],v[220:223],v[188:191],v[212:215]
tr a[222:223],v13,27136
mm v[208:211],v[220:223],v[196:199],v[208:211]
v_exp_f32 v125, v125
mm v[208:211],v[220:223],v[184:187],v[208:211]
s_waitcnt lgkmcnt(8)
tr a[224:225],v12,20480
mm v[16:19],a[192:195],v[184:187],v[16:19]
v_exp_f32 v126, v126
mm v[16:19],a[196:199],v[196:199],v[16:19]
tr a[226:227],v12,22528
cv v162,v124,v125
mm v[20:23],a[196:199],v[200:203],v[20:23]
v_exp_f32 v127, v127
mm v[20:23],a[192:195],v[188:191],v[20:23]
tr a[228:229],v12,28672
s_waitcnt vmcnt(3)
mm v[24:27],a[192:195],v[192:195],v[24:27]
v_exp_f32 v136, v136
mm v[24:27],a[196:199],v[204:207],v[24:27]
tr a[230:231],v12,30720
buffer_load_dwordx4 v8, s[12:15], s45 offen offset:3072 nt lds
mm v[36:39],a[204:207],v[204:207],v[36:39]
v_exp_f32 v137, v137
mm v[36:39],a[200:203],v[192:195],v[36:39]
tr a[232:233],v13,20480
cv v163,v126,v127
mm v[32:35],a[200:203],v[188:191],v[32:35]
v_exp_f32 v138, v138
mm v[32:35],a[204:207],v[200:203],v[32:35]
tr a[234:235],v13,22528
cv v172,v136,v137
mm v[28:31],a[204:207],v[196:199],v[28:31]
v_exp_f32 v139, v139
mm v[28:31],a[200:203],v[184:187],v[28:31]
s_waitcnt lgkmcnt(6)
tr a[236:237],v13,28672
mm v[40:43],a[208:211],v[184:187],v[40:43]
tr a[238:239],v13,30720
cv v173,v138,v139
mm v[40:43],a[212:215],v[196:199],v[40:43]
tr a[240:241],v12,20992
mm v[44:47],a[212:215],v[200:203],v[44:47]
v_exp_f32 v140, v140
mm v[44:47],a[208:211],v[188:191],v[44:47]
tr a[242:243],v12,23040
mm v[48:51],a[208:211],v[192:195],v[48:51]
v_exp_f32 v141, v141
mm v[48:51],a[212:215],v[204:207],v[48:51]
tr a[244:245],v12,29184
s_add_u32 s45, s45, 16384
mm v[60:63],a[220:223],v[204:207],v[60:63]
v_exp_f32 v142, v142
mm v[60:63],a[216:219],v[192:195],v[60:63]
tr a[246:247],v12,31232
s_add_u32 m0, s43, 98304
mm v[56:59],a[216:219],v[188:191],v[56:59]
v_exp_f32 v143, v143
mm v[56:59],a[220:223],v[200:203],v[56:59]
tr a[248:249],v13,20992
s_waitcnt vmcnt(3)
mm v[52:55],a[220:223],v[196:199],v[52:55]
buffer_load_dwordx4 v5, s[8:11], s45 offen offset:0 nt lds
s_waitcnt lgkmcnt(5)
mm v[52:55],a[216:219],v[184:187],v[52:55]
tr a[250:251],v13,23040
cv v176,v140,v141
mm v[64:67],a[224:227],v[184:187],v[64:67]
L_pg11:
s_cbranch_execz L_tret0
v_exp_f32 v144, v144
mm v[64:67],a[228:231],v[196:199],v[64:67]
tr a[252:253],v13,29184
cv v177,v142,v143
mm v[68:71],a[228:231],v[200:203],v[68:71]
v_exp_f32 v145, v145
mm v[68:71],a[224:227],v[188:191],v[68:71]
tr a[254:255],v13,31232
v_add_u32 v11, 4294836224, v11
mm v[72:75],a[224:227],v[192:195],v[72:75]
v_exp_f32 v146, v146
v_exp_f32 v147, v147
mm v[72:75],a[228:231],v[204:207],v[72:75]
cv v180,v144,v145
cv v181,v146,v147
mm v[84:87],a[236:239],v[204:207],v[84:87]
v_exp_f32 v156, v156
mm v[84:87],a[232:235],v[192:195],v[84:87]
v_exp_f32 v157, v157
mm v[80:83],a[232:235],v[188:191],v[80:83]
v_exp_f32 v158, v158
mm v[80:83],a[236:239],v[200:203],v[80:83]
s_waitcnt vmcnt(3)
mm v[76:79],a[236:239],v[196:199],v[76:79]
v_exp_f32 v159, v159
mm v[76:79],a[232:235],v[184:187],v[76:79]
s_waitcnt lgkmcnt(0)
buffer_load_dwordx4 v6, s[8:11], s45 offen offset:1024 nt lds
mm v[88:91],a[240:243],v[184:187],v[88:91]
s_barrier
cv v182,v156,v157
mm v[88:91],a[244:247],v[196:199],v[88:91]
lq a[192:195],v11,0
cv v183,v158,v159
mm v[92:95],a[244:247],v[200:203],v[92:95]
v_exp_f32 v152, v152
mm v[92:95],a[240:243],v[188:191],v[92:95]
lq a[196:199],v11,512
mm v[96:99],a[240:243],v[192:195],v[96:99]
lq a[200:203],v11,4096
mm v[96:99],a[244:247],v[204:207],v[96:99]
lq a[204:207],v11,4608
mm v[108:111],a[252:255],v[204:207],v[108:111]
v_exp_f32 v153, v153
mm v[108:111],a[248:251],v[192:195],v[108:111]
v_exp_f32 v154, v154
mm v[104:107],a[248:251],v[188:191],v[104:107]
v_exp_f32 v155, v155
mm v[104:107],a[252:255],v[200:203],v[104:107]
lq a[208:211],v11,2048
cv v178,v152,v153
v_rcp_f32 v240, v208
v_rcp_f32 v241, v212
v_rcp_f32 v242, v216
v_med3_f32 v248, v208, s57, v243
v_med3_f32 v249, v212, s57, v243
v_med3_f32 v250, v216, s57, v243
v_cmp_neq_f32 s[92:93], v248, v208
v_cmp_neq_f32 s[94:95], v249, v212
v_cmp_neq_f32 s[96:97], v250, v216
mm v[100:103],a[252:255],v[196:199],v[100:103]
lq a[212:215],v11,2560
cv v179,v154,v155
mm v[100:103],a[248:251],v[184:187],v[100:103]
s_waitcnt lgkmcnt(2)
s_waitcnt vmcnt(3)
s_nop 1
s_or_b64 s[92:93], s[92:93], s[94:95]
s_or_b64 s[92:93], s[92:93], s[96:97]
s_cbranch_scc1 L_slow0
L_back0:
v_pk_mul_f32 v[16:17], v[16:17], v[240:241] op_sel:[0,0] op_sel_hi:[1,0]
v_pk_mul_f32 v[18:19], v[18:19], v[240:241] op_sel:[0,0] op_sel_hi:[1,0]
v_pk_mul_f32 v[28:29], v[28:29], v[240:241] op_sel:[0,0] op_sel_hi:[1,0]
buffer_load_dwordx4 v7, s[8:11], s45 offen offset:2048 nt lds
v_pk_mul_f32 v[30:31], v[30:31], v[240:241] op_sel:[0,0] op_sel_hi:[1,0]
cv v16,v16,v17
cv v17,v18,v19
cv v28,v28,v29
cv v29,v30,v31
v_accvgpr_write_b32 a0, v16
v_accvgpr_write_b32 a1, v17
v_accvgpr_write_b32 a2, v28
v_accvgpr_write_b32 a3, v29
v_pk_mul_f32 v[20:21], v[20:21], v[240:241] op_sel:[0,1] op_sel_hi:[1,1]
v_pk_mul_f32 v[22:23], v[22:23], v[240:241] op_sel:[0,1] op_sel_hi:[1,1]
v_pk_mul_f32 v[32:33], v[32:33], v[240:241] op_sel:[0,1] op_sel_hi:[1,1]
v_pk_mul_f32 v[34:35], v[34:35], v[240:241] op_sel:[0,1] op_sel_hi:[1,1]
cv v20,v20,v21
cv v21,v22,v23
cv v32,v32,v33
cv v33,v34,v35
v_accvgpr_write_b32 a4, v20
v_accvgpr_write_b32 a5, v21
v_accvgpr_write_b32 a6, v32
v_accvgpr_write_b32 a7, v33
v_pk_mul_f32 v[24:25], v[24:25], v[242:243] op_sel:[0,0] op_sel_hi:[1,0]
v_pk_mul_f32 v[26:27], v[26:27], v[242:243] op_sel:[0,0] op_sel_hi:[1,0]
v_pk_mul_f32 v[36:37], v[36:37], v[242:243] op_sel:[0,0] op_sel_hi:[1,0]
v_pk_mul_f32 v[38:39], v[38:39], v[242:243] op_sel:[0,0] op_sel_hi:[1,0]
cv v24,v24,v25
cv v25,v26,v27
cv v36,v36,v37
cv v37,v38,v39
v_accvgpr_write_b32 a8, v24
v_accvgpr_write_b32 a9, v25
v_accvgpr_write_b32 a10, v36
v_accvgpr_write_b32 a11, v37
v_pk_mul_f32 v[40:41], v[40:41], v[240:241] op_sel:[0,0] op_sel_hi:[1,0]
v_pk_mul_f32 v[42:43], v[42:43], v[240:241] op_sel:[0,0] op_sel_hi:[1,0]
v_pk_mul_f32 v[52:53], v[52:53], v[240:241] op_sel:[0,0] op_sel_hi:[1,0]
v_pk_mul_f32 v[54:55], v[54:55], v[240:241] op_sel:[0,0] op_sel_hi:[1,0]
cv v40,v40,v41
cv v41,v42,v43
cv v52,v52,v53
cv v53,v54,v55
v_accvgpr_write_b32 a12, v40
v_accvgpr_write_b32 a13, v41
v_accvgpr_write_b32 a14, v52
v_accvgpr_write_b32 a15, v53
v_pk_mul_f32 v[44:45], v[44:45], v[240:241] op_sel:[0,1] op_sel_hi:[1,1]
v_pk_mul_f32 v[46:47], v[46:47], v[240:241] op_sel:[0,1] op_sel_hi:[1,1]
s_waitcnt vmcnt(3)
v_pk_mul_f32 v[56:57], v[56:57], v[240:241] op_sel:[0,1] op_sel_hi:[1,1]
v_pk_mul_f32 v[58:59], v[58:59], v[240:241] op_sel:[0,1] op_sel_hi:[1,1]
cv v44,v44,v45
buffer_load_dwordx4 v8, s[8:11], s45 offen offset:3072 nt lds
cv v45,v46,v47
cv v56,v56,v57
cv v57,v58,v59
v_accvgpr_write_b32 a16, v44
v_accvgpr_write_b32 a17, v45
v_accvgpr_write_b32 a18, v56
v_accvgpr_write_b32 a19, v57
v_pk_mul_f32 v[48:49], v[48:49], v[242:243] op_sel:[0,0] op_sel_hi:[1,0]
v_pk_mul_f32 v[50:51], v[50:51], v[242:243] op_sel:[0,0] op_sel_hi:[1,0]
v_pk_mul_f32 v[60:61], v[60:61], v[242:243] op_sel:[0,0] op_sel_hi:[1,0]
v_pk_mul_f32 v[62:63], v[62:63], v[242:243] op_sel:[0,0] op_sel_hi:[1,0]
cv v48,v48,v49
cv v49,v50,v51
cv v60,v60,v61
cv v61,v62,v63
v_accvgpr_write_b32 a20, v48
v_accvgpr_write_b32 a21, v49
v_accvgpr_write_b32 a22, v60
v_accvgpr_write_b32 a23, v61
v_pk_mul_f32 v[64:65], v[64:65], v[240:241] op_sel:[0,0] op_sel_hi:[1,0]
v_pk_mul_f32 v[66:67], v[66:67], v[240:241] op_sel:[0,0] op_sel_hi:[1,0]
v_pk_mul_f32 v[76:77], v[76:77], v[240:241] op_sel:[0,0] op_sel_hi:[1,0]
v_pk_mul_f32 v[78:79], v[78:79], v[240:241] op_sel:[0,0] op_sel_hi:[1,0]
cv v64,v64,v65
cv v65,v66,v67
cv v76,v76,v77
cv v77,v78,v79
v_accvgpr_write_b32 a24, v64
v_accvgpr_write_b32 a25, v65
v_accvgpr_write_b32 a26, v76
v_accvgpr_write_b32 a27, v77
v_pk_mul_f32 v[68:69], v[68:69], v[240:241] op_sel:[0,1] op_sel_hi:[1,1]
v_pk_mul_f32 v[70:71], v[70:71], v[240:241] op_sel:[0,1] op_sel_hi:[1,1]
v_pk_mul_f32 v[80:81], v[80:81], v[240:241] op_sel:[0,1] op_sel_hi:[1,1]
v_pk_mul_f32 v[82:83], v[82:83], v[240:241] op_sel:[0,1] op_sel_hi:[1,1]
cv v68,v68,v69
cv v69,v70,v71
cv v80,v80,v81
cv v81,v82,v83
v_accvgpr_write_b32 a28, v68
v_accvgpr_write_b32 a29, v69
v_accvgpr_write_b32 a30, v80
v_accvgpr_write_b32 a31, v81
v_pk_mul_f32 v[72:73], v[72:73], v[242:243] op_sel:[0,0] op_sel_hi:[1,0]
v_pk_mul_f32 v[74:75], v[74:75], v[242:243] op_sel:[0,0] op_sel_hi:[1,0]
s_waitcnt vmcnt(3)
s_add_u32 m0, s44, 98304
v_pk_mul_f32 v[84:85], v[84:85], v[242:243] op_sel:[0,0] op_sel_hi:[1,0]
v_pk_mul_f32 v[86:87], v[86:87], v[242:243] op_sel:[0,0] op_sel_hi:[1,0]
cv v72,v72,v73
buffer_load_dwordx4 v5, s[12:15], s45 offen offset:0 nt lds
cv v73,v74,v75
cv v84,v84,v85
cv v85,v86,v87
v_accvgpr_write_b32 a32, v72
v_accvgpr_write_b32 a33, v73
v_accvgpr_write_b32 a34, v84
v_accvgpr_write_b32 a35, v85
v_pk_mul_f32 v[88:89], v[88:89], v[240:241] op_sel:[0,0] op_sel_hi:[1,0]
v_pk_mul_f32 v[90:91], v[90:91], v[240:241] op_sel:[0,0] op_sel_hi:[1,0]
v_pk_mul_f32 v[100:101], v[100:101], v[240:241] op_sel:[0,0] op_sel_hi:[1,0]
v_pk_mul_f32 v[102:103], v[102:103], v[240:241] op_sel:[0,0] op_sel_hi:[1,0]
cv v88,v88,v89
cv v89,v90,v91
cv v100,v100,v101
cv v101,v102,v103
v_accvgpr_write_b32 a36, v88
v_accvgpr_write_b32 a37, v89
v_accvgpr_write_b32 a38, v100
v_accvgpr_write_b32 a39, v101
v_pk_mul_f32 v[92:93], v[92:93], v[240:241] op_sel:[0,1] op_sel_hi:[1,1]
v_pk_mul_f32 v[94:95], v[94:95], v[240:241] op_sel:[0,1] op_sel_hi:[1,1]
v_pk_mul_f32 v[104:105], v[104:105], v[240:241] op_sel:[0,1] op_sel_hi:[1,1]
v_pk_mul_f32 v[106:107], v[106:107], v[240:241] op_sel:[0,1] op_sel_hi:[1,1]
cv v92,v92,v93
cv v93,v94,v95
cv v104,v104,v105
cv v105,v106,v107
v_accvgpr_write_b32 a40, v92
v_accvgpr_write_b32 a41, v93
v_accvgpr_write_b32 a42, v104
v_accvgpr_write_b32 a43, v105
v_pk_mul_f32 v[96:97], v[96:97], v[242:243] op_sel:[0,0] op_sel_hi:[1,0]
v_pk_mul_f32 v[98:99], v[98:99], v[242:243] op_sel:[0,0] op_sel_hi:[1,0]
v_pk_mul_f32 v[108:109], v[108:109], v[242:243] op_sel:[0,0] op_sel_hi:[1,0]
v_pk_mul_f32 v[110:111], v[110:111], v[242:243] op_sel:[0,0] op_sel_hi:[1,0]
cv v96,v96,v97
cv v97,v98,v99
cv v108,v108,v109
cv v109,v110,v111
v_accvgpr_write_b32 a44, v96
v_accvgpr_write_b32 a45, v97
v_accvgpr_write_b32 a46, v108
v_accvgpr_write_b32 a47, v109
s_mov_b64 exec, 0
s_cmp_eq_u32 s42, 1
s_cbranch_scc1 L_pg13
s_cmp_eq_u32 s42, 2
s_cbranch_scc1 L_pg14
s_cmp_eq_u32 s42, 3
s_cbranch_scc1 L_pg15
s_branch L_pg12
L_tret1:
s_mov_b64 exec, -1
s_nop 0
L_mk_b8:
mm v[112:115],a[192:195],a[48:51],0
v_exp_f32 v148, v148
mm v[112:115],a[196:199],a[60:63],v[112:115]
lq a[216:219],v11,6144
s_waitcnt vmcnt(3)
mm v[112:115],a[200:203],a[72:75],v[112:115]
v_exp_f32 v149, v149
mm v[112:115],a[204:207],a[84:87],v[112:115]
lq a[220:223],v11,6656
buffer_load_dwordx4 v6, s[12:15], s45 offen offset:1024 nt lds
mm v[116:119],a[204:207],a[88:91],0
v_exp_f32 v150, v150
mm v[116:119],a[200:203],a[76:79],v[116:119]
lq a[224:227],v11,8192
cv v174,v148,v149
mm v[116:119],a[196:199],a[64:67],v[116:119]
v_exp_f32 v151, v151
mm v[116:119],a[192:195],a[52:55],v[116:119]
lq a[228:231],v11,8704
cv v175,v150,v151
mm v[120:123],a[192:195],a[56:59],0
v_exp_f32 v112, v112
mm v[120:123],a[196:199],a[68:71],v[120:123]
lq a[232:235],v11,12288
v_add_u32 v12, 98304, v12
mm v[120:123],a[200:203],a[80:83],v[120:123]
v_exp_f32 v113, v113
mm v[120:123],a[204:207],a[92:95],v[120:123]
s_waitcnt lgkmcnt(3)
lq a[236:239],v11,12800
mm v[132:135],a[220:223],a[92:95],0
v_exp_f32 v114, v114
mm v[132:135],a[216:219],a[80:83],v[132:135]
lq a[240:243],v11,10240
v_add_u32 v13, 98304, v13
mm v[132:135],a[212:215],a[68:71],v[132:135]
v_exp_f32 v115, v115
mm v[132:135],a[208:211],a[56:59],v[132:135]
lq a[244:247],v11,10752
cv v184,v112,v113
mm v[128:131],a[208:211],a[52:55],0
v_exp_f32 v116, v116
mm v[128:131],a[212:215],a[64:67],v[128:131]
lq a[248:251],v11,14336
s_waitcnt vmcnt(3)
mm v[128:131],a[216:219],a[76:79],v[128:131]
v_exp_f32 v117, v117
mm v[128:131],a[220:223],a[88:91],v[128:131]
lq a[252:255],v11,14848
buffer_load_dwordx4 v7, s[12:15], s45 offen offset:2048 nt lds
mm v[124:127],a[220:223],a[84:87],0
v_exp_f32 v118, v118
mm v[124:127],a[216:219],a[72:75],v[124:127]
tr a[192:193],v12,16384
cv v185,v114,v115
mm v[124:127],a[212:215],a[60:63],v[124:127]
v_exp_f32 v119, v119
mm v[124:127],a[208:211],a[48:51],v[124:127]
s_waitcnt lgkmcnt(5)
tr a[194:195],v12,18432
mm v[136:139],a[224:227],a[48:51],0
v_exp_f32 v120, v120
mm v[136:139],a[228:231],a[60:63],v[136:139]
tr a[196:197],v12,24576
cv v188,v116,v117
mm v[136:139],a[232:235],a[72:75],v[136:139]
v_exp_f32 v121, v121
mm v[136:139],a[236:239],a[84:87],v[136:139]
tr a[198:199],v12,26624
cv v189,v118,v119
mm v[140:143],a[236:239],a[88:91],0
v_exp_f32 v122, v122
mm v[140:143],a[232:235],a[76:79],v[140:143]
tr a[200:201],v13,16384
cv v192,v120,v121
mm v[140:143],a[228:231],a[64:67],v[140:143]
v_exp_f32 v123, v123
mm v[140:143],a[224:227],a[52:55],v[140:143]
tr a[202:203],v13,18432
s_waitcnt vmcnt(3)
mm v[144:147],a[224:227],a[56:59],0
v_exp_f32 v132, v132
mm v[144:147],a[228:231],a[68:71],v[144:147]
tr a[204:205],v13,24576
buffer_load_dwordx4 v8, s[12:15], s45 offen offset:3072 nt lds
mm v[144:147],a[232:235],a[80:83],v[144:147]
v_exp_f32 v133, v133
mm v[144:147],a[236:239],a[92:95],v[144:147]
s_waitcnt lgkmcnt(7)
tr a[206:207],v13,26624
mm v[156:159],a[252:255],a[92:95],0
v_exp_f32 v134, v134
mm v[156:159],a[248:251],a[80:83],v[156:159]
tr a[208:209],v12,16896
cv v193,v122,v123
mm v[156:159],a[244:247],a[68:71],v[156:159]
v_exp_f32 v135, v135
mm v[156:159],a[240:243],a[56:59],v[156:159]
tr a[210:211],v12,18944
cv v194,v132,v133
mm v[152:155],a[240:243],a[52:55],0
v_exp_f32 v128, v128
mm v[152:155],a[244:247],a[64:67],v[152:155]
tr a[212:213],v12,25088
cv v195,v134,v135
mm v[152:155],a[248:251],a[76:79],v[152:155]
v_exp_f32 v129, v129
mm v[152:155],a[252:255],a[88:91],v[152:155]
tr a[214:215],v12,27136
cv v190,v128,v129
mm v[148:151],a[252:255],a[84:87],0
v_exp_f32 v130, v130
mm v[148:151],a[248:251],a[72:75],v[148:151]
tr a[216:217],v13,16896
s_add_u32 s45, s45, 16384
mm v[148:151],a[244:247],a[60:63],v[148:151]
v_exp_f32 v131, v131
mm v[148:151],a[240:243],a[48:51],v[148:151]
tr a[218:219],v13,18944
s_add_u32 m0, s43, 32768
mm v[216:219],v[220:223],v[180:183],0
v_exp_f32 v124, v124
mm v[216:219],v[220:223],v[168:171],v[216:219]
s_waitcnt vmcnt(3)
tr a[220:221],v13,25088
mm v[212:215],v[220:223],v[176:179],0
v_exp_f32 v125, v125
mm v[212:215],v[220:223],v[164:167],v[212:215]
tr a[222:223],v13,27136
buffer_load_dwordx4 v5, s[8:11], s45 offen offset:0 nt lds
mm v[208:211],v[220:223],v[172:175],0
v_exp_f32 v126, v126
mm v[208:211],v[220:223],v[160:163],v[208:211]
s_waitcnt lgkmcnt(8)
tr a[224:225],v12,20480
mm v[16:19],a[192:195],v[160:163],0
v_exp_f32 v127, v127
mm v[16:19],a[196:199],v[172:175],v[16:19]
tr a[226:227],v12,22528
cv v191,v130,v131
mm v[20:23],a[196:199],v[176:179],0
v_exp_f32 v136, v136
mm v[20:23],a[192:195],v[164:167],v[20:23]
tr a[228:229],v12,28672
cv v186,v124,v125
mm v[24:27],a[192:195],v[168:171],0
v_exp_f32 v137, v137
mm v[24:27],a[196:199],v[180:183],v[24:27]
tr a[230:231],v12,30720
cv v187,v126,v127
mm v[36:39],a[204:207],v[180:183],0
v_exp_f32 v138, v138
mm v[36:39],a[200:203],v[168:171],v[36:39]
tr a[232:233],v13,20480
s_waitcnt vmcnt(3)
mm v[32:35],a[200:203],v[164:167],0
v_exp_f32 v139, v139
mm v[32:35],a[204:207],v[176:179],v[32:35]
tr a[234:235],v13,22528
buffer_load_dwordx4 v6, s[8:11], s45 offen offset:1024 nt lds
mm v[28:31],a[204:207],v[172:175],0
v_exp_f32 v140, v140
mm v[28:31],a[200:203],v[160:163],v[28:31]
s_waitcnt lgkmcnt(6)
tr a[236:237],v13,28672
mm v[40:43],a[208:211],v[160:163],0
tr a[238:239],v13,30720
cv v196,v136,v137
mm v[40:43],a[212:215],v[172:175],v[40:43]
tr a[240:241],v12,20992
cv v197,v138,v139
mm v[44:47],a[212:215],v[176:179],0
v_exp_f32 v141, v141
mm v[44:47],a[208:211],v[164:167],v[44:47]
tr a[242:243],v12,23040
cv v200,v140,v141
mm v[48:51],a[208:211],v[168:171],0
v_exp_f32 v142, v142
mm v[48:51],a[212:215],v[180:183],v[48:51]
tr a[244:245],v12,29184
mm v[60:63],a[220:223],v[180:183],0
v_exp_f32 v143, v143
mm v[60:63],a[216:219],v[168:171],v[60:63]
tr a[246:247],v12,31232
cv v201,v142,v143
mm v[56:59],a[216:219],v[164:167],0
v_exp_f32 v144, v144
mm v[56:59],a[220:223],v[176:179],v[56:59]
tr a[248:249],v13,20992
mm v[52:55],a[220:223],v[172:175],0
v_exp_f32 v145, v145
mm v[52:55],a[216:219],v[160:163],v[52:55]
s_waitcnt lgkmcnt(5)
tr a[250:251],v13,23040
mm v[64:67],a[224:227],v[160:163],0
v_exp_f32 v146, v146
mm v[64:67],a[228:231],v[172:175],v[64:67]
tr a[252:253],v13,29184
s_waitcnt vmcnt(3)
mm v[68:71],a[228:231],v[176:179],0
v_exp_f32 v147, v147
mm v[68:71],a[224:227],v[164:167],v[68:71]
tr a[254:255],v13,31232
buffer_load_dwordx4 v7, s[8:11], s45 offen offset:2048 nt lds
mm v[72:75],a[224:227],v[168:171],0
v_exp_f32 v156, v156
mm v[72:75],a[228:231],v[180:183],v[72:75]
v_add_u32 v11, 65536, v11
cv v204,v144,v145
mm v[84:87],a[236:239],v[180:183],0
v_exp_f32 v157, v157
mm v[84:87],a[232:235],v[168:171],v[84:87]
cv v205,v146,v147
cv v206,v156,v157
mm v[80:83],a[232:235],v[164:167],0
v_exp_f32 v158, v158
mm v[80:83],a[236:239],v[176:179],v[80:83]
mm v[76:79],a[236:239],v[172:175],0
v_exp_f32 v159, v159
mm v[76:79],a[232:235],v[160:163],v[76:79]
s_waitcnt lgkmcnt(0)
cv v207,v158,v159
mm v[88:91],a[240:243],v[160:163],0
s_barrier
mm v[88:91],a[244:247],v[172:175],v[88:91]
lq a[192:195],v11,0
s_waitcnt vmcnt(3)
mm v[92:95],a[244:247],v[176:179],0
v_exp_f32 v152, v152
mm v[92:95],a[240:243],v[164:167],v[92:95]
lq a[196:199],v11,512
buffer_load_dwordx4 v8, s[8:11], s45 offen offset:3072 nt lds
mm v[96:99],a[240:243],v[168:171],0
lq a[200:203],v11,4096
mm v[96:99],a[244:247],v[180:183],v[96:99]
lq a[204:207],v11,4608
mm v[108:111],a[252:255],v[180:183],0
v_exp_f32 v153, v153
mm v[108:111],a[248:251],v[168:171],v[108:111]
v_exp_f32 v154, v154
mm v[104:107],a[248:251],v[164:167],0
v_exp_f32 v155, v155
mm v[104:107],a[252:255],v[176:179],v[104:107]
lq a[208:211],v11,2048
cv v202,v152,v153
mm v[100:103],a[252:255],v[172:175],0
lq a[212:215],v11,2560
cv v203,v154,v155
mm v[100:103],a[248:251],v[160:163],v[100:103]
s_waitcnt lgkmcnt(2)
mm v[112:115],a[192:195],a[48:51],0
v_exp_f32 v148, v148
mm v[112:115],a[196:199],a[60:63],v[112:115]
lq a[216:219],v11,6144
mm v[112:115],a[200:203],a[72:75],v[112:115]
v_exp_f32 v149, v149
mm v[112:115],a[204:207],a[84:87],v[112:115]
lq a[220:223],v11,6656
cv v198,v148,v149
mm v[116:119],a[204:207],a[88:91],0
v_exp_f32 v150, v150
mm v[116:119],a[200:203],a[76:79],v[116:119]
s_add_u32 m0, s44, 32768
s_waitcnt vmcnt(3)
mm v[116:119],a[196:199],a[64:67],v[116:119]
v_exp_f32 v151, v151
mm v[116:119],a[192:195],a[52:55],v[116:119]
lq a[224:227],v11,8192
buffer_load_dwordx4 v5, s[12:15], s45 offen offset:0 nt lds
mm v[120:123],a[192:195],a[56:59],0
v_exp_f32 v112, v112
mm v[120:123],a[196:199],a[68:71],v[120:123]
lq a[228:231],v11,8704
v_add_u32 v12, 4294836224, v12
mm v[120:123],a[200:203],a[80:83],v[120:123]
v_exp_f32 v113, v113
mm v[120:123],a[204:207],a[92:95],v[120:123]
s_waitcnt lgkmcnt(2)
lq a[232:235],v11,12288
mm v[132:135],a[220:223],a[92:95],0
lq a[236:239],v11,12800
v_add_u32 v13, 4294836224, v13
mm v[132:135],a[216:219],a[80:83],v[132:135]
lq a[240:243],v11,10240
cv v160,v112,v113
mm v[132:135],a[212:215],a[68:71],v[132:135]
v_exp_f32 v114, v114
mm v[132:135],a[208:211],a[56:59],v[132:135]
lq a[244:247],v11,10752
cv v199,v150,v151
mm v[128:131],a[208:211],a[52:55],0
v_exp_f32 v115, v115
mm v[128:131],a[212:215],a[64:67],v[128:131]
lq a[248:251],v11,14336
cv v161,v114,v115
mm v[128:131],a[216:219],a[76:79],v[128:131]
v_exp_f32 v116, v116
mm v[128:131],a[220:223],a[88:91],v[128:131]
lq a[252:255],v11,14848
s_waitcnt vmcnt(3)
mm v[124:127],a[220:223],a[84:87],0
v_exp_f32 v117, v117
mm v[124:127],a[216:219],a[72:75],v[124:127]
buffer_load_dwordx4 v6, s[12:15], s45 offen offset:1024 nt lds
tr a[192:193],v12,16384
mm v[124:127],a[212:215],a[60:63],v[124:127]
v_exp_f32 v118, v118
mm v[124:127],a[208:211],a[48:51],v[124:127]
s_waitcnt lgkmcnt(5)
tr a[194:195],v12,18432
mm v[136:139],a[224:227],a[48:51],0
v_exp_f32 v119, v119
mm v[136:139],a[228:231],a[60:63],v[136:139]
tr a[196:197],v12,24576
cv v164,v116,v117
mm v[136:139],a[232:235],a[72:75],v[136:139]
v_exp_f32 v120, v120
mm v[136:139],a[236:239],a[84:87],v[136:139]
tr a[198:199],v12,26624
cv v165,v118,v119
mm v[140:143],a[236:239],a[88:91],0
v_exp_f32 v121, v121
mm v[140:143],a[232:235],a[76:79],v[140:143]
tr a[200:201],v13,16384
cv v168,v120,v121
mm v[140:143],a[228:231],a[64:67],v[140:143]
v_exp_f32 v122, v122
mm v[140:143],a[224:227],a[52:55],v[140:143]
tr a[202:203],v13,18432
mm v[144:147],a[224:227],a[56:59],0
v_exp_f32 v123, v123
mm v[144:147],a[228:231],a[68:71],v[144:147]
tr a[204:205],v13,24576
cv v169,v122,v123
mm v[144:147],a[232:235],a[80:83],v[144:147]
v_exp_f32 v132, v132
mm v[144:147],a[236:239],a[92:95],v[144:147]
s_waitcnt lgkmcnt(7)
tr a[206:207],v13,26624
mm v[156:159],a[252:255],a[92:95],0
v_exp_f32 v133, v133
mm v[156:159],a[248:251],a[80:83],v[156:159]
s_waitcnt vmcnt(3)
buffer_load_dwordx4 v7, s[12:15], s45 offen offset:2048 nt lds
L_pg12:
s_cbranch_execz L_tret1
mm v[156:159],a[244:247],a[68:71],v[156:159]
v_exp_f32 v134, v134
mm v[156:159],a[240:243],a[56:59],v[156:159]
tr a[208:209],v12,16896
cv v170,v132,v133
mm v[152:155],a[240:243],a[52:55],0
v_exp_f32 v135, v135
mm v[152:155],a[244:247],a[64:67],v[152:155]
tr a[210:211],v12,18944
cv v171,v134,v135
mm v[152:155],a[248:251],a[76:79],v[152:155]
v_exp_f32 v128, v128
mm v[152:155],a[252:255],a[88:91],v[152:155]
tr a[212:213],v12,25088
mm v[148:151],a[252:255],a[84:87],0
v_exp_f32 v129, v129
mm v[148:151],a[248:251],a[72:75],v[148:151]
tr a[214:215],v12,27136
cv v166,v128,v129
mm v[148:151],a[244:247],a[60:63],v[148:151]
v_exp_f32 v130, v130
mm v[148:151],a[240:243],a[48:51],v[148:151]
tr a[216:217],v13,16896
mm v[216:219],v[220:223],v[204:207],v[216:219]
v_exp_f32 v131, v131
mm v[216:219],v[220:223],v[192:195],v[216:219]
tr a[218:219],v13,18944
s_waitcnt vmcnt(3)
mm v[212:215],v[220:223],v[200:203],v[212:215]
v_exp_f32 v124, v124
mm v[212:215],v[220:223],v[188:191],v[212:215]
tr a[220:221],v13,25088
tr a[222:223],v13,27136
mm v[208:211],v[220:223],v[196:199],v[208:211]
v_exp_f32 v125, v125
mm v[208:211],v[220:223],v[184:187],v[208:211]
s_waitcnt lgkmcnt(8)
buffer_load_dwordx4 v8, s[12:15], s45 offen offset:3072 nt lds
mm v[16:19],a[192:195],v[184:187],v[16:19]
v_exp_f32 v126, v126
mm v[16:19],a[196:199],v[196:199],v[16:19]
tr a[224:225],v12,20480
cv v167,v130,v131
mm v[20:23],a[196:199],v[200:203],v[20:23]
v_exp_f32 v127, v127
mm v[20:23],a[192:195],v[188:191],v[20:23]
tr a[226:227],v12,22528
cv v162,v124,v125
mm v[24:27],a[192:195],v[192:195],v[24:27]
v_exp_f32 v136, v136
mm v[24:27],a[196:199],v[204:207],v[24:27]
tr a[228:229],v12,28672
cv v163,v126,v127
mm v[36:39],a[204:207],v[204:207],v[36:39]
v_exp_f32 v137, v137
mm v[36:39],a[200:203],v[192:195],v[36:39]
tr a[230:231],v12,30720
cv v172,v136,v137
mm v[32:35],a[200:203],v[188:191],v[32:35]
v_exp_f32 v138, v138
mm v[32:35],a[204:207],v[200:203],v[32:35]
tr a[232:233],v13,20480
s_add_u32 s45, s45, 16384
mm v[28:31],a[204:207],v[196:199],v[28:31]
v_exp_f32 v139, v139
mm v[28:31],a[200:203],v[184:187],v[28:31]
s_waitcnt lgkmcnt(5)
tr a[234:235],v13,22528
mm v[40:43],a[208:211],v[184:187],v[40:43]
tr a[236:237],v13,28672
tr a[238:239],v13,30720
mm v[40:43],a[212:215],v[196:199],v[40:43]
tr a[240:241],v12,20992
s_add_u32 m0, s43, 131072
mm v[44:47],a[212:215],v[200:203],v[44:47]
s_waitcnt vmcnt(3)
tr a[242:243],v12,23040
mm v[44:47],a[208:211],v[188:191],v[44:47]
buffer_load_dwordx4 v5, s[8:11], s45 offen offset:0 nt lds
tr a[244:245],v12,29184
mm v[48:51],a[208:211],v[192:195],v[48:51]
v_exp_f32 v140, v140
mm v[48:51],a[212:215],v[204:207],v[48:51]
tr a[246:247],v12,31232
cv v173,v138,v139
mm v[60:63],a[220:223],v[204:207],v[60:63]
v_exp_f32 v141, v141
mm v[60:63],a[216:219],v[192:195],v[60:63]
v_exp_f32 v142, v142
mm v[56:59],a[216:219],v[188:191],v[56:59]
v_exp_f32 v143, v143
mm v[56:59],a[220:223],v[200:203],v[56:59]
tr a[248:249],v13,20992
cv v176,v140,v141
mm v[52:55],a[220:223],v[196:199],v[52:55]
v_exp_f32 v144, v144
mm v[52:55],a[216:219],v[184:187],v[52:55]
s_waitcnt lgkmcnt(5)
tr a[250:251],v13,23040
mm v[64:67],a[224:227],v[184:187],v[64:67]
v_exp_f32 v145, v145
mm v[64:67],a[228:231],v[196:199],v[64:67]
tr a[252:253],v13,29184
s_waitcnt vmcnt(3)
mm v[68:71],a[228:231],v[200:203],v[68:71]
v_exp_f32 v146, v146
mm v[68:71],a[224:227],v[188:191],v[68:71]
tr a[254:255],v13,31232
buffer_load_dwordx4 v6, s[8:11], s45 offen offset:1024 nt lds
mm v[72:75],a[224:227],v[192:195],v[72:75]
v_exp_f32 v147, v147
mm v[72:75],a[228:231],v[204:207],v[72:75]
cv v177,v142,v143
cv v180,v144,v145
mm v[84:87],a[236:239],v[204:207],v[84:87]
v_exp_f32 v156, v156
mm v[84:87],a[232:235],v[192:195],v[84:87]
cv v181,v146,v147
mm v[80:83],a[232:235],v[188:191],v[80:83]
v_exp_f32 v157, v157
mm v[80:83],a[236:239],v[200:203],v[80:83]
cv v182,v156,v157
mm v[76:79],a[236:239],v[196:199],v[76:79]
v_exp_f32 v158, v158
mm v[76:79],a[232:235],v[184:187],v[76:79]
s_waitcnt lgkmcnt(0)
mm v[88:91],a[240:243],v[184:187],v[88:91]
s_barrier
v_exp_f32 v159, v159
mm v[88:91],a[244:247],v[196:199],v[88:91]
lq a[192:195],v11,32768
cv v183,v158,v159
mm v[92:95],a[244:247],v[200:203],v[92:95]
v_exp_f32 v152, v152
mm v[92:95],a[240:243],v[188:191],v[92:95]
lq a[196:199],v11,33280
mm v[96:99],a[240:243],v[192:195],v[96:99]
lq a[200:203],v11,36864
s_waitcnt vmcnt(3)
mm v[96:99],a[244:247],v[204:207],v[96:99]
lq a[204:207],v11,37376
buffer_load_dwordx4 v7, s[8:11], s45 offen offset:2048 nt lds
mm v[108:111],a[252:255],v[204:207],v[108:111]
v_exp_f32 v153, v153
mm v[108:111],a[248:251],v[192:195],v[108:111]
v_exp_f32 v154, v154
mm v[104:107],a[248:251],v[188:191],v[104:107]
v_exp_f32 v155, v155
mm v[104:107],a[252:255],v[200:203],v[104:107]
lq a[208:211],v11,34816
cv v178,v152,v153
mm v[100:103],a[252:255],v[196:199],v[100:103]
lq a[212:215],v11,35328
cv v179,v154,v155
mm v[100:103],a[248:251],v[184:187],v[100:103]
s_waitcnt lgkmcnt(2)
mm v[112:115],a[192:195],a[48:51],0
v_exp_f32 v148, v148
mm v[112:115],a[196:199],a[60:63],v[112:115]
lq a[216:219],v11,38912
mm v[112:115],a[200:203],a[72:75],v[112:115]
v_exp_f32 v149, v149
mm v[112:115],a[204:207],a[84:87],v[112:115]
lq a[220:223],v11,39424
cv v174,v148,v149
mm v[116:119],a[204:207],a[88:91],0
v_exp_f32 v150, v150
mm v[116:119],a[200:203],a[76:79],v[116:119]
lq a[224:227],v11,40960
mm v[116:119],a[196:199],a[64:67],v[116:119]
v_exp_f32 v151, v151
mm v[116:119],a[192:195],a[52:55],v[116:119]
lq a[228:231],v11,41472
s_waitcnt vmcnt(3)
mm v[120:123],a[192:195],a[56:59],0
v_exp_f32 v112, v112
mm v[120:123],a[196:199],a[68:71],v[120:123]
lq a[232:235],v11,45056
buffer_load_dwordx4 v8, s[8:11], s45 offen offset:3072 nt lds
mm v[120:123],a[200:203],a[80:83],v[120:123]
v_exp_f32 v113, v113
mm v[120:123],a[204:207],a[92:95],v[120:123]
s_waitcnt lgkmcnt(3)
lq a[236:239],v11,45568
mm v[132:135],a[220:223],a[92:95],0
v_exp_f32 v114, v114
mm v[132:135],a[216:219],a[80:83],v[132:135]
lq a[240:243],v11,43008
v_add_u32 v12, 65536, v12
mm v[132:135],a[212:215],a[68:71],v[132:135]
v_exp_f32 v115, v115
mm v[132:135],a[208:211],a[56:59],v[132:135]
lq a[244:247],v11,43520
v_add_u32 v13, 65536, v13
mm v[128:131],a[208:211],a[52:55],0
v_exp_f32 v116, v116
mm v[128:131],a[212:215],a[64:67],v[128:131]
lq a[248:251],v11,47104
cv v184,v112,v113
mm v[128:131],a[216:219],a[76:79],v[128:131]
v_exp_f32 v117, v117
mm v[128:131],a[220:223],a[88:91],v[128:131]
lq a[252:255],v11,47616
cv v185,v114,v115
mm v[124:127],a[220:223],a[84:87],0
v_exp_f32 v118, v118
mm v[124:127],a[216:219],a[72:75],v[124:127]
tr a[192:193],v12,16384
cv v188,v116,v117
mm v[124:127],a[212:215],a[60:63],v[124:127]
v_exp_f32 v119, v119
mm v[124:127],a[208:211],a[48:51],v[124:127]
s_waitcnt lgkmcnt(5)
s_add_u32 m0, s44, 131072
mm v[136:139],a[224:227],a[48:51],0
v_exp_f32 v120, v120
mm v[136:139],a[228:231],a[60:63],v[136:139]
s_waitcnt vmcnt(3)
tr a[194:195],v12,18432
mm v[136:139],a[232:235],a[72:75],v[136:139]
v_exp_f32 v121, v121
mm v[136:139],a[236:239],a[84:87],v[136:139]
buffer_load_dwordx4 v5, s[12:15], s45 offen offset:0 nt lds
tr a[196:197],v12,24576
mm v[140:143],a[236:239],a[88:91],0
v_exp_f32 v122, v122
mm v[140:143],a[232:235],a[76:79],v[140:143]
tr a[198:199],v12,26624
cv v189,v118,v119
mm v[140:143],a[228:231],a[64:67],v[140:143]
v_exp_f32 v123, v123
mm v[140:143],a[224:227],a[52:55],v[140:143]
tr a[200:201],v13,16384
cv v175,v150,v151
mm v[144:147],a[224:227],a[56:59],0
v_exp_f32 v132, v132
mm v[144:147],a[228:231],a[68:71],v[144:147]
tr a[202:203],v13,18432
cv v192,v120,v121
mm v[144:147],a[232:235],a[80:83],v[144:147]
v_exp_f32 v133, v133
mm v[144:147],a[236:239],a[92:95],v[144:147]
s_waitcnt lgkmcnt(6)
tr a[204:205],v13,24576
mm v[156:159],a[252:255],a[92:95],0
tr a[206:207],v13,26624
cv v193,v122,v123
mm v[156:159],a[248:251],a[80:83],v[156:159]
tr a[208:209],v12,16896
s_waitcnt vmcnt(3)
mm v[156:159],a[244:247],a[68:71],v[156:159]
v_exp_f32 v134, v134
mm v[156:159],a[240:243],a[56:59],v[156:159]
tr a[210:211],v12,18944
buffer_load_dwordx4 v6, s[12:15], s45 offen offset:1024 nt lds
mm v[152:155],a[240:243],a[52:55],0
v_exp_f32 v135, v135
mm v[152:155],a[244:247],a[64:67],v[152:155]
tr a[212:213],v12,25088
cv v194,v132,v133
mm v[152:155],a[248:251],a[76:79],v[152:155]
v_exp_f32 v128, v128
mm v[152:155],a[252:255],a[88:91],v[152:155]
tr a[214:215],v12,27136
cv v195,v134,v135
mm v[148:151],a[252:255],a[84:87],0
v_exp_f32 v129, v129
mm v[148:151],a[248:251],a[72:75],v[148:151]
tr a[216:217],v13,16896
cv v190,v128,v129
mm v[148:151],a[244:247],a[60:63],v[148:151]
v_exp_f32 v130, v130
mm v[148:151],a[240:243],a[48:51],v[148:151]
tr a[218:219],v13,18944
mm v[216:219],v[220:223],v[180:183],v[216:219]
v_exp_f32 v131, v131
mm v[216:219],v[220:223],v[168:171],v[216:219]
tr a[220:221],v13,25088
cv v191,v130,v131
mm v[212:215],v[220:223],v[176:179],v[212:215]
v_exp_f32 v124, v124
mm v[212:215],v[220:223],v[164:167],v[212:215]
tr a[222:223],v13,27136
mm v[208:211],v[220:223],v[172:175],v[208:211]
v_exp_f32 v125, v125
mm v[208:211],v[220:223],v[160:163],v[208:211]
s_waitcnt lgkmcnt(8)
tr a[224:225],v12,20480
mm v[16:19],a[192:195],v[160:163],v[16:19]
v_exp_f32 v126, v126
mm v[16:19],a[196:199],v[172:175],v[16:19]
s_waitcnt vmcnt(3)
tr a[226:227],v12,22528
mm v[20:23],a[196:199],v[176:179],v[20:23]
v_exp_f32 v127, v127
mm v[20:23],a[192:195],v[164:167],v[20:23]
buffer_load_dwordx4 v7, s[12:15], s45 offen offset:2048 nt lds
tr a[228:229],v12,28672
mm v[24:27],a[192:195],v[168:171],v[24:27]
v_exp_f32 v136, v136
mm v[24:27],a[196:199],v[180:183],v[24:27]
tr a[230:231],v12,30720
cv v186,v124,v125
mm v[36:39],a[204:207],v[180:183],v[36:39]
v_exp_f32 v137, v137
mm v[36:39],a[200:203],v[168:171],v[36:39]
tr a[232:233],v13,20480
cv v187,v126,v127
mm v[32:35],a[200:203],v[164:167],v[32:35]
v_exp_f32 v138, v138
mm v[32:35],a[204:207],v[176:179],v[32:35]
tr a[234:235],v13,22528
cv v196,v136,v137
mm v[28:31],a[204:207],v[172:175],v[28:31]
v_exp_f32 v139, v139
mm v[28:31],a[200:203],v[160:163],v[28:31]
s_waitcnt lgkmcnt(6)
tr a[236:237],v13,28672
mm v[40:43],a[208:211],v[160:163],v[40:43]
tr a[238:239],v13,30720
cv v197,v138,v139
mm v[40:43],a[212:215],v[172:175],v[40:43]
tr a[240:241],v12,20992
s_waitcnt vmcnt(3)
mm v[44:47],a[212:215],v[176:179],v[44:47]
v_exp_f32 v140, v140
mm v[44:47],a[208:211],v[164:167],v[44:47]
tr a[242:243],v12,23040
buffer_load_dwordx4 v8, s[12:15], s45 offen offset:3072 nt lds
mm v[48:51],a[208:211],v[168:171],v[48:51]
v_exp_f32 v141, v141
mm v[48:51],a[212:215],v[180:183],v[48:51]
tr a[244:245],v12,29184
cv v200,v140,v141
mm v[60:63],a[220:223],v[180:183],v[60:63]
v_exp_f32 v142, v142
mm v[60:63],a[216:219],v[168:171],v[60:63]
tr a[246:247],v12,31232
mm v[56:59],a[216:219],v[164:167],v[56:59]
v_exp_f32 v143, v143
mm v[56:59],a[220:223],v[176:179],v[56:59]
tr a[248:249],v13,20992
cv v201,v142,v143
mm v[52:55],a[220:223],v[172:175],v[52:55]
v_exp_f32 v144, v144
mm v[52:55],a[216:219],v[160:163],v[52:55]
s_waitcnt lgkmcnt(5)
tr a[250:251],v13,23040
mm v[64:67],a[224:227],v[160:163],v[64:67]
v_exp_f32 v145, v145
mm v[64:67],a[228:231],v[172:175],v[64:67]
tr a[252:253],v13,29184
v_add_u32 v11, 4294934528, v11
mm v[68:71],a[228:231],v[176:179],v[68:71]
v_exp_f32 v146, v146
mm v[68:71],a[224:227],v[164:167],v[68:71]
tr a[254:255],v13,31232
s_add_u32 s45, s45, 16384
mm v[72:75],a[224:227],v[168:171],v[72:75]
v_exp_f32 v147, v147
mm v[72:75],a[228:231],v[180:183],v[72:75]
s_add_u32 m0, s43, 0
s_waitcnt vmcnt(3)
mm v[84:87],a[236:239],v[180:183],v[84:87]
v_exp_f32 v156, v156
mm v[84:87],a[232:235],v[168:171],v[84:87]
buffer_load_dwordx4 v5, s[8:11], s45 offen offset:0 nt lds
cv v204,v144,v145
mm v[80:83],a[232:235],v[164:167],v[80:83]
v_exp_f32 v157, v157
mm v[80:83],a[236:239],v[176:179],v[80:83]
cv v205,v146,v147
mm v[76:79],a[236:239],v[172:175],v[76:79]
v_exp_f32 v158, v158
mm v[76:79],a[232:235],v[160:163],v[76:79]
s_waitcnt lgkmcnt(0)
cv v206,v156,v157
mm v[88:91],a[240:243],v[160:163],v[88:91]
s_barrier
v_exp_f32 v159, v159
mm v[88:91],a[244:247],v[172:175],v[88:91]
lq a[192:195],v11,0
cv v207,v158,v159
mm v[92:95],a[244:247],v[176:179],v[92:95]
v_exp_f32 v152, v152
mm v[92:95],a[240:243],v[164:167],v[92:95]
lq a[196:199],v11,512
mm v[96:99],a[240:243],v[168:171],v[96:99]
lq a[200:203],v11,4096
mm v[96:99],a[244:247],v[180:183],v[96:99]
lq a[204:207],v11,4608
mm v[108:111],a[252:255],v[180:183],v[108:111]
v_exp_f32 v153, v153
mm v[108:111],a[248:251],v[168:171],v[108:111]
v_exp_f32 v154, v154
mm v[104:107],a[248:251],v[164:167],v[104:107]
v_exp_f32 v155, v155
mm v[104:107],a[252:255],v[176:179],v[104:107]
lq a[208:211],v11,2048
s_waitcnt vmcnt(3)
mm v[100:103],a[252:255],v[172:175],v[100:103]
lq a[212:215],v11,2560
cv v202,v152,v153
mm v[100:103],a[248:251],v[160:163],v[100:103]
s_waitcnt lgkmcnt(2)
cv v203,v154,v155
buffer_load_dwordx4 v6, s[8:11], s45 offen offset:1024 nt lds
mm v[112:115],a[192:195],a[48:51],0
v_exp_f32 v148, v148
mm v[112:115],a[196:199],a[60:63],v[112:115]
lq a[216:219],v11,6144
mm v[112:115],a[200:203],a[72:75],v[112:115]
v_exp_f32 v149, v149
mm v[112:115],a[204:207],a[84:87],v[112:115]
lq a[220:223],v11,6656
cv v198,v148,v149
mm v[116:119],a[204:207],a[88:91],0
v_exp_f32 v150, v150
mm v[116:119],a[200:203],a[76:79],v[116:119]
lq a[224:227],v11,8192
mm v[116:119],a[196:199],a[64:67],v[116:119]
v_exp_f32 v151, v151
mm v[116:119],a[192:195],a[52:55],v[116:119]
lq a[228:231],v11,8704
cv v199,v150,v151
mm v[120:123],a[192:195],a[56:59],0
v_exp_f32 v112, v112
mm v[120:123],a[196:199],a[68:71],v[120:123]
lq a[232:235],v11,12288
s_waitcnt vmcnt(3)
mm v[120:123],a[200:203],a[80:83],v[120:123]
v_exp_f32 v113, v113
mm v[120:123],a[204:207],a[92:95],v[120:123]
s_waitcnt lgkmcnt(3)
lq a[236:239],v11,12800
mm v[132:135],a[220:223],a[92:95],0
v_exp_f32 v114, v114
mm v[132:135],a[216:219],a[80:83],v[132:135]
buffer_load_dwordx4 v7, s[8:11], s45 offen offset:2048 nt lds
lq a[240:243],v11,10240
mm v[132:135],a[212:215],a[68:71],v[132:135]
v_exp_f32 v115, v115
mm v[132:135],a[208:211],a[56:59],v[132:135]
lq a[244:247],v11,10752
cv v160,v112,v113
mm v[128:131],a[208:211],a[52:55],0
v_exp_f32 v116, v116
mm v[128:131],a[212:215],a[64:67],v[128:131]
lq a[248:251],v11,14336
cv v161,v114,v115
mm v[128:131],a[216:219],a[76:79],v[128:131]
v_exp_f32 v117, v117
mm v[128:131],a[220:223],a[88:91],v[128:131]
lq a[252:255],v11,14848
cv v164,v116,v117
mm v[124:127],a[220:223],a[84:87],0
v_exp_f32 v118, v118
mm v[124:127],a[216:219],a[72:75],v[124:127]
s_waitcnt vmcnt(3)
tr a[192:193],v12,49152
mm v[124:127],a[212:215],a[60:63],v[124:127]
v_exp_f32 v119, v119
mm v[124:127],a[208:211],a[48:51],v[124:127]
s_waitcnt lgkmcnt(5)
buffer_load_dwordx4 v8, s[8:11], s45 offen offset:3072 nt lds
mm v[136:139],a[224:227],a[48:51],0
v_exp_f32 v120, v120
mm v[136:139],a[228:231],a[60:63],v[136:139]
tr a[194:195],v12,51200
cv v165,v118,v119
mm v[136:139],a[232:235],a[72:75],v[136:139]
v_exp_f32 v121, v121
mm v[136:139],a[236:239],a[84:87],v[136:139]
tr a[196:197],v12,57344
cv v168,v120,v121
mm v[140:143],a[236:239],a[88:91],0
v_exp_f32 v122, v122
mm v[140:143],a[232:235],a[76:79],v[140:143]
tr a[198:199],v12,59392
mm v[140:143],a[228:231],a[64:67],v[140:143]
v_exp_f32 v123, v123
mm v[140:143],a[224:227],a[52:55],v[140:143]
tr a[200:201],v13,49152
cv v169,v122,v123
mm v[144:147],a[224:227],a[56:59],0
v_exp_f32 v132, v132
mm v[144:147],a[228:231],a[68:71],v[144:147]
tr a[202:203],v13,51200
mm v[144:147],a[232:235],a[80:83],v[144:147]
v_exp_f32 v133, v133
mm v[144:147],a[236:239],a[92:95],v[144:147]
s_waitcnt lgkmcnt(6)
tr a[204:205],v13,57344
mm v[156:159],a[252:255],a[92:95],0
tr a[206:207],v13,59392
s_add_u32 m0, s44, 0
mm v[156:159],a[248:251],a[80:83],v[156:159]
s_waitcnt vmcnt(3)
buffer_load_dwordx4 v5, s[12:15], s45 offen offset:0 nt lds
mm v[156:159],a[244:247],a[68:71],v[156:159]
v_exp_f32 v134, v134
mm v[156:159],a[240:243],a[56:59],v[156:159]
tr a[208:209],v12,49664
cv v170,v132,v133
mm v[152:155],a[240:243],a[52:55],0
v_exp_f32 v135, v135
mm v[152:155],a[244:247],a[64:67],v[152:155]
tr a[210:211],v12,51712
cv v171,v134,v135
mm v[152:155],a[248:251],a[76:79],v[152:155]
v_exp_f32 v128, v128
mm v[152:155],a[252:255],a[88:91],v[152:155]
tr a[212:213],v12,57856
mm v[148:151],a[252:255],a[84:87],0
v_exp_f32 v129, v129
mm v[148:151],a[248:251],a[72:75],v[148:151]
tr a[214:215],v12,59904
cv v166,v128,v129
mm v[148:151],a[244:247],a[60:63],v[148:151]
v_exp_f32 v130, v130
mm v[148:151],a[240:243],a[48:51],v[148:151]
tr a[216:217],v13,49664
s_waitcnt vmcnt(3)
mm v[216:219],v[220:223],v[204:207],v[216:219]
v_exp_f32 v131, v131
mm v[216:219],v[220:223],v[192:195],v[216:219]
tr a[218:219],v13,51712
buffer_load_dwordx4 v6, s[12:15], s45 offen offset:1024 nt lds
mm v[212:215],v[220:223],v[200:203],v[212:215]
v_exp_f32 v124, v124
mm v[212:215],v[220:223],v[188:191],v[212:215]
tr a[220:221],v13,57856
tr a[222:223],v13,59904
mm v[208:211],v[220:223],v[196:199],v[208:211]
v_exp_f32 v125, v125
mm v[208:211],v[220:223],v[184:187],v[208:211]
s_waitcnt lgkmcnt(8)
tr a[224:225],v12,53248
mm v[16:19],a[192:195],v[184:187],v[16:19]
v_exp_f32 v126, v126
mm v[16:19],a[196:199],v[196:199],v[16:19]
tr a[226:227],v12,55296
cv v167,v130,v131
mm v[20:23],a[196:199],v[200:203],v[20:23]
v_exp_f32 v127, v127
mm v[20:23],a[192:195],v[188:191],v[20:23]
tr a[228:229],v12,61440
s_waitcnt vmcnt(3)
mm v[24:27],a[192:195],v[192:195],v[24:27]
v_exp_f32 v136, v136
mm v[24:27],a[196:199],v[204:207],v[24:27]
tr a[230:231],v12,63488
buffer_load_dwordx4 v7, s[12:15], s45 offen offset:2048 nt lds
mm v[36:39],a[204:207],v[204:207],v[36:39]
v_exp_f32 v137, v137
mm v[36:39],a[200:203],v[192:195],v[36:39]
tr a[232:233],v13,53248
cv v162,v124,v125
mm v[32:35],a[200:203],v[188:191],v[32:35]
v_exp_f32 v138, v138
mm v[32:35],a[204:207],v[200:203],v[32:35]
tr a[234:235],v13,55296
cv v163,v126,v127
mm v[28:31],a[204:207],v[196:199],v[28:31]
v_exp_f32 v139, v139
mm v[28:31],a[200:203],v[184:187],v[28:31]
s_waitcnt lgkmcnt(6)
tr a[236:237],v13,61440
mm v[40:43],a[208:211],v[184:187],v[40:43]
tr a[238:239],v13,63488
cv v172,v136,v137
mm v[40:43],a[212:215],v[196:199],v[40:43]
tr a[240:241],v12,53760
s_waitcnt vmcnt(3)
mm v[44:47],a[212:215],v[200:203],v[44:47]
v_exp_f32 v140, v140
mm v[44:47],a[208:211],v[188:191],v[44:47]
tr a[242:243],v12,55808
buffer_load_dwordx4 v8, s[12:15], s45 offen offset:3072 nt lds
mm v[48:51],a[208:211],v[192:195],v[48:51]
v_exp_f32 v141, v141
mm v[48:51],a[212:215],v[204:207],v[48:51]
tr a[244:245],v12,61952
cv v173,v138,v139
mm v[60:63],a[220:223],v[204:207],v[60:63]
v_exp_f32 v142, v142
mm v[60:63],a[216:219],v[192:195],v[60:63]
L_pg13:
s_cbranch_execz L_tret1
tr a[246:247],v12,64000
cv v176,v140,v141
mm v[56:59],a[216:219],v[188:191],v[56:59]
v_exp_f32 v143, v143
mm v[56:59],a[220:223],v[200:203],v[56:59]
tr a[248:249],v13,53760
cv v177,v142,v143
mm v[52:55],a[220:223],v[196:199],v[52:55]
v_exp_f32 v144, v144
mm v[52:55],a[216:219],v[184:187],v[52:55]
s_waitcnt lgkmcnt(5)
tr a[250:251],v13,55808
mm v[64:67],a[224:227],v[184:187],v[64:67]
v_exp_f32 v145, v145
mm v[64:67],a[228:231],v[196:199],v[64:67]
tr a[252:253],v13,61952
s_add_u32 s45, s45, 16384
mm v[68:71],a[228:231],v[200:203],v[68:71]
v_exp_f32 v146, v146
mm v[68:71],a[224:227],v[188:191],v[68:71]
tr a[254:255],v13,64000
s_add_u32 m0, s43, 65536
s_waitcnt vmcnt(3)
mm v[72:75],a[224:227],v[192:195],v[72:75]
v_exp_f32 v147, v147
buffer_load_dwordx4 v5, s[8:11], s45 offen offset:0 nt lds
mm v[72:75],a[228:231],v[204:207],v[72:75]
v_add_u32 v11, 98304, v11
cv v180,v144,v145
mm v[84:87],a[236:239],v[204:207],v[84:87]
v_exp_f32 v156, v156
mm v[84:87],a[232:235],v[192:195],v[84:87]
cv v181,v146,v147
mm v[80:83],a[232:235],v[188:191],v[80:83]
v_exp_f32 v157, v157
mm v[80:83],a[236:239],v[200:203],v[80:83]
cv v182,v156,v157
mm v[76:79],a[236:239],v[196:199],v[76:79]
v_exp_f32 v158, v158
mm v[76:79],a[232:235],v[184:187],v[76:79]
s_waitcnt lgkmcnt(0)
s_waitcnt vmcnt(3)
mm v[88:91],a[240:243],v[184:187],v[88:91]
s_barrier
buffer_load_dwordx4 v6, s[8:11], s45 offen offset:1024 nt lds
v_exp_f32 v159, v159
mm v[88:91],a[244:247],v[196:199],v[88:91]
lq a[192:195],v11,0
cv v183,v158,v159
mm v[92:95],a[244:247],v[200:203],v[92:95]
v_exp_f32 v152, v152
mm v[92:95],a[240:243],v[188:191],v[92:95]
lq a[196:199],v11,512
mm v[96:99],a[240:243],v[192:195],v[96:99]
lq a[200:203],v11,4096
mm v[96:99],a[244:247],v[204:207],v[96:99]
lq a[204:207],v11,4608
mm v[108:111],a[252:255],v[204:207],v[108:111]
v_exp_f32 v153, v153
mm v[108:111],a[248:251],v[192:195],v[108:111]
v_exp_f32 v154, v154
mm v[104:107],a[248:251],v[188:191],v[104:107]
v_exp_f32 v155, v155
mm v[104:107],a[252:255],v[200:203],v[104:107]
lq a[208:211],v11,2048
cv v178,v152,v153
mm v[100:103],a[252:255],v[196:199],v[100:103]
lq a[212:215],v11,2560
cv v179,v154,v155
mm v[100:103],a[248:251],v[184:187],v[100:103]
s_waitcnt lgkmcnt(2)
s_waitcnt vmcnt(3)
buffer_load_dwordx4 v7, s[8:11], s45 offen offset:2048 nt lds
mm v[112:115],a[192:195],a[48:51],0
v_exp_f32 v148, v148
mm v[112:115],a[196:199],a[60:63],v[112:115]
lq a[216:219],v11,6144
mm v[112:115],a[200:203],a[72:75],v[112:115]
v_exp_f32 v149, v149
mm v[112:115],a[204:207],a[84:87],v[112:115]
lq a[220:223],v11,6656
cv v174,v148,v149
mm v[116:119],a[204:207],a[88:91],0
v_exp_f32 v150, v150
mm v[116:119],a[200:203],a[76:79],v[116:119]
lq a[224:227],v11,8192
mm v[116:119],a[196:199],a[64:67],v[116:119]
v_exp_f32 v151, v151
mm v[116:119],a[192:195],a[52:55],v[116:119]
lq a[228:231],v11,8704
s_waitcnt vmcnt(3)
mm v[120:123],a[192:195],a[56:59],0
v_exp_f32 v112, v112
mm v[120:123],a[196:199],a[68:71],v[120:123]
lq a[232:235],v11,12288
buffer_load_dwordx4 v8, s[8:11], s45 offen offset:3072 nt lds
mm v[120:123],a[200:203],a[80:83],v[120:123]
v_exp_f32 v113, v113
mm v[120:123],a[204:207],a[92:95],v[120:123]
s_waitcnt lgkmcnt(3)
lq a[236:239],v11,12800
mm v[132:135],a[220:223],a[92:95],0
v_exp_f32 v114, v114
mm v[132:135],a[216:219],a[80:83],v[132:135]
lq a[240:243],v11,10240
v_add_u32 v12, 4294934528, v12
mm v[132:135],a[212:215],a[68:71],v[132:135]
v_exp_f32 v115, v115
mm v[132:135],a[208:211],a[56:59],v[132:135]
lq a[244:247],v11,10752
v_add_u32 v13, 4294934528, v13
mm v[128:131],a[208:211],a[52:55],0
v_exp_f32 v116, v116
mm v[128:131],a[212:215],a[64:67],v[128:131]
lq a[248:251],v11,14336
cv v184,v112,v113
mm v[128:131],a[216:219],a[76:79],v[128:131]
v_exp_f32 v117, v117
mm v[128:131],a[220:223],a[88:91],v[128:131]
lq a[252:255],v11,14848
cv v185,v114,v115
mm v[124:127],a[220:223],a[84:87],0
v_exp_f32 v118, v118
mm v[124:127],a[216:219],a[72:75],v[124:127]
tr a[192:193],v12,16384
cv v188,v116,v117
mm v[124:127],a[212:215],a[60:63],v[124:127]
v_exp_f32 v119, v119
mm v[124:127],a[208:211],a[48:51],v[124:127]
s_waitcnt lgkmcnt(5)
s_add_u32 m0, s44, 65536
mm v[136:139],a[224:227],a[48:51],0
v_exp_f32 v120, v120
mm v[136:139],a[228:231],a[60:63],v[136:139]
s_waitcnt vmcnt(3)
tr a[194:195],v12,18432
mm v[136:139],a[232:235],a[72:75],v[136:139]
v_exp_f32 v121, v121
mm v[136:139],a[236:239],a[84:87],v[136:139]
buffer_load_dwordx4 v5, s[12:15], s45 offen offset:0 nt lds
tr a[196:197],v12,24576
mm v[140:143],a[236:239],a[88:91],0
v_exp_f32 v122, v122
mm v[140:143],a[232:235],a[76:79],v[140:143]
tr a[198:199],v12,26624
cv v189,v118,v119
mm v[140:143],a[228:231],a[64:67],v[140:143]
v_exp_f32 v123, v123
mm v[140:143],a[224:227],a[52:55],v[140:143]
tr a[200:201],v13,16384
cv v175,v150,v151
mm v[144:147],a[224:227],a[56:59],0
v_exp_f32 v132, v132
mm v[144:147],a[228:231],a[68:71],v[144:147]
tr a[202:203],v13,18432
cv v192,v120,v121
mm v[144:147],a[232:235],a[80:83],v[144:147]
v_exp_f32 v133, v133
mm v[144:147],a[236:239],a[92:95],v[144:147]
s_waitcnt lgkmcnt(6)
tr a[204:205],v13,24576
mm v[156:159],a[252:255],a[92:95],0
tr a[206:207],v13,26624
cv v193,v122,v123
mm v[156:159],a[248:251],a[80:83],v[156:159]
tr a[208:209],v12,16896
s_waitcnt vmcnt(3)
mm v[156:159],a[244:247],a[68:71],v[156:159]
v_exp_f32 v134, v134
mm v[156:159],a[240:243],a[56:59],v[156:159]
tr a[210:211],v12,18944
buffer_load_dwordx4 v6, s[12:15], s45 offen offset:1024 nt lds
mm v[152:155],a[240:243],a[52:55],0
v_exp_f32 v135, v135
mm v[152:155],a[244:247],a[64:67],v[152:155]
tr a[212:213],v12,25088
cv v194,v132,v133
mm v[152:155],a[248:251],a[76:79],v[152:155]
v_exp_f32 v128, v128
mm v[152:155],a[252:255],a[88:91],v[152:155]
tr a[214:215],v12,27136
cv v195,v134,v135
mm v[148:151],a[252:255],a[84:87],0
v_exp_f32 v129, v129
mm v[148:151],a[248:251],a[72:75],v[148:151]
tr a[216:217],v13,16896
cv v190,v128,v129
mm v[148:151],a[244:247],a[60:63],v[148:151]
v_exp_f32 v130, v130
mm v[148:151],a[240:243],a[48:51],v[148:151]
tr a[218:219],v13,18944
mm v[216:219],v[220:223],v[180:183],v[216:219]
v_exp_f32 v131, v131
mm v[216:219],v[220:223],v[168:171],v[216:219]
tr a[220:221],v13,25088
cv v191,v130,v131
mm v[212:215],v[220:223],v[176:179],v[212:215]
v_exp_f32 v124, v124
mm v[212:215],v[220:223],v[164:167],v[212:215]
tr a[222:223],v13,27136
mm v[208:211],v[220:223],v[172:175],v[208:211]
v_exp_f32 v125, v125
mm v[208:211],v[220:223],v[160:163],v[208:211]
s_waitcnt lgkmcnt(8)
tr a[224:225],v12,20480
mm v[16:19],a[192:195],v[160:163],v[16:19]
v_exp_f32 v126, v126
mm v[16:19],a[196:199],v[172:175],v[16:19]
s_waitcnt vmcnt(3)
tr a[226:227],v12,22528
mm v[20:23],a[196:199],v[176:179],v[20:23]
v_exp_f32 v127, v127
mm v[20:23],a[192:195],v[164:167],v[20:23]
buffer_load_dwordx4 v7, s[12:15], s45 offen offset:2048 nt lds
tr a[228:229],v12,28672
mm v[24:27],a[192:195],v[168:171],v[24:27]
v_exp_f32 v136, v136
mm v[24:27],a[196:199],v[180:183],v[24:27]
tr a[230:231],v12,30720
cv v186,v124,v125
mm v[36:39],a[204:207],v[180:183],v[36:39]
v_exp_f32 v137, v137
mm v[36:39],a[200:203],v[168:171],v[36:39]
tr a[232:233],v13,20480
cv v187,v126,v127
mm v[32:35],a[200:203],v[164:167],v[32:35]
v_exp_f32 v138, v138
mm v[32:35],a[204:207],v[176:179],v[32:35]
tr a[234:235],v13,22528
cv v196,v136,v137
mm v[28:31],a[204:207],v[172:175],v[28:31]
v_exp_f32 v139, v139
mm v[28:31],a[200:203],v[160:163],v[28:31]
s_waitcnt lgkmcnt(6)
tr a[236:237],v13,28672
mm v[40:43],a[208:211],v[160:163],v[40:43]
tr a[238:239],v13,30720
cv v197,v138,v139
mm v[40:43],a[212:215],v[172:175],v[40:43]
tr a[240:241],v12,20992
s_waitcnt vmcnt(3)
mm v[44:47],a[212:215],v[176:179],v[44:47]
v_exp_f32 v140, v140
mm v[44:47],a[208:211],v[164:167],v[44:47]
tr a[242:243],v12,23040
buffer_load_dwordx4 v8, s[12:15], s45 offen offset:3072 nt lds
mm v[48:51],a[208:211],v[168:171],v[48:51]
v_exp_f32 v141, v141
mm v[48:51],a[212:215],v[180:183],v[48:51]
tr a[244:245],v12,29184
cv v200,v140,v141
mm v[60:63],a[220:223],v[180:183],v[60:63]
v_exp_f32 v142, v142
mm v[60:63],a[216:219],v[168:171],v[60:63]
tr a[246:247],v12,31232
mm v[56:59],a[216:219],v[164:167],v[56:59]
v_exp_f32 v143, v143
mm v[56:59],a[220:223],v[176:179],v[56:59]
tr a[248:249],v13,20992
cv v201,v142,v143
mm v[52:55],a[220:223],v[172:175],v[52:55]
v_exp_f32 v144, v144
mm v[52:55],a[216:219],v[160:163],v[52:55]
s_waitcnt lgkmcnt(5)
tr a[250:251],v13,23040
mm v[64:67],a[224:227],v[160:163],v[64:67]
v_exp_f32 v145, v145
mm v[64:67],a[228:231],v[172:175],v[64:67]
tr a[252:253],v13,29184
v_add_u32 v11, 4294836224, v11
mm v[68:71],a[228:231],v[176:179],v[68:71]
v_exp_f32 v146, v146
mm v[68:71],a[224:227],v[164:167],v[68:71]
tr a[254:255],v13,31232
s_add_u32 s45, s45, 16384
mm v[72:75],a[224:227],v[168:171],v[72:75]
v_exp_f32 v147, v147
mm v[72:75],a[228:231],v[180:183],v[72:75]
s_add_u32 m0, s43, 98304
s_waitcnt vmcnt(3)
mm v[84:87],a[236:239],v[180:183],v[84:87]
v_exp_f32 v156, v156
mm v[84:87],a[232:235],v[168:171],v[84:87]
buffer_load_dwordx4 v5, s[8:11], s45 offen offset:0 nt lds
cv v204,v144,v145
mm v[80:83],a[232:235],v[164:167],v[80:83]
v_exp_f32 v157, v157
mm v[80:83],a[236:239],v[176:179],v[80:83]
cv v205,v146,v147
mm v[76:79],a[236:239],v[172:175],v[76:79]
v_exp_f32 v158, v158
mm v[76:79],a[232:235],v[160:163],v[76:79]
s_waitcnt lgkmcnt(0)
cv v206,v156,v157
mm v[88:91],a[240:243],v[160:163],v[88:91]
s_barrier
v_exp_f32 v159, v159
mm v[88:91],a[244:247],v[172:175],v[88:91]
lq a[192:195],v11,0
cv v207,v158,v159
mm v[92:95],a[244:247],v[176:179],v[92:95]
v_exp_f32 v152, v152
mm v[92:95],a[240:243],v[164:167],v[92:95]
lq a[196:199],v11,512
mm v[96:99],a[240:243],v[168:171],v[96:99]
lq a[200:203],v11,4096
mm v[96:99],a[244:247],v[180:183],v[96:99]
lq a[204:207],v11,4608
mm v[108:111],a[252:255],v[180:183],v[108:111]
v_exp_f32 v153, v153
mm v[108:111],a[248:251],v[168:171],v[108:111]
v_exp_f32 v154, v154
mm v[104:107],a[248:251],v[164:167],v[104:107]
v_exp_f32 v155, v155
mm v[104:107],a[252:255],v[176:179],v[104:107]
lq a[208:211],v11,2048
cv v202,v152,v153
mm v[100:103],a[252:255],v[172:175],v[100:103]
lq a[212:215],v11,2560
cv v203,v154,v155
mm v[100:103],a[248:251],v[160:163],v[100:103]
s_waitcnt lgkmcnt(2)
s_waitcnt vmcnt(3)
buffer_load_dwordx4 v6, s[8:11], s45 offen offset:1024 nt lds
mm v[112:115],a[192:195],a[48:51],0
v_exp_f32 v148, v148
mm v[112:115],a[196:199],a[60:63],v[112:115]
lq a[216:219],v11,6144
mm v[112:115],a[200:203],a[72:75],v[112:115]
v_exp_f32 v149, v149
mm v[112:115],a[204:207],a[84:87],v[112:115]
lq a[220:223],v11,6656
cv v198,v148,v149
mm v[116:119],a[204:207],a[88:91],0
v_exp_f32 v150, v150
mm v[116:119],a[200:203],a[76:79],v[116:119]
lq a[224:227],v11,8192
mm v[116:119],a[196:199],a[64:67],v[116:119]
v_exp_f32 v151, v151
mm v[116:119],a[192:195],a[52:55],v[116:119]
lq a[228:231],v11,8704
cv v199,v150,v151
mm v[120:123],a[192:195],a[56:59],0
v_exp_f32 v112, v112
mm v[120:123],a[196:199],a[68:71],v[120:123]
lq a[232:235],v11,12288
v_add_u32 v12, 98304, v12
mm v[120:123],a[200:203],a[80:83],v[120:123]
v_exp_f32 v113, v113
mm v[120:123],a[204:207],a[92:95],v[120:123]
s_waitcnt lgkmcnt(3)
lq a[236:239],v11,12800
mm v[132:135],a[220:223],a[92:95],0
v_exp_f32 v114, v114
mm v[132:135],a[216:219],a[80:83],v[132:135]
s_waitcnt vmcnt(3)
buffer_load_dwordx4 v7, s[8:11], s45 offen offset:2048 nt lds
mm v[132:135],a[212:215],a[68:71],v[132:135]
v_exp_f32 v115, v115
mm v[132:135],a[208:211],a[56:59],v[132:135]
lq a[240:243],v11,10240
v_add_u32 v13, 98304, v13
mm v[128:131],a[208:211],a[52:55],0
v_exp_f32 v116, v116
mm v[128:131],a[212:215],a[64:67],v[128:131]
lq a[244:247],v11,10752
cv v160,v112,v113
mm v[128:131],a[216:219],a[76:79],v[128:131]
v_exp_f32 v117, v117
mm v[128:131],a[220:223],a[88:91],v[128:131]
lq a[248:251],v11,14336
cv v161,v114,v115
mm v[124:127],a[220:223],a[84:87],0
lq a[252:255],v11,14848
cv v164,v116,v117
mm v[124:127],a[216:219],a[72:75],v[124:127]
tr a[192:193],v12,16384
mm v[124:127],a[212:215],a[60:63],v[124:127]
v_exp_f32 v118, v118
mm v[124:127],a[208:211],a[48:51],v[124:127]
s_waitcnt lgkmcnt(5)
tr a[194:195],v12,18432
mm v[136:139],a[224:227],a[48:51],0
v_exp_f32 v119, v119
mm v[136:139],a[228:231],a[60:63],v[136:139]
tr a[196:197],v12,24576
s_waitcnt vmcnt(3)
mm v[136:139],a[232:235],a[72:75],v[136:139]
v_exp_f32 v120, v120
mm v[136:139],a[236:239],a[84:87],v[136:139]
buffer_load_dwordx4 v8, s[8:11], s45 offen offset:3072 nt lds
tr a[198:199],v12,26624
mm v[140:143],a[236:239],a[88:91],0
v_exp_f32 v121, v121
mm v[140:143],a[232:235],a[76:79],v[140:143]
tr a[200:201],v13,16384
cv v165,v118,v119
mm v[140:143],a[228:231],a[64:67],v[140:143]
v_exp_f32 v122, v122
mm v[140:143],a[224:227],a[52:55],v[140:143]
tr a[202:203],v13,18432
cv v168,v120,v121
mm v[144:147],a[224:227],a[56:59],0
v_exp_f32 v123, v123
mm v[144:147],a[228:231],a[68:71],v[144:147]
tr a[204:205],v13,24576
cv v169,v122,v123
mm v[144:147],a[232:235],a[80:83],v[144:147]
v_exp_f32 v132, v132
mm v[144:147],a[236:239],a[92:95],v[144:147]
s_waitcnt lgkmcnt(7)
tr a[206:207],v13,26624
mm v[156:159],a[252:255],a[92:95],0
v_exp_f32 v133, v133
mm v[156:159],a[248:251],a[80:83],v[156:159]
tr a[208:209],v12,16896
cv v170,v132,v133
mm v[156:159],a[244:247],a[68:71],v[156:159]
v_exp_f32 v134, v134
mm v[156:159],a[240:243],a[56:59],v[156:159]
tr a[210:211],v12,18944
mm v[152:155],a[240:243],a[52:55],0
v_exp_f32 v135, v135
mm v[152:155],a[244:247],a[64:67],v[152:155]
tr a[212:213],v12,25088
s_add_u32 m0, s44, 98304
mm v[152:155],a[248:251],a[76:79],v[152:155]
v_exp_f32 v128, v128
mm v[152:155],a[252:255],a[88:91],v[152:155]
s_waitcnt vmcnt(3)
buffer_load_dwordx4 v5, s[12:15], s45 offen offset:0 nt lds
mm v[148:151],a[252:255],a[84:87],0
v_exp_f32 v129, v129
mm v[148:151],a[248:251],a[72:75],v[148:151]
tr a[214:215],v12,27136
cv v171,v134,v135
mm v[148:151],a[244:247],a[60:63],v[148:151]
v_exp_f32 v130, v130
mm v[148:151],a[240:243],a[48:51],v[148:151]
tr a[216:217],v13,16896
cv v166,v128,v129
mm v[216:219],v[220:223],v[204:207],v[216:219]
v_exp_f32 v131, v131
mm v[216:219],v[220:223],v[192:195],v[216:219]
tr a[218:219],v13,18944
cv v167,v130,v131
mm v[212:215],v[220:223],v[200:203],v[212:215]
v_exp_f32 v124, v124
mm v[212:215],v[220:223],v[188:191],v[212:215]
tr a[220:221],v13,25088
tr a[222:223],v13,27136
mm v[208:211],v[220:223],v[196:199],v[208:211]
v_exp_f32 v125, v125
mm v[208:211],v[220:223],v[184:187],v[208:211]
s_waitcnt lgkmcnt(8)
tr a[224:225],v12,20480
mm v[16:19],a[192:195],v[184:187],v[16:19]
v_exp_f32 v126, v126
mm v[16:19],a[196:199],v[196:199],v[16:19]
tr a[226:227],v12,22528
s_waitcnt vmcnt(3)
mm v[20:23],a[196:199],v[200:203],v[20:23]
v_exp_f32 v127, v127
mm v[20:23],a[192:195],v[188:191],v[20:23]
tr a[228:229],v12,28672
buffer_load_dwordx4 v6, s[12:15], s45 offen offset:1024 nt lds
mm v[24:27],a[192:195],v[192:195],v[24:27]
v_exp_f32 v136, v136
mm v[24:27],a[196:199],v[204:207],v[24:27]
tr a[230:231],v12,30720
cv v162,v124,v125
mm v[36:39],a[204:207],v[204:207],v[36:39]
v_exp_f32 v137, v137
mm v[36:39],a[200:203],v[192:195],v[36:39]
tr a[232:233],v13,20480
cv v163,v126,v127
mm v[32:35],a[200:203],v[188:191],v[32:35]
v_exp_f32 v138, v138
mm v[32:35],a[204:207],v[200:203],v[32:35]
tr a[234:235],v13,22528
cv v172,v136,v137
mm v[28:31],a[204:207],v[196:199],v[28:31]
v_exp_f32 v139, v139
mm v[28:31],a[200:203],v[184:187],v[28:31]
s_waitcnt lgkmcnt(6)
tr a[236:237],v13,28672
mm v[40:43],a[208:211],v[184:187],v[40:43]
tr a[238:239],v13,30720
cv v173,v138,v139
mm v[40:43],a[212:215],v[196:199],v[40:43]
tr a[240:241],v12,20992
mm v[44:47],a[212:215],v[200:203],v[44:47]
v_exp_f32 v140, v140
mm v[44:47],a[208:211],v[188:191],v[44:47]
tr a[242:243],v12,23040
mm v[48:51],a[208:211],v[192:195],v[48:51]
v_exp_f32 v141, v141
mm v[48:51],a[212:215],v[204:207],v[48:51]
tr a[244:245],v12,29184
s_waitcnt vmcnt(3)
mm v[60:63],a[220:223],v[204:207],v[60:63]
v_exp_f32 v142, v142
mm v[60:63],a[216:219],v[192:195],v[60:63]
tr a[246:247],v12,31232
buffer_load_dwordx4 v7, s[12:15], s45 offen offset:2048 nt lds
mm v[56:59],a[216:219],v[188:191],v[56:59]
v_exp_f32 v143, v143
mm v[56:59],a[220:223],v[200:203],v[56:59]
tr a[248:249],v13,20992
cv v176,v140,v141
mm v[52:55],a[220:223],v[196:199],v[52:55]
v_exp_f32 v144, v144
mm v[52:55],a[216:219],v[184:187],v[52:55]
s_waitcnt lgkmcnt(5)
tr a[250:251],v13,23040
mm v[64:67],a[224:227],v[184:187],v[64:67]
v_exp_f32 v145, v145
mm v[64:67],a[228:231],v[196:199],v[64:67]
tr a[252:253],v13,29184
cv v177,v142,v143
mm v[68:71],a[228:231],v[200:203],v[68:71]
v_exp_f32 v146, v146
mm v[68:71],a[224:227],v[188:191],v[68:71]
tr a[254:255],v13,31232
v_add_u32 v11, 65536, v11
mm v[72:75],a[224:227],v[192:195],v[72:75]
v_exp_f32 v147, v147
mm v[72:75],a[228:231],v[204:207],v[72:75]
cv v180,v144,v145
cv v181,v146,v147
mm v[84:87],a[236:239],v[204:207],v[84:87]
v_exp_f32 v156, v156
mm v[84:87],a[232:235],v[192:195],v[84:87]
s_waitcnt vmcnt(3)
mm v[80:83],a[232:235],v[188:191],v[80:83]
v_exp_f32 v157, v157
mm v[80:83],a[236:239],v[200:203],v[80:83]
buffer_load_dwordx4 v8, s[12:15], s45 offen offset:3072 nt lds
mm v[76:79],a[236:239],v[196:199],v[76:79]
v_exp_f32 v158, v158
mm v[76:79],a[232:235],v[184:187],v[76:79]
s_waitcnt lgkmcnt(0)
cv v182,v156,v157
mm v[88:91],a[240:243],v[184:187],v[88:91]
s_barrier
v_exp_f32 v159, v159
mm v[88:91],a[244:247],v[196:199],v[88:91]
lq a[192:195],v11,0
cv v183,v158,v159
mm v[92:95],a[244:247],v[200:203],v[92:95]
v_exp_f32 v152, v152
mm v[92:95],a[240:243],v[188:191],v[92:95]
lq a[196:199],v11,512
mm v[96:99],a[240:243],v[192:195],v[96:99]
lq a[200:203],v11,4096
mm v[96:99],a[244:247],v[204:207],v[96:99]
lq a[204:207],v11,4608
mm v[108:111],a[252:255],v[204:207],v[108:111]
v_exp_f32 v153, v153
mm v[108:111],a[248:251],v[192:195],v[108:111]
v_exp_f32 v154, v154
mm v[104:107],a[248:251],v[188:191],v[104:107]
v_exp_f32 v155, v155
mm v[104:107],a[252:255],v[200:203],v[104:107]
lq a[208:211],v11,2048
cv v178,v152,v153
mm v[100:103],a[252:255],v[196:199],v[100:103]
lq a[212:215],v11,2560
cv v179,v154,v155
mm v[100:103],a[248:251],v[184:187],v[100:103]
s_waitcnt lgkmcnt(2)
s_add_u32 s45, s45, 16384
s_add_u32 m0, s43, 32768
s_waitcnt vmcnt(3)
buffer_load_dwordx4 v5, s[8:11], s45 offen offset:0 nt lds
mm v[112:115],a[192:195],a[48:51],0
v_exp_f32 v148, v148
mm v[112:115],a[196:199],a[60:63],v[112:115]
lq a[216:219],v11,6144
mm v[112:115],a[200:203],a[72:75],v[112:115]
v_exp_f32 v149, v149
mm v[112:115],a[204:207],a[84:87],v[112:115]
lq a[220:223],v11,6656
cv v174,v148,v149
mm v[116:119],a[204:207],a[88:91],0
v_exp_f32 v150, v150
mm v[116:119],a[200:203],a[76:79],v[116:119]
L_pg14:
s_cbranch_execz L_tret1
lq a[224:227],v11,8192
mm v[116:119],a[196:199],a[64:67],v[116:119]
v_exp_f32 v151, v151
mm v[116:119],a[192:195],a[52:55],v[116:119]
lq a[228:231],v11,8704
cv v175,v150,v151
mm v[120:123],a[192:195],a[56:59],0
v_exp_f32 v112, v112
mm v[120:123],a[196:199],a[68:71],v[120:123]
lq a[232:235],v11,12288
v_add_u32 v12, 4294836224, v12
mm v[120:123],a[200:203],a[80:83],v[120:123]
v_exp_f32 v113, v113
mm v[120:123],a[204:207],a[92:95],v[120:123]
s_waitcnt lgkmcnt(3)
lq a[236:239],v11,12800
mm v[132:135],a[220:223],a[92:95],0
v_exp_f32 v114, v114
mm v[132:135],a[216:219],a[80:83],v[132:135]
s_waitcnt vmcnt(3)
lq a[240:243],v11,10240
mm v[132:135],a[212:215],a[68:71],v[132:135]
v_exp_f32 v115, v115
mm v[132:135],a[208:211],a[56:59],v[132:135]
buffer_load_dwordx4 v6, s[8:11], s45 offen offset:1024 nt lds
lq a[244:247],v11,10752
mm v[128:131],a[208:211],a[52:55],0
v_exp_f32 v116, v116
mm v[128:131],a[212:215],a[64:67],v[128:131]
lq a[248:251],v11,14336
v_add_u32 v13, 4294836224, v13
mm v[128:131],a[216:219],a[76:79],v[128:131]
v_exp_f32 v117, v117
mm v[128:131],a[220:223],a[88:91],v[128:131]
lq a[252:255],v11,14848
cv v184,v112,v113
mm v[124:127],a[220:223],a[84:87],0
v_exp_f32 v118, v118
mm v[124:127],a[216:219],a[72:75],v[124:127]
tr a[192:193],v12,16384
cv v185,v114,v115
mm v[124:127],a[212:215],a[60:63],v[124:127]
v_exp_f32 v119, v119
mm v[124:127],a[208:211],a[48:51],v[124:127]
s_waitcnt lgkmcnt(5)
tr a[194:195],v12,18432
mm v[136:139],a[224:227],a[48:51],0
v_exp_f32 v120, v120
mm v[136:139],a[228:231],a[60:63],v[136:139]
tr a[196:197],v12,24576
cv v188,v116,v117
mm v[136:139],a[232:235],a[72:75],v[136:139]
v_exp_f32 v121, v121
mm v[136:139],a[236:239],a[84:87],v[136:139]
tr a[198:199],v12,26624
cv v189,v118,v119
mm v[140:143],a[236:239],a[88:91],0
v_exp_f32 v122, v122
mm v[140:143],a[232:235],a[76:79],v[140:143]
s_waitcnt vmcnt(3)
tr a[200:201],v13,16384
mm v[140:143],a[228:231],a[64:67],v[140:143]
v_exp_f32 v123, v123
mm v[140:143],a[224:227],a[52:55],v[140:143]
buffer_load_dwordx4 v7, s[8:11], s45 offen offset:2048 nt lds
tr a[202:203],v13,18432
mm v[144:147],a[224:227],a[56:59],0
v_exp_f32 v132, v132
mm v[144:147],a[228:231],a[68:71],v[144:147]
tr a[204:205],v13,24576
cv v192,v120,v121
mm v[144:147],a[232:235],a[80:83],v[144:147]
v_exp_f32 v133, v133
mm v[144:147],a[236:239],a[92:95],v[144:147]
s_waitcnt lgkmcnt(7)
tr a[206:207],v13,26624
mm v[156:159],a[252:255],a[92:95],0
v_exp_f32 v134, v134
mm v[156:159],a[248:251],a[80:83],v[156:159]
tr a[208:209],v12,16896
cv v193,v122,v123
mm v[156:159],a[244:247],a[68:71],v[156:159]
v_exp_f32 v135, v135
mm v[156:159],a[240:243],a[56:59],v[156:159]
tr a[210:211],v12,18944
cv v194,v132,v133
mm v[152:155],a[240:243],a[52:55],0
v_exp_f32 v128, v128
mm v[152:155],a[244:247],a[64:67],v[152:155]
tr a[212:213],v12,25088
cv v195,v134,v135
mm v[152:155],a[248:251],a[76:79],v[152:155]
v_exp_f32 v129, v129
mm v[152:155],a[252:255],a[88:91],v[152:155]
tr a[214:215],v12,27136
s_waitcnt vmcnt(3)
mm v[148:151],a[252:255],a[84:87],0
v_exp_f32 v130, v130
mm v[148:151],a[248:251],a[72:75],v[148:151]
tr a[216:217],v13,16896
buffer_load_dwordx4 v8, s[8:11], s45 offen offset:3072 nt lds
mm v[148:151],a[244:247],a[60:63],v[148:151]
v_exp_f32 v131, v131
mm v[148:151],a[240:243],a[48:51],v[148:151]
tr a[218:219],v13,18944
cv v190,v128,v129
mm v[216:219],v[220:223],v[180:183],v[216:219]
v_exp_f32 v124, v124
mm v[216:219],v[220:223],v[168:171],v[216:219]
tr a[220:221],v13,25088
cv v191,v130,v131
mm v[212:215],v[220:223],v[176:179],v[212:215]
v_exp_f32 v125, v125
mm v[212:215],v[220:223],v[164:167],v[212:215]
tr a[222:223],v13,27136
cv v186,v124,v125
mm v[208:211],v[220:223],v[172:175],v[208:211]
v_exp_f32 v126, v126
mm v[208:211],v[220:223],v[160:163],v[208:211]
s_waitcnt lgkmcnt(8)
tr a[224:225],v12,20480
mm v[16:19],a[192:195],v[160:163],v[16:19]
v_exp_f32 v127, v127
mm v[16:19],a[196:199],v[172:175],v[16:19]
tr a[226:227],v12,22528
cv v187,v126,v127
mm v[20:23],a[196:199],v[176:179],v[20:23]
v_exp_f32 v136, v136
mm v[20:23],a[192:195],v[164:167],v[20:23]
tr a[228:229],v12,28672
mm v[24:27],a[192:195],v[168:171],v[24:27]
v_exp_f32 v137, v137
mm v[24:27],a[196:199],v[180:183],v[24:27]
tr a[230:231],v12,30720
s_add_u32 m0, s44, 32768
mm v[36:39],a[204:207],v[180:183],v[36:39]
v_exp_f32 v138, v138
mm v[36:39],a[200:203],v[168:171],v[36:39]
s_waitcnt vmcnt(3)
tr a[232:233],v13,20480
mm v[32:35],a[200:203],v[164:167],v[32:35]
v_exp_f32 v139, v139
mm v[32:35],a[204:207],v[176:179],v[32:35]
buffer_load_dwordx4 v5, s[12:15], s45 offen offset:0 nt lds
tr a[234:235],v13,22528
mm v[28:31],a[204:207],v[172:175],v[28:31]
v_exp_f32 v140, v140
mm v[28:31],a[200:203],v[160:163],v[28:31]
s_waitcnt lgkmcnt(6)
tr a[236:237],v13,28672
mm v[40:43],a[208:211],v[160:163],v[40:43]
tr a[238:239],v13,30720
cv v196,v136,v137
mm v[40:43],a[212:215],v[172:175],v[40:43]
tr a[240:241],v12,20992
cv v197,v138,v139
mm v[44:47],a[212:215],v[176:179],v[44:47]
v_exp_f32 v141, v141
mm v[44:47],a[208:211],v[164:167],v[44:47]
tr a[242:243],v12,23040
cv v200,v140,v141
mm v[48:51],a[208:211],v[168:171],v[48:51]
v_exp_f32 v142, v142
mm v[48:51],a[212:215],v[180:183],v[48:51]
tr a[244:245],v12,29184
mm v[60:63],a[220:223],v[180:183],v[60:63]
v_exp_f32 v143, v143
mm v[60:63],a[216:219],v[168:171],v[60:63]
tr a[246:247],v12,31232
s_waitcnt vmcnt(3)
mm v[56:59],a[216:219],v[164:167],v[56:59]
v_exp_f32 v144, v144
mm v[56:59],a[220:223],v[176:179],v[56:59]
tr a[248:249],v13,20992
buffer_load_dwordx4 v6, s[12:15], s45 offen offset:1024 nt lds
mm v[52:55],a[220:223],v[172:175],v[52:55]
v_exp_f32 v145, v145
mm v[52:55],a[216:219],v[160:163],v[52:55]
s_waitcnt lgkmcnt(5)
tr a[250:251],v13,23040
mm v[64:67],a[224:227],v[160:163],v[64:67]
v_exp_f32 v146, v146
mm v[64:67],a[228:231],v[172:175],v[64:67]
tr a[252:253],v13,29184
cv v201,v142,v143
mm v[68:71],a[228:231],v[176:179],v[68:71]
v_exp_f32 v147, v147
mm v[68:71],a[224:227],v[164:167],v[68:71]
tr a[254:255],v13,31232
cv v204,v144,v145
mm v[72:75],a[224:227],v[168:171],v[72:75]
v_exp_f32 v156, v156
mm v[72:75],a[228:231],v[180:183],v[72:75]
cv v205,v146,v147
mm v[84:87],a[236:239],v[180:183],v[84:87]
v_exp_f32 v157, v157
mm v[84:87],a[232:235],v[168:171],v[84:87]
cv v206,v156,v157
mm v[80:83],a[232:235],v[164:167],v[80:83]
v_exp_f32 v158, v158
mm v[80:83],a[236:239],v[176:179],v[80:83]
mm v[76:79],a[236:239],v[172:175],v[76:79]
v_exp_f32 v159, v159
mm v[76:79],a[232:235],v[160:163],v[76:79]
s_waitcnt lgkmcnt(0)
s_waitcnt vmcnt(3)
mm v[88:91],a[240:243],v[160:163],v[88:91]
s_barrier
buffer_load_dwordx4 v7, s[12:15], s45 offen offset:2048 nt lds
mm v[88:91],a[244:247],v[172:175],v[88:91]
lq a[192:195],v11,32768
cv v207,v158,v159
mm v[92:95],a[244:247],v[176:179],v[92:95]
v_exp_f32 v152, v152
mm v[92:95],a[240:243],v[164:167],v[92:95]
lq a[196:199],v11,33280
mm v[96:99],a[240:243],v[168:171],v[96:99]
lq a[200:203],v11,36864
mm v[96:99],a[244:247],v[180:183],v[96:99]
lq a[204:207],v11,37376
mm v[108:111],a[252:255],v[180:183],v[108:111]
v_exp_f32 v153, v153
mm v[108:111],a[248:251],v[168:171],v[108:111]
v_exp_f32 v154, v154
mm v[104:107],a[248:251],v[164:167],v[104:107]
v_exp_f32 v155, v155
mm v[104:107],a[252:255],v[176:179],v[104:107]
lq a[208:211],v11,34816
cv v202,v152,v153
mm v[100:103],a[252:255],v[172:175],v[100:103]
lq a[212:215],v11,35328
cv v203,v154,v155
mm v[100:103],a[248:251],v[160:163],v[100:103]
s_waitcnt lgkmcnt(2)
mm v[112:115],a[192:195],a[96:99],0
v_exp_f32 v148, v148
mm v[112:115],a[196:199],a[108:111],v[112:115]
lq a[216:219],v11,38912
s_waitcnt vmcnt(3)
mm v[112:115],a[200:203],a[120:123],v[112:115]
v_exp_f32 v149, v149
mm v[112:115],a[204:207],a[132:135],v[112:115]
lq a[220:223],v11,39424
buffer_load_dwordx4 v8, s[12:15], s45 offen offset:3072 nt lds
mm v[116:119],a[204:207],a[136:139],0
v_exp_f32 v150, v150
mm v[116:119],a[200:203],a[124:127],v[116:119]
lq a[224:227],v11,40960
cv v198,v148,v149
mm v[116:119],a[196:199],a[112:115],v[116:119]
v_exp_f32 v151, v151
mm v[116:119],a[192:195],a[100:103],v[116:119]
lq a[228:231],v11,41472
cv v199,v150,v151
mm v[120:123],a[192:195],a[104:107],0
v_exp_f32 v112, v112
mm v[120:123],a[196:199],a[116:119],v[120:123]
lq a[232:235],v11,45056
v_add_u32 v12, 65536, v12
mm v[120:123],a[200:203],a[128:131],v[120:123]
v_exp_f32 v113, v113
mm v[120:123],a[204:207],a[140:143],v[120:123]
s_waitcnt lgkmcnt(3)
lq a[236:239],v11,45568
mm v[132:135],a[220:223],a[140:143],0
v_exp_f32 v114, v114
mm v[132:135],a[216:219],a[128:131],v[132:135]
lq a[240:243],v11,43008
v_add_u32 v13, 65536, v13
mm v[132:135],a[212:215],a[116:119],v[132:135]
v_exp_f32 v115, v115
mm v[132:135],a[208:211],a[104:107],v[132:135]
s_add_u32 s45, s45, 16384
lq a[244:247],v11,43520
mm v[128:131],a[208:211],a[100:103],0
v_exp_f32 v116, v116
mm v[128:131],a[212:215],a[112:115],v[128:131]
lq a[248:251],v11,47104
s_add_u32 m0, s43, 131072
mm v[128:131],a[216:219],a[124:127],v[128:131]
v_exp_f32 v117, v117
mm v[128:131],a[220:223],a[136:139],v[128:131]
lq a[252:255],v11,47616
s_waitcnt vmcnt(3)
mm v[124:127],a[220:223],a[132:135],0
v_exp_f32 v118, v118
mm v[124:127],a[216:219],a[120:123],v[124:127]
buffer_load_dwordx4 v5, s[8:11], s45 offen offset:0 nt lds
tr a[192:193],v12,16384
mm v[124:127],a[212:215],a[108:111],v[124:127]
v_exp_f32 v119, v119
mm v[124:127],a[208:211],a[96:99],v[124:127]
s_waitcnt lgkmcnt(5)
tr a[194:195],v12,18432
mm v[136:139],a[224:227],a[96:99],0
v_exp_f32 v120, v120
mm v[136:139],a[228:231],a[108:111],v[136:139]
tr a[196:197],v12,24576
cv v160,v112,v113
mm v[136:139],a[232:235],a[120:123],v[136:139]
v_exp_f32 v121, v121
mm v[136:139],a[236:239],a[132:135],v[136:139]
tr a[198:199],v12,26624
cv v161,v114,v115
mm v[140:143],a[236:239],a[136:139],0
v_exp_f32 v122, v122
mm v[140:143],a[232:235],a[124:127],v[140:143]
tr a[200:201],v13,16384
cv v164,v116,v117
mm v[140:143],a[228:231],a[112:115],v[140:143]
v_exp_f32 v123, v123
mm v[140:143],a[224:227],a[100:103],v[140:143]
tr a[202:203],v13,18432
s_waitcnt vmcnt(3)
mm v[144:147],a[224:227],a[104:107],0
v_exp_f32 v132, v132
mm v[144:147],a[228:231],a[116:119],v[144:147]
tr a[204:205],v13,24576
buffer_load_dwordx4 v6, s[8:11], s45 offen offset:1024 nt lds
mm v[144:147],a[232:235],a[128:131],v[144:147]
v_exp_f32 v133, v133
mm v[144:147],a[236:239],a[140:143],v[144:147]
s_waitcnt lgkmcnt(7)
tr a[206:207],v13,26624
mm v[156:159],a[252:255],a[140:143],0
v_exp_f32 v134, v134
mm v[156:159],a[248:251],a[128:131],v[156:159]
tr a[208:209],v12,16896
cv v165,v118,v119
mm v[156:159],a[244:247],a[116:119],v[156:159]
v_exp_f32 v135, v135
mm v[156:159],a[240:243],a[104:107],v[156:159]
tr a[210:211],v12,18944
cv v168,v120,v121
mm v[152:155],a[240:243],a[100:103],0
v_exp_f32 v128, v128
mm v[152:155],a[244:247],a[112:115],v[152:155]
tr a[212:213],v12,25088
cv v169,v122,v123
mm v[152:155],a[248:251],a[124:127],v[152:155]
v_exp_f32 v129, v129
mm v[152:155],a[252:255],a[136:139],v[152:155]
tr a[214:215],v12,27136
cv v170,v132,v133
mm v[148:151],a[252:255],a[132:135],0
v_exp_f32 v130, v130
mm v[148:151],a[248:251],a[120:123],v[148:151]
tr a[216:217],v13,16896
cv v171,v134,v135
mm v[148:151],a[244:247],a[108:111],v[148:151]
v_exp_f32 v131, v131
mm v[148:151],a[240:243],a[96:99],v[148:151]
tr a[218:219],v13,18944
s_waitcnt vmcnt(3)
mm v[216:219],v[220:223],v[204:207],v[216:219]
v_exp_f32 v124, v124
mm v[216:219],v[220:223],v[192:195],v[216:219]
tr a[220:221],v13,25088
buffer_load_dwordx4 v7, s[8:11], s45 offen offset:2048 nt lds
mm v[212:215],v[220:223],v[200:203],v[212:215]
v_exp_f32 v125, v125
mm v[212:215],v[220:223],v[188:191],v[212:215]
tr a[222:223],v13,27136
cv v166,v128,v129
mm v[208:211],v[220:223],v[196:199],v[208:211]
v_exp_f32 v126, v126
mm v[208:211],v[220:223],v[184:187],v[208:211]
s_waitcnt lgkmcnt(8)
tr a[224:225],v12,20480
mm v[16:19],a[192:195],v[184:187],v[16:19]
v_exp_f32 v127, v127
mm v[16:19],a[196:199],v[196:199],v[16:19]
tr a[226:227],v12,22528
cv v167,v130,v131
mm v[20:23],a[196:199],v[200:203],v[20:23]
v_exp_f32 v136, v136
mm v[20:23],a[192:195],v[188:191],v[20:23]
tr a[228:229],v12,28672
cv v162,v124,v125
mm v[24:27],a[192:195],v[192:195],v[24:27]
v_exp_f32 v137, v137
mm v[24:27],a[196:199],v[204:207],v[24:27]
tr a[230:231],v12,30720
cv v163,v126,v127
mm v[36:39],a[204:207],v[204:207],v[36:39]
v_exp_f32 v138, v138
mm v[36:39],a[200:203],v[192:195],v[36:39]
tr a[232:233],v13,20480
s_waitcnt vmcnt(3)
mm v[32:35],a[200:203],v[188:191],v[32:35]
v_exp_f32 v139, v139
mm v[32:35],a[204:207],v[200:203],v[32:35]
tr a[234:235],v13,22528
buffer_load_dwordx4 v8, s[8:11], s45 offen offset:3072 nt lds
mm v[28:31],a[204:207],v[196:199],v[28:31]
v_exp_f32 v140, v140
mm v[28:31],a[200:203],v[184:187],v[28:31]
s_waitcnt lgkmcnt(6)
tr a[236:237],v13,28672
mm v[40:43],a[208:211],v[184:187],v[40:43]
tr a[238:239],v13,30720
cv v172,v136,v137
mm v[40:43],a[212:215],v[196:199],v[40:43]
tr a[240:241],v12,20992
cv v173,v138,v139
mm v[44:47],a[212:215],v[200:203],v[44:47]
v_exp_f32 v141, v141
mm v[44:47],a[208:211],v[188:191],v[44:47]
tr a[242:243],v12,23040
cv v176,v140,v141
mm v[48:51],a[208:211],v[192:195],v[48:51]
v_exp_f32 v142, v142
mm v[48:51],a[212:215],v[204:207],v[48:51]
tr a[244:245],v12,29184
mm v[60:63],a[220:223],v[204:207],v[60:63]
v_exp_f32 v143, v143
mm v[60:63],a[216:219],v[192:195],v[60:63]
tr a[246:247],v12,31232
cv v177,v142,v143
mm v[56:59],a[216:219],v[188:191],v[56:59]
v_exp_f32 v144, v144
mm v[56:59],a[220:223],v[200:203],v[56:59]
tr a[248:249],v13,20992
mm v[52:55],a[220:223],v[196:199],v[52:55]
v_exp_f32 v145, v145
mm v[52:55],a[216:219],v[184:187],v[52:55]
s_waitcnt lgkmcnt(5)
tr a[250:251],v13,23040
mm v[64:67],a[224:227],v[184:187],v[64:67]
v_exp_f32 v146, v146
mm v[64:67],a[228:231],v[196:199],v[64:67]
tr a[252:253],v13,29184
s_add_u32 m0, s44, 131072
mm v[68:71],a[228:231],v[200:203],v[68:71]
s_waitcnt vmcnt(3)
tr a[254:255],v13,31232
mm v[68:71],a[224:227],v[188:191],v[68:71]
buffer_load_dwordx4 v5, s[12:15], s45 offen offset:0 nt lds
v_add_u32 v11, 4294934528, v11
mm v[72:75],a[224:227],v[192:195],v[72:75]
v_exp_f32 v147, v147
mm v[72:75],a[228:231],v[204:207],v[72:75]
cv v180,v144,v145
cv v181,v146,v147
mm v[84:87],a[236:239],v[204:207],v[84:87]
v_exp_f32 v156, v156
mm v[84:87],a[232:235],v[192:195],v[84:87]
v_exp_f32 v157, v157
mm v[80:83],a[232:235],v[188:191],v[80:83]
v_exp_f32 v158, v158
mm v[80:83],a[236:239],v[200:203],v[80:83]
cv v182,v156,v157
mm v[76:79],a[236:239],v[196:199],v[76:79]
v_exp_f32 v159, v159
mm v[76:79],a[232:235],v[184:187],v[76:79]
s_waitcnt lgkmcnt(0)
cv v183,v158,v159
mm v[88:91],a[240:243],v[184:187],v[88:91]
s_barrier
mm v[88:91],a[244:247],v[196:199],v[88:91]
lq a[192:195],v11,0
s_waitcnt vmcnt(3)
mm v[92:95],a[244:247],v[200:203],v[92:95]
v_exp_f32 v152, v152
mm v[92:95],a[240:243],v[188:191],v[92:95]
lq a[196:199],v11,512
buffer_load_dwordx4 v6, s[12:15], s45 offen offset:1024 nt lds
mm v[96:99],a[240:243],v[192:195],v[96:99]
lq a[200:203],v11,4096
mm v[96:99],a[244:247],v[204:207],v[96:99]
lq a[204:207],v11,4608
mm v[108:111],a[252:255],v[204:207],v[108:111]
v_exp_f32 v153, v153
mm v[108:111],a[248:251],v[192:195],v[108:111]
v_exp_f32 v154, v154
mm v[104:107],a[248:251],v[188:191],v[104:107]
v_exp_f32 v155, v155
mm v[104:107],a[252:255],v[200:203],v[104:107]
lq a[208:211],v11,2048
cv v178,v152,v153
v_rcp_f32 v240, v208
v_rcp_f32 v241, v212
v_rcp_f32 v242, v216
v_med3_f32 v248, v208, s57, v243
v_med3_f32 v249, v212, s57, v243
v_med3_f32 v250, v216, s57, v243
v_cmp_neq_f32 s[92:93], v248, v208
v_cmp_neq_f32 s[94:95], v249, v212
v_cmp_neq_f32 s[96:97], v250, v216
mm v[100:103],a[252:255],v[196:199],v[100:103]
lq a[212:215],v11,2560
cv v179,v154,v155
mm v[100:103],a[248:251],v[184:187],v[100:103]
s_waitcnt lgkmcnt(2)
s_nop 1
s_or_b64 s[92:93], s[92:93], s[94:95]
s_or_b64 s[92:93], s[92:93], s[96:97]
s_cbranch_scc1 L_slow1
L_back1:
v_pk_mul_f32 v[16:17], v[16:17], v[240:241] op_sel:[0,0] op_sel_hi:[1,0]
v_pk_mul_f32 v[18:19], v[18:19], v[240:241] op_sel:[0,0] op_sel_hi:[1,0]
v_pk_mul_f32 v[28:29], v[28:29], v[240:241] op_sel:[0,0] op_sel_hi:[1,0]
v_pk_mul_f32 v[30:31], v[30:31], v[240:241] op_sel:[0,0] op_sel_hi:[1,0]
cv v16,v16,v17
cv v17,v18,v19
cv v28,v28,v29
cv v29,v30,v31
v_accvgpr_write_b32 a48, v16
v_accvgpr_write_b32 a49, v17
v_accvgpr_write_b32 a50, v28
v_accvgpr_write_b32 a51, v29
v_pk_mul_f32 v[20:21], v[20:21], v[240:241] op_sel:[0,1] op_sel_hi:[1,1]
v_pk_mul_f32 v[22:23], v[22:23], v[240:241] op_sel:[0,1] op_sel_hi:[1,1]
v_pk_mul_f32 v[32:33], v[32:33], v[240:241] op_sel:[0,1] op_sel_hi:[1,1]
v_pk_mul_f32 v[34:35], v[34:35], v[240:241] op_sel:[0,1] op_sel_hi:[1,1]
s_waitcnt vmcnt(3)
cv v20,v20,v21
cv v21,v22,v23
cv v32,v32,v33
buffer_load_dwordx4 v7, s[12:15], s45 offen offset:2048 nt lds
cv v33,v34,v35
v_accvgpr_write_b32 a52, v20
v_accvgpr_write_b32 a53, v21
v_accvgpr_write_b32 a54, v32
v_accvgpr_write_b32 a55, v33
v_pk_mul_f32 v[24:25], v[24:25], v[242:243] op_sel:[0,0] op_sel_hi:[1,0]
v_pk_mul_f32 v[26:27], v[26:27], v[242:243] op_sel:[0,0] op_sel_hi:[1,0]
v_pk_mul_f32 v[36:37], v[36:37], v[242:243] op_sel:[0,0] op_sel_hi:[1,0]
v_pk_mul_f32 v[38:39], v[38:39], v[242:243] op_sel:[0,0] op_sel_hi:[1,0]
cv v24,v24,v25
cv v25,v26,v27
cv v36,v36,v37
cv v37,v38,v39
v_accvgpr_write_b32 a56, v24
v_accvgpr_write_b32 a57, v25
v_accvgpr_write_b32 a58, v36
v_accvgpr_write_b32 a59, v37
v_pk_mul_f32 v[40:41], v[40:41], v[240:241] op_sel:[0,0] op_sel_hi:[1,0]
v_pk_mul_f32 v[42:43], v[42:43], v[240:241] op_sel:[0,0] op_sel_hi:[1,0]
v_pk_mul_f32 v[52:53], v[52:53], v[240:241] op_sel:[0,0] op_sel_hi:[1,0]
v_pk_mul_f32 v[54:55], v[54:55], v[240:241] op_sel:[0,0] op_sel_hi:[1,0]
cv v40,v40,v41
cv v41,v42,v43
cv v52,v52,v53
cv v53,v54,v55
v_accvgpr_write_b32 a60, v40
v_accvgpr_write_b32 a61, v41
v_accvgpr_write_b32 a62, v52
v_accvgpr_write_b32 a63, v53
v_pk_mul_f32 v[44:45], v[44:45], v[240:241] op_sel:[0,1] op_sel_hi:[1,1]
v_pk_mul_f32 v[46:47], v[46:47], v[240:241] op_sel:[0,1] op_sel_hi:[1,1]
v_pk_mul_f32 v[56:57], v[56:57], v[240:241] op_sel:[0,1] op_sel_hi:[1,1]
v_pk_mul_f32 v[58:59], v[58:59], v[240:241] op_sel:[0,1] op_sel_hi:[1,1]
cv v44,v44,v45
cv v45,v46,v47
cv v56,v56,v57
cv v57,v58,v59
v_accvgpr_write_b32 a64, v44
v_accvgpr_write_b32 a65, v45
v_accvgpr_write_b32 a66, v56
v_accvgpr_write_b32 a67, v57
v_pk_mul_f32 v[48:49], v[48:49], v[242:243] op_sel:[0,0] op_sel_hi:[1,0]
v_pk_mul_f32 v[50:51], v[50:51], v[242:243] op_sel:[0,0] op_sel_hi:[1,0]
v_pk_mul_f32 v[60:61], v[60:61], v[242:243] op_sel:[0,0] op_sel_hi:[1,0]
v_pk_mul_f32 v[62:63], v[62:63], v[242:243] op_sel:[0,0] op_sel_hi:[1,0]
cv v48,v48,v49
cv v49,v50,v51
s_waitcnt vmcnt(3)
cv v60,v60,v61
cv v61,v62,v63
v_accvgpr_write_b32 a68, v48
buffer_load_dwordx4 v8, s[12:15], s45 offen offset:3072 nt lds
v_accvgpr_write_b32 a69, v49
v_accvgpr_write_b32 a70, v60
v_accvgpr_write_b32 a71, v61
v_pk_mul_f32 v[64:65], v[64:65], v[240:241] op_sel:[0,0] op_sel_hi:[1,0]
v_pk_mul_f32 v[66:67], v[66:67], v[240:241] op_sel:[0,0] op_sel_hi:[1,0]
v_pk_mul_f32 v[76:77], v[76:77], v[240:241] op_sel:[0,0] op_sel_hi:[1,0]
v_pk_mul_f32 v[78:79], v[78:79], v[240:241] op_sel:[0,0] op_sel_hi:[1,0]
L_pg15:
s_cbranch_execz L_tret1
cv v64,v64,v65
cv v65,v66,v67
cv v76,v76,v77
cv v77,v78,v79
v_accvgpr_write_b32 a72, v64
v_accvgpr_write_b32 a73, v65
v_accvgpr_write_b32 a74, v76
v_accvgpr_write_b32 a75, v77
v_pk_mul_f32 v[68:69], v[68:69], v[240:241] op_sel:[0,1] op_sel_hi:[1,1]
v_pk_mul_f32 v[70:71], v[70:71], v[240:241] op_sel:[0,1] op_sel_hi:[1,1]
v_pk_mul_f32 v[80:81], v[80:81], v[240:241] op_sel:[0,1] op_sel_hi:[1,1]
v_pk_mul_f32 v[82:83], v[82:83], v[240:241] op_sel:[0,1] op_sel_hi:[1,1]
cv v68,v68,v69
cv v69,v70,v71
cv v80,v80,v81
cv v81,v82,v83
v_accvgpr_write_b32 a76, v68
v_accvgpr_write_b32 a77, v69
v_accvgpr_write_b32 a78, v80
v_accvgpr_write_b32 a79, v81
v_pk_mul_f32 v[72:73], v[72:73], v[242:243] op_sel:[0,0] op_sel_hi:[1,0]
v_pk_mul_f32 v[74:75], v[74:75], v[242:243] op_sel:[0,0] op_sel_hi:[1,0]
v_pk_mul_f32 v[84:85], v[84:85], v[242:243] op_sel:[0,0] op_sel_hi:[1,0]
v_pk_mul_f32 v[86:87], v[86:87], v[242:243] op_sel:[0,0] op_sel_hi:[1,0]
cv v72,v72,v73
cv v73,v74,v75
cv v84,v84,v85
cv v85,v86,v87
v_accvgpr_write_b32 a80, v72
v_accvgpr_write_b32 a81, v73
v_accvgpr_write_b32 a82, v84
v_accvgpr_write_b32 a83, v85
v_pk_mul_f32 v[88:89], v[88:89], v[240:241] op_sel:[0,0] op_sel_hi:[1,0]
v_pk_mul_f32 v[90:91], v[90:91], v[240:241] op_sel:[0,0] op_sel_hi:[1,0]
v_pk_mul_f32 v[100:101], v[100:101], v[240:241] op_sel:[0,0] op_sel_hi:[1,0]
v_pk_mul_f32 v[102:103], v[102:103], v[240:241] op_sel:[0,0] op_sel_hi:[1,0]
s_add_u32 s45, s45, 16384
cv v88,v88,v89
cv v89,v90,v91
s_waitcnt vmcnt(3)
s_add_u32 m0, s43, 0
cv v100,v100,v101
cv v101,v102,v103
v_accvgpr_write_b32 a84, v88
buffer_load_dwordx4 v5, s[8:11], s45 offen offset:0 nt lds
v_accvgpr_write_b32 a85, v89
v_accvgpr_write_b32 a86, v100
v_accvgpr_write_b32 a87, v101
v_pk_mul_f32 v[92:93], v[92:93], v[240:241] op_sel:[0,1] op_sel_hi:[1,1]
v_pk_mul_f32 v[94:95], v[94:95], v[240:241] op_sel:[0,1] op_sel_hi:[1,1]
v_pk_mul_f32 v[104:105], v[104:105], v[240:241] op_sel:[0,1] op_sel_hi:[1,1]
v_pk_mul_f32 v[106:107], v[106:107], v[240:241] op_sel:[0,1] op_sel_hi:[1,1]
cv v92,v92,v93
cv v93,v94,v95
cv v104,v104,v105
cv v105,v106,v107
v_accvgpr_write_b32 a88, v92
v_accvgpr_write_b32 a89, v93
v_accvgpr_write_b32 a90, v104
v_accvgpr_write_b32 a91, v105
v_pk_mul_f32 v[96:97], v[96:97], v[242:243] op_sel:[0,0] op_sel_hi:[1,0]
v_pk_mul_f32 v[98:99], v[98:99], v[242:243] op_sel:[0,0] op_sel_hi:[1,0]
v_pk_mul_f32 v[108:109], v[108:109], v[242:243] op_sel:[0,0] op_sel_hi:[1,0]
v_pk_mul_f32 v[110:111], v[110:111], v[242:243] op_sel:[0,0] op_sel_hi:[1,0]
cv v96,v96,v97
cv v97,v98,v99
cv v108,v108,v109
cv v109,v110,v111
v_accvgpr_write_b32 a92, v96
v_accvgpr_write_b32 a93, v97
v_accvgpr_write_b32 a94, v108
v_accvgpr_write_b32 a95, v109
s_mov_b64 exec, 0
s_cmp_eq_u32 s42, 1
s_cbranch_scc1 L_pg17
s_cmp_eq_u32 s42, 2
s_cbranch_scc1 L_pg18
s_cmp_eq_u32 s42, 3
s_cbranch_scc1 L_tret2
s_branch L_pg16
L_tret2:
s_mov_b64 exec, -1
s_nop 0
L_mk_b16:
mm v[112:115],a[192:195],a[96:99],0
v_exp_f32 v148, v148
mm v[112:115],a[196:199],a[108:111],v[112:115]
lq a[216:219],v11,6144
mm v[112:115],a[200:203],a[120:123],v[112:115]
v_exp_f32 v149, v149
mm v[112:115],a[204:207],a[132:135],v[112:115]
lq a[220:223],v11,6656
cv v174,v148,v149
mm v[116:119],a[204:207],a[136:139],0
v_exp_f32 v150, v150
mm v[116:119],a[200:203],a[124:127],v[116:119]
lq a[224:227],v11,8192
s_waitcnt vmcnt(3)
mm v[116:119],a[196:199],a[112:115],v[116:119]
v_exp_f32 v151, v151
mm v[116:119],a[192:195],a[100:103],v[116:119]
buffer_load_dwordx4 v6, s[8:11], s45 offen offset:1024 nt lds
lq a[228:231],v11,8704
mm v[120:123],a[192:195],a[104:107],0
v_exp_f32 v112, v112
mm v[120:123],a[196:199],a[116:119],v[120:123]
lq a[232:235],v11,12288
cv v175,v150,v151
mm v[120:123],a[200:203],a[128:131],v[120:123]
v_exp_f32 v113, v113
mm v[120:123],a[204:207],a[140:143],v[120:123]
s_waitcnt lgkmcnt(3)
lq a[236:239],v11,12800
mm v[132:135],a[220:223],a[140:143],0
v_exp_f32 v114, v114
mm v[132:135],a[216:219],a[128:131],v[132:135]
lq a[240:243],v11,10240
cv v184,v112,v113
mm v[132:135],a[212:215],a[116:119],v[132:135]
v_exp_f32 v115, v115
mm v[132:135],a[208:211],a[104:107],v[132:135]
lq a[244:247],v11,10752
cv v185,v114,v115
mm v[128:131],a[208:211],a[100:103],0
v_exp_f32 v116, v116
mm v[128:131],a[212:215],a[112:115],v[128:131]
lq a[248:251],v11,14336
mm v[128:131],a[216:219],a[124:127],v[128:131]
v_exp_f32 v117, v117
mm v[128:131],a[220:223],a[136:139],v[128:131]
lq a[252:255],v11,14848
cv v188,v116,v117
mm v[124:127],a[220:223],a[132:135],0
v_exp_f32 v118, v118
mm v[124:127],a[216:219],a[120:123],v[124:127]
s_waitcnt vmcnt(3)
buffer_load_dwordx4 v7, s[8:11], s45 offen offset:2048 nt lds
mm v[124:127],a[212:215],a[108:111],v[124:127]
v_exp_f32 v119, v119
mm v[124:127],a[208:211],a[96:99],v[124:127]
s_waitcnt lgkmcnt(4)
tr a[192:193],v12,49152
mm v[136:139],a[224:227],a[96:99],0
v_exp_f32 v120, v120
mm v[136:139],a[228:231],a[108:111],v[136:139]
tr a[194:195],v12,51200
cv v189,v118,v119
mm v[136:139],a[232:235],a[120:123],v[136:139]
v_exp_f32 v121, v121
mm v[136:139],a[236:239],a[132:135],v[136:139]
tr a[196:197],v12,57344
cv v192,v120,v121
mm v[140:143],a[236:239],a[136:139],0
v_exp_f32 v122, v122
mm v[140:143],a[232:235],a[124:127],v[140:143]
tr a[198:199],v12,59392
mm v[140:143],a[228:231],a[112:115],v[140:143]
v_exp_f32 v123, v123
mm v[140:143],a[224:227],a[100:103],v[140:143]
tr a[200:201],v13,49152
cv v193,v122,v123
mm v[144:147],a[224:227],a[104:107],0
v_exp_f32 v132, v132
mm v[144:147],a[228:231],a[116:119],v[144:147]
tr a[202:203],v13,51200
mm v[144:147],a[232:235],a[128:131],v[144:147]
v_exp_f32 v133, v133
mm v[144:147],a[236:239],a[140:143],v[144:147]
s_waitcnt lgkmcnt(6)
tr a[204:205],v13,57344
mm v[156:159],a[252:255],a[140:143],0
tr a[206:207],v13,59392
s_waitcnt vmcnt(3)
mm v[156:159],a[248:251],a[128:131],v[156:159]
buffer_load_dwordx4 v8, s[8:11], s45 offen offset:3072 nt lds
tr a[208:209],v12,49664
mm v[156:159],a[244:247],a[116:119],v[156:159]
v_exp_f32 v134, v134
mm v[156:159],a[240:243],a[104:107],v[156:159]
tr a[210:211],v12,51712
cv v194,v132,v133
mm v[152:155],a[240:243],a[100:103],0
v_exp_f32 v135, v135
mm v[152:155],a[244:247],a[112:115],v[152:155]
tr a[212:213],v12,57856
cv v195,v134,v135
mm v[152:155],a[248:251],a[124:127],v[152:155]
v_exp_f32 v128, v128
mm v[152:155],a[252:255],a[136:139],v[152:155]
tr a[214:215],v12,59904
mm v[148:151],a[252:255],a[132:135],0
v_exp_f32 v129, v129
mm v[148:151],a[248:251],a[120:123],v[148:151]
tr a[216:217],v13,49664
cv v190,v128,v129
mm v[148:151],a[244:247],a[108:111],v[148:151]
v_exp_f32 v130, v130
mm v[148:151],a[240:243],a[96:99],v[148:151]
tr a[218:219],v13,51712
mm v[216:219],v[220:223],v[180:183],0
v_exp_f32 v131, v131
mm v[216:219],v[220:223],v[168:171],v[216:219]
tr a[220:221],v13,57856
cv v191,v130,v131
mm v[212:215],v[220:223],v[176:179],0
v_exp_f32 v124, v124
mm v[212:215],v[220:223],v[164:167],v[212:215]
tr a[222:223],v13,59904
s_add_u32 m0, s44, 0
mm v[208:211],v[220:223],v[172:175],0
v_exp_f32 v125, v125
mm v[208:211],v[220:223],v[160:163],v[208:211]
s_waitcnt lgkmcnt(8)
s_waitcnt vmcnt(3)
mm v[16:19],a[192:195],v[160:163],0
v_exp_f32 v126, v126
mm v[16:19],a[196:199],v[172:175],v[16:19]
buffer_load_dwordx4 v5, s[12:15], s45 offen offset:0 nt lds
tr a[224:225],v12,53248
mm v[20:23],a[196:199],v[176:179],0
v_exp_f32 v127, v127
mm v[20:23],a[192:195],v[164:167],v[20:23]
tr a[226:227],v12,55296
cv v186,v124,v125
mm v[24:27],a[192:195],v[168:171],0
v_exp_f32 v136, v136
mm v[24:27],a[196:199],v[180:183],v[24:27]
tr a[228:229],v12,61440
cv v187,v126,v127
mm v[36:39],a[204:207],v[180:183],0
v_exp_f32 v137, v137
mm v[36:39],a[200:203],v[168:171],v[36:39]
tr a[230:231],v12,63488
cv v196,v136,v137
mm v[32:35],a[200:203],v[164:167],0
v_exp_f32 v138, v138
mm v[32:35],a[204:207],v[176:179],v[32:35]
tr a[232:233],v13,53248
mm v[28:31],a[204:207],v[172:175],0
v_exp_f32 v139, v139
mm v[28:31],a[200:203],v[160:163],v[28:31]
s_waitcnt lgkmcnt(5)
tr a[234:235],v13,55296
mm v[40:43],a[208:211],v[160:163],0
tr a[236:237],v13,61440
tr a[238:239],v13,63488
mm v[40:43],a[212:215],v[172:175],v[40:43]
tr a[240:241],v12,53760
s_waitcnt vmcnt(3)
mm v[44:47],a[212:215],v[176:179],0
v_exp_f32 v140, v140
mm v[44:47],a[208:211],v[164:167],v[44:47]
tr a[242:243],v12,55808
buffer_load_dwordx4 v6, s[12:15], s45 offen offset:1024 nt lds
mm v[48:51],a[208:211],v[168:171],0
v_exp_f32 v141, v141
mm v[48:51],a[212:215],v[180:183],v[48:51]
tr a[244:245],v12,61952
cv v197,v138,v139
mm v[60:63],a[220:223],v[180:183],0
v_exp_f32 v142, v142
mm v[60:63],a[216:219],v[168:171],v[60:63]
tr a[246:247],v12,64000
cv v200,v140,v141
mm v[56:59],a[216:219],v[164:167],0
v_exp_f32 v143, v143
mm v[56:59],a[220:223],v[176:179],v[56:59]
tr a[248:249],v13,53760
cv v201,v142,v143
mm v[52:55],a[220:223],v[172:175],0
v_exp_f32 v144, v144
mm v[52:55],a[216:219],v[160:163],v[52:55]
s_waitcnt lgkmcnt(5)
tr a[250:251],v13,55808
mm v[64:67],a[224:227],v[160:163],0
v_exp_f32 v145, v145
mm v[64:67],a[228:231],v[172:175],v[64:67]
tr a[252:253],v13,61952
v_add_u32 v11, 98304, v11
mm v[68:71],a[228:231],v[176:179],0
v_exp_f32 v146, v146
mm v[68:71],a[224:227],v[164:167],v[68:71]
tr a[254:255],v13,64000
s_waitcnt vmcnt(3)
mm v[72:75],a[224:227],v[168:171],0
v_exp_f32 v147, v147
mm v[72:75],a[228:231],v[180:183],v[72:75]
buffer_load_dwordx4 v7, s[12:15], s45 offen offset:2048 nt lds
cv v204,v144,v145
mm v[84:87],a[236:239],v[180:183],0
v_exp_f32 v156, v156
mm v[84:87],a[232:235],v[168:171],v[84:87]
cv v205,v146,v147
mm v[80:83],a[232:235],v[164:167],0
v_exp_f32 v157, v157
mm v[80:83],a[236:239],v[176:179],v[80:83]
cv v206,v156,v157
mm v[76:79],a[236:239],v[172:175],0
v_exp_f32 v158, v158
mm v[76:79],a[232:235],v[160:163],v[76:79]
s_waitcnt lgkmcnt(0)
mm v[88:91],a[240:243],v[160:163],0
s_barrier
v_exp_f32 v159, v159
mm v[88:91],a[244:247],v[172:175],v[88:91]
lq a[192:195],v11,0
cv v207,v158,v159
mm v[92:95],a[244:247],v[176:179],0
v_exp_f32 v152, v152
mm v[92:95],a[240:243],v[164:167],v[92:95]
lq a[196:199],v11,512
mm v[96:99],a[240:243],v[168:171],0
lq a[200:203],v11,4096
mm v[96:99],a[244:247],v[180:183],v[96:99]
lq a[204:207],v11,4608
s_waitcnt vmcnt(3)
mm v[108:111],a[252:255],v[180:183],0
v_exp_f32 v153, v153
mm v[108:111],a[248:251],v[168:171],v[108:111]
v_exp_f32 v154, v154
mm v[104:107],a[248:251],v[164:167],0
v_exp_f32 v155, v155
mm v[104:107],a[252:255],v[176:179],v[104:107]
lq a[208:211],v11,2048
buffer_load_dwordx4 v8, s[12:15], s45 offen offset:3072 nt lds
mm v[100:103],a[252:255],v[172:175],0
lq a[212:215],v11,2560
cv v202,v152,v153
mm v[100:103],a[248:251],v[160:163],v[100:103]
s_waitcnt lgkmcnt(2)
cv v203,v154,v155
mm v[112:115],a[192:195],a[96:99],0
v_exp_f32 v148, v148
mm v[112:115],a[196:199],a[108:111],v[112:115]
lq a[216:219],v11,6144
mm v[112:115],a[200:203],a[120:123],v[112:115]
v_exp_f32 v149, v149
mm v[112:115],a[204:207],a[132:135],v[112:115]
lq a[220:223],v11,6656
cv v198,v148,v149
mm v[116:119],a[204:207],a[136:139],0
v_exp_f32 v150, v150
mm v[116:119],a[200:203],a[124:127],v[116:119]
lq a[224:227],v11,8192
mm v[116:119],a[196:199],a[112:115],v[116:119]
v_exp_f32 v151, v151
mm v[116:119],a[192:195],a[100:103],v[116:119]
lq a[228:231],v11,8704
s_add_u32 s45, s45, 16384
mm v[120:123],a[192:195],a[104:107],0
v_exp_f32 v112, v112
mm v[120:123],a[196:199],a[116:119],v[120:123]
lq a[232:235],v11,12288
s_add_u32 m0, s43, 65536
mm v[120:123],a[200:203],a[128:131],v[120:123]
v_exp_f32 v113, v113
mm v[120:123],a[204:207],a[140:143],v[120:123]
s_waitcnt lgkmcnt(3)
lq a[236:239],v11,12800
mm v[132:135],a[220:223],a[140:143],0
s_waitcnt vmcnt(3)
buffer_load_dwordx4 v5, s[8:11], s45 offen offset:0 nt lds
mm v[132:135],a[216:219],a[128:131],v[132:135]
lq a[240:243],v11,10240
v_add_u32 v12, 4294934528, v12
mm v[132:135],a[212:215],a[116:119],v[132:135]
v_exp_f32 v114, v114
mm v[132:135],a[208:211],a[104:107],v[132:135]
lq a[244:247],v11,10752
v_add_u32 v13, 4294934528, v13
mm v[128:131],a[208:211],a[100:103],0
v_exp_f32 v115, v115
mm v[128:131],a[212:215],a[112:115],v[128:131]
lq a[248:251],v11,14336
cv v160,v112,v113
mm v[128:131],a[216:219],a[124:127],v[128:131]
v_exp_f32 v116, v116
mm v[128:131],a[220:223],a[136:139],v[128:131]
lq a[252:255],v11,14848
cv v161,v114,v115
mm v[124:127],a[220:223],a[132:135],0
v_exp_f32 v117, v117
mm v[124:127],a[216:219],a[120:123],v[124:127]
tr a[192:193],v12,16384
cv v164,v116,v117
mm v[124:127],a[212:215],a[108:111],v[124:127]
v_exp_f32 v118, v118
mm v[124:127],a[208:211],a[96:99],v[124:127]
s_waitcnt lgkmcnt(5)
tr a[194:195],v12,18432
mm v[136:139],a[224:227],a[96:99],0
v_exp_f32 v119, v119
mm v[136:139],a[228:231],a[108:111],v[136:139]
s_waitcnt vmcnt(3)
buffer_load_dwordx4 v6, s[8:11], s45 offen offset:1024 nt lds
mm v[136:139],a[232:235],a[120:123],v[136:139]
v_exp_f32 v120, v120
mm v[136:139],a[236:239],a[132:135],v[136:139]
tr a[196:197],v12,24576
cv v165,v118,v119
mm v[140:143],a[236:239],a[136:139],0
v_exp_f32 v121, v121
mm v[140:143],a[232:235],a[124:127],v[140:143]
tr a[198:199],v12,26624
cv v199,v150,v151
mm v[140:143],a[228:231],a[112:115],v[140:143]
v_exp_f32 v122, v122
mm v[140:143],a[224:227],a[100:103],v[140:143]
tr a[200:201],v13,16384
cv v168,v120,v121
mm v[144:147],a[224:227],a[104:107],0
v_exp_f32 v123, v123
mm v[144:147],a[228:231],a[116:119],v[144:147]
tr a[202:203],v13,18432
cv v169,v122,v123
mm v[144:147],a[232:235],a[128:131],v[144:147]
v_exp_f32 v132, v132
mm v[144:147],a[236:239],a[140:143],v[144:147]
s_waitcnt lgkmcnt(6)
tr a[204:205],v13,24576
mm v[156:159],a[252:255],a[140:143],0
tr a[206:207],v13,26624
mm v[156:159],a[248:251],a[128:131],v[156:159]
tr a[208:209],v12,16896
mm v[156:159],a[244:247],a[116:119],v[156:159]
v_exp_f32 v133, v133
mm v[156:159],a[240:243],a[104:107],v[156:159]
tr a[210:211],v12,18944
s_waitcnt vmcnt(3)
mm v[152:155],a[240:243],a[100:103],0
v_exp_f32 v134, v134
mm v[152:155],a[244:247],a[112:115],v[152:155]
v_exp_f32 v135, v135
mm v[152:155],a[248:251],a[124:127],v[152:155]
v_exp_f32 v128, v128
mm v[152:155],a[252:255],a[136:139],v[152:155]
buffer_load_dwordx4 v7, s[8:11], s45 offen offset:2048 nt lds
tr a[212:213],v12,25088
mm v[148:151],a[252:255],a[132:135],0
v_exp_f32 v129, v129
mm v[148:151],a[248:251],a[120:123],v[148:151]
tr a[214:215],v12,27136
cv v170,v132,v133
mm v[148:151],a[244:247],a[108:111],v[148:151]
v_exp_f32 v130, v130
mm v[148:151],a[240:243],a[96:99],v[148:151]
tr a[216:217],v13,16896
cv v171,v134,v135
mm v[216:219],v[220:223],v[204:207],v[216:219]
v_exp_f32 v131, v131
mm v[216:219],v[220:223],v[192:195],v[216:219]
tr a[218:219],v13,18944
cv v166,v128,v129
mm v[212:215],v[220:223],v[200:203],v[212:215]
v_exp_f32 v124, v124
mm v[212:215],v[220:223],v[188:191],v[212:215]
tr a[220:221],v13,25088
tr a[222:223],v13,27136
mm v[208:211],v[220:223],v[196:199],v[208:211]
v_exp_f32 v125, v125
mm v[208:211],v[220:223],v[184:187],v[208:211]
s_waitcnt lgkmcnt(8)
tr a[224:225],v12,20480
mm v[16:19],a[192:195],v[184:187],v[16:19]
v_exp_f32 v126, v126
mm v[16:19],a[196:199],v[196:199],v[16:19]
tr a[226:227],v12,22528
s_waitcnt vmcnt(3)
mm v[20:23],a[196:199],v[200:203],v[20:23]
v_exp_f32 v127, v127
mm v[20:23],a[192:195],v[188:191],v[20:23]
buffer_load_dwordx4 v8, s[8:11], s45 offen offset:3072 nt lds
tr a[228:229],v12,28672
mm v[24:27],a[192:195],v[192:195],v[24:27]
v_exp_f32 v136, v136
mm v[24:27],a[196:199],v[204:207],v[24:27]
tr a[230:231],v12,30720
cv v167,v130,v131
mm v[36:39],a[204:207],v[204:207],v[36:39]
v_exp_f32 v137, v137
mm v[36:39],a[200:203],v[192:195],v[36:39]
tr a[232:233],v13,20480
cv v162,v124,v125
mm v[32:35],a[200:203],v[188:191],v[32:35]
v_exp_f32 v138, v138
mm v[32:35],a[204:207],v[200:203],v[32:35]
tr a[234:235],v13,22528
cv v163,v126,v127
mm v[28:31],a[204:207],v[196:199],v[28:31]
v_exp_f32 v139, v139
mm v[28:31],a[200:203],v[184:187],v[28:31]
s_waitcnt lgkmcnt(6)
tr a[236:237],v13,28672
mm v[40:43],a[208:211],v[184:187],v[40:43]
tr a[238:239],v13,30720
cv v172,v136,v137
mm v[40:43],a[212:215],v[196:199],v[40:43]
tr a[240:241],v12,20992
cv v173,v138,v139
mm v[44:47],a[212:215],v[200:203],v[44:47]
v_exp_f32 v140, v140
mm v[44:47],a[208:211],v[188:191],v[44:47]
tr a[242:243],v12,23040
s_add_u32 m0, s44, 65536
mm v[48:51],a[208:211],v[192:195],v[48:51]
v_exp_f32 v141, v141
mm v[48:51],a[212:215],v[204:207],v[48:51]
tr a[244:245],v12,29184
s_waitcnt vmcnt(3)
mm v[60:63],a[220:223],v[204:207],v[60:63]
v_exp_f32 v142, v142
mm v[60:63],a[216:219],v[192:195],v[60:63]
tr a[246:247],v12,31232
buffer_load_dwordx4 v5, s[12:15], s45 offen offset:0 nt lds
mm v[56:59],a[216:219],v[188:191],v[56:59]
v_exp_f32 v143, v143
mm v[56:59],a[220:223],v[200:203],v[56:59]
tr a[248:249],v13,20992
cv v176,v140,v141
mm v[52:55],a[220:223],v[196:199],v[52:55]
v_exp_f32 v144, v144
mm v[52:55],a[216:219],v[184:187],v[52:55]
s_waitcnt lgkmcnt(5)
tr a[250:251],v13,23040
mm v[64:67],a[224:227],v[184:187],v[64:67]
v_exp_f32 v145, v145
mm v[64:67],a[228:231],v[196:199],v[64:67]
tr a[252:253],v13,29184
cv v177,v142,v143
mm v[68:71],a[228:231],v[200:203],v[68:71]
v_exp_f32 v146, v146
mm v[68:71],a[224:227],v[188:191],v[68:71]
tr a[254:255],v13,31232
v_add_u32 v11, 4294836224, v11
mm v[72:75],a[224:227],v[192:195],v[72:75]
v_exp_f32 v147, v147
mm v[72:75],a[228:231],v[204:207],v[72:75]
s_waitcnt vmcnt(3)
cv v180,v144,v145
mm v[84:87],a[236:239],v[204:207],v[84:87]
v_exp_f32 v156, v156
mm v[84:87],a[232:235],v[192:195],v[84:87]
buffer_load_dwordx4 v6, s[12:15], s45 offen offset:1024 nt lds
cv v181,v146,v147
mm v[80:83],a[232:235],v[188:191],v[80:83]
v_exp_f32 v157, v157
mm v[80:83],a[236:239],v[200:203],v[80:83]
cv v182,v156,v157
mm v[76:79],a[236:239],v[196:199],v[76:79]
v_exp_f32 v158, v158
mm v[76:79],a[232:235],v[184:187],v[76:79]
s_waitcnt lgkmcnt(0)
mm v[88:91],a[240:243],v[184:187],v[88:91]
s_barrier
v_exp_f32 v159, v159
mm v[88:91],a[244:247],v[196:199],v[88:91]
lq a[192:195],v11,0
cv v183,v158,v159
mm v[92:95],a[244:247],v[200:203],v[92:95]
v_exp_f32 v152, v152
mm v[92:95],a[240:243],v[188:191],v[92:95]
lq a[196:199],v11,512
mm v[96:99],a[240:243],v[192:195],v[96:99]
lq a[200:203],v11,4096
mm v[96:99],a[244:247],v[204:207],v[96:99]
lq a[204:207],v11,4608
mm v[108:111],a[252:255],v[204:207],v[108:111]
v_exp_f32 v153, v153
mm v[108:111],a[248:251],v[192:195],v[108:111]
v_exp_f32 v154, v154
mm v[104:107],a[248:251],v[188:191],v[104:107]
v_exp_f32 v155, v155
mm v[104:107],a[252:255],v[200:203],v[104:107]
lq a[208:211],v11,2048
cv v178,v152,v153
mm v[100:103],a[252:255],v[196:199],v[100:103]
lq a[212:215],v11,2560
cv v179,v154,v155
mm v[100:103],a[248:251],v[184:187],v[100:103]
s_waitcnt lgkmcnt(2)
s_waitcnt vmcnt(3)
buffer_load_dwordx4 v7, s[12:15], s45 offen offset:2048 nt lds
mm v[112:115],a[192:195],a[96:99],0
v_exp_f32 v148, v148
mm v[112:115],a[196:199],a[108:111],v[112:115]
L_pg16:
s_cbranch_execz L_tret2
lq a[216:219],v11,6144
mm v[112:115],a[200:203],a[120:123],v[112:115]
v_exp_f32 v149, v149
mm v[112:115],a[204:207],a[132:135],v[112:115]
lq a[220:223],v11,6656
cv v174,v148,v149
mm v[116:119],a[204:207],a[136:139],0
v_exp_f32 v150, v150
mm v[116:119],a[200:203],a[124:127],v[116:119]
lq a[224:227],v11,8192
mm v[116:119],a[196:199],a[112:115],v[116:119]
v_exp_f32 v151, v151
mm v[116:119],a[192:195],a[100:103],v[116:119]
lq a[228:231],v11,8704
cv v175,v150,v151
mm v[120:123],a[192:195],a[104:107],0
v_exp_f32 v112, v112
mm v[120:123],a[196:199],a[116:119],v[120:123]
lq a[232:235],v11,12288
v_add_u32 v12, 98304, v12
mm v[120:123],a[200:203],a[128:131],v[120:123]
v_exp_f32 v113, v113
mm v[120:123],a[204:207],a[140:143],v[120:123]
s_waitcnt lgkmcnt(3)
lq a[236:239],v11,12800
mm v[132:135],a[220:223],a[140:143],0
v_exp_f32 v114, v114
mm v[132:135],a[216:219],a[128:131],v[132:135]
s_waitcnt vmcnt(3)
buffer_load_dwordx4 v8, s[12:15], s45 offen offset:3072 nt lds
mm v[132:135],a[212:215],a[116:119],v[132:135]
v_exp_f32 v115, v115
mm v[132:135],a[208:211],a[104:107],v[132:135]
lq a[240:243],v11,10240
v_add_u32 v13, 98304, v13
mm v[128:131],a[208:211],a[100:103],0
v_exp_f32 v116, v116
mm v[128:131],a[212:215],a[112:115],v[128:131]
lq a[244:247],v11,10752
cv v184,v112,v113
mm v[128:131],a[216:219],a[124:127],v[128:131]
v_exp_f32 v117, v117
mm v[128:131],a[220:223],a[136:139],v[128:131]
lq a[248:251],v11,14336
cv v185,v114,v115
mm v[124:127],a[220:223],a[132:135],0
lq a[252:255],v11,14848
cv v188,v116,v117
mm v[124:127],a[216:219],a[120:123],v[124:127]
tr a[192:193],v12,16384
mm v[124:127],a[212:215],a[108:111],v[124:127]
v_exp_f32 v118, v118
mm v[124:127],a[208:211],a[96:99],v[124:127]
s_waitcnt lgkmcnt(5)
tr a[194:195],v12,18432
mm v[136:139],a[224:227],a[96:99],0
v_exp_f32 v119, v119
mm v[136:139],a[228:231],a[108:111],v[136:139]
tr a[196:197],v12,24576
cv v189,v118,v119
mm v[136:139],a[232:235],a[120:123],v[136:139]
v_exp_f32 v120, v120
mm v[136:139],a[236:239],a[132:135],v[136:139]
s_add_u32 s45, s45, 16384
tr a[198:199],v12,26624
mm v[140:143],a[236:239],a[136:139],0
v_exp_f32 v121, v121
mm v[140:143],a[232:235],a[124:127],v[140:143]
s_add_u32 m0, s43, 98304
s_waitcnt vmcnt(3)
mm v[140:143],a[228:231],a[112:115],v[140:143]
v_exp_f32 v122, v122
mm v[140:143],a[224:227],a[100:103],v[140:143]
buffer_load_dwordx4 v5, s[8:11], s45 offen offset:0 nt lds
tr a[200:201],v13,16384
mm v[144:147],a[224:227],a[104:107],0
v_exp_f32 v123, v123
mm v[144:147],a[228:231],a[116:119],v[144:147]
tr a[202:203],v13,18432
cv v192,v120,v121
mm v[144:147],a[232:235],a[128:131],v[144:147]
v_exp_f32 v132, v132
mm v[144:147],a[236:239],a[140:143],v[144:147]
s_waitcnt lgkmcnt(6)
tr a[204:205],v13,24576
mm v[156:159],a[252:255],a[140:143],0
tr a[206:207],v13,26624
cv v193,v122,v123
mm v[156:159],a[248:251],a[128:131],v[156:159]
tr a[208:209],v12,16896
mm v[156:159],a[244:247],a[116:119],v[156:159]
v_exp_f32 v133, v133
mm v[156:159],a[240:243],a[104:107],v[156:159]
tr a[210:211],v12,18944
cv v194,v132,v133
mm v[152:155],a[240:243],a[100:103],0
v_exp_f32 v134, v134
mm v[152:155],a[244:247],a[112:115],v[152:155]
v_exp_f32 v135, v135
mm v[152:155],a[248:251],a[124:127],v[152:155]
v_exp_f32 v128, v128
mm v[152:155],a[252:255],a[136:139],v[152:155]
tr a[212:213],v12,25088
s_waitcnt vmcnt(3)
mm v[148:151],a[252:255],a[132:135],0
v_exp_f32 v129, v129
mm v[148:151],a[248:251],a[120:123],v[148:151]
tr a[214:215],v12,27136
buffer_load_dwordx4 v6, s[8:11], s45 offen offset:1024 nt lds
mm v[148:151],a[244:247],a[108:111],v[148:151]
v_exp_f32 v130, v130
mm v[148:151],a[240:243],a[96:99],v[148:151]
tr a[216:217],v13,16896
cv v195,v134,v135
mm v[216:219],v[220:223],v[180:183],v[216:219]
v_exp_f32 v131, v131
mm v[216:219],v[220:223],v[168:171],v[216:219]
tr a[218:219],v13,18944
cv v190,v128,v129
mm v[212:215],v[220:223],v[176:179],v[212:215]
v_exp_f32 v124, v124
mm v[212:215],v[220:223],v[164:167],v[212:215]
tr a[220:221],v13,25088
tr a[222:223],v13,27136
mm v[208:211],v[220:223],v[172:175],v[208:211]
v_exp_f32 v125, v125
mm v[208:211],v[220:223],v[160:163],v[208:211]
s_waitcnt lgkmcnt(8)
tr a[224:225],v12,20480
mm v[16:19],a[192:195],v[160:163],v[16:19]
v_exp_f32 v126, v126
mm v[16:19],a[196:199],v[172:175],v[16:19]
tr a[226:227],v12,22528
cv v191,v130,v131
mm v[20:23],a[196:199],v[176:179],v[20:23]
v_exp_f32 v127, v127
mm v[20:23],a[192:195],v[164:167],v[20:23]
tr a[228:229],v12,28672
s_waitcnt vmcnt(3)
mm v[24:27],a[192:195],v[168:171],v[24:27]
v_exp_f32 v136, v136
mm v[24:27],a[196:199],v[180:183],v[24:27]
tr a[230:231],v12,30720
buffer_load_dwordx4 v7, s[8:11], s45 offen offset:2048 nt lds
mm v[36:39],a[204:207],v[180:183],v[36:39]
v_exp_f32 v137, v137
mm v[36:39],a[200:203],v[168:171],v[36:39]
tr a[232:233],v13,20480
cv v186,v124,v125
mm v[32:35],a[200:203],v[164:167],v[32:35]
v_exp_f32 v138, v138
mm v[32:35],a[204:207],v[176:179],v[32:35]
tr a[234:235],v13,22528
cv v187,v126,v127
mm v[28:31],a[204:207],v[172:175],v[28:31]
v_exp_f32 v139, v139
mm v[28:31],a[200:203],v[160:163],v[28:31]
s_waitcnt lgkmcnt(6)
tr a[236:237],v13,28672
mm v[40:43],a[208:211],v[160:163],v[40:43]
tr a[238:239],v13,30720
cv v196,v136,v137
mm v[40:43],a[212:215],v[172:175],v[40:43]
tr a[240:241],v12,20992
cv v197,v138,v139
mm v[44:47],a[212:215],v[176:179],v[44:47]
v_exp_f32 v140, v140
mm v[44:47],a[208:211],v[164:167],v[44:47]
tr a[242:243],v12,23040
mm v[48:51],a[208:211],v[168:171],v[48:51]
v_exp_f32 v141, v141
mm v[48:51],a[212:215],v[180:183],v[48:51]
tr a[244:245],v12,29184
cv v200,v140,v141
mm v[60:63],a[220:223],v[180:183],v[60:63]
v_exp_f32 v142, v142
mm v[60:63],a[216:219],v[168:171],v[60:63]
tr a[246:247],v12,31232
s_waitcnt vmcnt(3)
mm v[56:59],a[216:219],v[164:167],v[56:59]
v_exp_f32 v143, v143
mm v[56:59],a[220:223],v[176:179],v[56:59]
tr a[248:249],v13,20992
buffer_load_dwordx4 v8, s[8:11], s45 offen offset:3072 nt lds
mm v[52:55],a[220:223],v[172:175],v[52:55]
v_exp_f32 v144, v144
mm v[52:55],a[216:219],v[160:163],v[52:55]
s_waitcnt lgkmcnt(5)
tr a[250:251],v13,23040
mm v[64:67],a[224:227],v[160:163],v[64:67]
v_exp_f32 v145, v145
mm v[64:67],a[228:231],v[172:175],v[64:67]
tr a[252:253],v13,29184
cv v201,v142,v143
mm v[68:71],a[228:231],v[176:179],v[68:71]
v_exp_f32 v146, v146
mm v[68:71],a[224:227],v[164:167],v[68:71]
tr a[254:255],v13,31232
v_add_u32 v11, 65536, v11
mm v[72:75],a[224:227],v[168:171],v[72:75]
v_exp_f32 v147, v147
mm v[72:75],a[228:231],v[180:183],v[72:75]
cv v204,v144,v145
cv v205,v146,v147
mm v[84:87],a[236:239],v[180:183],v[84:87]
v_exp_f32 v156, v156
mm v[84:87],a[232:235],v[168:171],v[84:87]
v_exp_f32 v157, v157
mm v[80:83],a[232:235],v[164:167],v[80:83]
v_exp_f32 v158, v158
mm v[80:83],a[236:239],v[176:179],v[80:83]
s_add_u32 m0, s44, 98304
mm v[76:79],a[236:239],v[172:175],v[76:79]
v_exp_f32 v159, v159
mm v[76:79],a[232:235],v[160:163],v[76:79]
s_waitcnt lgkmcnt(0)
s_waitcnt vmcnt(3)
mm v[88:91],a[240:243],v[160:163],v[88:91]
s_barrier
buffer_load_dwordx4 v5, s[12:15], s45 offen offset:0 nt lds
mm v[88:91],a[244:247],v[172:175],v[88:91]
lq a[192:195],v11,0
cv v206,v156,v157
mm v[92:95],a[244:247],v[176:179],v[92:95]
v_exp_f32 v152, v152
mm v[92:95],a[240:243],v[164:167],v[92:95]
lq a[196:199],v11,512
cv v207,v158,v159
mm v[96:99],a[240:243],v[168:171],v[96:99]
lq a[200:203],v11,4096
mm v[96:99],a[244:247],v[180:183],v[96:99]
lq a[204:207],v11,4608
mm v[108:111],a[252:255],v[180:183],v[108:111]
v_exp_f32 v153, v153
mm v[108:111],a[248:251],v[168:171],v[108:111]
v_exp_f32 v154, v154
mm v[104:107],a[248:251],v[164:167],v[104:107]
v_exp_f32 v155, v155
mm v[104:107],a[252:255],v[176:179],v[104:107]
lq a[208:211],v11,2048
cv v202,v152,v153
mm v[100:103],a[252:255],v[172:175],v[100:103]
lq a[212:215],v11,2560
cv v203,v154,v155
mm v[100:103],a[248:251],v[160:163],v[100:103]
s_waitcnt lgkmcnt(2)
mm v[112:115],a[192:195],a[96:99],0
v_exp_f32 v148, v148
mm v[112:115],a[196:199],a[108:111],v[112:115]
lq a[216:219],v11,6144
s_waitcnt vmcnt(3)
mm v[112:115],a[200:203],a[120:123],v[112:115]
v_exp_f32 v149, v149
mm v[112:115],a[204:207],a[132:135],v[112:115]
lq a[220:223],v11,6656
buffer_load_dwordx4 v6, s[12:15], s45 offen offset:1024 nt lds
mm v[116:119],a[204:207],a[136:139],0
v_exp_f32 v150, v150
mm v[116:119],a[200:203],a[124:127],v[116:119]
lq a[224:227],v11,8192
cv v198,v148,v149
mm v[116:119],a[196:199],a[112:115],v[116:119]
v_exp_f32 v151, v151
mm v[116:119],a[192:195],a[100:103],v[116:119]
lq a[228:231],v11,8704
cv v199,v150,v151
mm v[120:123],a[192:195],a[104:107],0
v_exp_f32 v112, v112
mm v[120:123],a[196:199],a[116:119],v[120:123]
lq a[232:235],v11,12288
v_add_u32 v12, 4294836224, v12
mm v[120:123],a[200:203],a[128:131],v[120:123]
v_exp_f32 v113, v113
mm v[120:123],a[204:207],a[140:143],v[120:123]
s_waitcnt lgkmcnt(3)
lq a[236:239],v11,12800
mm v[132:135],a[220:223],a[140:143],0
v_exp_f32 v114, v114
mm v[132:135],a[216:219],a[128:131],v[132:135]
lq a[240:243],v11,10240
v_add_u32 v13, 4294836224, v13
mm v[132:135],a[212:215],a[116:119],v[132:135]
v_exp_f32 v115, v115
mm v[132:135],a[208:211],a[104:107],v[132:135]
s_waitcnt vmcnt(3)
lq a[244:247],v11,10752
mm v[128:131],a[208:211],a[100:103],0
v_exp_f32 v116, v116
mm v[128:131],a[212:215],a[112:115],v[128:131]
lq a[248:251],v11,14336
buffer_load_dwordx4 v7, s[12:15], s45 offen offset:2048 nt lds
mm v[128:131],a[216:219],a[124:127],v[128:131]
v_exp_f32 v117, v117
mm v[128:131],a[220:223],a[136:139],v[128:131]
lq a[252:255],v11,14848
cv v160,v112,v113
mm v[124:127],a[220:223],a[132:135],0
v_exp_f32 v118, v118
mm v[124:127],a[216:219],a[120:123],v[124:127]
tr a[192:193],v12,16384
cv v161,v114,v115
mm v[124:127],a[212:215],a[108:111],v[124:127]
v_exp_f32 v119, v119
mm v[124:127],a[208:211],a[96:99],v[124:127]
s_waitcnt lgkmcnt(5)
tr a[194:195],v12,18432
mm v[136:139],a[224:227],a[96:99],0
v_exp_f32 v120, v120
mm v[136:139],a[228:231],a[108:111],v[136:139]
tr a[196:197],v12,24576
cv v164,v116,v117
mm v[136:139],a[232:235],a[120:123],v[136:139]
v_exp_f32 v121, v121
mm v[136:139],a[236:239],a[132:135],v[136:139]
tr a[198:199],v12,26624
cv v165,v118,v119
mm v[140:143],a[236:239],a[136:139],0
v_exp_f32 v122, v122
mm v[140:143],a[232:235],a[124:127],v[140:143]
tr a[200:201],v13,16384
cv v168,v120,v121
mm v[140:143],a[228:231],a[112:115],v[140:143]
v_exp_f32 v123, v123
mm v[140:143],a[224:227],a[100:103],v[140:143]
s_waitcnt vmcnt(3)
tr a[202:203],v13,18432
mm v[144:147],a[224:227],a[104:107],0
v_exp_f32 v132, v132
mm v[144:147],a[228:231],a[116:119],v[144:147]
buffer_load_dwordx4 v8, s[12:15], s45 offen offset:3072 nt lds
tr a[204:205],v13,24576
mm v[144:147],a[232:235],a[128:131],v[144:147]
v_exp_f32 v133, v133
mm v[144:147],a[236:239],a[140:143],v[144:147]
s_waitcnt lgkmcnt(7)
tr a[206:207],v13,26624
mm v[156:159],a[252:255],a[140:143],0
v_exp_f32 v134, v134
mm v[156:159],a[248:251],a[128:131],v[156:159]
tr a[208:209],v12,16896
cv v169,v122,v123
mm v[156:159],a[244:247],a[116:119],v[156:159]
v_exp_f32 v135, v135
mm v[156:159],a[240:243],a[104:107],v[156:159]
tr a[210:211],v12,18944
cv v170,v132,v133
mm v[152:155],a[240:243],a[100:103],0
v_exp_f32 v128, v128
mm v[152:155],a[244:247],a[112:115],v[152:155]
tr a[212:213],v12,25088
cv v171,v134,v135
mm v[152:155],a[248:251],a[124:127],v[152:155]
v_exp_f32 v129, v129
mm v[152:155],a[252:255],a[136:139],v[152:155]
tr a[214:215],v12,27136
cv v166,v128,v129
mm v[148:151],a[252:255],a[132:135],0
v_exp_f32 v130, v130
mm v[148:151],a[248:251],a[120:123],v[148:151]
tr a[216:217],v13,16896
s_add_u32 s45, s45, 16384
mm v[148:151],a[244:247],a[108:111],v[148:151]
v_exp_f32 v131, v131
mm v[148:151],a[240:243],a[96:99],v[148:151]
s_add_u32 m0, s43, 32768
s_waitcnt vmcnt(3)
mm v[216:219],v[220:223],v[204:207],v[216:219]
v_exp_f32 v124, v124
mm v[216:219],v[220:223],v[192:195],v[216:219]
tr a[218:219],v13,18944
buffer_load_dwordx4 v5, s[8:11], s45 offen offset:0 nt lds
mm v[212:215],v[220:223],v[200:203],v[212:215]
v_exp_f32 v125, v125
mm v[212:215],v[220:223],v[188:191],v[212:215]
tr a[220:221],v13,25088
tr a[222:223],v13,27136
mm v[208:211],v[220:223],v[196:199],v[208:211]
v_exp_f32 v126, v126
mm v[208:211],v[220:223],v[184:187],v[208:211]
s_waitcnt lgkmcnt(8)
tr a[224:225],v12,20480
mm v[16:19],a[192:195],v[184:187],v[16:19]
v_exp_f32 v127, v127
mm v[16:19],a[196:199],v[196:199],v[16:19]
tr a[226:227],v12,22528
cv v167,v130,v131
mm v[20:23],a[196:199],v[200:203],v[20:23]
v_exp_f32 v136, v136
mm v[20:23],a[192:195],v[188:191],v[20:23]
tr a[228:229],v12,28672
cv v162,v124,v125
mm v[24:27],a[192:195],v[192:195],v[24:27]
v_exp_f32 v137, v137
mm v[24:27],a[196:199],v[204:207],v[24:27]
tr a[230:231],v12,30720
s_waitcnt vmcnt(3)
mm v[36:39],a[204:207],v[204:207],v[36:39]
v_exp_f32 v138, v138
mm v[36:39],a[200:203],v[192:195],v[36:39]
tr a[232:233],v13,20480
buffer_load_dwordx4 v6, s[8:11], s45 offen offset:1024 nt lds
mm v[32:35],a[200:203],v[188:191],v[32:35]
v_exp_f32 v139, v139
mm v[32:35],a[204:207],v[200:203],v[32:35]
tr a[234:235],v13,22528
cv v163,v126,v127
mm v[28:31],a[204:207],v[196:199],v[28:31]
v_exp_f32 v140, v140
mm v[28:31],a[200:203],v[184:187],v[28:31]
s_waitcnt lgkmcnt(6)
tr a[236:237],v13,28672
mm v[40:43],a[208:211],v[184:187],v[40:43]
tr a[238:239],v13,30720
cv v172,v136,v137
mm v[40:43],a[212:215],v[196:199],v[40:43]
tr a[240:241],v12,20992
cv v173,v138,v139
mm v[44:47],a[212:215],v[200:203],v[44:47]
v_exp_f32 v141, v141
mm v[44:47],a[208:211],v[188:191],v[44:47]
tr a[242:243],v12,23040
cv v176,v140,v141
mm v[48:51],a[208:211],v[192:195],v[48:51]
v_exp_f32 v142, v142
mm v[48:51],a[212:215],v[204:207],v[48:51]
tr a[244:245],v12,29184
mm v[60:63],a[220:223],v[204:207],v[60:63]
v_exp_f32 v143, v143
mm v[60:63],a[216:219],v[192:195],v[60:63]
tr a[246:247],v12,31232
s_waitcnt vmcnt(3)
mm v[56:59],a[216:219],v[188:191],v[56:59]
v_exp_f32 v144, v144
mm v[56:59],a[220:223],v[200:203],v[56:59]
tr a[248:249],v13,20992
buffer_load_dwordx4 v7, s[8:11], s45 offen offset:2048 nt lds
mm v[52:55],a[220:223],v[196:199],v[52:55]
v_exp_f32 v145, v145
mm v[52:55],a[216:219],v[184:187],v[52:55]
s_waitcnt lgkmcnt(5)
tr a[250:251],v13,23040
mm v[64:67],a[224:227],v[184:187],v[64:67]
v_exp_f32 v146, v146
mm v[64:67],a[228:231],v[196:199],v[64:67]
tr a[252:253],v13,29184
cv v177,v142,v143
mm v[68:71],a[228:231],v[200:203],v[68:71]
v_exp_f32 v147, v147
mm v[68:71],a[224:227],v[188:191],v[68:71]
tr a[254:255],v13,31232
cv v180,v144,v145
mm v[72:75],a[224:227],v[192:195],v[72:75]
v_exp_f32 v156, v156
mm v[72:75],a[228:231],v[204:207],v[72:75]
cv v181,v146,v147
mm v[84:87],a[236:239],v[204:207],v[84:87]
v_exp_f32 v157, v157
mm v[84:87],a[232:235],v[192:195],v[84:87]
cv v182,v156,v157
mm v[80:83],a[232:235],v[188:191],v[80:83]
v_exp_f32 v158, v158
mm v[80:83],a[236:239],v[200:203],v[80:83]
s_waitcnt vmcnt(3)
mm v[76:79],a[236:239],v[196:199],v[76:79]
v_exp_f32 v159, v159
mm v[76:79],a[232:235],v[184:187],v[76:79]
s_waitcnt lgkmcnt(0)
buffer_load_dwordx4 v8, s[8:11], s45 offen offset:3072 nt lds
mm v[88:91],a[240:243],v[184:187],v[88:91]
s_barrier
cv v183,v158,v159
mm v[88:91],a[244:247],v[196:199],v[88:91]
lq a[192:195],v11,32768
mm v[92:95],a[244:247],v[200:203],v[92:95]
v_exp_f32 v152, v152
mm v[92:95],a[240:243],v[188:191],v[92:95]
lq a[196:199],v11,33280
mm v[96:99],a[240:243],v[192:195],v[96:99]
lq a[200:203],v11,36864
mm v[96:99],a[244:247],v[204:207],v[96:99]
lq a[204:207],v11,37376
mm v[108:111],a[252:255],v[204:207],v[108:111]
v_exp_f32 v153, v153
mm v[108:111],a[248:251],v[192:195],v[108:111]
v_exp_f32 v154, v154
mm v[104:107],a[248:251],v[188:191],v[104:107]
v_exp_f32 v155, v155
mm v[104:107],a[252:255],v[200:203],v[104:107]
lq a[208:211],v11,34816
cv v178,v152,v153
mm v[100:103],a[252:255],v[196:199],v[100:103]
lq a[212:215],v11,35328
cv v179,v154,v155
mm v[100:103],a[248:251],v[184:187],v[100:103]
s_waitcnt lgkmcnt(2)
s_add_u32 m0, s44, 32768
s_waitcnt vmcnt(3)
buffer_load_dwordx4 v5, s[12:15], s45 offen offset:0 nt lds
mm v[112:115],a[192:195],a[96:99],0
v_exp_f32 v148, v148
mm v[112:115],a[196:199],a[108:111],v[112:115]
lq a[216:219],v11,38912
mm v[112:115],a[200:203],a[120:123],v[112:115]
v_exp_f32 v149, v149
mm v[112:115],a[204:207],a[132:135],v[112:115]
lq a[220:223],v11,39424
cv v174,v148,v149
mm v[116:119],a[204:207],a[136:139],0
v_exp_f32 v150, v150
mm v[116:119],a[200:203],a[124:127],v[116:119]
lq a[224:227],v11,40960
mm v[116:119],a[196:199],a[112:115],v[116:119]
v_exp_f32 v151, v151
mm v[116:119],a[192:195],a[100:103],v[116:119]
lq a[228:231],v11,41472
cv v175,v150,v151
mm v[120:123],a[192:195],a[104:107],0
v_exp_f32 v112, v112
mm v[120:123],a[196:199],a[116:119],v[120:123]
lq a[232:235],v11,45056
s_waitcnt vmcnt(3)
mm v[120:123],a[200:203],a[128:131],v[120:123]
v_exp_f32 v113, v113
mm v[120:123],a[204:207],a[140:143],v[120:123]
s_waitcnt lgkmcnt(3)
lq a[236:239],v11,45568
mm v[132:135],a[220:223],a[140:143],0
v_exp_f32 v114, v114
mm v[132:135],a[216:219],a[128:131],v[132:135]
buffer_load_dwordx4 v6, s[12:15], s45 offen offset:1024 nt lds
lq a[240:243],v11,43008
mm v[132:135],a[212:215],a[116:119],v[132:135]
v_exp_f32 v115, v115
mm v[132:135],a[208:211],a[104:107],v[132:135]
lq a[244:247],v11,43520
v_add_u32 v12, 65536, v12
mm v[128:131],a[208:211],a[100:103],0
v_exp_f32 v116, v116
mm v[128:131],a[212:215],a[112:115],v[128:131]
lq a[248:251],v11,47104
v_add_u32 v13, 65536, v13
mm v[128:131],a[216:219],a[124:127],v[128:131]
v_exp_f32 v117, v117
mm v[128:131],a[220:223],a[136:139],v[128:131]
lq a[252:255],v11,47616
s_waitcnt vmcnt(3)
mm v[124:127],a[220:223],a[132:135],0
v_exp_f32 v118, v118
mm v[124:127],a[216:219],a[120:123],v[124:127]
buffer_load_dwordx4 v7, s[12:15], s45 offen offset:2048 nt lds
tr a[192:193],v12,16384
mm v[124:127],a[212:215],a[108:111],v[124:127]
v_exp_f32 v119, v119
mm v[124:127],a[208:211],a[96:99],v[124:127]
s_waitcnt lgkmcnt(5)
tr a[194:195],v12,18432
mm v[136:139],a[224:227],a[96:99],0
v_exp_f32 v120, v120
mm v[136:139],a[228:231],a[108:111],v[136:139]
tr a[196:197],v12,24576
cv v184,v112,v113
mm v[136:139],a[232:235],a[120:123],v[136:139]
v_exp_f32 v121, v121
mm v[136:139],a[236:239],a[132:135],v[136:139]
tr a[198:199],v12,26624
cv v185,v114,v115
mm v[140:143],a[236:239],a[136:139],0
v_exp_f32 v122, v122
mm v[140:143],a[232:235],a[124:127],v[140:143]
tr a[200:201],v13,16384
cv v188,v116,v117
mm v[140:143],a[228:231],a[112:115],v[140:143]
v_exp_f32 v123, v123
mm v[140:143],a[224:227],a[100:103],v[140:143]
s_waitcnt vmcnt(3)
tr a[202:203],v13,18432
mm v[144:147],a[224:227],a[104:107],0
v_exp_f32 v132, v132
mm v[144:147],a[228:231],a[116:119],v[144:147]
buffer_load_dwordx4 v8, s[12:15], s45 offen offset:3072 nt lds
tr a[204:205],v13,24576
mm v[144:147],a[232:235],a[128:131],v[144:147]
v_exp_f32 v133, v133
mm v[144:147],a[236:239],a[140:143],v[144:147]
s_waitcnt lgkmcnt(7)
tr a[206:207],v13,26624
mm v[156:159],a[252:255],a[140:143],0
L_pg17:
s_cbranch_execz L_tret2
v_exp_f32 v134, v134
mm v[156:159],a[248:251],a[128:131],v[156:159]
tr a[208:209],v12,16896
cv v189,v118,v119
mm v[156:159],a[244:247],a[116:119],v[156:159]
v_exp_f32 v135, v135
mm v[156:159],a[240:243],a[104:107],v[156:159]
tr a[210:211],v12,18944
s_add_u32 s45, s45, 16384
mm v[152:155],a[240:243],a[100:103],0
v_exp_f32 v128, v128
mm v[152:155],a[244:247],a[112:115],v[152:155]
tr a[212:213],v12,25088
s_add_u32 m0, s43, 131072
mm v[152:155],a[248:251],a[124:127],v[152:155]
v_exp_f32 v129, v129
mm v[152:155],a[252:255],a[136:139],v[152:155]
s_waitcnt vmcnt(3)
buffer_load_dwordx4 v5, s[8:11], s45 offen offset:0 nt lds
mm v[148:151],a[252:255],a[132:135],0
v_exp_f32 v130, v130
mm v[148:151],a[248:251],a[120:123],v[148:151]
tr a[214:215],v12,27136
cv v192,v120,v121
mm v[148:151],a[244:247],a[108:111],v[148:151]
tr a[216:217],v13,16896
cv v193,v122,v123
mm v[148:151],a[240:243],a[96:99],v[148:151]
tr a[218:219],v13,18944
cv v194,v132,v133
mm v[216:219],v[220:223],v[180:183],v[216:219]
v_exp_f32 v131, v131
mm v[216:219],v[220:223],v[168:171],v[216:219]
tr a[220:221],v13,25088
cv v195,v134,v135
mm v[212:215],v[220:223],v[176:179],v[212:215]
v_exp_f32 v124, v124
mm v[212:215],v[220:223],v[164:167],v[212:215]
tr a[222:223],v13,27136
s_waitcnt vmcnt(3)
mm v[208:211],v[220:223],v[172:175],v[208:211]
v_exp_f32 v125, v125
mm v[208:211],v[220:223],v[160:163],v[208:211]
s_waitcnt lgkmcnt(8)
tr a[224:225],v12,20480
mm v[16:19],a[192:195],v[160:163],v[16:19]
v_exp_f32 v126, v126
mm v[16:19],a[196:199],v[172:175],v[16:19]
buffer_load_dwordx4 v6, s[8:11], s45 offen offset:1024 nt lds
tr a[226:227],v12,22528
mm v[20:23],a[196:199],v[176:179],v[20:23]
v_exp_f32 v127, v127
mm v[20:23],a[192:195],v[164:167],v[20:23]
tr a[228:229],v12,28672
cv v190,v128,v129
mm v[24:27],a[192:195],v[168:171],v[24:27]
v_exp_f32 v136, v136
mm v[24:27],a[196:199],v[180:183],v[24:27]
tr a[230:231],v12,30720
cv v191,v130,v131
mm v[36:39],a[204:207],v[180:183],v[36:39]
v_exp_f32 v137, v137
mm v[36:39],a[200:203],v[168:171],v[36:39]
tr a[232:233],v13,20480
s_waitcnt vmcnt(3)
mm v[32:35],a[200:203],v[164:167],v[32:35]
v_exp_f32 v138, v138
mm v[32:35],a[204:207],v[176:179],v[32:35]
tr a[234:235],v13,22528
buffer_load_dwordx4 v7, s[8:11], s45 offen offset:2048 nt lds
mm v[28:31],a[204:207],v[172:175],v[28:31]
v_exp_f32 v139, v139
mm v[28:31],a[200:203],v[160:163],v[28:31]
s_waitcnt lgkmcnt(6)
tr a[236:237],v13,28672
mm v[40:43],a[208:211],v[160:163],v[40:43]
tr a[238:239],v13,30720
cv v186,v124,v125
mm v[40:43],a[212:215],v[172:175],v[40:43]
tr a[240:241],v12,20992
cv v187,v126,v127
mm v[44:47],a[212:215],v[176:179],v[44:47]
v_exp_f32 v140, v140
mm v[44:47],a[208:211],v[164:167],v[44:47]
tr a[242:243],v12,23040
cv v196,v136,v137
mm v[48:51],a[208:211],v[168:171],v[48:51]
v_exp_f32 v141, v141
mm v[48:51],a[212:215],v[180:183],v[48:51]
tr a[244:245],v12,29184
cv v197,v138,v139
mm v[60:63],a[220:223],v[180:183],v[60:63]
v_exp_f32 v142, v142
mm v[60:63],a[216:219],v[168:171],v[60:63]
tr a[246:247],v12,31232
s_waitcnt vmcnt(3)
mm v[56:59],a[216:219],v[164:167],v[56:59]
v_exp_f32 v143, v143
mm v[56:59],a[220:223],v[176:179],v[56:59]
tr a[248:249],v13,20992
buffer_load_dwordx4 v8, s[8:11], s45 offen offset:3072 nt lds
mm v[52:55],a[220:223],v[172:175],v[52:55]
v_exp_f32 v144, v144
mm v[52:55],a[216:219],v[160:163],v[52:55]
s_waitcnt lgkmcnt(5)
tr a[250:251],v13,23040
mm v[64:67],a[224:227],v[160:163],v[64:67]
v_exp_f32 v145, v145
mm v[64:67],a[228:231],v[172:175],v[64:67]
tr a[252:253],v13,29184
cv v200,v140,v141
mm v[68:71],a[228:231],v[176:179],v[68:71]
v_exp_f32 v146, v146
mm v[68:71],a[224:227],v[164:167],v[68:71]
tr a[254:255],v13,31232
cv v201,v142,v143
mm v[72:75],a[224:227],v[168:171],v[72:75]
v_exp_f32 v147, v147
mm v[72:75],a[228:231],v[180:183],v[72:75]
v_add_u32 v11, 4294934528, v11
cv v204,v144,v145
mm v[84:87],a[236:239],v[180:183],v[84:87]
v_exp_f32 v156, v156
mm v[84:87],a[232:235],v[168:171],v[84:87]
cv v205,v146,v147
mm v[80:83],a[232:235],v[164:167],v[80:83]
v_exp_f32 v157, v157
mm v[80:83],a[236:239],v[176:179],v[80:83]
s_add_u32 m0, s44, 131072
mm v[76:79],a[236:239],v[172:175],v[76:79]
v_exp_f32 v158, v158
mm v[76:79],a[232:235],v[160:163],v[76:79]
s_waitcnt lgkmcnt(0)
s_waitcnt vmcnt(3)
mm v[88:91],a[240:243],v[160:163],v[88:91]
s_barrier
buffer_load_dwordx4 v5, s[12:15], s45 offen offset:0 nt lds
v_exp_f32 v159, v159
mm v[88:91],a[244:247],v[172:175],v[88:91]
lq a[192:195],v11,0
cv v206,v156,v157
mm v[92:95],a[244:247],v[176:179],v[92:95]
v_exp_f32 v152, v152
mm v[92:95],a[240:243],v[164:167],v[92:95]
lq a[196:199],v11,512
cv v207,v158,v159
mm v[96:99],a[240:243],v[168:171],v[96:99]
lq a[200:203],v11,4096
mm v[96:99],a[244:247],v[180:183],v[96:99]
lq a[204:207],v11,4608
mm v[108:111],a[252:255],v[180:183],v[108:111]
v_exp_f32 v153, v153
mm v[108:111],a[248:251],v[168:171],v[108:111]
v_exp_f32 v154, v154
mm v[104:107],a[248:251],v[164:167],v[104:107]
v_exp_f32 v155, v155
mm v[104:107],a[252:255],v[176:179],v[104:107]
lq a[208:211],v11,2048
cv v202,v152,v153
mm v[100:103],a[252:255],v[172:175],v[100:103]
lq a[212:215],v11,2560
cv v203,v154,v155
mm v[100:103],a[248:251],v[160:163],v[100:103]
s_waitcnt lgkmcnt(2)
mm v[112:115],a[192:195],a[96:99],0
v_exp_f32 v148, v148
mm v[112:115],a[196:199],a[108:111],v[112:115]
lq a[216:219],v11,6144
s_waitcnt vmcnt(3)
mm v[112:115],a[200:203],a[120:123],v[112:115]
v_exp_f32 v149, v149
mm v[112:115],a[204:207],a[132:135],v[112:115]
lq a[220:223],v11,6656
buffer_load_dwordx4 v6, s[12:15], s45 offen offset:1024 nt lds
mm v[116:119],a[204:207],a[136:139],0
v_exp_f32 v150, v150
mm v[116:119],a[200:203],a[124:127],v[116:119]
lq a[224:227],v11,8192
cv v198,v148,v149
mm v[116:119],a[196:199],a[112:115],v[116:119]
v_exp_f32 v151, v151
mm v[116:119],a[192:195],a[100:103],v[116:119]
lq a[228:231],v11,8704
cv v199,v150,v151
mm v[120:123],a[192:195],a[104:107],0
v_exp_f32 v112, v112
mm v[120:123],a[196:199],a[116:119],v[120:123]
lq a[232:235],v11,12288
mm v[120:123],a[200:203],a[128:131],v[120:123]
v_exp_f32 v113, v113
mm v[120:123],a[204:207],a[140:143],v[120:123]
s_waitcnt lgkmcnt(3)
lq a[236:239],v11,12800
mm v[132:135],a[220:223],a[140:143],0
v_exp_f32 v114, v114
mm v[132:135],a[216:219],a[128:131],v[132:135]
lq a[240:243],v11,10240
cv v160,v112,v113
mm v[132:135],a[212:215],a[116:119],v[132:135]
v_exp_f32 v115, v115
mm v[132:135],a[208:211],a[104:107],v[132:135]
s_waitcnt vmcnt(3)
lq a[244:247],v11,10752
mm v[128:131],a[208:211],a[100:103],0
v_exp_f32 v116, v116
mm v[128:131],a[212:215],a[112:115],v[128:131]
lq a[248:251],v11,14336
buffer_load_dwordx4 v7, s[12:15], s45 offen offset:2048 nt lds
mm v[128:131],a[216:219],a[124:127],v[128:131]
v_exp_f32 v117, v117
mm v[128:131],a[220:223],a[136:139],v[128:131]
lq a[252:255],v11,14848
cv v161,v114,v115
mm v[124:127],a[220:223],a[132:135],0
v_exp_f32 v118, v118
mm v[124:127],a[216:219],a[120:123],v[124:127]
tr a[192:193],v12,49152
cv v164,v116,v117
mm v[124:127],a[212:215],a[108:111],v[124:127]
v_exp_f32 v119, v119
mm v[124:127],a[208:211],a[96:99],v[124:127]
s_waitcnt lgkmcnt(5)
tr a[194:195],v12,51200
mm v[136:139],a[224:227],a[96:99],0
v_exp_f32 v120, v120
mm v[136:139],a[228:231],a[108:111],v[136:139]
tr a[196:197],v12,57344
cv v165,v118,v119
mm v[136:139],a[232:235],a[120:123],v[136:139]
v_exp_f32 v121, v121
mm v[136:139],a[236:239],a[132:135],v[136:139]
tr a[198:199],v12,59392
cv v168,v120,v121
mm v[140:143],a[236:239],a[136:139],0
v_exp_f32 v122, v122
mm v[140:143],a[232:235],a[124:127],v[140:143]
tr a[200:201],v13,49152
mm v[140:143],a[228:231],a[112:115],v[140:143]
v_exp_f32 v123, v123
mm v[140:143],a[224:227],a[100:103],v[140:143]
s_waitcnt vmcnt(3)
tr a[202:203],v13,51200
mm v[144:147],a[224:227],a[104:107],0
v_exp_f32 v132, v132
mm v[144:147],a[228:231],a[116:119],v[144:147]
buffer_load_dwordx4 v8, s[12:15], s45 offen offset:3072 nt lds
tr a[204:205],v13,57344
mm v[144:147],a[232:235],a[128:131],v[144:147]
v_exp_f32 v133, v133
mm v[144:147],a[236:239],a[140:143],v[144:147]
s_waitcnt lgkmcnt(7)
tr a[206:207],v13,59392
mm v[156:159],a[252:255],a[140:143],0
v_exp_f32 v134, v134
mm v[156:159],a[248:251],a[128:131],v[156:159]
tr a[208:209],v12,49664
cv v169,v122,v123
mm v[156:159],a[244:247],a[116:119],v[156:159]
v_exp_f32 v135, v135
mm v[156:159],a[240:243],a[104:107],v[156:159]
tr a[210:211],v12,51712
cv v170,v132,v133
mm v[152:155],a[240:243],a[100:103],0
v_exp_f32 v128, v128
mm v[152:155],a[244:247],a[112:115],v[152:155]
tr a[212:213],v12,57856
cv v171,v134,v135
mm v[152:155],a[248:251],a[124:127],v[152:155]
v_exp_f32 v129, v129
mm v[152:155],a[252:255],a[136:139],v[152:155]
tr a[214:215],v12,59904
cv v166,v128,v129
mm v[148:151],a[252:255],a[132:135],0
v_exp_f32 v130, v130
mm v[148:151],a[248:251],a[120:123],v[148:151]
tr a[216:217],v13,49664
s_add_u32 s45, s45, 16384
mm v[148:151],a[244:247],a[108:111],v[148:151]
v_exp_f32 v131, v131
mm v[148:151],a[240:243],a[96:99],v[148:151]
s_add_u32 m0, s43, 0
s_waitcnt vmcnt(3)
mm v[216:219],v[220:223],v[204:207],v[216:219]
v_exp_f32 v124, v124
mm v[216:219],v[220:223],v[192:195],v[216:219]
tr a[218:219],v13,51712
buffer_load_dwordx4 v5, s[8:11], s45 offen offset:0 nt lds
mm v[212:215],v[220:223],v[200:203],v[212:215]
v_exp_f32 v125, v125
mm v[212:215],v[220:223],v[188:191],v[212:215]
tr a[220:221],v13,57856
tr a[222:223],v13,59904
mm v[208:211],v[220:223],v[196:199],v[208:211]
v_exp_f32 v126, v126
mm v[208:211],v[220:223],v[184:187],v[208:211]
s_waitcnt lgkmcnt(8)
tr a[224:225],v12,53248
mm v[16:19],a[192:195],v[184:187],v[16:19]
v_exp_f32 v127, v127
mm v[16:19],a[196:199],v[196:199],v[16:19]
tr a[226:227],v12,55296
cv v167,v130,v131
mm v[20:23],a[196:199],v[200:203],v[20:23]
v_exp_f32 v136, v136
mm v[20:23],a[192:195],v[188:191],v[20:23]
tr a[228:229],v12,61440
cv v162,v124,v125
mm v[24:27],a[192:195],v[192:195],v[24:27]
v_exp_f32 v137, v137
mm v[24:27],a[196:199],v[204:207],v[24:27]
tr a[230:231],v12,63488
cv v163,v126,v127
mm v[36:39],a[204:207],v[204:207],v[36:39]
v_exp_f32 v138, v138
mm v[36:39],a[200:203],v[192:195],v[36:39]
tr a[232:233],v13,53248
s_waitcnt vmcnt(3)
mm v[32:35],a[200:203],v[188:191],v[32:35]
v_exp_f32 v139, v139
mm v[32:35],a[204:207],v[200:203],v[32:35]
tr a[234:235],v13,55296
buffer_load_dwordx4 v6, s[8:11], s45 offen offset:1024 nt lds
mm v[28:31],a[204:207],v[196:199],v[28:31]
v_exp_f32 v140, v140
mm v[28:31],a[200:203],v[184:187],v[28:31]
s_waitcnt lgkmcnt(6)
tr a[236:237],v13,61440
mm v[40:43],a[208:211],v[184:187],v[40:43]
tr a[238:239],v13,63488
cv v172,v136,v137
mm v[40:43],a[212:215],v[196:199],v[40:43]
tr a[240:241],v12,53760
cv v173,v138,v139
mm v[44:47],a[212:215],v[200:203],v[44:47]
v_exp_f32 v141, v141
mm v[44:47],a[208:211],v[188:191],v[44:47]
tr a[242:243],v12,55808
cv v176,v140,v141
mm v[48:51],a[208:211],v[192:195],v[48:51]
v_exp_f32 v142, v142
mm v[48:51],a[212:215],v[204:207],v[48:51]
tr a[244:245],v12,61952
mm v[60:63],a[220:223],v[204:207],v[60:63]
v_exp_f32 v143, v143
mm v[60:63],a[216:219],v[192:195],v[60:63]
tr a[246:247],v12,64000
cv v177,v142,v143
mm v[56:59],a[216:219],v[188:191],v[56:59]
v_exp_f32 v144, v144
mm v[56:59],a[220:223],v[200:203],v[56:59]
tr a[248:249],v13,53760
s_waitcnt vmcnt(3)
mm v[52:55],a[220:223],v[196:199],v[52:55]
v_exp_f32 v145, v145
mm v[52:55],a[216:219],v[184:187],v[52:55]
s_waitcnt lgkmcnt(5)
tr a[250:251],v13,55808
mm v[64:67],a[224:227],v[184:187],v[64:67]
v_exp_f32 v146, v146
mm v[64:67],a[228:231],v[196:199],v[64:67]
tr a[252:253],v13,61952
buffer_load_dwordx4 v7, s[8:11], s45 offen offset:2048 nt lds
mm v[68:71],a[228:231],v[200:203],v[68:71]
v_exp_f32 v147, v147
mm v[68:71],a[224:227],v[188:191],v[68:71]
tr a[254:255],v13,64000
v_add_u32 v11, 98304, v11
mm v[72:75],a[224:227],v[192:195],v[72:75]
v_exp_f32 v156, v156
mm v[72:75],a[228:231],v[204:207],v[72:75]
cv v180,v144,v145
cv v181,v146,v147
mm v[84:87],a[236:239],v[204:207],v[84:87]
v_exp_f32 v157, v157
mm v[84:87],a[232:235],v[192:195],v[84:87]
cv v182,v156,v157
mm v[80:83],a[232:235],v[188:191],v[80:83]
v_exp_f32 v158, v158
mm v[80:83],a[236:239],v[200:203],v[80:83]
mm v[76:79],a[236:239],v[196:199],v[76:79]
v_exp_f32 v159, v159
mm v[76:79],a[232:235],v[184:187],v[76:79]
s_waitcnt lgkmcnt(0)
cv v183,v158,v159
mm v[88:91],a[240:243],v[184:187],v[88:91]
s_barrier
s_waitcnt vmcnt(3)
mm v[88:91],a[244:247],v[196:199],v[88:91]
lq a[192:195],v11,0
buffer_load_dwordx4 v8, s[8:11], s45 offen offset:3072 nt lds
mm v[92:95],a[244:247],v[200:203],v[92:95]
v_exp_f32 v152, v152
mm v[92:95],a[240:243],v[188:191],v[92:95]
lq a[196:199],v11,512
mm v[96:99],a[240:243],v[192:195],v[96:99]
lq a[200:203],v11,4096
mm v[96:99],a[244:247],v[204:207],v[96:99]
lq a[204:207],v11,4608
mm v[108:111],a[252:255],v[204:207],v[108:111]
v_exp_f32 v153, v153
mm v[108:111],a[248:251],v[192:195],v[108:111]
v_exp_f32 v154, v154
mm v[104:107],a[248:251],v[188:191],v[104:107]
v_exp_f32 v155, v155
mm v[104:107],a[252:255],v[200:203],v[104:107]
lq a[208:211],v11,2048
cv v178,v152,v153
mm v[100:103],a[252:255],v[196:199],v[100:103]
lq a[212:215],v11,2560
cv v179,v154,v155
mm v[100:103],a[248:251],v[184:187],v[100:103]
s_waitcnt lgkmcnt(2)
mm v[112:115],a[192:195],a[96:99],0
v_exp_f32 v148, v148
mm v[112:115],a[196:199],a[108:111],v[112:115]
lq a[216:219],v11,6144
mm v[112:115],a[200:203],a[120:123],v[112:115]
v_exp_f32 v149, v149
mm v[112:115],a[204:207],a[132:135],v[112:115]
lq a[220:223],v11,6656
s_add_u32 m0, s44, 0
mm v[116:119],a[204:207],a[136:139],0
v_exp_f32 v150, v150
mm v[116:119],a[200:203],a[124:127],v[116:119]
s_waitcnt vmcnt(3)
buffer_load_dwordx4 v5, s[12:15], s45 offen offset:0 nt lds
mm v[116:119],a[196:199],a[112:115],v[116:119]
v_exp_f32 v151, v151
mm v[116:119],a[192:195],a[100:103],v[116:119]
lq a[224:227],v11,8192
cv v174,v148,v149
mm v[120:123],a[192:195],a[104:107],0
v_exp_f32 v112, v112
mm v[120:123],a[196:199],a[116:119],v[120:123]
lq a[228:231],v11,8704
v_add_u32 v12, 4294934528, v12
mm v[120:123],a[200:203],a[128:131],v[120:123]
v_exp_f32 v113, v113
mm v[120:123],a[204:207],a[140:143],v[120:123]
s_waitcnt lgkmcnt(2)
lq a[232:235],v11,12288
mm v[132:135],a[220:223],a[140:143],0
lq a[236:239],v11,12800
v_add_u32 v13, 4294934528, v13
mm v[132:135],a[216:219],a[128:131],v[132:135]
lq a[240:243],v11,10240
cv v184,v112,v113
mm v[132:135],a[212:215],a[116:119],v[132:135]
v_exp_f32 v114, v114
mm v[132:135],a[208:211],a[104:107],v[132:135]
lq a[244:247],v11,10752
cv v175,v150,v151
mm v[128:131],a[208:211],a[100:103],0
v_exp_f32 v115, v115
mm v[128:131],a[212:215],a[112:115],v[128:131]
lq a[248:251],v11,14336
cv v185,v114,v115
mm v[128:131],a[216:219],a[124:127],v[128:131]
v_exp_f32 v116, v116
mm v[128:131],a[220:223],a[136:139],v[128:131]
lq a[252:255],v11,14848
s_waitcnt vmcnt(3)
mm v[124:127],a[220:223],a[132:135],0
v_exp_f32 v117, v117
mm v[124:127],a[216:219],a[120:123],v[124:127]
buffer_load_dwordx4 v6, s[12:15], s45 offen offset:1024 nt lds
tr a[192:193],v12,16384
mm v[124:127],a[212:215],a[108:111],v[124:127]
v_exp_f32 v118, v118
mm v[124:127],a[208:211],a[96:99],v[124:127]
s_waitcnt lgkmcnt(5)
tr a[194:195],v12,18432
mm v[136:139],a[224:227],a[96:99],0
v_exp_f32 v119, v119
mm v[136:139],a[228:231],a[108:111],v[136:139]
tr a[196:197],v12,24576
cv v188,v116,v117
mm v[136:139],a[232:235],a[120:123],v[136:139]
v_exp_f32 v120, v120
mm v[136:139],a[236:239],a[132:135],v[136:139]
tr a[198:199],v12,26624
cv v189,v118,v119
mm v[140:143],a[236:239],a[136:139],0
v_exp_f32 v121, v121
mm v[140:143],a[232:235],a[124:127],v[140:143]
tr a[200:201],v13,16384
cv v192,v120,v121
mm v[140:143],a[228:231],a[112:115],v[140:143]
v_exp_f32 v122, v122
mm v[140:143],a[224:227],a[100:103],v[140:143]
tr a[202:203],v13,18432
mm v[144:147],a[224:227],a[104:107],0
v_exp_f32 v123, v123
mm v[144:147],a[228:231],a[116:119],v[144:147]
tr a[204:205],v13,24576
s_waitcnt vmcnt(3)
mm v[144:147],a[232:235],a[128:131],v[144:147]
v_exp_f32 v132, v132
mm v[144:147],a[236:239],a[140:143],v[144:147]
s_waitcnt lgkmcnt(7)
tr a[206:207],v13,26624
mm v[156:159],a[252:255],a[140:143],0
v_exp_f32 v133, v133
mm v[156:159],a[248:251],a[128:131],v[156:159]
buffer_load_dwordx4 v7, s[12:15], s45 offen offset:2048 nt lds
tr a[208:209],v12,16896
mm v[156:159],a[244:247],a[116:119],v[156:159]
v_exp_f32 v134, v134
mm v[156:159],a[240:243],a[104:107],v[156:159]
tr a[210:211],v12,18944
cv v193,v122,v123
mm v[152:155],a[240:243],a[100:103],0
v_exp_f32 v135, v135
mm v[152:155],a[244:247],a[112:115],v[152:155]
tr a[212:213],v12,25088
cv v194,v132,v133
mm v[152:155],a[248:251],a[124:127],v[152:155]
v_exp_f32 v128, v128
mm v[152:155],a[252:255],a[136:139],v[152:155]
tr a[214:215],v12,27136
cv v195,v134,v135
mm v[148:151],a[252:255],a[132:135],0
v_exp_f32 v129, v129
mm v[148:151],a[248:251],a[120:123],v[148:151]
tr a[216:217],v13,16896
cv v190,v128,v129
mm v[148:151],a[244:247],a[108:111],v[148:151]
v_exp_f32 v130, v130
mm v[148:151],a[240:243],a[96:99],v[148:151]
tr a[218:219],v13,18944
mm v[216:219],v[220:223],v[180:183],v[216:219]
v_exp_f32 v131, v131
mm v[216:219],v[220:223],v[168:171],v[216:219]
tr a[220:221],v13,25088
s_waitcnt vmcnt(3)
mm v[212:215],v[220:223],v[176:179],v[212:215]
v_exp_f32 v124, v124
mm v[212:215],v[220:223],v[164:167],v[212:215]
tr a[222:223],v13,27136
buffer_load_dwordx4 v8, s[12:15], s45 offen offset:3072 nt lds
mm v[208:211],v[220:223],v[172:175],v[208:211]
v_exp_f32 v125, v125
mm v[208:211],v[220:223],v[160:163],v[208:211]
s_waitcnt lgkmcnt(8)
tr a[224:225],v12,20480
mm v[16:19],a[192:195],v[160:163],v[16:19]
v_exp_f32 v126, v126
mm v[16:19],a[196:199],v[172:175],v[16:19]
tr a[226:227],v12,22528
cv v191,v130,v131
mm v[20:23],a[196:199],v[176:179],v[20:23]
v_exp_f32 v127, v127
mm v[20:23],a[192:195],v[164:167],v[20:23]
tr a[228:229],v12,28672
cv v186,v124,v125
mm v[24:27],a[192:195],v[168:171],v[24:27]
v_exp_f32 v136, v136
mm v[24:27],a[196:199],v[180:183],v[24:27]
tr a[230:231],v12,30720
cv v187,v126,v127
mm v[36:39],a[204:207],v[180:183],v[36:39]
v_exp_f32 v137, v137
mm v[36:39],a[200:203],v[168:171],v[36:39]
tr a[232:233],v13,20480
cv v196,v136,v137
mm v[32:35],a[200:203],v[164:167],v[32:35]
v_exp_f32 v138, v138
mm v[32:35],a[204:207],v[176:179],v[32:35]
tr a[234:235],v13,22528
s_add_u32 s45, s45, 16384
mm v[28:31],a[204:207],v[172:175],v[28:31]
v_exp_f32 v139, v139
mm v[28:31],a[200:203],v[160:163],v[28:31]
s_waitcnt lgkmcnt(6)
tr a[236:237],v13,28672
mm v[40:43],a[208:211],v[160:163],v[40:43]
tr a[238:239],v13,30720
s_add_u32 m0, s43, 65536
mm v[40:43],a[212:215],v[172:175],v[40:43]
s_waitcnt vmcnt(3)
tr a[240:241],v12,20992
mm v[44:47],a[212:215],v[176:179],v[44:47]
buffer_load_dwordx4 v5, s[8:11], s45 offen offset:0 nt lds
tr a[242:243],v12,23040
mm v[44:47],a[208:211],v[164:167],v[44:47]
tr a[244:245],v12,29184
L_pg18:
s_cbranch_execz L_tret2
cv v197,v138,v139
mm v[48:51],a[208:211],v[168:171],v[48:51]
v_exp_f32 v140, v140
mm v[48:51],a[212:215],v[180:183],v[48:51]
tr a[246:247],v12,31232
mm v[60:63],a[220:223],v[180:183],v[60:63]
v_exp_f32 v141, v141
mm v[60:63],a[216:219],v[168:171],v[60:63]
v_exp_f32 v142, v142
mm v[56:59],a[216:219],v[164:167],v[56:59]
v_exp_f32 v143, v143
mm v[56:59],a[220:223],v[176:179],v[56:59]
tr a[248:249],v13,20992
cv v200,v140,v141
mm v[52:55],a[220:223],v[172:175],v[52:55]
v_exp_f32 v144, v144
mm v[52:55],a[216:219],v[160:163],v[52:55]
s_waitcnt lgkmcnt(5)
tr a[250:251],v13,23040
mm v[64:67],a[224:227],v[160:163],v[64:67]
v_exp_f32 v145, v145
mm v[64:67],a[228:231],v[172:175],v[64:67]
tr a[252:253],v13,29184
s_waitcnt vmcnt(3)
mm v[68:71],a[228:231],v[176:179],v[68:71]
v_exp_f32 v146, v146
mm v[68:71],a[224:227],v[164:167],v[68:71]
tr a[254:255],v13,31232
buffer_load_dwordx4 v6, s[8:11], s45 offen offset:1024 nt lds
mm v[72:75],a[224:227],v[168:171],v[72:75]
v_exp_f32 v147, v147
mm v[72:75],a[228:231],v[180:183],v[72:75]
cv v201,v142,v143
v_add_u32 v11, 4294836224, v11
mm v[84:87],a[236:239],v[180:183],v[84:87]
v_exp_f32 v156, v156
mm v[84:87],a[232:235],v[168:171],v[84:87]
cv v204,v144,v145
cv v205,v146,v147
mm v[80:83],a[232:235],v[164:167],v[80:83]
v_exp_f32 v157, v157
mm v[80:83],a[236:239],v[176:179],v[80:83]
cv v206,v156,v157
mm v[76:79],a[236:239],v[172:175],v[76:79]
v_exp_f32 v158, v158
mm v[76:79],a[232:235],v[160:163],v[76:79]
s_waitcnt lgkmcnt(0)
mm v[88:91],a[240:243],v[160:163],v[88:91]
s_barrier
v_exp_f32 v159, v159
mm v[88:91],a[244:247],v[172:175],v[88:91]
lq a[192:195],v11,0
cv v207,v158,v159
mm v[92:95],a[244:247],v[176:179],v[92:95]
v_exp_f32 v152, v152
mm v[92:95],a[240:243],v[164:167],v[92:95]
lq a[196:199],v11,512
s_waitcnt vmcnt(3)
mm v[96:99],a[240:243],v[168:171],v[96:99]
lq a[200:203],v11,4096
buffer_load_dwordx4 v7, s[8:11], s45 offen offset:2048 nt lds
mm v[96:99],a[244:247],v[180:183],v[96:99]
lq a[204:207],v11,4608
mm v[108:111],a[252:255],v[180:183],v[108:111]
v_exp_f32 v153, v153
mm v[108:111],a[248:251],v[168:171],v[108:111]
v_exp_f32 v154, v154
mm v[104:107],a[248:251],v[164:167],v[104:107]
v_exp_f32 v155, v155
mm v[104:107],a[252:255],v[176:179],v[104:107]
lq a[208:211],v11,2048
cv v202,v152,v153
mm v[100:103],a[252:255],v[172:175],v[100:103]
lq a[212:215],v11,2560
cv v203,v154,v155
mm v[100:103],a[248:251],v[160:163],v[100:103]
s_waitcnt lgkmcnt(2)
mm v[112:115],a[192:195],a[144:147],0
v_exp_f32 v148, v148
mm v[112:115],a[196:199],a[156:159],v[112:115]
lq a[216:219],v11,6144
mm v[112:115],a[200:203],a[168:171],v[112:115]
v_exp_f32 v149, v149
mm v[112:115],a[204:207],a[180:183],v[112:115]
lq a[220:223],v11,6656
cv v198,v148,v149
mm v[116:119],a[204:207],a[184:187],0
v_exp_f32 v150, v150
mm v[116:119],a[200:203],a[172:175],v[116:119]
lq a[224:227],v11,8192
mm v[116:119],a[196:199],a[160:163],v[116:119]
v_exp_f32 v151, v151
mm v[116:119],a[192:195],a[148:151],v[116:119]
s_waitcnt vmcnt(3)
lq a[228:231],v11,8704
mm v[120:123],a[192:195],a[152:155],0
v_exp_f32 v112, v112
mm v[120:123],a[196:199],a[164:167],v[120:123]
buffer_load_dwordx4 v8, s[8:11], s45 offen offset:3072 nt lds
lq a[232:235],v11,12288
mm v[120:123],a[200:203],a[176:179],v[120:123]
v_exp_f32 v113, v113
mm v[120:123],a[204:207],a[188:191],v[120:123]
s_waitcnt lgkmcnt(3)
lq a[236:239],v11,12800
mm v[132:135],a[220:223],a[188:191],0
v_exp_f32 v114, v114
mm v[132:135],a[216:219],a[176:179],v[132:135]
lq a[240:243],v11,10240
v_add_u32 v12, 98304, v12
mm v[132:135],a[212:215],a[164:167],v[132:135]
v_exp_f32 v115, v115
mm v[132:135],a[208:211],a[152:155],v[132:135]
lq a[244:247],v11,10752
v_add_u32 v13, 98304, v13
mm v[128:131],a[208:211],a[148:151],0
v_exp_f32 v116, v116
mm v[128:131],a[212:215],a[160:163],v[128:131]
lq a[248:251],v11,14336
cv v160,v112,v113
mm v[128:131],a[216:219],a[172:175],v[128:131]
v_exp_f32 v117, v117
mm v[128:131],a[220:223],a[184:187],v[128:131]
lq a[252:255],v11,14848
cv v161,v114,v115
mm v[124:127],a[220:223],a[180:183],0
v_exp_f32 v118, v118
mm v[124:127],a[216:219],a[168:171],v[124:127]
s_add_u32 m0, s44, 65536
s_waitcnt vmcnt(3)
mm v[124:127],a[212:215],a[156:159],v[124:127]
v_exp_f32 v119, v119
mm v[124:127],a[208:211],a[144:147],v[124:127]
s_waitcnt lgkmcnt(4)
tr a[192:193],v12,16384
mm v[136:139],a[224:227],a[144:147],0
v_exp_f32 v120, v120
mm v[136:139],a[228:231],a[156:159],v[136:139]
buffer_load_dwordx4 v5, s[12:15], s45 offen offset:0 nt lds
tr a[194:195],v12,18432
mm v[136:139],a[232:235],a[168:171],v[136:139]
v_exp_f32 v121, v121
mm v[136:139],a[236:239],a[180:183],v[136:139]
tr a[196:197],v12,24576
cv v164,v116,v117
mm v[140:143],a[236:239],a[184:187],0
v_exp_f32 v122, v122
mm v[140:143],a[232:235],a[172:175],v[140:143]
tr a[198:199],v12,26624
cv v165,v118,v119
mm v[140:143],a[228:231],a[160:163],v[140:143]
v_exp_f32 v123, v123
mm v[140:143],a[224:227],a[148:151],v[140:143]
tr a[200:201],v13,16384
cv v199,v150,v151
mm v[144:147],a[224:227],a[152:155],0
v_exp_f32 v132, v132
mm v[144:147],a[228:231],a[164:167],v[144:147]
tr a[202:203],v13,18432
cv v168,v120,v121
mm v[144:147],a[232:235],a[176:179],v[144:147]
v_exp_f32 v133, v133
mm v[144:147],a[236:239],a[188:191],v[144:147]
s_waitcnt lgkmcnt(6)
tr a[204:205],v13,24576
mm v[156:159],a[252:255],a[188:191],0
tr a[206:207],v13,26624
s_waitcnt vmcnt(3)
mm v[156:159],a[248:251],a[176:179],v[156:159]
tr a[208:209],v12,16896
buffer_load_dwordx4 v6, s[12:15], s45 offen offset:1024 nt lds
mm v[156:159],a[244:247],a[164:167],v[156:159]
v_exp_f32 v134, v134
mm v[156:159],a[240:243],a[152:155],v[156:159]
tr a[210:211],v12,18944
cv v169,v122,v123
mm v[152:155],a[240:243],a[148:151],0
v_exp_f32 v135, v135
mm v[152:155],a[244:247],a[160:163],v[152:155]
tr a[212:213],v12,25088
cv v170,v132,v133
mm v[152:155],a[248:251],a[172:175],v[152:155]
v_exp_f32 v128, v128
mm v[152:155],a[252:255],a[184:187],v[152:155]
tr a[214:215],v12,27136
cv v171,v134,v135
mm v[148:151],a[252:255],a[180:183],0
v_exp_f32 v129, v129
mm v[148:151],a[248:251],a[168:171],v[148:151]
tr a[216:217],v13,16896
cv v166,v128,v129
mm v[148:151],a[244:247],a[156:159],v[148:151]
v_exp_f32 v130, v130
mm v[148:151],a[240:243],a[144:147],v[148:151]
tr a[218:219],v13,18944
mm v[216:219],v[220:223],v[204:207],v[216:219]
v_exp_f32 v131, v131
mm v[216:219],v[220:223],v[192:195],v[216:219]
tr a[220:221],v13,25088
cv v167,v130,v131
mm v[212:215],v[220:223],v[200:203],v[212:215]
v_exp_f32 v124, v124
mm v[212:215],v[220:223],v[188:191],v[212:215]
tr a[222:223],v13,27136
s_waitcnt vmcnt(3)
mm v[208:211],v[220:223],v[196:199],v[208:211]
v_exp_f32 v125, v125
mm v[208:211],v[220:223],v[184:187],v[208:211]
s_waitcnt lgkmcnt(8)
tr a[224:225],v12,20480
mm v[16:19],a[192:195],v[184:187],v[16:19]
v_exp_f32 v126, v126
mm v[16:19],a[196:199],v[196:199],v[16:19]
buffer_load_dwordx4 v7, s[12:15], s45 offen offset:2048 nt lds
tr a[226:227],v12,22528
mm v[20:23],a[196:199],v[200:203],v[20:23]
v_exp_f32 v127, v127
mm v[20:23],a[192:195],v[188:191],v[20:23]
tr a[228:229],v12,28672
cv v162,v124,v125
mm v[24:27],a[192:195],v[192:195],v[24:27]
v_exp_f32 v136, v136
mm v[24:27],a[196:199],v[204:207],v[24:27]
tr a[230:231],v12,30720
cv v163,v126,v127
mm v[36:39],a[204:207],v[204:207],v[36:39]
v_exp_f32 v137, v137
mm v[36:39],a[200:203],v[192:195],v[36:39]
tr a[232:233],v13,20480
cv v172,v136,v137
mm v[32:35],a[200:203],v[188:191],v[32:35]
v_exp_f32 v138, v138
mm v[32:35],a[204:207],v[200:203],v[32:35]
tr a[234:235],v13,22528
mm v[28:31],a[204:207],v[196:199],v[28:31]
v_exp_f32 v139, v139
mm v[28:31],a[200:203],v[184:187],v[28:31]
s_waitcnt lgkmcnt(6)
tr a[236:237],v13,28672
mm v[40:43],a[208:211],v[184:187],v[40:43]
tr a[238:239],v13,30720
s_waitcnt vmcnt(3)
mm v[40:43],a[212:215],v[196:199],v[40:43]
tr a[240:241],v12,20992
buffer_load_dwordx4 v8, s[12:15], s45 offen offset:3072 nt lds
mm v[44:47],a[212:215],v[200:203],v[44:47]
v_exp_f32 v140, v140
mm v[44:47],a[208:211],v[188:191],v[44:47]
tr a[242:243],v12,23040
cv v173,v138,v139
mm v[48:51],a[208:211],v[192:195],v[48:51]
v_exp_f32 v141, v141
mm v[48:51],a[212:215],v[204:207],v[48:51]
tr a[244:245],v12,29184
cv v176,v140,v141
mm v[60:63],a[220:223],v[204:207],v[60:63]
v_exp_f32 v142, v142
mm v[60:63],a[216:219],v[192:195],v[60:63]
tr a[246:247],v12,31232
mm v[56:59],a[216:219],v[188:191],v[56:59]
v_exp_f32 v143, v143
mm v[56:59],a[220:223],v[200:203],v[56:59]
tr a[248:249],v13,20992
cv v177,v142,v143
mm v[52:55],a[220:223],v[196:199],v[52:55]
v_exp_f32 v144, v144
mm v[52:55],a[216:219],v[184:187],v[52:55]
s_waitcnt lgkmcnt(5)
tr a[250:251],v13,23040
mm v[64:67],a[224:227],v[184:187],v[64:67]
v_exp_f32 v145, v145
mm v[64:67],a[228:231],v[196:199],v[64:67]
tr a[252:253],v13,29184
v_add_u32 v11, 65536, v11
mm v[68:71],a[228:231],v[200:203],v[68:71]
v_exp_f32 v146, v146
mm v[68:71],a[224:227],v[188:191],v[68:71]
tr a[254:255],v13,31232
s_add_u32 s45, s45, 16384
mm v[72:75],a[224:227],v[192:195],v[72:75]
v_exp_f32 v147, v147
mm v[72:75],a[228:231],v[204:207],v[72:75]
s_add_u32 m0, s43, 98304
s_waitcnt vmcnt(3)
mm v[84:87],a[236:239],v[204:207],v[84:87]
v_exp_f32 v156, v156
mm v[84:87],a[232:235],v[192:195],v[84:87]
buffer_load_dwordx4 v5, s[8:11], s45 offen offset:0 nt lds
cv v180,v144,v145
mm v[80:83],a[232:235],v[188:191],v[80:83]
v_exp_f32 v157, v157
mm v[80:83],a[236:239],v[200:203],v[80:83]
cv v181,v146,v147
mm v[76:79],a[236:239],v[196:199],v[76:79]
v_exp_f32 v158, v158
mm v[76:79],a[232:235],v[184:187],v[76:79]
s_waitcnt lgkmcnt(0)
cv v182,v156,v157
mm v[88:91],a[240:243],v[184:187],v[88:91]
s_barrier
v_exp_f32 v159, v159
mm v[88:91],a[244:247],v[196:199],v[88:91]
lq a[192:195],v11,0
cv v183,v158,v159
mm v[92:95],a[244:247],v[200:203],v[92:95]
v_exp_f32 v152, v152
mm v[92:95],a[240:243],v[188:191],v[92:95]
lq a[196:199],v11,512
mm v[96:99],a[240:243],v[192:195],v[96:99]
lq a[200:203],v11,4096
mm v[96:99],a[244:247],v[204:207],v[96:99]
lq a[204:207],v11,4608
mm v[108:111],a[252:255],v[204:207],v[108:111]
v_exp_f32 v153, v153
mm v[108:111],a[248:251],v[192:195],v[108:111]
v_exp_f32 v154, v154
mm v[104:107],a[248:251],v[188:191],v[104:107]
v_exp_f32 v155, v155
mm v[104:107],a[252:255],v[200:203],v[104:107]
lq a[208:211],v11,2048
s_waitcnt vmcnt(3)
v_rcp_f32 v240, v208
v_rcp_f32 v241, v212
v_rcp_f32 v242, v216
v_med3_f32 v248, v208, s57, v243
v_med3_f32 v249, v212, s57, v243
v_med3_f32 v250, v216, s57, v243
v_cmp_neq_f32 s[92:93], v248, v208
v_cmp_neq_f32 s[94:95], v249, v212
v_cmp_neq_f32 s[96:97], v250, v216
mm v[100:103],a[252:255],v[196:199],v[100:103]
lq a[212:215],v11,2560
cv v178,v152,v153
mm v[100:103],a[248:251],v[184:187],v[100:103]
s_waitcnt lgkmcnt(2)
cv v179,v154,v155
buffer_load_dwordx4 v6, s[8:11], s45 offen offset:1024 nt lds
s_nop 1
s_or_b64 s[92:93], s[92:93], s[94:95]
s_or_b64 s[92:93], s[92:93], s[96:97]
s_cbranch_scc1 L_slow2
L_back2:
v_pk_mul_f32 v[16:17], v[16:17], v[240:241] op_sel:[0,0] op_sel_hi:[1,0]
v_pk_mul_f32 v[18:19], v[18:19], v[240:241] op_sel:[0,0] op_sel_hi:[1,0]
v_pk_mul_f32 v[28:29], v[28:29], v[240:241] op_sel:[0,0] op_sel_hi:[1,0]
v_pk_mul_f32 v[30:31], v[30:31], v[240:241] op_sel:[0,0] op_sel_hi:[1,0]
cv v16,v16,v17
cv v17,v18,v19
cv v28,v28,v29
cv v29,v30,v31
v_accvgpr_write_b32 a96, v16
v_accvgpr_write_b32 a97, v17
v_accvgpr_write_b32 a98, v28
v_accvgpr_write_b32 a99, v29
v_pk_mul_f32 v[20:21], v[20:21], v[240:241] op_sel:[0,1] op_sel_hi:[1,1]
v_pk_mul_f32 v[22:23], v[22:23], v[240:241] op_sel:[0,1] op_sel_hi:[1,1]
v_pk_mul_f32 v[32:33], v[32:33], v[240:241] op_sel:[0,1] op_sel_hi:[1,1]
v_pk_mul_f32 v[34:35], v[34:35], v[240:241] op_sel:[0,1] op_sel_hi:[1,1]
cv v20,v20,v21
cv v21,v22,v23
cv v32,v32,v33
cv v33,v34,v35
v_accvgpr_write_b32 a100, v20
v_accvgpr_write_b32 a101, v21
v_accvgpr_write_b32 a102, v32
v_accvgpr_write_b32 a103, v33
v_pk_mul_f32 v[24:25], v[24:25], v[242:243] op_sel:[0,0] op_sel_hi:[1,0]
v_pk_mul_f32 v[26:27], v[26:27], v[242:243] op_sel:[0,0] op_sel_hi:[1,0]
v_pk_mul_f32 v[36:37], v[36:37], v[242:243] op_sel:[0,0] op_sel_hi:[1,0]
v_pk_mul_f32 v[38:39], v[38:39], v[242:243] op_sel:[0,0] op_sel_hi:[1,0]
cv v24,v24,v25
cv v25,v26,v27
cv v36,v36,v37
cv v37,v38,v39
s_waitcnt vmcnt(3)
v_accvgpr_write_b32 a104, v24
v_accvgpr_write_b32 a105, v25
v_accvgpr_write_b32 a106, v36
buffer_load_dwordx4 v7, s[8:11], s45 offen offset:2048 nt lds
v_accvgpr_write_b32 a107, v37
v_pk_mul_f32 v[40:41], v[40:41], v[240:241] op_sel:[0,0] op_sel_hi:[1,0]
v_pk_mul_f32 v[42:43], v[42:43], v[240:241] op_sel:[0,0] op_sel_hi:[1,0]
v_pk_mul_f32 v[52:53], v[52:53], v[240:241] op_sel:[0,0] op_sel_hi:[1,0]
v_pk_mul_f32 v[54:55], v[54:55], v[240:241] op_sel:[0,0] op_sel_hi:[1,0]
cv v40,v40,v41
cv v41,v42,v43
cv v52,v52,v53
cv v53,v54,v55
v_accvgpr_write_b32 a108, v40
v_accvgpr_write_b32 a109, v41
v_accvgpr_write_b32 a110, v52
v_accvgpr_write_b32 a111, v53
v_pk_mul_f32 v[44:45], v[44:45], v[240:241] op_sel:[0,1] op_sel_hi:[1,1]
v_pk_mul_f32 v[46:47], v[46:47], v[240:241] op_sel:[0,1] op_sel_hi:[1,1]
v_pk_mul_f32 v[56:57], v[56:57], v[240:241] op_sel:[0,1] op_sel_hi:[1,1]
v_pk_mul_f32 v[58:59], v[58:59], v[240:241] op_sel:[0,1] op_sel_hi:[1,1]
cv v44,v44,v45
cv v45,v46,v47
cv v56,v56,v57
cv v57,v58,v59
v_accvgpr_write_b32 a112, v44
v_accvgpr_write_b32 a113, v45
v_accvgpr_write_b32 a114, v56
v_accvgpr_write_b32 a115, v57
v_pk_mul_f32 v[48:49], v[48:49], v[242:243] op_sel:[0,0] op_sel_hi:[1,0]
v_pk_mul_f32 v[50:51], v[50:51], v[242:243] op_sel:[0,0] op_sel_hi:[1,0]
v_pk_mul_f32 v[60:61], v[60:61], v[242:243] op_sel:[0,0] op_sel_hi:[1,0]
v_pk_mul_f32 v[62:63], v[62:63], v[242:243] op_sel:[0,0] op_sel_hi:[1,0]
cv v48,v48,v49
cv v49,v50,v51
cv v60,v60,v61
cv v61,v62,v63
v_accvgpr_write_b32 a116, v48
v_accvgpr_write_b32 a117, v49
v_accvgpr_write_b32 a118, v60
v_accvgpr_write_b32 a119, v61
v_pk_mul_f32 v[64:65], v[64:65], v[240:241] op_sel:[0,0] op_sel_hi:[1,0]
v_pk_mul_f32 v[66:67], v[66:67], v[240:241] op_sel:[0,0] op_sel_hi:[1,0]
v_pk_mul_f32 v[76:77], v[76:77], v[240:241] op_sel:[0,0] op_sel_hi:[1,0]
v_pk_mul_f32 v[78:79], v[78:79], v[240:241] op_sel:[0,0] op_sel_hi:[1,0]
cv v64,v64,v65
cv v65,v66,v67
cv v76,v76,v77
cv v77,v78,v79
v_accvgpr_write_b32 a120, v64
v_accvgpr_write_b32 a121, v65
s_waitcnt vmcnt(3)
v_accvgpr_write_b32 a122, v76
v_accvgpr_write_b32 a123, v77
v_pk_mul_f32 v[68:69], v[68:69], v[240:241] op_sel:[0,1] op_sel_hi:[1,1]
buffer_load_dwordx4 v8, s[8:11], s45 offen offset:3072 nt lds
v_pk_mul_f32 v[70:71], v[70:71], v[240:241] op_sel:[0,1] op_sel_hi:[1,1]
v_pk_mul_f32 v[80:81], v[80:81], v[240:241] op_sel:[0,1] op_sel_hi:[1,1]
v_pk_mul_f32 v[82:83], v[82:83], v[240:241] op_sel:[0,1] op_sel_hi:[1,1]
cv v68,v68,v69
cv v69,v70,v71
cv v80,v80,v81
cv v81,v82,v83
v_accvgpr_write_b32 a124, v68
v_accvgpr_write_b32 a125, v69
v_accvgpr_write_b32 a126, v80
v_accvgpr_write_b32 a127, v81
v_pk_mul_f32 v[72:73], v[72:73], v[242:243] op_sel:[0,0] op_sel_hi:[1,0]
v_pk_mul_f32 v[74:75], v[74:75], v[242:243] op_sel:[0,0] op_sel_hi:[1,0]
v_pk_mul_f32 v[84:85], v[84:85], v[242:243] op_sel:[0,0] op_sel_hi:[1,0]
v_pk_mul_f32 v[86:87], v[86:87], v[242:243] op_sel:[0,0] op_sel_hi:[1,0]
cv v72,v72,v73
cv v73,v74,v75
cv v84,v84,v85
cv v85,v86,v87
v_accvgpr_write_b32 a128, v72
v_accvgpr_write_b32 a129, v73
v_accvgpr_write_b32 a130, v84
v_accvgpr_write_b32 a131, v85
v_pk_mul_f32 v[88:89], v[88:89], v[240:241] op_sel:[0,0] op_sel_hi:[1,0]
v_pk_mul_f32 v[90:91], v[90:91], v[240:241] op_sel:[0,0] op_sel_hi:[1,0]
v_pk_mul_f32 v[100:101], v[100:101], v[240:241] op_sel:[0,0] op_sel_hi:[1,0]
v_pk_mul_f32 v[102:103], v[102:103], v[240:241] op_sel:[0,0] op_sel_hi:[1,0]
cv v88,v88,v89
cv v89,v90,v91
cv v100,v100,v101
cv v101,v102,v103
v_accvgpr_write_b32 a132, v88
v_accvgpr_write_b32 a133, v89
v_accvgpr_write_b32 a134, v100
v_accvgpr_write_b32 a135, v101
v_pk_mul_f32 v[92:93], v[92:93], v[240:241] op_sel:[0,1] op_sel_hi:[1,1]
v_pk_mul_f32 v[94:95], v[94:95], v[240:241] op_sel:[0,1] op_sel_hi:[1,1]
v_pk_mul_f32 v[104:105], v[104:105], v[240:241] op_sel:[0,1] op_sel_hi:[1,1]
v_pk_mul_f32 v[106:107], v[106:107], v[240:241] op_sel:[0,1] op_sel_hi:[1,1]
cv v92,v92,v93
cv v93,v94,v95
cv v104,v104,v105
cv v105,v106,v107
v_accvgpr_write_b32 a136, v92
v_accvgpr_write_b32 a137, v93
s_waitcnt vmcnt(3)
s_add_u32 m0, s44, 98304
v_accvgpr_write_b32 a138, v104
v_accvgpr_write_b32 a139, v105
buffer_load_dwordx4 v5, s[12:15], s45 offen offset:0 nt lds
v_pk_mul_f32 v[96:97], v[96:97], v[242:243] op_sel:[0,0] op_sel_hi:[1,0]
v_pk_mul_f32 v[98:99], v[98:99], v[242:243] op_sel:[0,0] op_sel_hi:[1,0]
v_pk_mul_f32 v[108:109], v[108:109], v[242:243] op_sel:[0,0] op_sel_hi:[1,0]
v_pk_mul_f32 v[110:111], v[110:111], v[242:243] op_sel:[0,0] op_sel_hi:[1,0]
cv v96,v96,v97
cv v97,v98,v99
cv v108,v108,v109
cv v109,v110,v111
v_accvgpr_write_b32 a140, v96
v_accvgpr_write_b32 a141, v97
v_accvgpr_write_b32 a142, v108
v_accvgpr_write_b32 a143, v109
s_mov_b64 exec, 0
s_cmp_eq_u32 s42, 1
s_cbranch_scc1 L_pg20
s_cmp_eq_u32 s42, 2
s_cbranch_scc1 L_pg21
s_cmp_eq_u32 s42, 3
s_cbranch_scc1 L_pg22
s_branch L_pg19
L_tret3:
s_mov_b64 exec, -1
s_nop 0
L_mk_b24:
mm v[112:115],a[192:195],a[144:147],0
v_exp_f32 v148, v148
mm v[112:115],a[196:199],a[156:159],v[112:115]
lq a[216:219],v11,6144
mm v[112:115],a[200:203],a[168:171],v[112:115]
v_exp_f32 v149, v149
mm v[112:115],a[204:207],a[180:183],v[112:115]
lq a[220:223],v11,6656
cv v174,v148,v149
mm v[116:119],a[204:207],a[184:187],0
v_exp_f32 v150, v150
mm v[116:119],a[200:203],a[172:175],v[116:119]
lq a[224:227],v11,8192
mm v[116:119],a[196:199],a[160:163],v[116:119]
v_exp_f32 v151, v151
mm v[116:119],a[192:195],a[148:151],v[116:119]
lq a[228:231],v11,8704
cv v175,v150,v151
mm v[120:123],a[192:195],a[152:155],0
v_exp_f32 v112, v112
mm v[120:123],a[196:199],a[164:167],v[120:123]
lq a[232:235],v11,12288
v_add_u32 v12, 4294836224, v12
mm v[120:123],a[200:203],a[176:179],v[120:123]
v_exp_f32 v113, v113
mm v[120:123],a[204:207],a[188:191],v[120:123]
s_waitcnt lgkmcnt(3)
lq a[236:239],v11,12800
mm v[132:135],a[220:223],a[188:191],0
v_exp_f32 v114, v114
mm v[132:135],a[216:219],a[176:179],v[132:135]
s_waitcnt vmcnt(3)
buffer_load_dwordx4 v6, s[12:15], s45 offen offset:1024 nt lds
mm v[132:135],a[212:215],a[164:167],v[132:135]
v_exp_f32 v115, v115
mm v[132:135],a[208:211],a[152:155],v[132:135]
lq a[240:243],v11,10240
v_add_u32 v13, 4294836224, v13
mm v[128:131],a[208:211],a[148:151],0
v_exp_f32 v116, v116
mm v[128:131],a[212:215],a[160:163],v[128:131]
lq a[244:247],v11,10752
cv v184,v112,v113
mm v[128:131],a[216:219],a[172:175],v[128:131]
v_exp_f32 v117, v117
mm v[128:131],a[220:223],a[184:187],v[128:131]
lq a[248:251],v11,14336
cv v185,v114,v115
mm v[124:127],a[220:223],a[180:183],0
lq a[252:255],v11,14848
cv v188,v116,v117
mm v[124:127],a[216:219],a[168:171],v[124:127]
tr a[192:193],v12,16384
mm v[124:127],a[212:215],a[156:159],v[124:127]
v_exp_f32 v118, v118
mm v[124:127],a[208:211],a[144:147],v[124:127]
s_waitcnt lgkmcnt(5)
tr a[194:195],v12,18432
mm v[136:139],a[224:227],a[144:147],0
v_exp_f32 v119, v119
mm v[136:139],a[228:231],a[156:159],v[136:139]
tr a[196:197],v12,24576
s_waitcnt vmcnt(3)
mm v[136:139],a[232:235],a[168:171],v[136:139]
v_exp_f32 v120, v120
mm v[136:139],a[236:239],a[180:183],v[136:139]
buffer_load_dwordx4 v7, s[12:15], s45 offen offset:2048 nt lds
tr a[198:199],v12,26624
mm v[140:143],a[236:239],a[184:187],0
v_exp_f32 v121, v121
mm v[140:143],a[232:235],a[172:175],v[140:143]
L_pg19:
s_cbranch_execz L_pg23
tr a[200:201],v13,16384
cv v189,v118,v119
mm v[140:143],a[228:231],a[160:163],v[140:143]
v_exp_f32 v122, v122
mm v[140:143],a[224:227],a[148:151],v[140:143]
tr a[202:203],v13,18432
cv v192,v120,v121
mm v[144:147],a[224:227],a[152:155],0
v_exp_f32 v123, v123
mm v[144:147],a[228:231],a[164:167],v[144:147]
tr a[204:205],v13,24576
cv v193,v122,v123
mm v[144:147],a[232:235],a[176:179],v[144:147]
v_exp_f32 v132, v132
mm v[144:147],a[236:239],a[188:191],v[144:147]
s_waitcnt lgkmcnt(7)
tr a[206:207],v13,26624
mm v[156:159],a[252:255],a[188:191],0
v_exp_f32 v133, v133
mm v[156:159],a[248:251],a[176:179],v[156:159]
tr a[208:209],v12,16896
cv v194,v132,v133
mm v[156:159],a[244:247],a[164:167],v[156:159]
v_exp_f32 v134, v134
mm v[156:159],a[240:243],a[152:155],v[156:159]
tr a[210:211],v12,18944
mm v[152:155],a[240:243],a[148:151],0
v_exp_f32 v135, v135
mm v[152:155],a[244:247],a[160:163],v[152:155]
tr a[212:213],v12,25088
s_waitcnt vmcnt(3)
mm v[152:155],a[248:251],a[172:175],v[152:155]
v_exp_f32 v128, v128
mm v[152:155],a[252:255],a[184:187],v[152:155]
buffer_load_dwordx4 v8, s[12:15], s45 offen offset:3072 nt lds
tr a[214:215],v12,27136
mm v[148:151],a[252:255],a[180:183],0
v_exp_f32 v129, v129
mm v[148:151],a[248:251],a[168:171],v[148:151]
tr a[216:217],v13,16896
cv v195,v134,v135
mm v[148:151],a[244:247],a[156:159],v[148:151]
v_exp_f32 v130, v130
mm v[148:151],a[240:243],a[144:147],v[148:151]
tr a[218:219],v13,18944
cv v190,v128,v129
mm v[216:219],v[220:223],v[180:183],0
v_exp_f32 v131, v131
mm v[216:219],v[220:223],v[168:171],v[216:219]
tr a[220:221],v13,25088
cv v191,v130,v131
mm v[212:215],v[220:223],v[176:179],0
v_exp_f32 v124, v124
mm v[212:215],v[220:223],v[164:167],v[212:215]
tr a[222:223],v13,27136
mm v[208:211],v[220:223],v[172:175],0
v_exp_f32 v125, v125
mm v[208:211],v[220:223],v[160:163],v[208:211]
s_waitcnt lgkmcnt(8)
tr a[224:225],v12,20480
mm v[16:19],a[192:195],v[160:163],0
v_exp_f32 v126, v126
mm v[16:19],a[196:199],v[172:175],v[16:19]
tr a[226:227],v12,22528
s_add_u32 s45, s45, 16384
mm v[20:23],a[196:199],v[176:179],0
v_exp_f32 v127, v127
mm v[20:23],a[192:195],v[164:167],v[20:23]
tr a[228:229],v12,28672
s_add_u32 m0, s43, 32768
mm v[24:27],a[192:195],v[168:171],0
v_exp_f32 v136, v136
mm v[24:27],a[196:199],v[180:183],v[24:27]
s_waitcnt vmcnt(3)
buffer_load_dwordx4 v5, s[8:11], s45 offen offset:0 nt lds
mm v[36:39],a[204:207],v[180:183],0
v_exp_f32 v137, v137
mm v[36:39],a[200:203],v[168:171],v[36:39]
tr a[230:231],v12,30720
cv v186,v124,v125
mm v[32:35],a[200:203],v[164:167],0
v_exp_f32 v138, v138
mm v[32:35],a[204:207],v[176:179],v[32:35]
tr a[232:233],v13,20480
cv v187,v126,v127
mm v[28:31],a[204:207],v[172:175],0
v_exp_f32 v139, v139
mm v[28:31],a[200:203],v[160:163],v[28:31]
s_waitcnt lgkmcnt(5)
tr a[234:235],v13,22528
mm v[40:43],a[208:211],v[160:163],0
tr a[236:237],v13,28672
tr a[238:239],v13,30720
mm v[40:43],a[212:215],v[172:175],v[40:43]
tr a[240:241],v12,20992
cv v196,v136,v137
mm v[44:47],a[212:215],v[176:179],0
v_exp_f32 v140, v140
mm v[44:47],a[208:211],v[164:167],v[44:47]
tr a[242:243],v12,23040
cv v197,v138,v139
mm v[48:51],a[208:211],v[168:171],0
v_exp_f32 v141, v141
mm v[48:51],a[212:215],v[180:183],v[48:51]
tr a[244:245],v12,29184
s_waitcnt vmcnt(3)
mm v[60:63],a[220:223],v[180:183],0
v_exp_f32 v142, v142
mm v[60:63],a[216:219],v[168:171],v[60:63]
tr a[246:247],v12,31232
buffer_load_dwordx4 v6, s[8:11], s45 offen offset:1024 nt lds
mm v[56:59],a[216:219],v[164:167],0
v_exp_f32 v143, v143
mm v[56:59],a[220:223],v[176:179],v[56:59]
tr a[248:249],v13,20992
cv v200,v140,v141
mm v[52:55],a[220:223],v[172:175],0
v_exp_f32 v144, v144
mm v[52:55],a[216:219],v[160:163],v[52:55]
s_waitcnt lgkmcnt(5)
tr a[250:251],v13,23040
mm v[64:67],a[224:227],v[160:163],0
v_exp_f32 v145, v145
mm v[64:67],a[228:231],v[172:175],v[64:67]
tr a[252:253],v13,29184
cv v201,v142,v143
mm v[68:71],a[228:231],v[176:179],0
v_exp_f32 v146, v146
mm v[68:71],a[224:227],v[164:167],v[68:71]
tr a[254:255],v13,31232
cv v204,v144,v145
mm v[72:75],a[224:227],v[168:171],0
v_exp_f32 v147, v147
mm v[72:75],a[228:231],v[180:183],v[72:75]
cv v205,v146,v147
mm v[84:87],a[236:239],v[180:183],0
v_exp_f32 v156, v156
mm v[84:87],a[232:235],v[168:171],v[84:87]
s_waitcnt vmcnt(3)
mm v[80:83],a[232:235],v[164:167],0
v_exp_f32 v157, v157
mm v[80:83],a[236:239],v[176:179],v[80:83]
buffer_load_dwordx4 v7, s[8:11], s45 offen offset:2048 nt lds
mm v[76:79],a[236:239],v[172:175],0
v_exp_f32 v158, v158
mm v[76:79],a[232:235],v[160:163],v[76:79]
s_waitcnt lgkmcnt(0)
cv v206,v156,v157
mm v[88:91],a[240:243],v[160:163],0
s_barrier
v_exp_f32 v159, v159
mm v[88:91],a[244:247],v[172:175],v[88:91]
lq a[192:195],v11,32768
cv v207,v158,v159
mm v[92:95],a[244:247],v[176:179],0
v_exp_f32 v152, v152
mm v[92:95],a[240:243],v[164:167],v[92:95]
lq a[196:199],v11,33280
mm v[96:99],a[240:243],v[168:171],0
lq a[200:203],v11,36864
mm v[96:99],a[244:247],v[180:183],v[96:99]
lq a[204:207],v11,37376
mm v[108:111],a[252:255],v[180:183],0
v_exp_f32 v153, v153
mm v[108:111],a[248:251],v[168:171],v[108:111]
v_exp_f32 v154, v154
mm v[104:107],a[248:251],v[164:167],0
v_exp_f32 v155, v155
mm v[104:107],a[252:255],v[176:179],v[104:107]
lq a[208:211],v11,34816
cv v202,v152,v153
mm v[100:103],a[252:255],v[172:175],0
lq a[212:215],v11,35328
cv v203,v154,v155
mm v[100:103],a[248:251],v[160:163],v[100:103]
s_waitcnt lgkmcnt(2)
s_waitcnt vmcnt(3)
buffer_load_dwordx4 v8, s[8:11], s45 offen offset:3072 nt lds
mm v[112:115],a[192:195],a[144:147],0
v_exp_f32 v148, v148
mm v[112:115],a[196:199],a[156:159],v[112:115]
lq a[216:219],v11,38912
mm v[112:115],a[200:203],a[168:171],v[112:115]
v_exp_f32 v149, v149
mm v[112:115],a[204:207],a[180:183],v[112:115]
lq a[220:223],v11,39424
cv v198,v148,v149
mm v[116:119],a[204:207],a[184:187],0
v_exp_f32 v150, v150
mm v[116:119],a[200:203],a[172:175],v[116:119]
lq a[224:227],v11,40960
mm v[116:119],a[196:199],a[160:163],v[116:119]
v_exp_f32 v151, v151
mm v[116:119],a[192:195],a[148:151],v[116:119]
lq a[228:231],v11,41472
cv v199,v150,v151
mm v[120:123],a[192:195],a[152:155],0
v_exp_f32 v112, v112
mm v[120:123],a[196:199],a[164:167],v[120:123]
lq a[232:235],v11,45056
v_add_u32 v12, 65536, v12
mm v[120:123],a[200:203],a[176:179],v[120:123]
v_exp_f32 v113, v113
mm v[120:123],a[204:207],a[188:191],v[120:123]
s_waitcnt lgkmcnt(3)
lq a[236:239],v11,45568
mm v[132:135],a[220:223],a[188:191],0
v_exp_f32 v114, v114
mm v[132:135],a[216:219],a[176:179],v[132:135]
s_add_u32 m0, s44, 32768
s_waitcnt vmcnt(3)
mm v[132:135],a[212:215],a[164:167],v[132:135]
v_exp_f32 v115, v115
mm v[132:135],a[208:211],a[152:155],v[132:135]
lq a[240:243],v11,43008
buffer_load_dwordx4 v5, s[12:15], s45 offen offset:0 nt lds
mm v[128:131],a[208:211],a[148:151],0
v_exp_f32 v116, v116
mm v[128:131],a[212:215],a[160:163],v[128:131]
lq a[244:247],v11,43520
v_add_u32 v13, 65536, v13
mm v[128:131],a[216:219],a[172:175],v[128:131]
v_exp_f32 v117, v117
mm v[128:131],a[220:223],a[184:187],v[128:131]
lq a[248:251],v11,47104
cv v160,v112,v113
mm v[124:127],a[220:223],a[180:183],0
lq a[252:255],v11,47616
cv v161,v114,v115
mm v[124:127],a[216:219],a[168:171],v[124:127]
tr a[192:193],v12,16384
cv v164,v116,v117
mm v[124:127],a[212:215],a[156:159],v[124:127]
v_exp_f32 v118, v118
mm v[124:127],a[208:211],a[144:147],v[124:127]
s_waitcnt lgkmcnt(5)
tr a[194:195],v12,18432
mm v[136:139],a[224:227],a[144:147],0
v_exp_f32 v119, v119
mm v[136:139],a[228:231],a[156:159],v[136:139]
tr a[196:197],v12,24576
cv v165,v118,v119
mm v[136:139],a[232:235],a[168:171],v[136:139]
v_exp_f32 v120, v120
mm v[136:139],a[236:239],a[180:183],v[136:139]
tr a[198:199],v12,26624
mm v[140:143],a[236:239],a[184:187],0
v_exp_f32 v121, v121
mm v[140:143],a[232:235],a[172:175],v[140:143]
s_waitcnt vmcnt(3)
tr a[200:201],v13,16384
mm v[140:143],a[228:231],a[160:163],v[140:143]
v_exp_f32 v122, v122
mm v[140:143],a[224:227],a[148:151],v[140:143]
buffer_load_dwordx4 v6, s[12:15], s45 offen offset:1024 nt lds
tr a[202:203],v13,18432
mm v[144:147],a[224:227],a[152:155],0
v_exp_f32 v123, v123
mm v[144:147],a[228:231],a[164:167],v[144:147]
tr a[204:205],v13,24576
cv v168,v120,v121
mm v[144:147],a[232:235],a[176:179],v[144:147]
v_exp_f32 v132, v132
mm v[144:147],a[236:239],a[188:191],v[144:147]
s_waitcnt lgkmcnt(7)
tr a[206:207],v13,26624
mm v[156:159],a[252:255],a[188:191],0
v_exp_f32 v133, v133
mm v[156:159],a[248:251],a[176:179],v[156:159]
tr a[208:209],v12,16896
cv v169,v122,v123
mm v[156:159],a[244:247],a[164:167],v[156:159]
v_exp_f32 v134, v134
mm v[156:159],a[240:243],a[152:155],v[156:159]
tr a[210:211],v12,18944
cv v170,v132,v133
mm v[152:155],a[240:243],a[148:151],0
v_exp_f32 v135, v135
mm v[152:155],a[244:247],a[160:163],v[152:155]
tr a[212:213],v12,25088
cv v171,v134,v135
mm v[152:155],a[248:251],a[172:175],v[152:155]
v_exp_f32 v128, v128
mm v[152:155],a[252:255],a[184:187],v[152:155]
tr a[214:215],v12,27136
s_waitcnt vmcnt(3)
mm v[148:151],a[252:255],a[180:183],0
v_exp_f32 v129, v129
mm v[148:151],a[248:251],a[168:171],v[148:151]
tr a[216:217],v13,16896
buffer_load_dwordx4 v7, s[12:15], s45 offen offset:2048 nt lds
mm v[148:151],a[244:247],a[156:159],v[148:151]
v_exp_f32 v130, v130
mm v[148:151],a[240:243],a[144:147],v[148:151]
tr a[218:219],v13,18944
cv v166,v128,v129
mm v[216:219],v[220:223],v[204:207],v[216:219]
v_exp_f32 v131, v131
mm v[216:219],v[220:223],v[192:195],v[216:219]
tr a[220:221],v13,25088
cv v167,v130,v131
mm v[212:215],v[220:223],v[200:203],v[212:215]
v_exp_f32 v124, v124
mm v[212:215],v[220:223],v[188:191],v[212:215]
tr a[222:223],v13,27136
mm v[208:211],v[220:223],v[196:199],v[208:211]
v_exp_f32 v125, v125
mm v[208:211],v[220:223],v[184:187],v[208:211]
s_waitcnt lgkmcnt(8)
tr a[224:225],v12,20480
mm v[16:19],a[192:195],v[184:187],v[16:19]
v_exp_f32 v126, v126
mm v[16:19],a[196:199],v[196:199],v[16:19]
tr a[226:227],v12,22528
cv v162,v124,v125
mm v[20:23],a[196:199],v[200:203],v[20:23]
v_exp_f32 v127, v127
mm v[20:23],a[192:195],v[188:191],v[20:23]
tr a[228:229],v12,28672
cv v163,v126,v127
mm v[24:27],a[192:195],v[192:195],v[24:27]
v_exp_f32 v136, v136
mm v[24:27],a[196:199],v[204:207],v[24:27]
tr a[230:231],v12,30720
s_waitcnt vmcnt(3)
mm v[36:39],a[204:207],v[204:207],v[36:39]
v_exp_f32 v137, v137
mm v[36:39],a[200:203],v[192:195],v[36:39]
tr a[232:233],v13,20480
buffer_load_dwordx4 v8, s[12:15], s45 offen offset:3072 nt lds
mm v[32:35],a[200:203],v[188:191],v[32:35]
v_exp_f32 v138, v138
mm v[32:35],a[204:207],v[200:203],v[32:35]
tr a[234:235],v13,22528
cv v172,v136,v137
mm v[28:31],a[204:207],v[196:199],v[28:31]
v_exp_f32 v139, v139
mm v[28:31],a[200:203],v[184:187],v[28:31]
s_waitcnt lgkmcnt(6)
tr a[236:237],v13,28672
mm v[40:43],a[208:211],v[184:187],v[40:43]
tr a[238:239],v13,30720
cv v173,v138,v139
mm v[40:43],a[212:215],v[196:199],v[40:43]
tr a[240:241],v12,20992
mm v[44:47],a[212:215],v[200:203],v[44:47]
v_exp_f32 v140, v140
mm v[44:47],a[208:211],v[188:191],v[44:47]
tr a[242:243],v12,23040
mm v[48:51],a[208:211],v[192:195],v[48:51]
v_exp_f32 v141, v141
mm v[48:51],a[212:215],v[204:207],v[48:51]
tr a[244:245],v12,29184
cv v176,v140,v141
mm v[60:63],a[220:223],v[204:207],v[60:63]
v_exp_f32 v142, v142
mm v[60:63],a[216:219],v[192:195],v[60:63]
tr a[246:247],v12,31232
s_add_u32 s45, s45, 16384
mm v[56:59],a[216:219],v[188:191],v[56:59]
v_exp_f32 v143, v143
mm v[56:59],a[220:223],v[200:203],v[56:59]
tr a[248:249],v13,20992
s_add_u32 m0, s43, 131072
mm v[52:55],a[220:223],v[196:199],v[52:55]
v_exp_f32 v144, v144
mm v[52:55],a[216:219],v[184:187],v[52:55]
s_waitcnt lgkmcnt(5)
tr a[250:251],v13,23040
s_waitcnt vmcnt(3)
mm v[64:67],a[224:227],v[184:187],v[64:67]
buffer_load_dwordx4 v5, s[8:11], s45 offen offset:0 nt lds
tr a[252:253],v13,29184
mm v[64:67],a[228:231],v[196:199],v[64:67]
tr a[254:255],v13,31232
cv v177,v142,v143
mm v[68:71],a[228:231],v[200:203],v[68:71]
v_exp_f32 v145, v145
mm v[68:71],a[224:227],v[188:191],v[68:71]
v_exp_f32 v146, v146
mm v[72:75],a[224:227],v[192:195],v[72:75]
v_exp_f32 v147, v147
mm v[72:75],a[228:231],v[204:207],v[72:75]
v_add_u32 v11, 4294934528, v11
cv v180,v144,v145
mm v[84:87],a[236:239],v[204:207],v[84:87]
v_exp_f32 v156, v156
mm v[84:87],a[232:235],v[192:195],v[84:87]
cv v181,v146,v147
mm v[80:83],a[232:235],v[188:191],v[80:83]
v_exp_f32 v157, v157
mm v[80:83],a[236:239],v[200:203],v[80:83]
cv v182,v156,v157
mm v[76:79],a[236:239],v[196:199],v[76:79]
v_exp_f32 v158, v158
mm v[76:79],a[232:235],v[184:187],v[76:79]
s_waitcnt lgkmcnt(0)
s_waitcnt vmcnt(3)
mm v[88:91],a[240:243],v[184:187],v[88:91]
s_barrier
buffer_load_dwordx4 v6, s[8:11], s45 offen offset:1024 nt lds
v_exp_f32 v159, v159
mm v[88:91],a[244:247],v[196:199],v[88:91]
lq a[192:195],v11,0
cv v183,v158,v159
mm v[92:95],a[244:247],v[200:203],v[92:95]
v_exp_f32 v152, v152
mm v[92:95],a[240:243],v[188:191],v[92:95]
lq a[196:199],v11,512
mm v[96:99],a[240:243],v[192:195],v[96:99]
lq a[200:203],v11,4096
mm v[96:99],a[244:247],v[204:207],v[96:99]
lq a[204:207],v11,4608
mm v[108:111],a[252:255],v[204:207],v[108:111]
v_exp_f32 v153, v153
mm v[108:111],a[248:251],v[192:195],v[108:111]
v_exp_f32 v154, v154
mm v[104:107],a[248:251],v[188:191],v[104:107]
v_exp_f32 v155, v155
mm v[104:107],a[252:255],v[200:203],v[104:107]
lq a[208:211],v11,2048
cv v178,v152,v153
mm v[100:103],a[252:255],v[196:199],v[100:103]
lq a[212:215],v11,2560
cv v179,v154,v155
mm v[100:103],a[248:251],v[184:187],v[100:103]
s_waitcnt lgkmcnt(2)
mm v[112:115],a[192:195],a[144:147],0
v_exp_f32 v148, v148
mm v[112:115],a[196:199],a[156:159],v[112:115]
lq a[216:219],v11,6144
s_waitcnt vmcnt(3)
mm v[112:115],a[200:203],a[168:171],v[112:115]
v_exp_f32 v149, v149
mm v[112:115],a[204:207],a[180:183],v[112:115]
lq a[220:223],v11,6656
buffer_load_dwordx4 v7, s[8:11], s45 offen offset:2048 nt lds
mm v[116:119],a[204:207],a[184:187],0
v_exp_f32 v150, v150
mm v[116:119],a[200:203],a[172:175],v[116:119]
lq a[224:227],v11,8192
cv v174,v148,v149
mm v[116:119],a[196:199],a[160:163],v[116:119]
v_exp_f32 v151, v151
mm v[116:119],a[192:195],a[148:151],v[116:119]
lq a[228:231],v11,8704
cv v175,v150,v151
mm v[120:123],a[192:195],a[152:155],0
v_exp_f32 v112, v112
mm v[120:123],a[196:199],a[164:167],v[120:123]
lq a[232:235],v11,12288
mm v[120:123],a[200:203],a[176:179],v[120:123]
v_exp_f32 v113, v113
mm v[120:123],a[204:207],a[188:191],v[120:123]
s_waitcnt lgkmcnt(3)
lq a[236:239],v11,12800
mm v[132:135],a[220:223],a[188:191],0
v_exp_f32 v114, v114
mm v[132:135],a[216:219],a[176:179],v[132:135]
lq a[240:243],v11,10240
cv v184,v112,v113
mm v[132:135],a[212:215],a[164:167],v[132:135]
v_exp_f32 v115, v115
mm v[132:135],a[208:211],a[152:155],v[132:135]
lq a[244:247],v11,10752
cv v185,v114,v115
mm v[128:131],a[208:211],a[148:151],0
v_exp_f32 v116, v116
mm v[128:131],a[212:215],a[160:163],v[128:131]
lq a[248:251],v11,14336
s_waitcnt vmcnt(3)
mm v[128:131],a[216:219],a[172:175],v[128:131]
v_exp_f32 v117, v117
mm v[128:131],a[220:223],a[184:187],v[128:131]
lq a[252:255],v11,14848
buffer_load_dwordx4 v8, s[8:11], s45 offen offset:3072 nt lds
mm v[124:127],a[220:223],a[180:183],0
v_exp_f32 v118, v118
mm v[124:127],a[216:219],a[168:171],v[124:127]
tr a[192:193],v12,49152
cv v188,v116,v117
mm v[124:127],a[212:215],a[156:159],v[124:127]
v_exp_f32 v119, v119
mm v[124:127],a[208:211],a[144:147],v[124:127]
s_waitcnt lgkmcnt(5)
tr a[194:195],v12,51200
mm v[136:139],a[224:227],a[144:147],0
v_exp_f32 v120, v120
mm v[136:139],a[228:231],a[156:159],v[136:139]
tr a[196:197],v12,57344
cv v189,v118,v119
mm v[136:139],a[232:235],a[168:171],v[136:139]
v_exp_f32 v121, v121
mm v[136:139],a[236:239],a[180:183],v[136:139]
tr a[198:199],v12,59392
cv v192,v120,v121
mm v[140:143],a[236:239],a[184:187],0
v_exp_f32 v122, v122
mm v[140:143],a[232:235],a[172:175],v[140:143]
tr a[200:201],v13,49152
mm v[140:143],a[228:231],a[160:163],v[140:143]
v_exp_f32 v123, v123
mm v[140:143],a[224:227],a[148:151],v[140:143]
tr a[202:203],v13,51200
s_add_u32 m0, s44, 131072
mm v[144:147],a[224:227],a[152:155],0
v_exp_f32 v132, v132
mm v[144:147],a[228:231],a[164:167],v[144:147]
s_waitcnt vmcnt(3)
tr a[204:205],v13,57344
mm v[144:147],a[232:235],a[176:179],v[144:147]
v_exp_f32 v133, v133
mm v[144:147],a[236:239],a[188:191],v[144:147]
s_waitcnt lgkmcnt(7)
tr a[206:207],v13,59392
mm v[156:159],a[252:255],a[188:191],0
buffer_load_dwordx4 v5, s[12:15], s45 offen offset:0 nt lds
tr a[208:209],v12,49664
mm v[156:159],a[248:251],a[176:179],v[156:159]
tr a[210:211],v12,51712
cv v193,v122,v123
mm v[156:159],a[244:247],a[164:167],v[156:159]
v_exp_f32 v134, v134
mm v[156:159],a[240:243],a[152:155],v[156:159]
tr a[212:213],v12,57856
cv v194,v132,v133
mm v[152:155],a[240:243],a[148:151],0
v_exp_f32 v135, v135
mm v[152:155],a[244:247],a[160:163],v[152:155]
tr a[214:215],v12,59904
cv v195,v134,v135
mm v[152:155],a[248:251],a[172:175],v[152:155]
v_exp_f32 v128, v128
mm v[152:155],a[252:255],a[184:187],v[152:155]
tr a[216:217],v13,49664
mm v[148:151],a[252:255],a[180:183],0
v_exp_f32 v129, v129
mm v[148:151],a[248:251],a[168:171],v[148:151]
tr a[218:219],v13,51712
cv v190,v128,v129
mm v[148:151],a[244:247],a[156:159],v[148:151]
v_exp_f32 v130, v130
mm v[148:151],a[240:243],a[144:147],v[148:151]
s_waitcnt vmcnt(3)
tr a[220:221],v13,57856
mm v[216:219],v[220:223],v[180:183],v[216:219]
v_exp_f32 v131, v131
mm v[216:219],v[220:223],v[168:171],v[216:219]
tr a[222:223],v13,59904
buffer_load_dwordx4 v6, s[12:15], s45 offen offset:1024 nt lds
mm v[212:215],v[220:223],v[176:179],v[212:215]
v_exp_f32 v124, v124
mm v[212:215],v[220:223],v[164:167],v[212:215]
tr a[224:225],v12,53248
cv v191,v130,v131
mm v[208:211],v[220:223],v[172:175],v[208:211]
v_exp_f32 v125, v125
mm v[208:211],v[220:223],v[160:163],v[208:211]
s_waitcnt lgkmcnt(9)
tr a[226:227],v12,55296
mm v[16:19],a[192:195],v[160:163],v[16:19]
v_exp_f32 v126, v126
mm v[16:19],a[196:199],v[172:175],v[16:19]
tr a[228:229],v12,61440
cv v186,v124,v125
mm v[20:23],a[196:199],v[176:179],v[20:23]
v_exp_f32 v127, v127
mm v[20:23],a[192:195],v[164:167],v[20:23]
tr a[230:231],v12,63488
cv v187,v126,v127
mm v[24:27],a[192:195],v[168:171],v[24:27]
v_exp_f32 v136, v136
mm v[24:27],a[196:199],v[180:183],v[24:27]
tr a[232:233],v13,53248
mm v[36:39],a[204:207],v[180:183],v[36:39]
v_exp_f32 v137, v137
mm v[36:39],a[200:203],v[168:171],v[36:39]
tr a[234:235],v13,55296
s_waitcnt vmcnt(3)
mm v[32:35],a[200:203],v[164:167],v[32:35]
v_exp_f32 v138, v138
mm v[32:35],a[204:207],v[176:179],v[32:35]
tr a[236:237],v13,61440
buffer_load_dwordx4 v7, s[12:15], s45 offen offset:2048 nt lds
mm v[28:31],a[204:207],v[172:175],v[28:31]
v_exp_f32 v139, v139
mm v[28:31],a[200:203],v[160:163],v[28:31]
L_pg20:
s_cbranch_execz L_pg24
s_waitcnt lgkmcnt(7)
tr a[238:239],v13,63488
mm v[40:43],a[208:211],v[160:163],v[40:43]
v_exp_f32 v140, v140
mm v[40:43],a[212:215],v[172:175],v[40:43]
tr a[240:241],v12,53760
cv v196,v136,v137
mm v[44:47],a[212:215],v[176:179],v[44:47]
v_exp_f32 v141, v141
mm v[44:47],a[208:211],v[164:167],v[44:47]
tr a[242:243],v12,55808
cv v197,v138,v139
mm v[48:51],a[208:211],v[168:171],v[48:51]
v_exp_f32 v142, v142
mm v[48:51],a[212:215],v[180:183],v[48:51]
tr a[244:245],v12,61952
cv v200,v140,v141
mm v[60:63],a[220:223],v[180:183],v[60:63]
v_exp_f32 v143, v143
mm v[60:63],a[216:219],v[168:171],v[60:63]
tr a[246:247],v12,64000
cv v201,v142,v143
mm v[56:59],a[216:219],v[164:167],v[56:59]
v_exp_f32 v144, v144
mm v[56:59],a[220:223],v[176:179],v[56:59]
tr a[248:249],v13,53760
mm v[52:55],a[220:223],v[172:175],v[52:55]
v_exp_f32 v145, v145
mm v[52:55],a[216:219],v[160:163],v[52:55]
s_waitcnt lgkmcnt(5)
tr a[250:251],v13,55808
mm v[64:67],a[224:227],v[160:163],v[64:67]
v_exp_f32 v146, v146
mm v[64:67],a[228:231],v[172:175],v[64:67]
tr a[252:253],v13,61952
s_waitcnt vmcnt(3)
mm v[68:71],a[228:231],v[176:179],v[68:71]
v_exp_f32 v147, v147
mm v[68:71],a[224:227],v[164:167],v[68:71]
tr a[254:255],v13,64000
buffer_load_dwordx4 v8, s[12:15], s45 offen offset:3072 nt lds
mm v[72:75],a[224:227],v[168:171],v[72:75]
v_exp_f32 v156, v156
mm v[72:75],a[228:231],v[180:183],v[72:75]
v_add_u32 v11, 98304, v11
cv v204,v144,v145
mm v[84:87],a[236:239],v[180:183],v[84:87]
v_exp_f32 v157, v157
mm v[84:87],a[232:235],v[168:171],v[84:87]
cv v205,v146,v147
cv v206,v156,v157
mm v[80:83],a[232:235],v[164:167],v[80:83]
v_exp_f32 v158, v158
mm v[80:83],a[236:239],v[176:179],v[80:83]
mm v[76:79],a[236:239],v[172:175],v[76:79]
v_exp_f32 v159, v159
mm v[76:79],a[232:235],v[160:163],v[76:79]
s_waitcnt lgkmcnt(0)
cv v207,v158,v159
mm v[88:91],a[240:243],v[160:163],v[88:91]
s_barrier
s_add_u32 s45, s45, 16384
mm v[88:91],a[244:247],v[172:175],v[88:91]
lq a[192:195],v11,0
s_add_u32 m0, s43, 0
mm v[92:95],a[244:247],v[176:179],v[92:95]
v_exp_f32 v152, v152
mm v[92:95],a[240:243],v[164:167],v[92:95]
lq a[196:199],v11,512
s_waitcnt vmcnt(3)
mm v[96:99],a[240:243],v[168:171],v[96:99]
lq a[200:203],v11,4096
buffer_load_dwordx4 v5, s[8:11], s45 offen offset:0 nt lds
mm v[96:99],a[244:247],v[180:183],v[96:99]
lq a[204:207],v11,4608
mm v[108:111],a[252:255],v[180:183],v[108:111]
v_exp_f32 v153, v153
mm v[108:111],a[248:251],v[168:171],v[108:111]
v_exp_f32 v154, v154
mm v[104:107],a[248:251],v[164:167],v[104:107]
v_exp_f32 v155, v155
mm v[104:107],a[252:255],v[176:179],v[104:107]
lq a[208:211],v11,2048
cv v202,v152,v153
mm v[100:103],a[252:255],v[172:175],v[100:103]
lq a[212:215],v11,2560
cv v203,v154,v155
mm v[100:103],a[248:251],v[160:163],v[100:103]
s_waitcnt lgkmcnt(2)
mm v[112:115],a[192:195],a[144:147],0
v_exp_f32 v148, v148
mm v[112:115],a[196:199],a[156:159],v[112:115]
lq a[216:219],v11,6144
mm v[112:115],a[200:203],a[168:171],v[112:115]
v_exp_f32 v149, v149
mm v[112:115],a[204:207],a[180:183],v[112:115]
lq a[220:223],v11,6656
cv v198,v148,v149
mm v[116:119],a[204:207],a[184:187],0
v_exp_f32 v150, v150
mm v[116:119],a[200:203],a[172:175],v[116:119]
s_waitcnt vmcnt(3)
lq a[224:227],v11,8192
mm v[116:119],a[196:199],a[160:163],v[116:119]
v_exp_f32 v151, v151
mm v[116:119],a[192:195],a[148:151],v[116:119]
buffer_load_dwordx4 v6, s[8:11], s45 offen offset:1024 nt lds
lq a[228:231],v11,8704
mm v[120:123],a[192:195],a[152:155],0
v_exp_f32 v112, v112
mm v[120:123],a[196:199],a[164:167],v[120:123]
lq a[232:235],v11,12288
v_add_u32 v12, 4294934528, v12
mm v[120:123],a[200:203],a[176:179],v[120:123]
v_exp_f32 v113, v113
mm v[120:123],a[204:207],a[188:191],v[120:123]
s_waitcnt lgkmcnt(3)
lq a[236:239],v11,12800
mm v[132:135],a[220:223],a[188:191],0
v_exp_f32 v114, v114
mm v[132:135],a[216:219],a[176:179],v[132:135]
lq a[240:243],v11,10240
v_add_u32 v13, 4294934528, v13
mm v[132:135],a[212:215],a[164:167],v[132:135]
v_exp_f32 v115, v115
mm v[132:135],a[208:211],a[152:155],v[132:135]
lq a[244:247],v11,10752
cv v160,v112,v113
mm v[128:131],a[208:211],a[148:151],0
v_exp_f32 v116, v116
mm v[128:131],a[212:215],a[160:163],v[128:131]
lq a[248:251],v11,14336
cv v161,v114,v115
mm v[128:131],a[216:219],a[172:175],v[128:131]
v_exp_f32 v117, v117
mm v[128:131],a[220:223],a[184:187],v[128:131]
lq a[252:255],v11,14848
s_waitcnt vmcnt(3)
mm v[124:127],a[220:223],a[180:183],0
v_exp_f32 v118, v118
mm v[124:127],a[216:219],a[168:171],v[124:127]
buffer_load_dwordx4 v7, s[8:11], s45 offen offset:2048 nt lds
tr a[192:193],v12,16384
mm v[124:127],a[212:215],a[156:159],v[124:127]
v_exp_f32 v119, v119
mm v[124:127],a[208:211],a[144:147],v[124:127]
s_waitcnt lgkmcnt(5)
tr a[194:195],v12,18432
mm v[136:139],a[224:227],a[144:147],0
v_exp_f32 v120, v120
mm v[136:139],a[228:231],a[156:159],v[136:139]
tr a[196:197],v12,24576
cv v164,v116,v117
mm v[136:139],a[232:235],a[168:171],v[136:139]
v_exp_f32 v121, v121
mm v[136:139],a[236:239],a[180:183],v[136:139]
tr a[198:199],v12,26624
cv v165,v118,v119
mm v[140:143],a[236:239],a[184:187],0
v_exp_f32 v122, v122
mm v[140:143],a[232:235],a[172:175],v[140:143]
tr a[200:201],v13,16384
cv v199,v150,v151
mm v[140:143],a[228:231],a[160:163],v[140:143]
v_exp_f32 v123, v123
mm v[140:143],a[224:227],a[148:151],v[140:143]
tr a[202:203],v13,18432
cv v168,v120,v121
mm v[144:147],a[224:227],a[152:155],0
v_exp_f32 v132, v132
mm v[144:147],a[228:231],a[164:167],v[144:147]
tr a[204:205],v13,24576
cv v169,v122,v123
mm v[144:147],a[232:235],a[176:179],v[144:147]
v_exp_f32 v133, v133
mm v[144:147],a[236:239],a[188:191],v[144:147]
s_waitcnt lgkmcnt(7)
tr a[206:207],v13,26624
mm v[156:159],a[252:255],a[188:191],0
v_exp_f32 v134, v134
mm v[156:159],a[248:251],a[176:179],v[156:159]
s_waitcnt vmcnt(3)
buffer_load_dwordx4 v8, s[8:11], s45 offen offset:3072 nt lds
mm v[156:159],a[244:247],a[164:167],v[156:159]
v_exp_f32 v135, v135
mm v[156:159],a[240:243],a[152:155],v[156:159]
tr a[208:209],v12,16896
cv v170,v132,v133
mm v[152:155],a[240:243],a[148:151],0
v_exp_f32 v128, v128
mm v[152:155],a[244:247],a[160:163],v[152:155]
tr a[210:211],v12,18944
cv v171,v134,v135
mm v[152:155],a[248:251],a[172:175],v[152:155]
v_exp_f32 v129, v129
mm v[152:155],a[252:255],a[184:187],v[152:155]
tr a[212:213],v12,25088
cv v166,v128,v129
mm v[148:151],a[252:255],a[180:183],0
v_exp_f32 v130, v130
mm v[148:151],a[248:251],a[168:171],v[148:151]
tr a[214:215],v12,27136
mm v[148:151],a[244:247],a[156:159],v[148:151]
v_exp_f32 v131, v131
mm v[148:151],a[240:243],a[144:147],v[148:151]
tr a[216:217],v13,16896
cv v167,v130,v131
mm v[216:219],v[220:223],v[204:207],v[216:219]
v_exp_f32 v124, v124
mm v[216:219],v[220:223],v[192:195],v[216:219]
tr a[218:219],v13,18944
s_add_u32 m0, s44, 0
mm v[212:215],v[220:223],v[200:203],v[212:215]
v_exp_f32 v125, v125
mm v[212:215],v[220:223],v[188:191],v[212:215]
tr a[220:221],v13,25088
tr a[222:223],v13,27136
mm v[208:211],v[220:223],v[196:199],v[208:211]
v_exp_f32 v126, v126
mm v[208:211],v[220:223],v[184:187],v[208:211]
s_waitcnt lgkmcnt(8)
s_waitcnt vmcnt(3)
mm v[16:19],a[192:195],v[184:187],v[16:19]
buffer_load_dwordx4 v5, s[12:15], s45 offen offset:0 nt lds
tr a[224:225],v12,20480
mm v[16:19],a[196:199],v[196:199],v[16:19]
tr a[226:227],v12,22528
cv v162,v124,v125
mm v[20:23],a[196:199],v[200:203],v[20:23]
v_exp_f32 v127, v127
mm v[20:23],a[192:195],v[188:191],v[20:23]
tr a[228:229],v12,28672
cv v163,v126,v127
mm v[24:27],a[192:195],v[192:195],v[24:27]
v_exp_f32 v136, v136
mm v[24:27],a[196:199],v[204:207],v[24:27]
tr a[230:231],v12,30720
mm v[36:39],a[204:207],v[204:207],v[36:39]
v_exp_f32 v137, v137
mm v[36:39],a[200:203],v[192:195],v[36:39]
tr a[232:233],v13,20480
cv v172,v136,v137
mm v[32:35],a[200:203],v[188:191],v[32:35]
v_exp_f32 v138, v138
mm v[32:35],a[204:207],v[200:203],v[32:35]
tr a[234:235],v13,22528
mm v[28:31],a[204:207],v[196:199],v[28:31]
v_exp_f32 v139, v139
mm v[28:31],a[200:203],v[184:187],v[28:31]
s_waitcnt lgkmcnt(6)
tr a[236:237],v13,28672
mm v[40:43],a[208:211],v[184:187],v[40:43]
tr a[238:239],v13,30720
s_waitcnt vmcnt(3)
mm v[40:43],a[212:215],v[196:199],v[40:43]
tr a[240:241],v12,20992
buffer_load_dwordx4 v6, s[12:15], s45 offen offset:1024 nt lds
mm v[44:47],a[212:215],v[200:203],v[44:47]
v_exp_f32 v140, v140
mm v[44:47],a[208:211],v[188:191],v[44:47]
tr a[242:243],v12,23040
cv v173,v138,v139
mm v[48:51],a[208:211],v[192:195],v[48:51]
v_exp_f32 v141, v141
mm v[48:51],a[212:215],v[204:207],v[48:51]
tr a[244:245],v12,29184
cv v176,v140,v141
mm v[60:63],a[220:223],v[204:207],v[60:63]
v_exp_f32 v142, v142
mm v[60:63],a[216:219],v[192:195],v[60:63]
tr a[246:247],v12,31232
mm v[56:59],a[216:219],v[188:191],v[56:59]
v_exp_f32 v143, v143
mm v[56:59],a[220:223],v[200:203],v[56:59]
tr a[248:249],v13,20992
cv v177,v142,v143
mm v[52:55],a[220:223],v[196:199],v[52:55]
v_exp_f32 v144, v144
mm v[52:55],a[216:219],v[184:187],v[52:55]
s_waitcnt lgkmcnt(5)
tr a[250:251],v13,23040
mm v[64:67],a[224:227],v[184:187],v[64:67]
v_exp_f32 v145, v145
mm v[64:67],a[228:231],v[196:199],v[64:67]
tr a[252:253],v13,29184
s_waitcnt vmcnt(3)
mm v[68:71],a[228:231],v[200:203],v[68:71]
v_exp_f32 v146, v146
mm v[68:71],a[224:227],v[188:191],v[68:71]
tr a[254:255],v13,31232
buffer_load_dwordx4 v7, s[12:15], s45 offen offset:2048 nt lds
mm v[72:75],a[224:227],v[192:195],v[72:75]
v_exp_f32 v147, v147
mm v[72:75],a[228:231],v[204:207],v[72:75]
v_add_u32 v11, 4294836224, v11
cv v180,v144,v145
mm v[84:87],a[236:239],v[204:207],v[84:87]
v_exp_f32 v156, v156
mm v[84:87],a[232:235],v[192:195],v[84:87]
cv v181,v146,v147
mm v[80:83],a[232:235],v[188:191],v[80:83]
v_exp_f32 v157, v157
mm v[80:83],a[236:239],v[200:203],v[80:83]
s_waitcnt vmcnt(3)
cv v182,v156,v157
mm v[76:79],a[236:239],v[196:199],v[76:79]
v_exp_f32 v158, v158
mm v[76:79],a[232:235],v[184:187],v[76:79]
s_waitcnt lgkmcnt(0)
mm v[88:91],a[240:243],v[184:187],v[88:91]
s_barrier
v_exp_f32 v159, v159
mm v[88:91],a[244:247],v[196:199],v[88:91]
lq a[192:195],v11,0
cv v183,v158,v159
mm v[92:95],a[244:247],v[200:203],v[92:95]
v_exp_f32 v152, v152
mm v[92:95],a[240:243],v[188:191],v[92:95]
lq a[196:199],v11,512
mm v[96:99],a[240:243],v[192:195],v[96:99]
lq a[200:203],v11,4096
mm v[96:99],a[244:247],v[204:207],v[96:99]
lq a[204:207],v11,4608
buffer_load_dwordx4 v8, s[12:15], s45 offen offset:3072 nt lds
mm v[108:111],a[252:255],v[204:207],v[108:111]
v_exp_f32 v153, v153
mm v[108:111],a[248:251],v[192:195],v[108:111]
v_exp_f32 v154, v154
mm v[104:107],a[248:251],v[188:191],v[104:107]
v_exp_f32 v155, v155
mm v[104:107],a[252:255],v[200:203],v[104:107]
lq a[208:211],v11,2048
cv v178,v152,v153
mm v[100:103],a[252:255],v[196:199],v[100:103]
lq a[212:215],v11,2560
cv v179,v154,v155
mm v[100:103],a[248:251],v[184:187],v[100:103]
s_waitcnt lgkmcnt(2)
s_add_u32 s50, s60, 0
s_add_u32 m0, s43, 32768
mm v[112:115],a[192:195],a[144:147],0
v_exp_f32 v148, v148
mm v[112:115],a[196:199],a[156:159],v[112:115]
lq a[216:219],v11,6144
buffer_load_dwordx4 v1, s[20:23], s50 offen offset:0 lds
mm v[112:115],a[200:203],a[168:171],v[112:115]
v_exp_f32 v149, v149
mm v[112:115],a[204:207],a[180:183],v[112:115]
lq a[220:223],v11,6656
buffer_load_dwordx4 v2, s[20:23], s50 offen offset:1024 lds
mm v[116:119],a[204:207],a[184:187],0
v_exp_f32 v150, v150
mm v[116:119],a[200:203],a[172:175],v[116:119]
buffer_load_dwordx4 v3, s[20:23], s50 offen offset:2048 lds
lq a[224:227],v11,8192
mm v[116:119],a[196:199],a[160:163],v[116:119]
v_exp_f32 v151, v151
mm v[116:119],a[192:195],a[148:151],v[116:119]
buffer_load_dwordx4 v4, s[20:23], s50 offen offset:3072 lds
s_add_u32 s45, s45, 16384
mm v[120:123],a[192:195],a[152:155],0
v_exp_f32 v112, v112
mm v[120:123],a[196:199],a[164:167],v[120:123]
lq a[228:231],v11,8704
s_add_u32 m0, s43, 65536
mm v[120:123],a[200:203],a[176:179],v[120:123]
v_exp_f32 v113, v113
mm v[120:123],a[204:207],a[188:191],v[120:123]
s_waitcnt lgkmcnt(2)
s_waitcnt vmcnt(7)
mm v[132:135],a[220:223],a[188:191],0
lq a[232:235],v11,12288
lq a[236:239],v11,12800
buffer_load_dwordx4 v5, s[8:11], s45 offen offset:0 nt lds
mm v[132:135],a[216:219],a[176:179],v[132:135]
lq a[240:243],v11,10240
v_add_u32 v12, 98304, v12
mm v[132:135],a[212:215],a[164:167],v[132:135]
v_exp_f32 v114, v114
mm v[132:135],a[208:211],a[152:155],v[132:135]
lq a[244:247],v11,10752
v_add_u32 v13, 98304, v13
mm v[128:131],a[208:211],a[148:151],0
v_exp_f32 v115, v115
mm v[128:131],a[212:215],a[160:163],v[128:131]
lq a[248:251],v11,14336
cv v184,v112,v113
mm v[128:131],a[216:219],a[172:175],v[128:131]
v_exp_f32 v116, v116
mm v[128:131],a[220:223],a[184:187],v[128:131]
lq a[252:255],v11,14848
cv v185,v114,v115
mm v[124:127],a[220:223],a[180:183],0
v_exp_f32 v117, v117
mm v[124:127],a[216:219],a[168:171],v[124:127]
tr a[192:193],v12,16384
cv v188,v116,v117
mm v[124:127],a[212:215],a[156:159],v[124:127]
v_exp_f32 v118, v118
mm v[124:127],a[208:211],a[144:147],v[124:127]
s_waitcnt lgkmcnt(5)
s_waitcnt vmcnt(7)
mm v[136:139],a[224:227],a[144:147],0
v_exp_f32 v119, v119
mm v[136:139],a[228:231],a[156:159],v[136:139]
tr a[194:195],v12,18432
buffer_load_dwordx4 v6, s[8:11], s45 offen offset:1024 nt lds
mm v[136:139],a[232:235],a[168:171],v[136:139]
v_exp_f32 v120, v120
mm v[136:139],a[236:239],a[180:183],v[136:139]
tr a[196:197],v12,24576
cv v189,v118,v119
mm v[140:143],a[236:239],a[184:187],0
v_exp_f32 v121, v121
mm v[140:143],a[232:235],a[172:175],v[140:143]
tr a[198:199],v12,26624
cv v174,v148,v149
mm v[140:143],a[228:231],a[160:163],v[140:143]
v_exp_f32 v122, v122
mm v[140:143],a[224:227],a[148:151],v[140:143]
tr a[200:201],v13,16384
cv v175,v150,v151
mm v[144:147],a[224:227],a[152:155],0
v_exp_f32 v123, v123
mm v[144:147],a[228:231],a[164:167],v[144:147]
tr a[202:203],v13,18432
cv v192,v120,v121
mm v[144:147],a[232:235],a[176:179],v[144:147]
v_exp_f32 v132, v132
mm v[144:147],a[236:239],a[188:191],v[144:147]
s_waitcnt lgkmcnt(6)
tr a[204:205],v13,24576
mm v[156:159],a[252:255],a[188:191],0
tr a[206:207],v13,26624
s_waitcnt vmcnt(7)
mm v[156:159],a[248:251],a[176:179],v[156:159]
tr a[208:209],v12,16896
buffer_load_dwordx4 v7, s[8:11], s45 offen offset:2048 nt lds
mm v[156:159],a[244:247],a[164:167],v[156:159]
v_exp_f32 v133, v133
mm v[156:159],a[240:243],a[152:155],v[156:159]
tr a[210:211],v12,18944
cv v193,v122,v123
mm v[152:155],a[240:243],a[148:151],0
v_exp_f32 v134, v134
mm v[152:155],a[244:247],a[160:163],v[152:155]
v_exp_f32 v135, v135
mm v[152:155],a[248:251],a[172:175],v[152:155]
v_exp_f32 v128, v128
mm v[152:155],a[252:255],a[184:187],v[152:155]
tr a[212:213],v12,25088
cv v194,v132,v133
mm v[148:151],a[252:255],a[180:183],0
v_exp_f32 v129, v129
mm v[148:151],a[248:251],a[168:171],v[148:151]
tr a[214:215],v12,27136
cv v195,v134,v135
mm v[148:151],a[244:247],a[156:159],v[148:151]
v_exp_f32 v130, v130
mm v[148:151],a[240:243],a[144:147],v[148:151]
tr a[216:217],v13,16896
cv v190,v128,v129
mm v[216:219],v[220:223],v[180:183],v[216:219]
v_exp_f32 v131, v131
mm v[216:219],v[220:223],v[168:171],v[216:219]
tr a[218:219],v13,18944
cv v191,v130,v131
mm v[212:215],v[220:223],v[176:179],v[212:215]
v_exp_f32 v124, v124
mm v[212:215],v[220:223],v[164:167],v[212:215]
tr a[220:221],v13,25088
tr a[222:223],v13,27136
mm v[208:211],v[220:223],v[172:175],v[208:211]
v_exp_f32 v125, v125
mm v[208:211],v[220:223],v[160:163],v[208:211]
s_waitcnt lgkmcnt(8)
s_waitcnt vmcnt(7)
mm v[16:19],a[192:195],v[160:163],v[16:19]
v_exp_f32 v126, v126
mm v[16:19],a[196:199],v[172:175],v[16:19]
tr a[224:225],v12,20480
buffer_load_dwordx4 v8, s[8:11], s45 offen offset:3072 nt lds
mm v[20:23],a[196:199],v[176:179],v[20:23]
v_exp_f32 v127, v127
mm v[20:23],a[192:195],v[164:167],v[20:23]
tr a[226:227],v12,22528
s_add_u32 s50, s60, 131072
mm v[24:27],a[192:195],v[168:171],v[24:27]
v_exp_f32 v136, v136
mm v[24:27],a[196:199],v[180:183],v[24:27]
tr a[228:229],v12,28672
s_add_u32 m0, s44, 32768
mm v[36:39],a[204:207],v[180:183],v[36:39]
v_exp_f32 v137, v137
mm v[36:39],a[200:203],v[168:171],v[36:39]
tr a[230:231],v12,30720
buffer_load_dwordx4 v1, s[20:23], s50 offen offset:0 lds
mm v[32:35],a[200:203],v[164:167],v[32:35]
v_exp_f32 v138, v138
mm v[32:35],a[204:207],v[176:179],v[32:35]
tr a[232:233],v13,20480
buffer_load_dwordx4 v2, s[20:23], s50 offen offset:1024 lds
mm v[28:31],a[204:207],v[172:175],v[28:31]
v_exp_f32 v139, v139
mm v[28:31],a[200:203],v[160:163],v[28:31]
s_waitcnt lgkmcnt(5)
tr a[234:235],v13,22528
buffer_load_dwordx4 v3, s[20:23], s50 offen offset:2048 lds
mm v[40:43],a[208:211],v[160:163],v[40:43]
tr a[236:237],v13,28672
tr a[238:239],v13,30720
mm v[40:43],a[212:215],v[172:175],v[40:43]
buffer_load_dwordx4 v4, s[20:23], s50 offen offset:3072 lds
tr a[240:241],v12,20992
mm v[44:47],a[212:215],v[176:179],v[44:47]
v_exp_f32 v140, v140
mm v[44:47],a[208:211],v[164:167],v[44:47]
tr a[242:243],v12,23040
s_add_u32 m0, s44, 65536
s_waitcnt vmcnt(7)
mm v[48:51],a[208:211],v[168:171],v[48:51]
buffer_load_dwordx4 v5, s[12:15], s45 offen offset:0 nt lds
cv v186,v124,v125
cv v187,v126,v127
mm v[48:51],a[212:215],v[180:183],v[48:51]
tr a[244:245],v12,29184
cv v196,v136,v137
mm v[60:63],a[220:223],v[180:183],v[60:63]
v_exp_f32 v141, v141
mm v[60:63],a[216:219],v[168:171],v[60:63]
tr a[246:247],v12,31232
cv v197,v138,v139
mm v[56:59],a[216:219],v[164:167],v[56:59]
v_exp_f32 v142, v142
v_exp_f32 v143, v143
mm v[56:59],a[220:223],v[176:179],v[56:59]
tr a[248:249],v13,20992
cv v200,v140,v141
mm v[52:55],a[220:223],v[172:175],v[52:55]
v_exp_f32 v144, v144
mm v[52:55],a[216:219],v[160:163],v[52:55]
s_waitcnt lgkmcnt(5)
tr a[250:251],v13,23040
mm v[64:67],a[224:227],v[160:163],v[64:67]
v_exp_f32 v145, v145
mm v[64:67],a[228:231],v[172:175],v[64:67]
tr a[252:253],v13,29184
s_waitcnt vmcnt(7)
mm v[68:71],a[228:231],v[176:179],v[68:71]
v_exp_f32 v146, v146
mm v[68:71],a[224:227],v[164:167],v[68:71]
tr a[254:255],v13,31232
buffer_load_dwordx4 v6, s[12:15], s45 offen offset:1024 nt lds
mm v[72:75],a[224:227],v[168:171],v[72:75]
v_exp_f32 v147, v147
mm v[72:75],a[228:231],v[180:183],v[72:75]
cv v201,v142,v143
v_add_u32 v11, 65536, v11
mm v[84:87],a[236:239],v[180:183],v[84:87]
v_exp_f32 v156, v156
mm v[84:87],a[232:235],v[168:171],v[84:87]
cv v204,v144,v145
cv v205,v146,v147
mm v[80:83],a[232:235],v[164:167],v[80:83]
v_exp_f32 v157, v157
mm v[80:83],a[236:239],v[176:179],v[80:83]
s_waitcnt vmcnt(6)
cv v206,v156,v157
mm v[76:79],a[236:239],v[172:175],v[76:79]
v_exp_f32 v158, v158
mm v[76:79],a[232:235],v[160:163],v[76:79]
s_waitcnt lgkmcnt(0)
mm v[88:91],a[240:243],v[160:163],v[88:91]
s_barrier
v_exp_f32 v159, v159
mm v[88:91],a[244:247],v[172:175],v[88:91]
lq a[192:195],v11,0
mm v[92:95],a[244:247],v[176:179],v[92:95]
v_exp_f32 v152, v152
mm v[92:95],a[240:243],v[164:167],v[92:95]
lq a[196:199],v11,512
buffer_load_dwordx4 v7, s[12:15], s45 offen offset:2048 nt lds
mm v[96:99],a[240:243],v[168:171],v[96:99]
lq a[200:203],v11,4096
cv v207,v158,v159
mm v[96:99],a[244:247],v[180:183],v[96:99]
L_pg21:
s_cbranch_execz L_pg25
lq a[204:207],v11,4608
mm v[108:111],a[252:255],v[180:183],v[108:111]
v_exp_f32 v153, v153
mm v[108:111],a[248:251],v[168:171],v[108:111]
v_exp_f32 v154, v154
mm v[104:107],a[248:251],v[164:167],v[104:107]
v_exp_f32 v155, v155
mm v[104:107],a[252:255],v[176:179],v[104:107]
lq a[208:211],v11,2048
cv v202,v152,v153
mm v[100:103],a[252:255],v[172:175],v[100:103]
lq a[212:215],v11,2560
cv v203,v154,v155
mm v[100:103],a[248:251],v[160:163],v[100:103]
s_waitcnt lgkmcnt(2)
mm v[112:115],a[192:195],a[144:147],0
v_exp_f32 v148, v148
mm v[112:115],a[196:199],a[156:159],v[112:115]
lq a[216:219],v11,6144
mm v[112:115],a[200:203],a[168:171],v[112:115]
v_exp_f32 v149, v149
mm v[112:115],a[204:207],a[180:183],v[112:115]
lq a[220:223],v11,6656
mm v[116:119],a[204:207],a[184:187],0
v_exp_f32 v150, v150
mm v[116:119],a[200:203],a[172:175],v[116:119]
buffer_load_dwordx4 v8, s[12:15], s45 offen offset:3072 nt lds
lq a[224:227],v11,8192
mm v[116:119],a[196:199],a[160:163],v[116:119]
v_exp_f32 v151, v151
mm v[116:119],a[192:195],a[148:151],v[116:119]
s_add_u32 s50, s60, 262144
s_add_u32 m0, s43, 131072
mm v[120:123],a[192:195],a[152:155],0
v_exp_f32 v112, v112
mm v[120:123],a[196:199],a[164:167],v[120:123]
lq a[228:231],v11,8704
buffer_load_dwordx4 v1, s[20:23], s50 offen offset:0 lds
mm v[120:123],a[200:203],a[176:179],v[120:123]
v_exp_f32 v113, v113
mm v[120:123],a[204:207],a[188:191],v[120:123]
s_waitcnt lgkmcnt(2)
lq a[232:235],v11,12288
mm v[132:135],a[220:223],a[188:191],0
lq a[236:239],v11,12800
buffer_load_dwordx4 v2, s[20:23], s50 offen offset:1024 lds
mm v[132:135],a[216:219],a[176:179],v[132:135]
buffer_load_dwordx4 v3, s[20:23], s50 offen offset:2048 lds
buffer_load_dwordx4 v4, s[20:23], s50 offen offset:3072 lds
mm v[132:135],a[212:215],a[164:167],v[132:135]
v_exp_f32 v114, v114
mm v[132:135],a[208:211],a[152:155],v[132:135]
s_add_u32 s45, s45, 16384
lq a[240:243],v11,10240
mm v[128:131],a[208:211],a[148:151],0
v_exp_f32 v115, v115
mm v[128:131],a[212:215],a[160:163],v[128:131]
s_add_u32 m0, s43, 98304
s_waitcnt vmcnt(7)
mm v[128:131],a[216:219],a[172:175],v[128:131]
v_exp_f32 v116, v116
mm v[128:131],a[220:223],a[184:187],v[128:131]
buffer_load_dwordx4 v5, s[8:11], s45 offen offset:0 nt lds
lq a[244:247],v11,10752
mm v[124:127],a[220:223],a[180:183],0
lq a[248:251],v11,14336
lq a[252:255],v11,14848
mm v[124:127],a[216:219],a[168:171],v[124:127]
v_add_u32 v12, 4294836224, v12
v_add_u32 v13, 4294836224, v13
mm v[124:127],a[212:215],a[156:159],v[124:127]
v_exp_f32 v117, v117
mm v[124:127],a[208:211],a[144:147],v[124:127]
s_waitcnt lgkmcnt(4)
tr a[192:193],v12,16384
mm v[136:139],a[224:227],a[144:147],0
v_exp_f32 v118, v118
mm v[136:139],a[228:231],a[156:159],v[136:139]
v_exp_f32 v119, v119
mm v[136:139],a[232:235],a[168:171],v[136:139]
v_exp_f32 v120, v120
mm v[136:139],a[236:239],a[180:183],v[136:139]
tr a[194:195],v12,18432
cv v160,v112,v113
mm v[140:143],a[236:239],a[184:187],0
v_exp_f32 v121, v121
mm v[140:143],a[232:235],a[172:175],v[140:143]
tr a[196:197],v12,24576
cv v161,v114,v115
mm v[140:143],a[228:231],a[160:163],v[140:143]
v_exp_f32 v122, v122
mm v[140:143],a[224:227],a[148:151],v[140:143]
tr a[198:199],v12,26624
s_waitcnt vmcnt(7)
mm v[144:147],a[224:227],a[152:155],0
buffer_load_dwordx4 v6, s[8:11], s45 offen offset:1024 nt lds
tr a[200:201],v13,16384
mm v[144:147],a[228:231],a[164:167],v[144:147]
v_exp_f32 v123, v123
mm v[144:147],a[232:235],a[176:179],v[144:147]
v_exp_f32 v132, v132
mm v[144:147],a[236:239],a[188:191],v[144:147]
s_waitcnt lgkmcnt(5)
tr a[202:203],v13,18432
mm v[156:159],a[252:255],a[188:191],0
tr a[204:205],v13,24576
tr a[206:207],v13,26624
mm v[156:159],a[248:251],a[176:179],v[156:159]
tr a[208:209],v12,16896
cv v164,v116,v117
mm v[156:159],a[244:247],a[164:167],v[156:159]
tr a[210:211],v12,18944
cv v165,v118,v119
mm v[156:159],a[240:243],a[152:155],v[156:159]
tr a[212:213],v12,25088
cv v198,v148,v149
mm v[152:155],a[240:243],a[148:151],0
v_exp_f32 v133, v133
mm v[152:155],a[244:247],a[160:163],v[152:155]
tr a[214:215],v12,27136
cv v199,v150,v151
mm v[152:155],a[248:251],a[172:175],v[152:155]
v_exp_f32 v134, v134
v_exp_f32 v135, v135
mm v[152:155],a[252:255],a[184:187],v[152:155]
s_waitcnt vmcnt(7)
buffer_load_dwordx4 v7, s[8:11], s45 offen offset:2048 nt lds
mm v[148:151],a[252:255],a[180:183],0
v_exp_f32 v128, v128
mm v[148:151],a[248:251],a[168:171],v[148:151]
tr a[216:217],v13,16896
cv v168,v120,v121
mm v[148:151],a[244:247],a[156:159],v[148:151]
tr a[218:219],v13,18944
cv v169,v122,v123
mm v[148:151],a[240:243],a[144:147],v[148:151]
tr a[220:221],v13,25088
cv v170,v132,v133
mm v[216:219],v[220:223],v[204:207],v[216:219]
v_exp_f32 v129, v129
mm v[216:219],v[220:223],v[192:195],v[216:219]
v_exp_f32 v130, v130
mm v[212:215],v[220:223],v[200:203],v[212:215]
v_exp_f32 v131, v131
mm v[212:215],v[220:223],v[188:191],v[212:215]
tr a[222:223],v13,27136
cv v171,v134,v135
mm v[208:211],v[220:223],v[196:199],v[208:211]
v_exp_f32 v124, v124
mm v[208:211],v[220:223],v[184:187],v[208:211]
s_waitcnt lgkmcnt(8)
tr a[224:225],v12,20480
mm v[16:19],a[192:195],v[184:187],v[16:19]
v_exp_f32 v125, v125
mm v[16:19],a[196:199],v[196:199],v[16:19]
tr a[226:227],v12,22528
s_waitcnt vmcnt(7)
mm v[20:23],a[196:199],v[200:203],v[20:23]
v_exp_f32 v126, v126
mm v[20:23],a[192:195],v[188:191],v[20:23]
v_exp_f32 v127, v127
mm v[24:27],a[192:195],v[192:195],v[24:27]
buffer_load_dwordx4 v8, s[8:11], s45 offen offset:3072 nt lds
tr a[228:229],v12,28672
mm v[24:27],a[196:199],v[204:207],v[24:27]
tr a[230:231],v12,30720
cv v166,v128,v129
mm v[36:39],a[204:207],v[204:207],v[36:39]
v_exp_f32 v136, v136
mm v[36:39],a[200:203],v[192:195],v[36:39]
tr a[232:233],v13,20480
cv v167,v130,v131
mm v[32:35],a[200:203],v[188:191],v[32:35]
v_exp_f32 v137, v137
mm v[32:35],a[204:207],v[200:203],v[32:35]
tr a[234:235],v13,22528
cv v162,v124,v125
mm v[28:31],a[204:207],v[196:199],v[28:31]
v_exp_f32 v138, v138
mm v[28:31],a[200:203],v[184:187],v[28:31]
s_waitcnt lgkmcnt(6)
tr a[236:237],v13,28672
mm v[40:43],a[208:211],v[184:187],v[40:43]
tr a[238:239],v13,30720
cv v163,v126,v127
v_exp_f32 v139, v139
mm v[40:43],a[212:215],v[196:199],v[40:43]
tr a[240:241],v12,20992
cv v172,v136,v137
mm v[44:47],a[212:215],v[200:203],v[44:47]
v_exp_f32 v140, v140
mm v[44:47],a[208:211],v[188:191],v[44:47]
tr a[242:243],v12,23040
s_add_u32 s50, s60, 393216
mm v[48:51],a[208:211],v[192:195],v[48:51]
v_exp_f32 v141, v141
mm v[48:51],a[212:215],v[204:207],v[48:51]
tr a[244:245],v12,29184
s_add_u32 m0, s44, 131072
mm v[60:63],a[220:223],v[204:207],v[60:63]
v_exp_f32 v142, v142
mm v[60:63],a[216:219],v[192:195],v[60:63]
tr a[246:247],v12,31232
buffer_load_dwordx4 v1, s[20:23], s50 offen offset:0 lds
mm v[56:59],a[216:219],v[188:191],v[56:59]
v_exp_f32 v143, v143
mm v[56:59],a[220:223],v[200:203],v[56:59]
tr a[248:249],v13,20992
buffer_load_dwordx4 v2, s[20:23], s50 offen offset:1024 lds
mm v[52:55],a[220:223],v[196:199],v[52:55]
v_exp_f32 v144, v144
mm v[52:55],a[216:219],v[184:187],v[52:55]
s_waitcnt lgkmcnt(5)
tr a[250:251],v13,23040
mm v[64:67],a[224:227],v[184:187],v[64:67]
buffer_load_dwordx4 v3, s[20:23], s50 offen offset:2048 lds
cv v173,v138,v139
mm v[64:67],a[228:231],v[196:199],v[64:67]
tr a[252:253],v13,29184
buffer_load_dwordx4 v4, s[20:23], s50 offen offset:3072 lds
mm v[68:71],a[228:231],v[200:203],v[68:71]
v_exp_f32 v145, v145
mm v[68:71],a[224:227],v[188:191],v[68:71]
tr a[254:255],v13,31232
s_add_u32 m0, s44, 98304
mm v[72:75],a[224:227],v[192:195],v[72:75]
v_exp_f32 v146, v146
v_exp_f32 v147, v147
s_waitcnt vmcnt(7)
mm v[72:75],a[228:231],v[204:207],v[72:75]
buffer_load_dwordx4 v5, s[12:15], s45 offen offset:0 nt lds
cv v176,v140,v141
mm v[84:87],a[236:239],v[204:207],v[84:87]
v_exp_f32 v156, v156
mm v[84:87],a[232:235],v[192:195],v[84:87]
cv v177,v142,v143
cv v180,v144,v145
mm v[80:83],a[232:235],v[188:191],v[80:83]
v_exp_f32 v157, v157
mm v[80:83],a[236:239],v[200:203],v[80:83]
s_waitcnt vmcnt(5)
cv v181,v146,v147
mm v[76:79],a[236:239],v[196:199],v[76:79]
v_exp_f32 v158, v158
mm v[76:79],a[232:235],v[184:187],v[76:79]
s_waitcnt lgkmcnt(0)
cv v182,v156,v157
mm v[88:91],a[240:243],v[184:187],v[88:91]
s_barrier
v_exp_f32 v159, v159
mm v[88:91],a[244:247],v[196:199],v[88:91]
lq a[192:195],v11,32768
cv v183,v158,v159
mm v[92:95],a[244:247],v[200:203],v[92:95]
v_exp_f32 v152, v152
mm v[92:95],a[240:243],v[188:191],v[92:95]
lq a[196:199],v11,33280
mm v[96:99],a[240:243],v[192:195],v[96:99]
lq a[200:203],v11,36864
mm v[96:99],a[244:247],v[204:207],v[96:99]
lq a[204:207],v11,37376
mm v[108:111],a[252:255],v[204:207],v[108:111]
v_exp_f32 v153, v153
mm v[108:111],a[248:251],v[192:195],v[108:111]
v_exp_f32 v154, v154
mm v[104:107],a[248:251],v[188:191],v[104:107]
v_exp_f32 v155, v155
mm v[104:107],a[252:255],v[200:203],v[104:107]
lq a[208:211],v11,34816
cv v178,v152,v153
mm v[100:103],a[252:255],v[196:199],v[100:103]
lq a[212:215],v11,35328
cv v179,v154,v155
mm v[100:103],a[248:251],v[184:187],v[100:103]
s_waitcnt lgkmcnt(2)
mm v[112:115],a[192:195],a[144:147],0
v_exp_f32 v148, v148
mm v[112:115],a[196:199],a[156:159],v[112:115]
lq a[216:219],v11,38912
buffer_load_dwordx4 v6, s[12:15], s45 offen offset:1024 nt lds
mm v[112:115],a[200:203],a[168:171],v[112:115]
v_exp_f32 v149, v149
mm v[112:115],a[204:207],a[180:183],v[112:115]
lq a[220:223],v11,39424
cv v174,v148,v149
mm v[116:119],a[204:207],a[184:187],0
v_exp_f32 v150, v150
mm v[116:119],a[200:203],a[172:175],v[116:119]
lq a[224:227],v11,40960
mm v[116:119],a[196:199],a[160:163],v[116:119]
v_exp_f32 v151, v151
mm v[116:119],a[192:195],a[148:151],v[116:119]
lq a[228:231],v11,41472
cv v175,v150,v151
mm v[120:123],a[192:195],a[152:155],0
v_exp_f32 v112, v112
mm v[120:123],a[196:199],a[164:167],v[120:123]
lq a[232:235],v11,45056
v_add_u32 v12, 65536, v12
mm v[120:123],a[200:203],a[176:179],v[120:123]
v_exp_f32 v113, v113
mm v[120:123],a[204:207],a[188:191],v[120:123]
s_waitcnt lgkmcnt(3)
lq a[236:239],v11,45568
mm v[132:135],a[220:223],a[188:191],0
v_exp_f32 v114, v114
mm v[132:135],a[216:219],a[176:179],v[132:135]
lq a[240:243],v11,43008
v_add_u32 v13, 65536, v13
mm v[132:135],a[212:215],a[164:167],v[132:135]
v_exp_f32 v115, v115
mm v[132:135],a[208:211],a[152:155],v[132:135]
lq a[244:247],v11,43520
cv v184,v112,v113
mm v[128:131],a[208:211],a[148:151],0
v_exp_f32 v116, v116
mm v[128:131],a[212:215],a[160:163],v[128:131]
lq a[248:251],v11,47104
cv v185,v114,v115
mm v[128:131],a[216:219],a[172:175],v[128:131]
v_exp_f32 v117, v117
mm v[128:131],a[220:223],a[184:187],v[128:131]
lq a[252:255],v11,47616
cv v188,v116,v117
mm v[124:127],a[220:223],a[180:183],0
v_exp_f32 v118, v118
mm v[124:127],a[216:219],a[168:171],v[124:127]
tr a[192:193],v12,16384
mm v[124:127],a[212:215],a[156:159],v[124:127]
v_exp_f32 v119, v119
mm v[124:127],a[208:211],a[144:147],v[124:127]
s_waitcnt lgkmcnt(5)
buffer_load_dwordx4 v7, s[12:15], s45 offen offset:2048 nt lds
mm v[136:139],a[224:227],a[144:147],0
v_exp_f32 v120, v120
mm v[136:139],a[228:231],a[156:159],v[136:139]
tr a[194:195],v12,18432
cv v189,v118,v119
mm v[136:139],a[232:235],a[168:171],v[136:139]
v_exp_f32 v121, v121
mm v[136:139],a[236:239],a[180:183],v[136:139]
tr a[196:197],v12,24576
cv v192,v120,v121
mm v[140:143],a[236:239],a[184:187],0
v_exp_f32 v122, v122
mm v[140:143],a[232:235],a[172:175],v[140:143]
tr a[198:199],v12,26624
mm v[140:143],a[228:231],a[160:163],v[140:143]
v_exp_f32 v123, v123
mm v[140:143],a[224:227],a[148:151],v[140:143]
tr a[200:201],v13,16384
cv v193,v122,v123
mm v[144:147],a[224:227],a[152:155],0
v_exp_f32 v132, v132
mm v[144:147],a[228:231],a[164:167],v[144:147]
tr a[202:203],v13,18432
mm v[144:147],a[232:235],a[176:179],v[144:147]
v_exp_f32 v133, v133
mm v[144:147],a[236:239],a[188:191],v[144:147]
s_waitcnt lgkmcnt(6)
tr a[204:205],v13,24576
mm v[156:159],a[252:255],a[188:191],0
tr a[206:207],v13,26624
cv v194,v132,v133
mm v[156:159],a[248:251],a[176:179],v[156:159]
tr a[208:209],v12,16896
mm v[156:159],a[244:247],a[164:167],v[156:159]
v_exp_f32 v134, v134
mm v[156:159],a[240:243],a[152:155],v[156:159]
tr a[210:211],v12,18944
mm v[152:155],a[240:243],a[148:151],0
v_exp_f32 v135, v135
mm v[152:155],a[244:247],a[160:163],v[152:155]
tr a[212:213],v12,25088
cv v195,v134,v135
mm v[152:155],a[248:251],a[172:175],v[152:155]
v_exp_f32 v128, v128
mm v[152:155],a[252:255],a[184:187],v[152:155]
tr a[214:215],v12,27136
mm v[148:151],a[252:255],a[180:183],0
v_exp_f32 v129, v129
mm v[148:151],a[248:251],a[168:171],v[148:151]
tr a[216:217],v13,16896
mm v[148:151],a[244:247],a[156:159],v[148:151]
v_exp_f32 v130, v130
mm v[148:151],a[240:243],a[144:147],v[148:151]
buffer_load_dwordx4 v8, s[12:15], s45 offen offset:3072 nt lds
tr a[218:219],v13,18944
mm v[216:219],v[220:223],v[180:183],v[216:219]
v_exp_f32 v131, v131
mm v[216:219],v[220:223],v[168:171],v[216:219]
tr a[220:221],v13,25088
s_add_u32 s50, s61, 0
mm v[212:215],v[220:223],v[176:179],v[212:215]
v_exp_f32 v124, v124
mm v[212:215],v[220:223],v[164:167],v[212:215]
tr a[222:223],v13,27136
s_add_u32 m0, s43, 0
mm v[208:211],v[220:223],v[172:175],v[208:211]
v_exp_f32 v125, v125
mm v[208:211],v[220:223],v[160:163],v[208:211]
s_waitcnt lgkmcnt(8)
buffer_load_dwordx4 v1, s[20:23], s50 offen offset:0 lds
mm v[16:19],a[192:195],v[160:163],v[16:19]
v_exp_f32 v126, v126
mm v[16:19],a[196:199],v[172:175],v[16:19]
tr a[224:225],v12,20480
buffer_load_dwordx4 v2, s[20:23], s50 offen offset:1024 lds
mm v[20:23],a[196:199],v[176:179],v[20:23]
v_exp_f32 v127, v127
mm v[20:23],a[192:195],v[164:167],v[20:23]
tr a[226:227],v12,22528
buffer_load_dwordx4 v3, s[20:23], s50 offen offset:2048 lds
mm v[24:27],a[192:195],v[168:171],v[24:27]
v_exp_f32 v136, v136
mm v[24:27],a[196:199],v[180:183],v[24:27]
tr a[228:229],v12,28672
cv v190,v128,v129
mm v[36:39],a[204:207],v[180:183],v[36:39]
v_exp_f32 v137, v137
mm v[36:39],a[200:203],v[168:171],v[36:39]
tr a[230:231],v12,30720
cv v191,v130,v131
mm v[32:35],a[200:203],v[164:167],v[32:35]
v_exp_f32 v138, v138
mm v[32:35],a[204:207],v[176:179],v[32:35]
tr a[232:233],v13,20480
buffer_load_dwordx4 v4, s[20:23], s50 offen offset:3072 lds
mm v[28:31],a[204:207],v[172:175],v[28:31]
v_exp_f32 v139, v139
mm v[28:31],a[200:203],v[160:163],v[28:31]
s_waitcnt lgkmcnt(5)
tr a[234:235],v13,22528
mm v[40:43],a[208:211],v[160:163],v[40:43]
tr a[236:237],v13,28672
tr a[238:239],v13,30720
s_add_u32 s50, s61, 131072
mm v[40:43],a[212:215],v[172:175],v[40:43]
s_add_u32 m0, s44, 0
tr a[240:241],v12,20992
mm v[44:47],a[212:215],v[176:179],v[44:47]
buffer_load_dwordx4 v1, s[20:23], s50 offen offset:0 lds
tr a[242:243],v12,23040
mm v[44:47],a[208:211],v[164:167],v[44:47]
tr a[244:245],v12,29184
cv v186,v124,v125
mm v[48:51],a[208:211],v[168:171],v[48:51]
buffer_load_dwordx4 v2, s[20:23], s50 offen offset:1024 lds
cv v187,v126,v127
mm v[48:51],a[212:215],v[180:183],v[48:51]
tr a[246:247],v12,31232
buffer_load_dwordx4 v3, s[20:23], s50 offen offset:2048 lds
mm v[60:63],a[220:223],v[180:183],v[60:63]
v_exp_f32 v140, v140
mm v[60:63],a[216:219],v[168:171],v[60:63]
v_exp_f32 v141, v141
mm v[56:59],a[216:219],v[164:167],v[56:59]
v_exp_f32 v142, v142
v_exp_f32 v143, v143
mm v[56:59],a[220:223],v[176:179],v[56:59]
tr a[248:249],v13,20992
buffer_load_dwordx4 v4, s[20:23], s50 offen offset:3072 lds
mm v[52:55],a[220:223],v[172:175],v[52:55]
v_exp_f32 v144, v144
mm v[52:55],a[216:219],v[160:163],v[52:55]
s_waitcnt lgkmcnt(5)
tr a[250:251],v13,23040
mm v[64:67],a[224:227],v[160:163],v[64:67]
tr a[252:253],v13,29184
cv v196,v136,v137
cv v197,v138,v139
mm v[64:67],a[228:231],v[172:175],v[64:67]
tr a[254:255],v13,31232
cv v200,v140,v141
mm v[68:71],a[228:231],v[176:179],v[68:71]
v_exp_f32 v145, v145
mm v[68:71],a[224:227],v[164:167],v[68:71]
v_exp_f32 v146, v146
mm v[72:75],a[224:227],v[168:171],v[72:75]
v_exp_f32 v147, v147
mm v[72:75],a[228:231],v[180:183],v[72:75]
cv v201,v142,v143
cv v204,v144,v145
mm v[84:87],a[236:239],v[180:183],v[84:87]
v_exp_f32 v156, v156
mm v[84:87],a[232:235],v[168:171],v[84:87]
cv v205,v146,v147
mm v[80:83],a[232:235],v[164:167],v[80:83]
v_exp_f32 v157, v157
mm v[80:83],a[236:239],v[176:179],v[80:83]
s_waitcnt vmcnt(8)
cv v206,v156,v157
mm v[76:79],a[236:239],v[172:175],v[76:79]
v_exp_f32 v158, v158
mm v[76:79],a[232:235],v[160:163],v[76:79]
s_waitcnt lgkmcnt(0)
mm v[88:91],a[240:243],v[160:163],v[88:91]
s_barrier
v_exp_f32 v159, v159
mm v[88:91],a[244:247],v[172:175],v[88:91]
tr a[208:209],v12,49152
cv v207,v158,v159
mm v[92:95],a[244:247],v[176:179],v[92:95]
v_exp_f32 v152, v152
mm v[92:95],a[240:243],v[164:167],v[92:95]
tr a[210:211],v12,51200
mm v[96:99],a[240:243],v[168:171],v[96:99]
v_exp_f32 v153, v153
mm v[96:99],a[244:247],v[180:183],v[96:99]
tr a[212:213],v12,57344
cv v202,v152,v153
mm v[108:111],a[252:255],v[180:183],v[108:111]
tr a[214:215],v12,59392
mm v[108:111],a[248:251],v[168:171],v[108:111]
tr a[216:217],v13,49152
mm v[104:107],a[248:251],v[164:167],v[104:107]
v_exp_f32 v154, v154
v_exp_f32 v155, v155
mm v[104:107],a[252:255],v[176:179],v[104:107]
tr a[218:219],v13,51200
cv v203,v154,v155
mm v[100:103],a[252:255],v[172:175],v[100:103]
tr a[220:221],v13,57344
mm v[100:103],a[248:251],v[160:163],v[100:103]
tr a[222:223],v13,59392
v_exp_f32 v148, v148
v_exp_f32 v149, v149
v_exp_f32 v150, v150
v_exp_f32 v151, v151
cv v198,v148,v149
cv v199,v150,v151
mm v[216:219],v[220:223],v[204:207],v[216:219]
tr a[224:225],v12,49664
v_mov_b32 v251, 0
mm v[216:219],v[220:223],v[192:195],v[216:219]
tr a[226:227],v12,51712
s_add_u32 s50, s61, 262144
mm v[212:215],v[220:223],v[200:203],v[212:215]
s_add_u32 s51, s61, 393216
tr a[228:229],v12,57856
mm v[212:215],v[220:223],v[188:191],v[212:215]
s_lshl_b32 s54, s40, 3
tr a[230:231],v12,59904
mm v[208:211],v[220:223],v[196:199],v[208:211]
s_waitcnt lgkmcnt(4)
tr a[232:233],v13,49664
mm v[208:211],v[220:223],v[184:187],v[208:211]
tr a[234:235],v13,51712
s_add_u32 m0, s43, 65536
mm v[16:19],a[208:211],v[184:187],v[16:19]
buffer_load_dwordx4 v1, s[20:23], s50 offen offset:0 lds
tr a[236:237],v13,57856
mm v[16:19],a[212:215],v[196:199],v[16:19]
buffer_load_dword v252, v251, s[32:35], s54 offen offset:4 sc1
tr a[238:239],v13,59904
mm v[20:23],a[212:215],v[200:203],v[20:23]
mm v[20:23],a[208:211],v[188:191],v[20:23]
tr a[192:193],v12,53248
buffer_load_dwordx4 v2, s[20:23], s50 offen offset:1024 lds
mm v[24:27],a[208:211],v[192:195],v[24:27]
tr a[194:195],v12,55296
mm v[24:27],a[212:215],v[204:207],v[24:27]
tr a[196:197],v12,61440
mm v[36:39],a[220:223],v[204:207],v[36:39]
v_rcp_f32 v240, v208
mm v[36:39],a[216:219],v[192:195],v[36:39]
tr a[198:199],v12,63488
mm v[32:35],a[216:219],v[188:191],v[32:35]
tr a[200:201],v13,53248
mm v[32:35],a[220:223],v[200:203],v[32:35]
tr a[202:203],v13,55296
mm v[28:31],a[220:223],v[196:199],v[28:31]
s_waitcnt lgkmcnt(6)
buffer_load_dwordx4 v3, s[20:23], s50 offen offset:2048 lds
mm v[28:31],a[216:219],v[184:187],v[28:31]
tr a[204:205],v13,61440
mm v[40:43],a[224:227],v[184:187],v[40:43]
tr a[206:207],v13,63488
mm v[40:43],a[228:231],v[196:199],v[40:43]
v_rcp_f32 v241, v212
L_pg22:
s_cbranch_execz L_pg26
mm v[44:47],a[228:231],v[200:203],v[44:47]
tr v[224:225],v12,53760
mm v[44:47],a[224:227],v[188:191],v[44:47]
tr v[226:227],v12,55808
mm v[48:51],a[224:227],v[192:195],v[48:51]
tr v[228:229],v12,61952
mm v[48:51],a[228:231],v[204:207],v[48:51]
tr v[230:231],v12,64000
buffer_load_dwordx4 v4, s[20:23], s50 offen offset:3072 lds
mm v[60:63],a[236:239],v[204:207],v[60:63]
v_rcp_f32 v242, v216
mm v[60:63],a[232:235],v[192:195],v[60:63]
tr v[232:233],v13,53760
v_med3_f32 v248, v208, s57, v243
mm v[56:59],a[232:235],v[188:191],v[56:59]
tr v[234:235],v13,55808
v_med3_f32 v249, v212, s57, v243
mm v[56:59],a[236:239],v[200:203],v[56:59]
tr v[236:237],v13,61952
v_med3_f32 v250, v216, s57, v243
mm v[52:55],a[236:239],v[196:199],v[52:55]
s_waitcnt lgkmcnt(7)
tr v[238:239],v13,64000
mm v[52:55],a[232:235],v[184:187],v[52:55]
v_cmp_neq_f32 s[92:93], v248, v208
v_cmp_neq_f32 s[94:95], v249, v212
mm v[64:67],a[192:195],v[184:187],v[64:67]
s_add_u32 m0, s44, 65536
tr a[216:217],v9,32768
mm v[64:67],a[196:199],v[196:199],v[64:67]
buffer_load_dwordx4 v1, s[20:23], s51 offen offset:0 lds
tr a[218:219],v9,34816
mm v[68:71],a[196:199],v[200:203],v[68:71]
tr a[220:221],v9,36864
v_cmp_neq_f32 s[96:97], v250, v216
mm v[68:71],a[192:195],v[188:191],v[68:71]
tr a[222:223],v9,38912
mm v[72:75],a[192:195],v[192:195],v[72:75]
tr a[224:225],v10,32768
mm v[72:75],a[196:199],v[204:207],v[72:75]
tr a[226:227],v10,34816
mm v[84:87],a[204:207],v[204:207],v[84:87]
tr a[228:229],v10,36864
mm v[84:87],a[200:203],v[192:195],v[84:87]
buffer_load_dwordx4 v2, s[20:23], s51 offen offset:1024 lds
tr a[230:231],v10,38912
mm v[80:83],a[200:203],v[188:191],v[80:83]
tr a[232:233],v9,33280
mm v[80:83],a[204:207],v[200:203],v[80:83]
tr a[234:235],v9,35328
mm v[76:79],a[204:207],v[196:199],v[76:79]
s_waitcnt lgkmcnt(10)
tr a[236:237],v9,37376
mm v[76:79],a[200:203],v[184:187],v[76:79]
tr a[238:239],v9,39424
mm v[88:91],v[224:227],v[184:187],v[88:91]
tr a[240:241],v10,33280
mm v[88:91],v[228:231],v[196:199],v[88:91]
tr a[242:243],v10,35328
mm v[92:95],v[228:231],v[200:203],v[92:95]
buffer_load_dwordx4 v3, s[20:23], s51 offen offset:2048 lds
tr a[244:245],v10,37376
mm v[92:95],v[224:227],v[188:191],v[92:95]
tr a[246:247],v10,39424
mm v[96:99],v[224:227],v[192:195],v[96:99]
mm v[96:99],v[228:231],v[204:207],v[96:99]
mm v[108:111],v[236:239],v[204:207],v[108:111]
mm v[108:111],v[232:235],v[192:195],v[108:111]
mm v[104:107],v[232:235],v[188:191],v[104:107]
mm v[104:107],v[236:239],v[200:203],v[104:107]
buffer_load_dwordx4 v4, s[20:23], s51 offen offset:3072 lds
mm v[100:103],v[236:239],v[196:199],v[100:103]
mm v[100:103],v[232:235],v[184:187],v[100:103]
s_waitcnt lgkmcnt(8)
s_nop 1
s_or_b64 s[92:93], s[92:93], s[94:95]
s_or_b64 s[92:93], s[92:93], s[96:97]
s_cbranch_scc1 L_slow3
L_back3:
mm v[112:115],a[216:219],a[0:3],0
mm v[112:115],a[220:223],a[12:15],v[112:115]
s_barrier
v_mul_f32 v16, v240, v16
mm v[116:119],a[220:223],a[16:19],0
v_mul_f32 v17, v240, v17
v_mul_f32 v18, v240, v18
mm v[116:119],a[216:219],a[4:7],v[116:119]
s_add_u32 s50, s62, 0
s_add_u32 s51, s62, 131072
mm v[120:123],a[216:219],a[8:11],0
s_add_u32 m0, s43, 98304
tr a[216:217],v9,40960
mm v[120:123],a[220:223],a[20:23],v[120:123]
buffer_load_dwordx4 v1, s[20:23], s50 offen offset:0 lds
tr a[218:219],v9,43008
mm v[132:135],a[228:231],a[20:23],0
tr a[220:221],v9,45056
v_mul_f32 v19, v240, v19
mm v[132:135],a[224:227],a[8:11],v[132:135]
tr a[222:223],v9,47104
v_mul_f32 v28, v240, v28
mm v[128:131],a[224:227],a[4:7],0
v_mul_f32 v29, v240, v29
v_mul_f32 v30, v240, v30
mm v[128:131],a[228:231],a[16:19],v[128:131]
v_mul_f32 v31, v240, v31
cv v16,v16,v17
mm v[124:127],a[228:231],a[12:15],0
s_waitcnt lgkmcnt(4)
s_mov_b32 s6, 0
mm v[124:127],a[224:227],a[0:3],v[124:127]
buffer_load_dwordx4 v2, s[20:23], s50 offen offset:1024 lds
tr a[224:225],v10,40960
mm v[136:139],a[232:235],a[0:3],0
tr a[226:227],v10,43008
s_mov_b32 s7, 0x7ff00000
mm v[136:139],a[236:239],a[12:15],v[136:139]
tr a[228:229],v10,45056
cv v17,v18,v19
mm v[140:143],a[236:239],a[16:19],0
tr a[230:231],v10,47104
cv v28,v28,v29
mm v[140:143],a[232:235],a[4:7],v[140:143]
cv v29,v30,v31
v_accvgpr_write_b32 a144, v16
mm v[144:147],a[232:235],a[8:11],0
tr a[232:233],v9,41472
v_accvgpr_write_b32 a145, v17
mm v[144:147],a[236:239],a[20:23],v[144:147]
tr a[234:235],v9,43520
v_accvgpr_write_b32 a146, v28
mm v[156:159],a[244:247],a[20:23],0
tr a[236:237],v9,45568
buffer_load_dwordx4 v3, s[20:23], s50 offen offset:2048 lds
mm v[156:159],a[240:243],a[8:11],v[156:159]
tr a[238:239],v9,47616
v_accvgpr_write_b32 a147, v29
mm v[152:155],a[240:243],a[4:7],0
v_mul_f32 v20, v241, v20
v_mul_f32 v21, v241, v21
mm v[152:155],a[244:247],a[16:19],v[152:155]
v_mul_f32 v22, v241, v22
v_mul_f32 v23, v241, v23
mm v[148:151],a[244:247],a[12:15],0
s_waitcnt lgkmcnt(4)
v_mul_f32 v32, v241, v32
mm v[148:151],a[240:243],a[0:3],v[148:151]
tr a[240:241],v10,41472
v_mul_f32 v33, v241, v33
mm v[112:115],a[216:219],a[24:27],v[112:115]
tr a[242:243],v10,43520
v_mul_f32 v34, v241, v34
mm v[112:115],a[220:223],a[36:39],v[112:115]
tr a[244:245],v10,45568
buffer_load_dwordx4 v4, s[20:23], s50 offen offset:3072 lds
mm v[116:119],a[220:223],a[40:43],v[116:119]
tr a[246:247],v10,47616
v_mul_f32 v35, v241, v35
mm v[116:119],a[216:219],a[28:31],v[116:119]
cv v20,v20,v21
cv v21,v22,v23
mm v[120:123],a[216:219],a[32:35],v[120:123]
tr a[216:217],v9,49152
cv v32,v32,v33
mm v[120:123],a[220:223],a[44:47],v[120:123]
tr a[218:219],v9,51200
cv v33,v34,v35
mm v[132:135],a[228:231],a[44:47],v[132:135]
tr a[220:221],v9,53248
v_accvgpr_write_b32 a148, v20
mm v[132:135],a[224:227],a[32:35],v[132:135]
tr a[222:223],v9,55296
v_accvgpr_write_b32 a149, v21
mm v[128:131],a[224:227],a[28:31],v[128:131]
s_add_u32 m0, s44, 98304
v_accvgpr_write_b32 a150, v32
mm v[128:131],a[228:231],a[40:43],v[128:131]
buffer_load_dwordx4 v1, s[20:23], s51 offen offset:0 lds
v_accvgpr_write_b32 a151, v33
mm v[124:127],a[228:231],a[36:39],v[124:127]
s_waitcnt lgkmcnt(4)
v_mul_f32 v24, v242, v24
mm v[124:127],a[224:227],a[24:27],v[124:127]
tr a[224:225],v10,49152
v_mul_f32 v25, v242, v25
mm v[136:139],a[232:235],a[24:27],v[136:139]
tr a[226:227],v10,51200
v_mul_f32 v26, v242, v26
mm v[136:139],a[236:239],a[36:39],v[136:139]
tr a[228:229],v10,53248
v_mul_f32 v27, v242, v27
mm v[140:143],a[236:239],a[40:43],v[140:143]
tr a[230:231],v10,55296
v_mul_f32 v36, v242, v36
mm v[140:143],a[232:235],a[28:31],v[140:143]
buffer_load_dwordx4 v2, s[20:23], s51 offen offset:1024 lds
v_mul_f32 v37, v242, v37
mm v[144:147],a[232:235],a[32:35],v[144:147]
tr a[232:233],v9,49664
v_mul_f32 v38, v242, v38
mm v[144:147],a[236:239],a[44:47],v[144:147]
tr a[234:235],v9,51712
v_mul_f32 v39, v242, v39
mm v[156:159],a[244:247],a[44:47],v[156:159]
tr a[236:237],v9,53760
cv v24,v24,v25
mm v[156:159],a[240:243],a[32:35],v[156:159]
tr a[238:239],v9,55808
cv v25,v26,v27
mm v[152:155],a[240:243],a[28:31],v[152:155]
cv v36,v36,v37
cv v37,v38,v39
mm v[152:155],a[244:247],a[40:43],v[152:155]
v_accvgpr_write_b32 a152, v24
v_accvgpr_write_b32 a153, v25
mm v[148:151],a[244:247],a[36:39],v[148:151]
s_waitcnt lgkmcnt(4)
buffer_load_dwordx4 v3, s[20:23], s51 offen offset:2048 lds
mm v[148:151],a[240:243],a[24:27],v[148:151]
tr a[240:241],v10,49664
v_accvgpr_write_b32 a154, v36
mm v[112:115],a[216:219],a[48:51],v[112:115]
tr a[242:243],v10,51712
v_accvgpr_write_b32 a155, v37
mm v[112:115],a[220:223],a[60:63],v[112:115]
tr a[244:245],v10,53760
v_mul_f32 v40, v240, v40
mm v[116:119],a[220:223],a[64:67],v[116:119]
tr a[246:247],v10,55808
v_mul_f32 v41, v240, v41
mm v[116:119],a[216:219],a[52:55],v[116:119]
v_mul_f32 v42, v240, v42
v_mul_f32 v43, v240, v43
mm v[120:123],a[216:219],a[56:59],v[120:123]
tr a[216:217],v9,57344
v_mul_f32 v52, v240, v52
mm v[120:123],a[220:223],a[68:71],v[120:123]
tr a[218:219],v9,59392
buffer_load_dwordx4 v4, s[20:23], s51 offen offset:3072 lds
mm v[132:135],a[228:231],a[68:71],v[132:135]
tr a[220:221],v9,61440
v_mul_f32 v53, v240, v53
mm v[132:135],a[224:227],a[56:59],v[132:135]
tr a[222:223],v9,63488
v_mul_f32 v54, v240, v54
mm v[128:131],a[224:227],a[52:55],v[128:131]
v_mul_f32 v55, v240, v55
cv v40,v40,v41
mm v[128:131],a[228:231],a[64:67],v[128:131]
cv v41,v42,v43
cv v52,v52,v53
mm v[124:127],a[228:231],a[60:63],v[124:127]
s_waitcnt lgkmcnt(4)
cv v53,v54,v55
mm v[124:127],a[224:227],a[48:51],v[124:127]
tr a[224:225],v10,57344
v_accvgpr_write_b32 a156, v40
mm v[136:139],a[232:235],a[48:51],v[136:139]
tr a[226:227],v10,59392
v_accvgpr_write_b32 a157, v41
mm v[136:139],a[236:239],a[60:63],v[136:139]
tr a[228:229],v10,61440
v_accvgpr_write_b32 a158, v52
mm v[140:143],a[236:239],a[64:67],v[140:143]
tr a[230:231],v10,63488
v_accvgpr_write_b32 a159, v53
mm v[140:143],a[232:235],a[52:55],v[140:143]
v_mul_f32 v44, v241, v44
v_mul_f32 v45, v241, v45
mm v[144:147],a[232:235],a[56:59],v[144:147]
tr a[232:233],v9,57856
v_mul_f32 v46, v241, v46
mm v[144:147],a[236:239],a[68:71],v[144:147]
tr a[234:235],v9,59904
v_mul_f32 v47, v241, v47
mm v[156:159],a[244:247],a[68:71],v[156:159]
tr a[236:237],v9,61952
v_mul_f32 v56, v241, v56
mm v[156:159],a[240:243],a[56:59],v[156:159]
tr a[238:239],v9,64000
v_mul_f32 v57, v241, v57
mm v[152:155],a[240:243],a[52:55],v[152:155]
v_mul_f32 v58, v241, v58
v_mul_f32 v59, v241, v59
mm v[152:155],a[244:247],a[64:67],v[152:155]
cv v44,v44,v45
cv v45,v46,v47
mm v[148:151],a[244:247],a[60:63],v[148:151]
s_waitcnt vmcnt(63)
s_waitcnt lgkmcnt(4)
mm v[148:151],a[240:243],a[48:51],v[148:151]
tr a[240:241],v10,57856
cv v56,v56,v57
mm v[112:115],a[216:219],a[72:75],v[112:115]
s_barrier
tr a[242:243],v10,59904
mm v[112:115],a[220:223],a[84:87],v[112:115]
tr a[244:245],v10,61952
cv v57,v58,v59
mm v[116:119],a[220:223],a[88:91],v[116:119]
tr a[246:247],v10,64000
v_add_u32 v9, 131072, v9
mm v[116:119],a[216:219],a[76:79],v[116:119]
v_add_u32 v10, 131072, v10
v_accvgpr_write_b32 a160, v44
mm v[120:123],a[216:219],a[80:83],v[120:123]
tr a[216:217],v9,0
v_accvgpr_write_b32 a161, v45
mm v[120:123],a[220:223],a[92:95],v[120:123]
tr a[218:219],v9,2048
v_accvgpr_write_b32 a162, v56
mm v[132:135],a[228:231],a[92:95],v[132:135]
tr a[220:221],v9,4096
v_accvgpr_write_b32 a163, v57
mm v[132:135],a[224:227],a[80:83],v[132:135]
tr a[222:223],v9,6144
v_mul_f32 v48, v242, v48
mm v[128:131],a[224:227],a[76:79],v[128:131]
v_mul_f32 v49, v242, v49
v_mul_f32 v50, v242, v50
mm v[128:131],a[228:231],a[88:91],v[128:131]
v_mul_f32 v51, v242, v51
v_mul_f32 v60, v242, v60
mm v[124:127],a[228:231],a[84:87],v[124:127]
s_waitcnt lgkmcnt(4)
v_mul_f32 v61, v242, v61
mm v[124:127],a[224:227],a[72:75],v[124:127]
tr a[224:225],v10,0
v_mul_f32 v62, v242, v62
mm v[136:139],a[232:235],a[72:75],v[136:139]
tr a[226:227],v10,2048
v_mul_f32 v63, v242, v63
mm v[136:139],a[236:239],a[84:87],v[136:139]
tr a[228:229],v10,4096
cv v48,v48,v49
mm v[140:143],a[236:239],a[88:91],v[140:143]
tr a[230:231],v10,6144
cv v49,v50,v51
mm v[140:143],a[232:235],a[76:79],v[140:143]
cv v60,v60,v61
cv v61,v62,v63
mm v[144:147],a[232:235],a[80:83],v[144:147]
tr a[232:233],v9,512
v_accvgpr_write_b32 a164, v48
mm v[144:147],a[236:239],a[92:95],v[144:147]
tr a[234:235],v9,2560
v_accvgpr_write_b32 a165, v49
mm v[156:159],a[244:247],a[92:95],v[156:159]
tr a[236:237],v9,4608
v_accvgpr_write_b32 a166, v60
mm v[156:159],a[240:243],a[80:83],v[156:159]
tr a[238:239],v9,6656
v_accvgpr_write_b32 a167, v61
mm v[152:155],a[240:243],a[76:79],v[152:155]
v_mul_f32 v64, v240, v64
v_mul_f32 v65, v240, v65
mm v[152:155],a[244:247],a[88:91],v[152:155]
v_mul_f32 v66, v240, v66
v_mul_f32 v67, v240, v67
mm v[148:151],a[244:247],a[84:87],v[148:151]
s_waitcnt lgkmcnt(4)
v_mul_f32 v76, v240, v76
mm v[148:151],a[240:243],a[72:75],v[148:151]
tr a[240:241],v10,512
v_mul_f32 v77, v240, v77
mm v[112:115],a[216:219],a[96:99],v[112:115]
tr a[242:243],v10,2560
v_mul_f32 v78, v240, v78
mm v[112:115],a[220:223],a[108:111],v[112:115]
tr a[244:245],v10,4608
v_mul_f32 v79, v240, v79
mm v[116:119],a[220:223],a[112:115],v[116:119]
tr a[246:247],v10,6656
cv v64,v64,v65
mm v[116:119],a[216:219],a[100:103],v[116:119]
cv v65,v66,v67
cv v76,v76,v77
mm v[120:123],a[216:219],a[104:107],v[120:123]
tr a[216:217],v9,8192
cv v77,v78,v79
mm v[120:123],a[220:223],a[116:119],v[120:123]
tr a[218:219],v9,10240
v_accvgpr_write_b32 a168, v64
mm v[132:135],a[228:231],a[116:119],v[132:135]
tr a[220:221],v9,12288
v_accvgpr_write_b32 a169, v65
mm v[132:135],a[224:227],a[104:107],v[132:135]
tr a[222:223],v9,14336
v_accvgpr_write_b32 a170, v76
mm v[128:131],a[224:227],a[100:103],v[128:131]
v_accvgpr_write_b32 a171, v77
v_mul_f32 v68, v241, v68
mm v[128:131],a[228:231],a[112:115],v[128:131]
v_mul_f32 v69, v241, v69
v_mul_f32 v70, v241, v70
mm v[124:127],a[228:231],a[108:111],v[124:127]
s_waitcnt lgkmcnt(4)
v_mul_f32 v71, v241, v71
mm v[124:127],a[224:227],a[96:99],v[124:127]
tr a[224:225],v10,8192
v_mul_f32 v80, v241, v80
mm v[136:139],a[232:235],a[96:99],v[136:139]
tr a[226:227],v10,10240
v_mul_f32 v81, v241, v81
mm v[136:139],a[236:239],a[108:111],v[136:139]
tr a[228:229],v10,12288
v_mul_f32 v82, v241, v82
mm v[140:143],a[236:239],a[112:115],v[140:143]
tr a[230:231],v10,14336
v_mul_f32 v83, v241, v83
mm v[140:143],a[232:235],a[100:103],v[140:143]
cv v68,v68,v69
cv v69,v70,v71
mm v[144:147],a[232:235],a[104:107],v[144:147]
tr a[232:233],v9,8704
cv v80,v80,v81
mm v[144:147],a[236:239],a[116:119],v[144:147]
tr a[234:235],v9,10752
cv v81,v82,v83
mm v[156:159],a[244:247],a[116:119],v[156:159]
tr a[236:237],v9,12800
v_accvgpr_write_b32 a172, v68
mm v[156:159],a[240:243],a[104:107],v[156:159]
tr a[238:239],v9,14848
v_accvgpr_write_b32 a173, v69
mm v[152:155],a[240:243],a[100:103],v[152:155]
v_accvgpr_write_b32 a174, v80
v_accvgpr_write_b32 a175, v81
mm v[152:155],a[244:247],a[112:115],v[152:155]
v_mul_f32 v72, v242, v72
v_mul_f32 v73, v242, v73
mm v[148:151],a[244:247],a[108:111],v[148:151]
s_waitcnt lgkmcnt(4)
v_mul_f32 v74, v242, v74
mm v[148:151],a[240:243],a[96:99],v[148:151]
tr a[240:241],v10,8704
v_mul_f32 v75, v242, v75
mm v[112:115],a[216:219],a[120:123],v[112:115]
tr a[242:243],v10,10752
v_mul_f32 v84, v242, v84
mm v[112:115],a[220:223],a[132:135],v[112:115]
tr a[244:245],v10,12800
v_mul_f32 v85, v242, v85
mm v[116:119],a[220:223],a[136:139],v[116:119]
tr a[246:247],v10,14848
v_mul_f32 v86, v242, v86
mm v[116:119],a[216:219],a[124:127],v[116:119]
v_mul_f32 v87, v242, v87
cv v72,v72,v73
mm v[120:123],a[216:219],a[128:131],v[120:123]
tr a[216:217],v9,16384
cv v73,v74,v75
mm v[120:123],a[220:223],a[140:143],v[120:123]
tr a[218:219],v9,18432
cv v84,v84,v85
mm v[132:135],a[228:231],a[140:143],v[132:135]
tr a[220:221],v9,20480
cv v85,v86,v87
mm v[132:135],a[224:227],a[128:131],v[132:135]
tr a[222:223],v9,22528
v_accvgpr_write_b32 a176, v72
mm v[128:131],a[224:227],a[124:127],v[128:131]
v_accvgpr_write_b32 a177, v73
v_accvgpr_write_b32 a178, v84
mm v[128:131],a[228:231],a[136:139],v[128:131]
v_accvgpr_write_b32 a179, v85
v_mul_f32 v88, v240, v88
mm v[124:127],a[228:231],a[132:135],v[124:127]
s_waitcnt lgkmcnt(4)
v_mul_f32 v89, v240, v89
mm v[124:127],a[224:227],a[120:123],v[124:127]
tr a[224:225],v10,16384
v_mul_f32 v90, v240, v90
mm v[136:139],a[232:235],a[120:123],v[136:139]
tr a[226:227],v10,18432
v_mul_f32 v91, v240, v91
mm v[136:139],a[236:239],a[132:135],v[136:139]
tr a[228:229],v10,20480
v_mul_f32 v100, v240, v100
mm v[140:143],a[236:239],a[136:139],v[140:143]
tr a[230:231],v10,22528
v_mul_f32 v101, v240, v101
mm v[140:143],a[232:235],a[124:127],v[140:143]
v_mul_f32 v102, v240, v102
v_mul_f32 v103, v240, v103
mm v[144:147],a[232:235],a[128:131],v[144:147]
tr a[232:233],v9,16896
cv v88,v88,v89
mm v[144:147],a[236:239],a[140:143],v[144:147]
tr a[234:235],v9,18944
cv v89,v90,v91
mm v[156:159],a[244:247],a[140:143],v[156:159]
tr a[236:237],v9,20992
cv v100,v100,v101
mm v[156:159],a[240:243],a[128:131],v[156:159]
tr a[238:239],v9,23040
cv v101,v102,v103
mm v[152:155],a[240:243],a[124:127],v[152:155]
v_accvgpr_write_b32 a180, v88
v_accvgpr_write_b32 a181, v89
mm v[152:155],a[244:247],a[136:139],v[152:155]
v_accvgpr_write_b32 a182, v100
v_accvgpr_write_b32 a183, v101
mm v[148:151],a[244:247],a[132:135],v[148:151]
s_waitcnt lgkmcnt(4)
v_mul_f32 v92, v241, v92
mm v[148:151],a[240:243],a[120:123],v[148:151]
tr a[240:241],v10,16896
v_mul_f32 v93, v241, v93
mm v[112:115],a[216:219],a[144:147],v[112:115]
tr a[242:243],v10,18944
v_mul_f32 v94, v241, v94
mm v[112:115],a[220:223],a[156:159],v[112:115]
tr a[244:245],v10,20992
v_mul_f32 v95, v241, v95
mm v[116:119],a[220:223],a[160:163],v[116:119]
tr a[246:247],v10,23040
v_mul_f32 v104, v241, v104
mm v[116:119],a[216:219],a[148:151],v[116:119]
v_mul_f32 v105, v241, v105
v_mul_f32 v106, v241, v106
mm v[120:123],a[216:219],a[152:155],v[120:123]
tr a[216:217],v9,24576
v_mul_f32 v107, v241, v107
mm v[120:123],a[220:223],a[164:167],v[120:123]
tr a[218:219],v9,26624
cv v92,v92,v93
mm v[132:135],a[228:231],a[164:167],v[132:135]
tr a[220:221],v9,28672
cv v93,v94,v95
mm v[132:135],a[224:227],a[152:155],v[132:135]
tr a[222:223],v9,30720
cv v104,v104,v105
mm v[128:131],a[224:227],a[148:151],v[128:131]
cv v105,v106,v107
v_accvgpr_write_b32 a184, v92
mm v[128:131],a[228:231],a[160:163],v[128:131]
v_accvgpr_write_b32 a185, v93
v_accvgpr_write_b32 a186, v104
mm v[124:127],a[228:231],a[156:159],v[124:127]
s_waitcnt lgkmcnt(4)
v_accvgpr_write_b32 a187, v105
mm v[124:127],a[224:227],a[144:147],v[124:127]
tr a[224:225],v10,24576
v_mul_f32 v96, v242, v96
mm v[136:139],a[232:235],a[144:147],v[136:139]
tr a[226:227],v10,26624
v_mul_f32 v97, v242, v97
mm v[136:139],a[236:239],a[156:159],v[136:139]
tr a[228:229],v10,28672
v_mul_f32 v98, v242, v98
mm v[140:143],a[236:239],a[160:163],v[140:143]
tr a[230:231],v10,30720
v_mul_f32 v99, v242, v99
mm v[140:143],a[232:235],a[148:151],v[140:143]
v_mul_f32 v108, v242, v108
v_mul_f32 v109, v242, v109
mm v[144:147],a[232:235],a[152:155],v[144:147]
tr a[232:233],v9,25088
v_mul_f32 v110, v242, v110
mm v[144:147],a[236:239],a[164:167],v[144:147]
tr a[234:235],v9,27136
v_mul_f32 v111, v242, v111
mm v[156:159],a[244:247],a[164:167],v[156:159]
tr a[236:237],v9,29184
cv v96,v96,v97
mm v[156:159],a[240:243],a[152:155],v[156:159]
tr a[238:239],v9,31232
cv v97,v98,v99
mm v[152:155],a[240:243],a[148:151],v[152:155]
cv v108,v108,v109
cv v109,v110,v111
mm v[152:155],a[244:247],a[160:163],v[152:155]
v_accvgpr_write_b32 a188, v96
L_pg23:
s_cbranch_execz L_pg27
v_accvgpr_write_b32 a189, v97
v_accvgpr_write_b32 a190, v108
v_accvgpr_write_b32 a191, v109
mm v[148:151],a[244:247],a[156:159],v[148:151]
s_waitcnt vmcnt(17)
s_waitcnt lgkmcnt(4)
mm v[148:151],a[240:243],a[144:147],v[148:151]
tr a[240:241],v10,25088
v_lshlrev_b32 v244, 4, v0
mm v[112:115],a[216:219],a[168:171],v[112:115]
s_barrier
v_cmp_eq_u32 vcc, 0, v0
v_mov_b32 v247, 1
v_mov_b32 v245, 0x7fff0000
v_cndmask_b32_e64 v245, v245, 0, vcc
mm v[112:115],a[220:223],a[180:183],v[112:115]
s_add_u32 s50, s62, 262144
s_add_u32 s51, s62, 393216
mm v[116:119],a[220:223],a[184:187],v[116:119]
s_waitcnt vmcnt(15)
tr a[242:243],v10,27136
mm v[116:119],a[216:219],a[172:175],v[116:119]
tr a[244:245],v10,29184
v_cmp_ne_u32 vcc, 0xff, v252
mm v[120:123],a[216:219],a[176:179],v[120:123]
tr a[246:247],v10,31232
v_add_u32 v9, 4294836224, v9
v_add_u32 v10, 4294836224, v10
mm v[120:123],a[220:223],a[188:191],v[120:123]
s_add_u32 m0, s43, 32768
tr a[216:217],v9,0
mm v[132:135],a[228:231],a[188:191],v[132:135]
buffer_load_dwordx4 v1, s[20:23], s50 offen offset:0 lds
s_cbranch_vccnz L_notready
L_ready:
mm v[132:135],a[224:227],a[176:179],v[132:135]
tr a[218:219],v9,2048
v_lshlrev_b32 v255, 2, v0
mm v[128:131],a[224:227],a[172:175],v[128:131]
tr a[220:221],v9,4096
mm v[128:131],a[228:231],a[184:187],v[128:131]
tr a[222:223],v9,6144
buffer_load_dwordx4 v2, s[20:23], s50 offen offset:1024 lds
mm v[124:127],a[228:231],a[180:183],v[124:127]
s_waitcnt lgkmcnt(4)
mm v[124:127],a[224:227],a[168:171],v[124:127]
tr a[224:225],v10,0
mm v[136:139],a[232:235],a[168:171],v[136:139]
tr a[226:227],v10,2048
v_min_u32 v255, 24, v255
mm v[136:139],a[236:239],a[180:183],v[136:139]
tr a[228:229],v10,4096
mm v[140:143],a[236:239],a[184:187],v[140:143]
tr a[230:231],v10,6144
mm v[140:143],a[232:235],a[172:175],v[140:143]
mm v[144:147],a[232:235],a[176:179],v[144:147]
buffer_load_dwordx4 v3, s[20:23], s50 offen offset:2048 lds
tr a[232:233],v9,512
mm v[144:147],a[236:239],a[188:191],v[144:147]
tr a[234:235],v9,2560
mm v[156:159],a[244:247],a[188:191],v[156:159]
tr a[236:237],v9,4608
mm v[156:159],a[240:243],a[176:179],v[156:159]
tr a[238:239],v9,6656
mm v[152:155],a[240:243],a[172:175],v[152:155]
mm v[152:155],a[244:247],a[184:187],v[152:155]
mm v[148:151],a[244:247],a[180:183],v[148:151]
s_waitcnt lgkmcnt(4)
mm v[148:151],a[240:243],a[168:171],v[148:151]
buffer_load_dwordx4 v4, s[20:23], s50 offen offset:3072 lds
tr a[240:241],v10,512
mm v[160:163],a[216:219],a[0:3],0
tr a[242:243],v10,2560
mm v[160:163],a[220:223],a[12:15],v[160:163]
tr a[244:245],v10,4608
mm v[164:167],a[220:223],a[16:19],0
tr a[246:247],v10,6656
s_add_u32 s53, s68, 4096
mm v[164:167],a[216:219],a[4:7],v[164:167]
mm v[168:171],a[216:219],a[8:11],0
tr a[216:217],v9,8192
cv v112,v112,v113
mm v[168:171],a[220:223],a[20:23],v[168:171]
tr a[218:219],v9,10240
cv v113,v114,v115
mm v[180:183],a[228:231],a[20:23],0
tr a[220:221],v9,12288
s_add_u32 m0, s44, 32768
mm v[180:183],a[224:227],a[8:11],v[180:183]
tr a[222:223],v9,14336
buffer_load_dwordx4 v1, s[20:23], s51 offen offset:0 lds
mm v[176:179],a[224:227],a[4:7],0
cv v114,v116,v117
cv v115,v118,v119
mm v[176:179],a[228:231],a[16:19],v[176:179]
buffer_store_dwordx4 v[112:115], v244, s[24:27], s68 offen offset:0 sc1
mm v[172:175],a[228:231],a[12:15],0
s_waitcnt lgkmcnt(4)
cv v120,v120,v121
mm v[172:175],a[224:227],a[0:3],v[172:175]
tr a[224:225],v10,8192
cv v121,v122,v123
mm v[184:187],a[232:235],a[0:3],0
tr a[226:227],v10,10240
cv v122,v124,v125
mm v[184:187],a[236:239],a[12:15],v[184:187]
tr a[228:229],v10,12288
buffer_load_dwordx4 v2, s[20:23], s51 offen offset:1024 lds
mm v[188:191],a[236:239],a[16:19],0
tr a[230:231],v10,14336
cv v123,v126,v127
mm v[188:191],a[232:235],a[4:7],v[188:191]
buffer_store_dwordx4 v[120:123], v244, s[24:27], s68 offen offset:1024 sc1
mm v[192:195],a[232:235],a[8:11],0
tr a[232:233],v9,8704
cv v128,v128,v129
mm v[192:195],a[236:239],a[20:23],v[192:195]
tr a[234:235],v9,10752
cv v129,v130,v131
mm v[204:207],a[244:247],a[20:23],0
tr a[236:237],v9,12800
cv v130,v132,v133
mm v[204:207],a[240:243],a[8:11],v[204:207]
tr a[238:239],v9,14848
cv v131,v134,v135
mm v[200:203],a[240:243],a[4:7],0
buffer_load_dwordx4 v3, s[20:23], s51 offen offset:2048 lds
buffer_store_dwordx4 v[128:131], v244, s[24:27], s68 offen offset:2048 sc1
mm v[200:203],a[244:247],a[16:19],v[200:203]
mm v[196:199],a[244:247],a[12:15],0
s_waitcnt lgkmcnt(4)
cv v136,v136,v137
mm v[196:199],a[240:243],a[0:3],v[196:199]
tr a[240:241],v10,8704
cv v137,v138,v139
mm v[160:163],a[216:219],a[24:27],v[160:163]
tr a[242:243],v10,10752
cv v138,v140,v141
mm v[160:163],a[220:223],a[36:39],v[160:163]
tr a[244:245],v10,12800
cv v139,v142,v143
mm v[164:167],a[220:223],a[40:43],v[164:167]
tr a[246:247],v10,14848
buffer_store_dwordx4 v[136:139], v244, s[24:27], s68 offen offset:3072 sc1
mm v[164:167],a[216:219],a[28:31],v[164:167]
buffer_load_dwordx4 v4, s[20:23], s51 offen offset:3072 lds
mm v[168:171],a[216:219],a[32:35],v[168:171]
tr a[216:217],v9,16384
cv v144,v144,v145
mm v[168:171],a[220:223],a[44:47],v[168:171]
tr a[218:219],v9,18432
cv v145,v146,v147
mm v[180:183],a[228:231],a[44:47],v[180:183]
tr a[220:221],v9,20480
cv v146,v148,v149
mm v[180:183],a[224:227],a[32:35],v[180:183]
tr a[222:223],v9,22528
cv v147,v150,v151
mm v[176:179],a[224:227],a[28:31],v[176:179]
buffer_store_dwordx4 v[144:147], v244, s[24:27], s53 offen offset:0 sc1
mm v[176:179],a[228:231],a[40:43],v[176:179]
mm v[172:175],a[228:231],a[36:39],v[172:175]
s_waitcnt lgkmcnt(4)
cv v152,v152,v153
mm v[172:175],a[224:227],a[24:27],v[172:175]
tr a[224:225],v10,16384
cv v153,v154,v155
mm v[184:187],a[232:235],a[24:27],v[184:187]
tr a[226:227],v10,18432
cv v154,v156,v157
mm v[184:187],a[236:239],a[36:39],v[184:187]
tr a[228:229],v10,20480
cv v155,v158,v159
mm v[188:191],a[236:239],a[40:43],v[188:191]
buffer_store_dwordx4 v[152:155], v244, s[24:27], s53 offen offset:1024 sc1
tr a[230:231],v10,22528
mm v[188:191],a[232:235],a[28:31],v[188:191]
mm v[192:195],a[232:235],a[32:35],v[192:195]
tr a[232:233],v9,16896
mm v[192:195],a[236:239],a[44:47],v[192:195]
tr a[234:235],v9,18944
mm v[204:207],a[244:247],a[44:47],v[204:207]
tr a[236:237],v9,20992
mm v[204:207],a[240:243],a[32:35],v[204:207]
tr a[238:239],v9,23040
mm v[200:203],a[240:243],a[28:31],v[200:203]
mm v[200:203],a[244:247],a[40:43],v[200:203]
mm v[196:199],a[244:247],a[36:39],v[196:199]
s_waitcnt lgkmcnt(4)
mm v[196:199],a[240:243],a[24:27],v[196:199]
tr a[240:241],v10,16896
mm v[160:163],a[216:219],a[48:51],v[160:163]
tr a[242:243],v10,18944
mm v[160:163],a[220:223],a[60:63],v[160:163]
tr a[244:245],v10,20992
mm v[164:167],a[220:223],a[64:67],v[164:167]
tr a[246:247],v10,23040
mm v[164:167],a[216:219],a[52:55],v[164:167]
mm v[168:171],a[216:219],a[56:59],v[168:171]
tr a[216:217],v9,24576
mm v[168:171],a[220:223],a[68:71],v[168:171]
tr a[218:219],v9,26624
mm v[180:183],a[228:231],a[68:71],v[180:183]
tr a[220:221],v9,28672
mm v[180:183],a[224:227],a[56:59],v[180:183]
tr a[222:223],v9,30720
mm v[176:179],a[224:227],a[52:55],v[176:179]
mm v[176:179],a[228:231],a[64:67],v[176:179]
mm v[172:175],a[228:231],a[60:63],v[172:175]
s_waitcnt lgkmcnt(4)
mm v[172:175],a[224:227],a[48:51],v[172:175]
tr a[224:225],v10,24576
mm v[184:187],a[232:235],a[48:51],v[184:187]
tr a[226:227],v10,26624
mm v[184:187],a[236:239],a[60:63],v[184:187]
tr a[228:229],v10,28672
mm v[188:191],a[236:239],a[64:67],v[188:191]
tr a[230:231],v10,30720
mm v[188:191],a[232:235],a[52:55],v[188:191]
mm v[192:195],a[232:235],a[56:59],v[192:195]
tr a[232:233],v9,25088
mm v[192:195],a[236:239],a[68:71],v[192:195]
tr a[234:235],v9,27136
mm v[204:207],a[244:247],a[68:71],v[204:207]
tr a[236:237],v9,29184
mm v[204:207],a[240:243],a[56:59],v[204:207]
tr a[238:239],v9,31232
mm v[200:203],a[240:243],a[52:55],v[200:203]
mm v[200:203],a[244:247],a[64:67],v[200:203]
mm v[196:199],a[244:247],a[60:63],v[196:199]
s_waitcnt vmcnt(22)
s_waitcnt lgkmcnt(4)
mm v[196:199],a[240:243],a[48:51],v[196:199]
tr a[240:241],v10,25088
mm v[160:163],a[216:219],a[72:75],v[160:163]
s_barrier
tr a[242:243],v10,27136
mm v[160:163],a[220:223],a[84:87],v[160:163]
s_add_u32 s50, s63, 0
s_add_u32 s51, s63, 131072
mm v[164:167],a[220:223],a[88:91],v[164:167]
tr a[244:245],v10,29184
s_add_u32 m0, s43, 131072
mm v[164:167],a[216:219],a[76:79],v[164:167]
tr a[246:247],v10,31232
v_add_u32 v9, 65536, v9
mm v[168:171],a[216:219],a[80:83],v[168:171]
buffer_load_dwordx4 v1, s[20:23], s50 offen offset:0 lds
v_add_u32 v10, 65536, v10
mm v[168:171],a[220:223],a[92:95],v[168:171]
tr a[216:217],v9,0
mm v[180:183],a[228:231],a[92:95],v[180:183]
tr a[218:219],v9,2048
mm v[180:183],a[224:227],a[80:83],v[180:183]
tr a[220:221],v9,4096
mm v[176:179],a[224:227],a[76:79],v[176:179]
tr a[222:223],v9,6144
mm v[176:179],a[228:231],a[88:91],v[176:179]
buffer_load_dwordx4 v2, s[20:23], s50 offen offset:1024 lds
mm v[172:175],a[228:231],a[84:87],v[172:175]
s_waitcnt lgkmcnt(4)
mm v[172:175],a[224:227],a[72:75],v[172:175]
tr a[224:225],v10,0
mm v[184:187],a[232:235],a[72:75],v[184:187]
tr a[226:227],v10,2048
mm v[184:187],a[236:239],a[84:87],v[184:187]
tr a[228:229],v10,4096
mm v[188:191],a[236:239],a[88:91],v[188:191]
tr a[230:231],v10,6144
mm v[188:191],a[232:235],a[76:79],v[188:191]
mm v[192:195],a[232:235],a[80:83],v[192:195]
buffer_load_dwordx4 v3, s[20:23], s50 offen offset:2048 lds
tr a[232:233],v9,512
mm v[192:195],a[236:239],a[92:95],v[192:195]
tr a[234:235],v9,2560
mm v[204:207],a[244:247],a[92:95],v[204:207]
tr a[236:237],v9,4608
mm v[204:207],a[240:243],a[80:83],v[204:207]
tr a[238:239],v9,6656
mm v[200:203],a[240:243],a[76:79],v[200:203]
mm v[200:203],a[244:247],a[88:91],v[200:203]
mm v[196:199],a[244:247],a[84:87],v[196:199]
s_waitcnt lgkmcnt(4)
mm v[196:199],a[240:243],a[72:75],v[196:199]
buffer_load_dwordx4 v4, s[20:23], s50 offen offset:3072 lds
tr a[240:241],v10,512
mm v[160:163],a[216:219],a[96:99],v[160:163]
tr a[242:243],v10,2560
mm v[160:163],a[220:223],a[108:111],v[160:163]
tr a[244:245],v10,4608
mm v[164:167],a[220:223],a[112:115],v[164:167]
tr a[246:247],v10,6656
mm v[164:167],a[216:219],a[100:103],v[164:167]
mm v[168:171],a[216:219],a[104:107],v[168:171]
tr a[216:217],v9,8192
mm v[168:171],a[220:223],a[116:119],v[168:171]
tr a[218:219],v9,10240
mm v[180:183],a[228:231],a[116:119],v[180:183]
tr a[220:221],v9,12288
s_add_u32 m0, s44, 131072
mm v[180:183],a[224:227],a[104:107],v[180:183]
tr a[222:223],v9,14336
buffer_load_dwordx4 v1, s[20:23], s51 offen offset:0 lds
mm v[176:179],a[224:227],a[100:103],v[176:179]
mm v[176:179],a[228:231],a[112:115],v[176:179]
mm v[172:175],a[228:231],a[108:111],v[172:175]
s_waitcnt lgkmcnt(4)
mm v[172:175],a[224:227],a[96:99],v[172:175]
tr a[224:225],v10,8192
mm v[184:187],a[232:235],a[96:99],v[184:187]
tr a[226:227],v10,10240
mm v[184:187],a[236:239],a[108:111],v[184:187]
tr a[228:229],v10,12288
buffer_load_dwordx4 v2, s[20:23], s51 offen offset:1024 lds
mm v[188:191],a[236:239],a[112:115],v[188:191]
tr a[230:231],v10,14336
mm v[188:191],a[232:235],a[100:103],v[188:191]
mm v[192:195],a[232:235],a[104:107],v[192:195]
tr a[232:233],v9,8704
mm v[192:195],a[236:239],a[116:119],v[192:195]
tr a[234:235],v9,10752
mm v[204:207],a[244:247],a[116:119],v[204:207]
tr a[236:237],v9,12800
mm v[204:207],a[240:243],a[104:107],v[204:207]
tr a[238:239],v9,14848
mm v[200:203],a[240:243],a[100:103],v[200:203]
buffer_load_dwordx4 v3, s[20:23], s51 offen offset:2048 lds
mm v[200:203],a[244:247],a[112:115],v[200:203]
mm v[196:199],a[244:247],a[108:111],v[196:199]
s_waitcnt lgkmcnt(4)
mm v[196:199],a[240:243],a[96:99],v[196:199]
tr a[240:241],v10,8704
mm v[160:163],a[216:219],a[120:123],v[160:163]
tr a[242:243],v10,10752
mm v[160:163],a[220:223],a[132:135],v[160:163]
tr a[244:245],v10,12800
mm v[164:167],a[220:223],a[136:139],v[164:167]
tr a[246:247],v10,14848
mm v[164:167],a[216:219],a[124:127],v[164:167]
buffer_load_dwordx4 v4, s[20:23], s51 offen offset:3072 lds
mm v[168:171],a[216:219],a[128:131],v[168:171]
tr a[216:217],v9,16384
mm v[168:171],a[220:223],a[140:143],v[168:171]
tr a[218:219],v9,18432
mm v[180:183],a[228:231],a[140:143],v[180:183]
tr a[220:221],v9,20480
mm v[180:183],a[224:227],a[128:131],v[180:183]
tr a[222:223],v9,22528
mm v[176:179],a[224:227],a[124:127],v[176:179]
mm v[176:179],a[228:231],a[136:139],v[176:179]
mm v[172:175],a[228:231],a[132:135],v[172:175]
s_waitcnt lgkmcnt(4)
mm v[172:175],a[224:227],a[120:123],v[172:175]
tr a[224:225],v10,16384
mm v[184:187],a[232:235],a[120:123],v[184:187]
tr a[226:227],v10,18432
mm v[184:187],a[236:239],a[132:135],v[184:187]
tr a[228:229],v10,20480
mm v[188:191],a[236:239],a[136:139],v[188:191]
tr a[230:231],v10,22528
mm v[188:191],a[232:235],a[124:127],v[188:191]
s_waitcnt vmcnt(8)
mm v[192:195],a[232:235],a[128:131],v[192:195]
buffer_store_dword v247, v245, s[28:31], s84 offen offset:0 sc1
tr a[232:233],v9,16896
mm v[192:195],a[236:239],a[140:143],v[192:195]
tr a[234:235],v9,18944
mm v[204:207],a[244:247],a[140:143],v[204:207]
tr a[236:237],v9,20992
mm v[204:207],a[240:243],a[128:131],v[204:207]
tr a[238:239],v9,23040
mm v[200:203],a[240:243],a[124:127],v[200:203]
mm v[200:203],a[244:247],a[136:139],v[200:203]
mm v[196:199],a[244:247],a[132:135],v[196:199]
s_waitcnt lgkmcnt(4)
mm v[196:199],a[240:243],a[120:123],v[196:199]
tr a[240:241],v10,16896
mm v[160:163],a[216:219],a[144:147],v[160:163]
tr a[242:243],v10,18944
mm v[160:163],a[220:223],a[156:159],v[160:163]
tr a[244:245],v10,20992
mm v[164:167],a[220:223],a[160:163],v[164:167]
tr a[246:247],v10,23040
mm v[164:167],a[216:219],a[148:151],v[164:167]
mm v[168:171],a[216:219],a[152:155],v[168:171]
tr a[216:217],v9,24576
mm v[168:171],a[220:223],a[164:167],v[168:171]
tr a[218:219],v9,26624
mm v[180:183],a[228:231],a[164:167],v[180:183]
tr a[220:221],v9,28672
mm v[180:183],a[224:227],a[152:155],v[180:183]
tr a[222:223],v9,30720
mm v[176:179],a[224:227],a[148:151],v[176:179]
mm v[176:179],a[228:231],a[160:163],v[176:179]
mm v[172:175],a[228:231],a[156:159],v[172:175]
s_waitcnt lgkmcnt(4)
mm v[172:175],a[224:227],a[144:147],v[172:175]
tr a[224:225],v10,24576
mm v[184:187],a[232:235],a[144:147],v[184:187]
tr a[226:227],v10,26624
mm v[184:187],a[236:239],a[156:159],v[184:187]
tr a[228:229],v10,28672
mm v[188:191],a[236:239],a[160:163],v[188:191]
tr a[230:231],v10,30720
mm v[188:191],a[232:235],a[148:151],v[188:191]
mm v[192:195],a[232:235],a[152:155],v[192:195]
tr a[232:233],v9,25088
mm v[192:195],a[236:239],a[164:167],v[192:195]
tr a[234:235],v9,27136
mm v[204:207],a[244:247],a[164:167],v[204:207]
tr a[236:237],v9,29184
mm v[204:207],a[240:243],a[152:155],v[204:207]
tr a[238:239],v9,31232
mm v[200:203],a[240:243],a[148:151],v[200:203]
mm v[200:203],a[244:247],a[160:163],v[200:203]
mm v[196:199],a[244:247],a[156:159],v[196:199]
s_waitcnt vmcnt(63)
s_waitcnt lgkmcnt(4)
mm v[196:199],a[240:243],a[144:147],v[196:199]
tr a[240:241],v10,25088
mm v[160:163],a[216:219],a[168:171],v[160:163]
s_barrier
tr a[242:243],v10,27136
mm v[160:163],a[220:223],a[180:183],v[160:163]
s_add_u32 s50, s63, 262144
s_add_u32 s51, s63, 393216
mm v[164:167],a[220:223],a[184:187],v[164:167]
tr a[244:245],v10,29184
s_add_u32 m0, s43, 0
mm v[164:167],a[216:219],a[172:175],v[164:167]
tr a[246:247],v10,31232
buffer_load_dwordx4 v1, s[20:23], s50 offen offset:0 lds
mm v[168:171],a[216:219],a[176:179],v[168:171]
tr a[216:217],v9,32768
mm v[168:171],a[220:223],a[188:191],v[168:171]
tr a[218:219],v9,34816
mm v[180:183],a[228:231],a[188:191],v[180:183]
tr a[220:221],v9,36864
mm v[180:183],a[224:227],a[176:179],v[180:183]
tr a[222:223],v9,38912
mm v[176:179],a[224:227],a[172:175],v[176:179]
mm v[176:179],a[228:231],a[184:187],v[176:179]
buffer_load_dwordx4 v2, s[20:23], s50 offen offset:1024 lds
mm v[172:175],a[228:231],a[180:183],v[172:175]
s_waitcnt lgkmcnt(4)
mm v[172:175],a[224:227],a[168:171],v[172:175]
tr a[224:225],v10,32768
mm v[184:187],a[232:235],a[168:171],v[184:187]
tr a[226:227],v10,34816
mm v[184:187],a[236:239],a[180:183],v[184:187]
tr a[228:229],v10,36864
mm v[188:191],a[236:239],a[184:187],v[188:191]
tr a[230:231],v10,38912
mm v[188:191],a[232:235],a[172:175],v[188:191]
mm v[192:195],a[232:235],a[176:179],v[192:195]
buffer_load_dwordx4 v3, s[20:23], s50 offen offset:2048 lds
tr a[232:233],v9,33280
mm v[192:195],a[236:239],a[188:191],v[192:195]
tr a[234:235],v9,35328
mm v[204:207],a[244:247],a[188:191],v[204:207]
tr a[236:237],v9,37376
mm v[204:207],a[240:243],a[176:179],v[204:207]
tr a[238:239],v9,39424
mm v[200:203],a[240:243],a[172:175],v[200:203]
mm v[200:203],a[244:247],a[184:187],v[200:203]
mm v[196:199],a[244:247],a[180:183],v[196:199]
s_waitcnt lgkmcnt(4)
mm v[196:199],a[240:243],a[168:171],v[196:199]
buffer_load_dwordx4 v4, s[20:23], s50 offen offset:3072 lds
tr a[240:241],v10,33280
mm v[112:115],a[216:219],a[0:3],0
tr a[242:243],v10,35328
mm v[112:115],a[220:223],a[12:15],v[112:115]
tr a[244:245],v10,37376
mm v[116:119],a[220:223],a[16:19],0
tr a[246:247],v10,39424
s_add_u32 s53, s69, 4096
mm v[116:119],a[216:219],a[4:7],v[116:119]
mm v[120:123],a[216:219],a[8:11],0
tr a[216:217],v9,40960
cv v160,v160,v161
mm v[120:123],a[220:223],a[20:23],v[120:123]
tr a[218:219],v9,43008
cv v161,v162,v163
mm v[132:135],a[228:231],a[20:23],0
tr a[220:221],v9,45056
s_add_u32 m0, s44, 0
mm v[132:135],a[224:227],a[8:11],v[132:135]
tr a[222:223],v9,47104
buffer_load_dwordx4 v1, s[20:23], s51 offen offset:0 lds
mm v[128:131],a[224:227],a[4:7],0
cv v162,v164,v165
cv v163,v166,v167
mm v[128:131],a[228:231],a[16:19],v[128:131]
buffer_store_dwordx4 v[160:163], v244, s[24:27], s69 offen offset:0 sc1
mm v[124:127],a[228:231],a[12:15],0
s_waitcnt lgkmcnt(4)
cv v168,v168,v169
mm v[124:127],a[224:227],a[0:3],v[124:127]
tr a[224:225],v10,40960
cv v169,v170,v171
mm v[136:139],a[232:235],a[0:3],0
tr a[226:227],v10,43008
cv v170,v172,v173
mm v[136:139],a[236:239],a[12:15],v[136:139]
tr a[228:229],v10,45056
buffer_load_dwordx4 v2, s[20:23], s51 offen offset:1024 lds
mm v[140:143],a[236:239],a[16:19],0
tr a[230:231],v10,47104
cv v171,v174,v175
mm v[140:143],a[232:235],a[4:7],v[140:143]
buffer_store_dwordx4 v[168:171], v244, s[24:27], s69 offen offset:1024 sc1
mm v[144:147],a[232:235],a[8:11],0
tr a[232:233],v9,41472
cv v176,v176,v177
mm v[144:147],a[236:239],a[20:23],v[144:147]
tr a[234:235],v9,43520
cv v177,v178,v179
mm v[156:159],a[244:247],a[20:23],0
tr a[236:237],v9,45568
cv v178,v180,v181
mm v[156:159],a[240:243],a[8:11],v[156:159]
tr a[238:239],v9,47616
cv v179,v182,v183
mm v[152:155],a[240:243],a[4:7],0
buffer_load_dwordx4 v3, s[20:23], s51 offen offset:2048 lds
buffer_store_dwordx4 v[176:179], v244, s[24:27], s69 offen offset:2048 sc1
mm v[152:155],a[244:247],a[16:19],v[152:155]
mm v[148:151],a[244:247],a[12:15],0
s_waitcnt lgkmcnt(4)
cv v184,v184,v185
L_pg24:
s_cbranch_execz L_pg28
mm v[148:151],a[240:243],a[0:3],v[148:151]
tr a[240:241],v10,41472
cv v185,v186,v187
mm v[112:115],a[216:219],a[24:27],v[112:115]
tr a[242:243],v10,43520
cv v186,v188,v189
mm v[112:115],a[220:223],a[36:39],v[112:115]
tr a[244:245],v10,45568
cv v187,v190,v191
mm v[116:119],a[220:223],a[40:43],v[116:119]
tr a[246:247],v10,47616
buffer_store_dwordx4 v[184:187], v244, s[24:27], s69 offen offset:3072 sc1
mm v[116:119],a[216:219],a[28:31],v[116:119]
buffer_load_dwordx4 v4, s[20:23], s51 offen offset:3072 lds
mm v[120:123],a[216:219],a[32:35],v[120:123]
tr a[216:217],v9,49152
cv v192,v192,v193
mm v[120:123],a[220:223],a[44:47],v[120:123]
tr a[218:219],v9,51200
cv v193,v194,v195
mm v[132:135],a[228:231],a[44:47],v[132:135]
tr a[220:221],v9,53248
cv v194,v196,v197
mm v[132:135],a[224:227],a[32:35],v[132:135]
tr a[222:223],v9,55296
cv v195,v198,v199
mm v[128:131],a[224:227],a[28:31],v[128:131]
buffer_store_dwordx4 v[192:195], v244, s[24:27], s53 offen offset:0 sc1
mm v[128:131],a[228:231],a[40:43],v[128:131]
mm v[124:127],a[228:231],a[36:39],v[124:127]
s_waitcnt lgkmcnt(4)
cv v200,v200,v201
mm v[124:127],a[224:227],a[24:27],v[124:127]
tr a[224:225],v10,49152
cv v201,v202,v203
mm v[136:139],a[232:235],a[24:27],v[136:139]
tr a[226:227],v10,51200
cv v202,v204,v205
mm v[136:139],a[236:239],a[36:39],v[136:139]
tr a[228:229],v10,53248
cv v203,v206,v207
mm v[140:143],a[236:239],a[40:43],v[140:143]
buffer_store_dwordx4 v[200:203], v244, s[24:27], s53 offen offset:1024 sc1
tr a[230:231],v10,55296
mm v[140:143],a[232:235],a[28:31],v[140:143]
mm v[144:147],a[232:235],a[32:35],v[144:147]
tr a[232:233],v9,49664
mm v[144:147],a[236:239],a[44:47],v[144:147]
tr a[234:235],v9,51712
mm v[156:159],a[244:247],a[44:47],v[156:159]
tr a[236:237],v9,53760
mm v[156:159],a[240:243],a[32:35],v[156:159]
tr a[238:239],v9,55808
mm v[152:155],a[240:243],a[28:31],v[152:155]
mm v[152:155],a[244:247],a[40:43],v[152:155]
mm v[148:151],a[244:247],a[36:39],v[148:151]
s_waitcnt lgkmcnt(4)
buffer_load_dword v253, v255, s[28:31], s91 offen offset:0 sc1
mm v[148:151],a[240:243],a[24:27],v[148:151]
tr a[240:241],v10,49664
mm v[112:115],a[216:219],a[48:51],v[112:115]
tr a[242:243],v10,51712
mm v[112:115],a[220:223],a[60:63],v[112:115]
tr a[244:245],v10,53760
mm v[116:119],a[220:223],a[64:67],v[116:119]
tr a[246:247],v10,55808
mm v[116:119],a[216:219],a[52:55],v[116:119]
mm v[120:123],a[216:219],a[56:59],v[120:123]
tr a[216:217],v9,57344
mm v[120:123],a[220:223],a[68:71],v[120:123]
tr a[218:219],v9,59392
mm v[132:135],a[228:231],a[68:71],v[132:135]
tr a[220:221],v9,61440
mm v[132:135],a[224:227],a[56:59],v[132:135]
tr a[222:223],v9,63488
mm v[128:131],a[224:227],a[52:55],v[128:131]
mm v[128:131],a[228:231],a[64:67],v[128:131]
mm v[124:127],a[228:231],a[60:63],v[124:127]
s_waitcnt lgkmcnt(4)
mm v[124:127],a[224:227],a[48:51],v[124:127]
tr a[224:225],v10,57344
mm v[136:139],a[232:235],a[48:51],v[136:139]
tr a[226:227],v10,59392
mm v[136:139],a[236:239],a[60:63],v[136:139]
tr a[228:229],v10,61440
mm v[140:143],a[236:239],a[64:67],v[140:143]
tr a[230:231],v10,63488
mm v[140:143],a[232:235],a[52:55],v[140:143]
mm v[144:147],a[232:235],a[56:59],v[144:147]
tr a[232:233],v9,57856
mm v[144:147],a[236:239],a[68:71],v[144:147]
tr a[234:235],v9,59904
mm v[156:159],a[244:247],a[68:71],v[156:159]
tr a[236:237],v9,61952
mm v[156:159],a[240:243],a[56:59],v[156:159]
tr a[238:239],v9,64000
mm v[152:155],a[240:243],a[52:55],v[152:155]
mm v[152:155],a[244:247],a[64:67],v[152:155]
mm v[148:151],a[244:247],a[60:63],v[148:151]
s_waitcnt vmcnt(63)
s_waitcnt lgkmcnt(4)
mm v[148:151],a[240:243],a[48:51],v[148:151]
tr a[240:241],v10,57856
mm v[112:115],a[216:219],a[72:75],v[112:115]
s_barrier
tr a[242:243],v10,59904
mm v[112:115],a[220:223],a[84:87],v[112:115]
s_add_u32 s50, s64, 0
s_add_u32 s51, s64, 131072
mm v[116:119],a[220:223],a[88:91],v[116:119]
tr a[244:245],v10,61952
s_add_u32 m0, s43, 65536
mm v[116:119],a[216:219],a[76:79],v[116:119]
tr a[246:247],v10,64000
v_add_u32 v9, 4294934528, v9
mm v[120:123],a[216:219],a[80:83],v[120:123]
buffer_load_dwordx4 v1, s[20:23], s50 offen offset:0 lds
v_add_u32 v10, 4294934528, v10
mm v[120:123],a[220:223],a[92:95],v[120:123]
tr a[216:217],v9,0
mm v[132:135],a[228:231],a[92:95],v[132:135]
tr a[218:219],v9,2048
mm v[132:135],a[224:227],a[80:83],v[132:135]
tr a[220:221],v9,4096
mm v[128:131],a[224:227],a[76:79],v[128:131]
tr a[222:223],v9,6144
mm v[128:131],a[228:231],a[88:91],v[128:131]
buffer_load_dwordx4 v2, s[20:23], s50 offen offset:1024 lds
mm v[124:127],a[228:231],a[84:87],v[124:127]
s_waitcnt lgkmcnt(4)
mm v[124:127],a[224:227],a[72:75],v[124:127]
tr a[224:225],v10,0
mm v[136:139],a[232:235],a[72:75],v[136:139]
tr a[226:227],v10,2048
mm v[136:139],a[236:239],a[84:87],v[136:139]
tr a[228:229],v10,4096
mm v[140:143],a[236:239],a[88:91],v[140:143]
tr a[230:231],v10,6144
mm v[140:143],a[232:235],a[76:79],v[140:143]
mm v[144:147],a[232:235],a[80:83],v[144:147]
buffer_load_dwordx4 v3, s[20:23], s50 offen offset:2048 lds
tr a[232:233],v9,512
mm v[144:147],a[236:239],a[92:95],v[144:147]
tr a[234:235],v9,2560
mm v[156:159],a[244:247],a[92:95],v[156:159]
tr a[236:237],v9,4608
mm v[156:159],a[240:243],a[80:83],v[156:159]
tr a[238:239],v9,6656
mm v[152:155],a[240:243],a[76:79],v[152:155]
mm v[152:155],a[244:247],a[88:91],v[152:155]
mm v[148:151],a[244:247],a[84:87],v[148:151]
s_waitcnt lgkmcnt(4)
mm v[148:151],a[240:243],a[72:75],v[148:151]
buffer_load_dwordx4 v4, s[20:23], s50 offen offset:3072 lds
tr a[240:241],v10,512
mm v[112:115],a[216:219],a[96:99],v[112:115]
tr a[242:243],v10,2560
mm v[112:115],a[220:223],a[108:111],v[112:115]
tr a[244:245],v10,4608
mm v[116:119],a[220:223],a[112:115],v[116:119]
tr a[246:247],v10,6656
mm v[116:119],a[216:219],a[100:103],v[116:119]
mm v[120:123],a[216:219],a[104:107],v[120:123]
tr a[216:217],v9,8192
mm v[120:123],a[220:223],a[116:119],v[120:123]
tr a[218:219],v9,10240
mm v[132:135],a[228:231],a[116:119],v[132:135]
tr a[220:221],v9,12288
s_add_u32 m0, s44, 65536
mm v[132:135],a[224:227],a[104:107],v[132:135]
tr a[222:223],v9,14336
buffer_load_dwordx4 v1, s[20:23], s51 offen offset:0 lds
mm v[128:131],a[224:227],a[100:103],v[128:131]
mm v[128:131],a[228:231],a[112:115],v[128:131]
mm v[124:127],a[228:231],a[108:111],v[124:127]
s_waitcnt lgkmcnt(4)
mm v[124:127],a[224:227],a[96:99],v[124:127]
tr a[224:225],v10,8192
mm v[136:139],a[232:235],a[96:99],v[136:139]
tr a[226:227],v10,10240
mm v[136:139],a[236:239],a[108:111],v[136:139]
tr a[228:229],v10,12288
buffer_load_dwordx4 v2, s[20:23], s51 offen offset:1024 lds
mm v[140:143],a[236:239],a[112:115],v[140:143]
tr a[230:231],v10,14336
mm v[140:143],a[232:235],a[100:103],v[140:143]
mm v[144:147],a[232:235],a[104:107],v[144:147]
tr a[232:233],v9,8704
mm v[144:147],a[236:239],a[116:119],v[144:147]
tr a[234:235],v9,10752
mm v[156:159],a[244:247],a[116:119],v[156:159]
tr a[236:237],v9,12800
mm v[156:159],a[240:243],a[104:107],v[156:159]
tr a[238:239],v9,14848
mm v[152:155],a[240:243],a[100:103],v[152:155]
buffer_load_dwordx4 v3, s[20:23], s51 offen offset:2048 lds
mm v[152:155],a[244:247],a[112:115],v[152:155]
mm v[148:151],a[244:247],a[108:111],v[148:151]
s_waitcnt lgkmcnt(4)
mm v[148:151],a[240:243],a[96:99],v[148:151]
tr a[240:241],v10,8704
mm v[112:115],a[216:219],a[120:123],v[112:115]
tr a[242:243],v10,10752
mm v[112:115],a[220:223],a[132:135],v[112:115]
tr a[244:245],v10,12800
mm v[116:119],a[220:223],a[136:139],v[116:119]
tr a[246:247],v10,14848
mm v[116:119],a[216:219],a[124:127],v[116:119]
buffer_load_dwordx4 v4, s[20:23], s51 offen offset:3072 lds
mm v[120:123],a[216:219],a[128:131],v[120:123]
tr a[216:217],v9,16384
mm v[120:123],a[220:223],a[140:143],v[120:123]
tr a[218:219],v9,18432
mm v[132:135],a[228:231],a[140:143],v[132:135]
tr a[220:221],v9,20480
mm v[132:135],a[224:227],a[128:131],v[132:135]
tr a[222:223],v9,22528
mm v[128:131],a[224:227],a[124:127],v[128:131]
mm v[128:131],a[228:231],a[136:139],v[128:131]
mm v[124:127],a[228:231],a[132:135],v[124:127]
s_waitcnt lgkmcnt(4)
mm v[124:127],a[224:227],a[120:123],v[124:127]
tr a[224:225],v10,16384
mm v[136:139],a[232:235],a[120:123],v[136:139]
tr a[226:227],v10,18432
mm v[136:139],a[236:239],a[132:135],v[136:139]
tr a[228:229],v10,20480
mm v[140:143],a[236:239],a[136:139],v[140:143]
tr a[230:231],v10,22528
mm v[140:143],a[232:235],a[124:127],v[140:143]
s_waitcnt vmcnt(9)
mm v[144:147],a[232:235],a[128:131],v[144:147]
buffer_store_dword v247, v245, s[28:31], s85 offen offset:0 sc1
tr a[232:233],v9,16896
mm v[144:147],a[236:239],a[140:143],v[144:147]
tr a[234:235],v9,18944
mm v[156:159],a[244:247],a[140:143],v[156:159]
tr a[236:237],v9,20992
mm v[156:159],a[240:243],a[128:131],v[156:159]
tr a[238:239],v9,23040
mm v[152:155],a[240:243],a[124:127],v[152:155]
s_waitcnt vmcnt(9)
mm v[152:155],a[244:247],a[136:139],v[152:155]
v_cmp_ne_u32 s[92:93], 1, v253
mm v[148:151],a[244:247],a[132:135],v[148:151]
s_waitcnt lgkmcnt(4)
mm v[148:151],a[240:243],a[120:123],v[148:151]
tr a[240:241],v10,16896
mm v[112:115],a[216:219],a[144:147],v[112:115]
s_and_b32 s55, s92, 1
tr a[242:243],v10,18944
mm v[112:115],a[220:223],a[156:159],v[112:115]
tr a[244:245],v10,20992
s_or_b32 s6, s6, s55
mm v[116:119],a[220:223],a[160:163],v[116:119]
tr a[246:247],v10,23040
mm v[116:119],a[216:219],a[148:151],v[116:119]
mm v[120:123],a[216:219],a[152:155],v[120:123]
tr a[216:217],v9,24576
mm v[120:123],a[220:223],a[164:167],v[120:123]
tr a[218:219],v9,26624
mm v[132:135],a[228:231],a[164:167],v[132:135]
tr a[220:221],v9,28672
mm v[132:135],a[224:227],a[152:155],v[132:135]
tr a[222:223],v9,30720
mm v[128:131],a[224:227],a[148:151],v[128:131]
mm v[128:131],a[228:231],a[160:163],v[128:131]
mm v[124:127],a[228:231],a[156:159],v[124:127]
s_waitcnt lgkmcnt(4)
mm v[124:127],a[224:227],a[144:147],v[124:127]
tr a[224:225],v10,24576
mm v[136:139],a[232:235],a[144:147],v[136:139]
tr a[226:227],v10,26624
mm v[136:139],a[236:239],a[156:159],v[136:139]
tr a[228:229],v10,28672
mm v[140:143],a[236:239],a[160:163],v[140:143]
tr a[230:231],v10,30720
mm v[140:143],a[232:235],a[148:151],v[140:143]
mm v[144:147],a[232:235],a[152:155],v[144:147]
tr a[232:233],v9,25088
mm v[144:147],a[236:239],a[164:167],v[144:147]
tr a[234:235],v9,27136
mm v[156:159],a[244:247],a[164:167],v[156:159]
tr a[236:237],v9,29184
mm v[156:159],a[240:243],a[152:155],v[156:159]
tr a[238:239],v9,31232
mm v[152:155],a[240:243],a[148:151],v[152:155]
mm v[152:155],a[244:247],a[160:163],v[152:155]
mm v[148:151],a[244:247],a[156:159],v[148:151]
s_waitcnt vmcnt(63)
s_waitcnt lgkmcnt(4)
mm v[148:151],a[240:243],a[144:147],v[148:151]
tr a[240:241],v10,25088
mm v[112:115],a[216:219],a[168:171],v[112:115]
s_barrier
tr a[242:243],v10,27136
mm v[112:115],a[220:223],a[180:183],v[112:115]
s_add_u32 s50, s64, 262144
s_add_u32 s51, s64, 393216
mm v[116:119],a[220:223],a[184:187],v[116:119]
tr a[244:245],v10,29184
s_add_u32 m0, s43, 98304
mm v[116:119],a[216:219],a[172:175],v[116:119]
tr a[246:247],v10,31232
v_add_u32 v9, 98304, v9
mm v[120:123],a[216:219],a[176:179],v[120:123]
buffer_load_dwordx4 v1, s[20:23], s50 offen offset:0 lds
v_add_u32 v10, 98304, v10
mm v[120:123],a[220:223],a[188:191],v[120:123]
tr a[216:217],v9,0
mm v[132:135],a[228:231],a[188:191],v[132:135]
tr a[218:219],v9,2048
mm v[132:135],a[224:227],a[176:179],v[132:135]
tr a[220:221],v9,4096
mm v[128:131],a[224:227],a[172:175],v[128:131]
tr a[222:223],v9,6144
mm v[128:131],a[228:231],a[184:187],v[128:131]
buffer_load_dwordx4 v2, s[20:23], s50 offen offset:1024 lds
mm v[124:127],a[228:231],a[180:183],v[124:127]
s_waitcnt lgkmcnt(4)
mm v[124:127],a[224:227],a[168:171],v[124:127]
tr a[224:225],v10,0
mm v[136:139],a[232:235],a[168:171],v[136:139]
tr a[226:227],v10,2048
mm v[136:139],a[236:239],a[180:183],v[136:139]
tr a[228:229],v10,4096
mm v[140:143],a[236:239],a[184:187],v[140:143]
tr a[230:231],v10,6144
mm v[140:143],a[232:235],a[172:175],v[140:143]
mm v[144:147],a[232:235],a[176:179],v[144:147]
buffer_load_dwordx4 v3, s[20:23], s50 offen offset:2048 lds
tr a[232:233],v9,512
mm v[144:147],a[236:239],a[188:191],v[144:147]
tr a[234:235],v9,2560
mm v[156:159],a[244:247],a[188:191],v[156:159]
tr a[236:237],v9,4608
mm v[156:159],a[240:243],a[176:179],v[156:159]
tr a[238:239],v9,6656
mm v[152:155],a[240:243],a[172:175],v[152:155]
mm v[152:155],a[244:247],a[184:187],v[152:155]
mm v[148:151],a[244:247],a[180:183],v[148:151]
s_waitcnt lgkmcnt(4)
mm v[148:151],a[240:243],a[168:171],v[148:151]
buffer_load_dwordx4 v4, s[20:23], s50 offen offset:3072 lds
tr a[240:241],v10,512
mm v[160:163],a[216:219],a[0:3],0
tr a[242:243],v10,2560
mm v[160:163],a[220:223],a[12:15],v[160:163]
tr a[244:245],v10,4608
mm v[164:167],a[220:223],a[16:19],0
tr a[246:247],v10,6656
s_add_u32 s53, s70, 4096
mm v[164:167],a[216:219],a[4:7],v[164:167]
mm v[168:171],a[216:219],a[8:11],0
tr a[216:217],v9,8192
cv v112,v112,v113
mm v[168:171],a[220:223],a[20:23],v[168:171]
tr a[218:219],v9,10240
cv v113,v114,v115
mm v[180:183],a[228:231],a[20:23],0
tr a[220:221],v9,12288
s_add_u32 m0, s44, 98304
mm v[180:183],a[224:227],a[8:11],v[180:183]
tr a[222:223],v9,14336
buffer_load_dwordx4 v1, s[20:23], s51 offen offset:0 lds
mm v[176:179],a[224:227],a[4:7],0
cv v114,v116,v117
cv v115,v118,v119
mm v[176:179],a[228:231],a[16:19],v[176:179]
buffer_store_dwordx4 v[112:115], v244, s[24:27], s70 offen offset:0 sc1
mm v[172:175],a[228:231],a[12:15],0
s_waitcnt lgkmcnt(4)
cv v120,v120,v121
mm v[172:175],a[224:227],a[0:3],v[172:175]
tr a[224:225],v10,8192
cv v121,v122,v123
mm v[184:187],a[232:235],a[0:3],0
tr a[226:227],v10,10240
cv v122,v124,v125
mm v[184:187],a[236:239],a[12:15],v[184:187]
tr a[228:229],v10,12288
buffer_load_dwordx4 v2, s[20:23], s51 offen offset:1024 lds
mm v[188:191],a[236:239],a[16:19],0
tr a[230:231],v10,14336
cv v123,v126,v127
mm v[188:191],a[232:235],a[4:7],v[188:191]
buffer_store_dwordx4 v[120:123], v244, s[24:27], s70 offen offset:1024 sc1
mm v[192:195],a[232:235],a[8:11],0
tr a[232:233],v9,8704
cv v128,v128,v129
mm v[192:195],a[236:239],a[20:23],v[192:195]
tr a[234:235],v9,10752
cv v129,v130,v131
mm v[204:207],a[244:247],a[20:23],0
tr a[236:237],v9,12800
cv v130,v132,v133
mm v[204:207],a[240:243],a[8:11],v[204:207]
tr a[238:239],v9,14848
cv v131,v134,v135
mm v[200:203],a[240:243],a[4:7],0
buffer_load_dwordx4 v3, s[20:23], s51 offen offset:2048 lds
buffer_store_dwordx4 v[128:131], v244, s[24:27], s70 offen offset:2048 sc1
mm v[200:203],a[244:247],a[16:19],v[200:203]
mm v[196:199],a[244:247],a[12:15],0
s_waitcnt lgkmcnt(4)
cv v136,v136,v137
mm v[196:199],a[240:243],a[0:3],v[196:199]
tr a[240:241],v10,8704
cv v137,v138,v139
mm v[160:163],a[216:219],a[24:27],v[160:163]
tr a[242:243],v10,10752
cv v138,v140,v141
mm v[160:163],a[220:223],a[36:39],v[160:163]
tr a[244:245],v10,12800
cv v139,v142,v143
mm v[164:167],a[220:223],a[40:43],v[164:167]
tr a[246:247],v10,14848
buffer_store_dwordx4 v[136:139], v244, s[24:27], s70 offen offset:3072 sc1
mm v[164:167],a[216:219],a[28:31],v[164:167]
buffer_load_dwordx4 v4, s[20:23], s51 offen offset:3072 lds
mm v[168:171],a[216:219],a[32:35],v[168:171]
tr a[216:217],v9,16384
cv v144,v144,v145
mm v[168:171],a[220:223],a[44:47],v[168:171]
tr a[218:219],v9,18432
cv v145,v146,v147
mm v[180:183],a[228:231],a[44:47],v[180:183]
tr a[220:221],v9,20480
cv v146,v148,v149
mm v[180:183],a[224:227],a[32:35],v[180:183]
tr a[222:223],v9,22528
cv v147,v150,v151
mm v[176:179],a[224:227],a[28:31],v[176:179]
buffer_store_dwordx4 v[144:147], v244, s[24:27], s53 offen offset:0 sc1
mm v[176:179],a[228:231],a[40:43],v[176:179]
mm v[172:175],a[228:231],a[36:39],v[172:175]
s_waitcnt lgkmcnt(4)
cv v152,v152,v153
mm v[172:175],a[224:227],a[24:27],v[172:175]
tr a[224:225],v10,16384
cv v153,v154,v155
mm v[184:187],a[232:235],a[24:27],v[184:187]
tr a[226:227],v10,18432
cv v154,v156,v157
mm v[184:187],a[236:239],a[36:39],v[184:187]
tr a[228:229],v10,20480
cv v155,v158,v159
mm v[188:191],a[236:239],a[40:43],v[188:191]
buffer_store_dwordx4 v[152:155], v244, s[24:27], s53 offen offset:1024 sc1
tr a[230:231],v10,22528
mm v[188:191],a[232:235],a[28:31],v[188:191]
mm v[192:195],a[232:235],a[32:35],v[192:195]
tr a[232:233],v9,16896
mm v[192:195],a[236:239],a[44:47],v[192:195]
tr a[234:235],v9,18944
mm v[204:207],a[244:247],a[44:47],v[204:207]
tr a[236:237],v9,20992
mm v[204:207],a[240:243],a[32:35],v[204:207]
tr a[238:239],v9,23040
mm v[200:203],a[240:243],a[28:31],v[200:203]
s_bitcmp1_b32 s92, 0
s_cselect_b32 s4, s7, s76
mm v[200:203],a[244:247],a[40:43],v[200:203]
s_add_u32 s5, s4, 4096
mm v[196:199],a[244:247],a[36:39],v[196:199]
s_waitcnt lgkmcnt(4)
mm v[196:199],a[240:243],a[24:27],v[196:199]
tr a[240:241],v10,16896
mm v[160:163],a[216:219],a[48:51],v[160:163]
buffer_load_dwordx4 v[16:19], v244, s[24:27], s4 offen offset:0 sc1
tr a[242:243],v10,18944
mm v[160:163],a[220:223],a[60:63],v[160:163]
tr a[244:245],v10,20992
mm v[164:167],a[220:223],a[64:67],v[164:167]
tr a[246:247],v10,23040
mm v[164:167],a[216:219],a[52:55],v[164:167]
mm v[168:171],a[216:219],a[56:59],v[168:171]
tr a[216:217],v9,24576
mm v[168:171],a[220:223],a[68:71],v[168:171]
tr a[218:219],v9,26624
mm v[180:183],a[228:231],a[68:71],v[180:183]
tr a[220:221],v9,28672
mm v[180:183],a[224:227],a[56:59],v[180:183]
tr a[222:223],v9,30720
mm v[176:179],a[224:227],a[52:55],v[176:179]
mm v[176:179],a[228:231],a[64:67],v[176:179]
mm v[172:175],a[228:231],a[60:63],v[172:175]
s_waitcnt lgkmcnt(4)
mm v[172:175],a[224:227],a[48:51],v[172:175]
tr a[224:225],v10,24576
mm v[184:187],a[232:235],a[48:51],v[184:187]
buffer_load_dwordx4 v[20:23], v244, s[24:27], s4 offen offset:1024 sc1
tr a[226:227],v10,26624
mm v[184:187],a[236:239],a[60:63],v[184:187]
tr a[228:229],v10,28672
mm v[188:191],a[236:239],a[64:67],v[188:191]
tr a[230:231],v10,30720
mm v[188:191],a[232:235],a[52:55],v[188:191]
mm v[192:195],a[232:235],a[56:59],v[192:195]
tr a[232:233],v9,25088
mm v[192:195],a[236:239],a[68:71],v[192:195]
tr a[234:235],v9,27136
mm v[204:207],a[244:247],a[68:71],v[204:207]
tr a[236:237],v9,29184
mm v[204:207],a[240:243],a[56:59],v[204:207]
tr a[238:239],v9,31232
mm v[200:203],a[240:243],a[52:55],v[200:203]
mm v[200:203],a[244:247],a[64:67],v[200:203]
mm v[196:199],a[244:247],a[60:63],v[196:199]
s_waitcnt vmcnt(63)
s_waitcnt lgkmcnt(4)
mm v[196:199],a[240:243],a[48:51],v[196:199]
tr a[240:241],v10,25088
mm v[160:163],a[216:219],a[72:75],v[160:163]
s_barrier
tr a[242:243],v10,27136
mm v[160:163],a[220:223],a[84:87],v[160:163]
s_add_u32 s50, s65, 0
s_add_u32 s51, s65, 131072
mm v[164:167],a[220:223],a[88:91],v[164:167]
buffer_load_dwordx4 v[24:27], v244, s[24:27], s4 offen offset:2048 sc1
tr a[244:245],v10,29184
mm v[164:167],a[216:219],a[76:79],v[164:167]
tr a[246:247],v10,31232
v_add_u32 v9, 4294836224, v9
mm v[168:171],a[216:219],a[80:83],v[168:171]
v_add_u32 v10, 4294836224, v10
s_add_u32 m0, s43, 32768
mm v[168:171],a[220:223],a[92:95],v[168:171]
L_pg25:
s_cbranch_execz L_pg29
buffer_load_dwordx4 v1, s[20:23], s50 offen offset:0 lds
tr a[216:217],v9,0
mm v[180:183],a[228:231],a[92:95],v[180:183]
tr a[218:219],v9,2048
mm v[180:183],a[224:227],a[80:83],v[180:183]
tr a[220:221],v9,4096
mm v[176:179],a[224:227],a[76:79],v[176:179]
tr a[222:223],v9,6144
mm v[176:179],a[228:231],a[88:91],v[176:179]
buffer_load_dwordx4 v2, s[20:23], s50 offen offset:1024 lds
mm v[172:175],a[228:231],a[84:87],v[172:175]
s_waitcnt lgkmcnt(4)
mm v[172:175],a[224:227],a[72:75],v[172:175]
tr a[224:225],v10,0
mm v[184:187],a[232:235],a[72:75],v[184:187]
tr a[226:227],v10,2048
mm v[184:187],a[236:239],a[84:87],v[184:187]
tr a[228:229],v10,4096
mm v[188:191],a[236:239],a[88:91],v[188:191]
tr a[230:231],v10,6144
buffer_load_dwordx4 v[28:31], v244, s[24:27], s4 offen offset:3072 sc1
mm v[188:191],a[232:235],a[76:79],v[188:191]
mm v[192:195],a[232:235],a[80:83],v[192:195]
buffer_load_dwordx4 v3, s[20:23], s50 offen offset:2048 lds
tr a[232:233],v9,512
mm v[192:195],a[236:239],a[92:95],v[192:195]
tr a[234:235],v9,2560
mm v[204:207],a[244:247],a[92:95],v[204:207]
tr a[236:237],v9,4608
mm v[204:207],a[240:243],a[80:83],v[204:207]
tr a[238:239],v9,6656
mm v[200:203],a[240:243],a[76:79],v[200:203]
mm v[200:203],a[244:247],a[88:91],v[200:203]
mm v[196:199],a[244:247],a[84:87],v[196:199]
s_waitcnt lgkmcnt(4)
mm v[196:199],a[240:243],a[72:75],v[196:199]
buffer_load_dwordx4 v4, s[20:23], s50 offen offset:3072 lds
tr a[240:241],v10,512
mm v[160:163],a[216:219],a[96:99],v[160:163]
tr a[242:243],v10,2560
mm v[160:163],a[220:223],a[108:111],v[160:163]
tr a[244:245],v10,4608
mm v[164:167],a[220:223],a[112:115],v[164:167]
tr a[246:247],v10,6656
buffer_load_dwordx4 v[32:35], v244, s[24:27], s5 offen offset:0 sc1
mm v[164:167],a[216:219],a[100:103],v[164:167]
mm v[168:171],a[216:219],a[104:107],v[168:171]
tr a[216:217],v9,8192
mm v[168:171],a[220:223],a[116:119],v[168:171]
tr a[218:219],v9,10240
mm v[180:183],a[228:231],a[116:119],v[180:183]
tr a[220:221],v9,12288
s_add_u32 m0, s44, 32768
mm v[180:183],a[224:227],a[104:107],v[180:183]
tr a[222:223],v9,14336
buffer_load_dwordx4 v1, s[20:23], s51 offen offset:0 lds
mm v[176:179],a[224:227],a[100:103],v[176:179]
mm v[176:179],a[228:231],a[112:115],v[176:179]
mm v[172:175],a[228:231],a[108:111],v[172:175]
s_waitcnt lgkmcnt(4)
mm v[172:175],a[224:227],a[96:99],v[172:175]
tr a[224:225],v10,8192
mm v[184:187],a[232:235],a[96:99],v[184:187]
tr a[226:227],v10,10240
mm v[184:187],a[236:239],a[108:111],v[184:187]
tr a[228:229],v10,12288
buffer_load_dwordx4 v2, s[20:23], s51 offen offset:1024 lds
mm v[188:191],a[236:239],a[112:115],v[188:191]
tr a[230:231],v10,14336
mm v[188:191],a[232:235],a[100:103],v[188:191]
buffer_load_dwordx4 v[36:39], v244, s[24:27], s5 offen offset:1024 sc1
mm v[192:195],a[232:235],a[104:107],v[192:195]
tr a[232:233],v9,8704
mm v[192:195],a[236:239],a[116:119],v[192:195]
tr a[234:235],v9,10752
mm v[204:207],a[244:247],a[116:119],v[204:207]
tr a[236:237],v9,12800
mm v[204:207],a[240:243],a[104:107],v[204:207]
tr a[238:239],v9,14848
mm v[200:203],a[240:243],a[100:103],v[200:203]
buffer_load_dwordx4 v3, s[20:23], s51 offen offset:2048 lds
mm v[200:203],a[244:247],a[112:115],v[200:203]
mm v[196:199],a[244:247],a[108:111],v[196:199]
s_waitcnt lgkmcnt(4)
mm v[196:199],a[240:243],a[96:99],v[196:199]
tr a[240:241],v10,8704
mm v[160:163],a[216:219],a[120:123],v[160:163]
tr a[242:243],v10,10752
mm v[160:163],a[220:223],a[132:135],v[160:163]
tr a[244:245],v10,12800
mm v[164:167],a[220:223],a[136:139],v[164:167]
tr a[246:247],v10,14848
mm v[164:167],a[216:219],a[124:127],v[164:167]
buffer_load_dwordx4 v4, s[20:23], s51 offen offset:3072 lds
mm v[168:171],a[216:219],a[128:131],v[168:171]
tr a[216:217],v9,16384
mm v[168:171],a[220:223],a[140:143],v[168:171]
buffer_load_dword v253, v255, s[28:31], s91 offen offset:0 sc1
tr a[218:219],v9,18432
mm v[180:183],a[228:231],a[140:143],v[180:183]
tr a[220:221],v9,20480
mm v[180:183],a[224:227],a[128:131],v[180:183]
tr a[222:223],v9,22528
mm v[176:179],a[224:227],a[124:127],v[176:179]
mm v[176:179],a[228:231],a[136:139],v[176:179]
mm v[172:175],a[228:231],a[132:135],v[172:175]
s_waitcnt lgkmcnt(4)
mm v[172:175],a[224:227],a[120:123],v[172:175]
tr a[224:225],v10,16384
mm v[184:187],a[232:235],a[120:123],v[184:187]
tr a[226:227],v10,18432
mm v[184:187],a[236:239],a[132:135],v[184:187]
tr a[228:229],v10,20480
mm v[188:191],a[236:239],a[136:139],v[188:191]
tr a[230:231],v10,22528
mm v[188:191],a[232:235],a[124:127],v[188:191]
s_waitcnt vmcnt(15)
mm v[192:195],a[232:235],a[128:131],v[192:195]
buffer_store_dword v247, v245, s[28:31], s86 offen offset:0 sc1
tr a[232:233],v9,16896
mm v[192:195],a[236:239],a[140:143],v[192:195]
tr a[234:235],v9,18944
mm v[204:207],a[244:247],a[140:143],v[204:207]
tr a[236:237],v9,20992
mm v[204:207],a[240:243],a[128:131],v[204:207]
tr a[238:239],v9,23040
mm v[200:203],a[240:243],a[124:127],v[200:203]
mm v[200:203],a[244:247],a[136:139],v[200:203]
mm v[196:199],a[244:247],a[132:135],v[196:199]
s_waitcnt lgkmcnt(4)
mm v[196:199],a[240:243],a[120:123],v[196:199]
tr a[240:241],v10,16896
mm v[160:163],a[216:219],a[144:147],v[160:163]
tr a[242:243],v10,18944
mm v[160:163],a[220:223],a[156:159],v[160:163]
tr a[244:245],v10,20992
mm v[164:167],a[220:223],a[160:163],v[164:167]
tr a[246:247],v10,23040
mm v[164:167],a[216:219],a[148:151],v[164:167]
mm v[168:171],a[216:219],a[152:155],v[168:171]
tr a[216:217],v9,24576
mm v[168:171],a[220:223],a[164:167],v[168:171]
tr a[218:219],v9,26624
mm v[180:183],a[228:231],a[164:167],v[180:183]
tr a[220:221],v9,28672
mm v[180:183],a[224:227],a[152:155],v[180:183]
tr a[222:223],v9,30720
mm v[176:179],a[224:227],a[148:151],v[176:179]
mm v[176:179],a[228:231],a[160:163],v[176:179]
mm v[172:175],a[228:231],a[156:159],v[172:175]
s_waitcnt lgkmcnt(4)
mm v[172:175],a[224:227],a[144:147],v[172:175]
tr a[224:225],v10,24576
mm v[184:187],a[232:235],a[144:147],v[184:187]
tr a[226:227],v10,26624
mm v[184:187],a[236:239],a[156:159],v[184:187]
tr a[228:229],v10,28672
mm v[188:191],a[236:239],a[160:163],v[188:191]
tr a[230:231],v10,30720
mm v[188:191],a[232:235],a[148:151],v[188:191]
mm v[192:195],a[232:235],a[152:155],v[192:195]
tr a[232:233],v9,25088
mm v[192:195],a[236:239],a[164:167],v[192:195]
tr a[234:235],v9,27136
mm v[204:207],a[244:247],a[164:167],v[204:207]
tr a[236:237],v9,29184
mm v[204:207],a[240:243],a[152:155],v[204:207]
tr a[238:239],v9,31232
mm v[200:203],a[240:243],a[148:151],v[200:203]
mm v[200:203],a[244:247],a[160:163],v[200:203]
mm v[196:199],a[244:247],a[156:159],v[196:199]
s_waitcnt vmcnt(63)
s_waitcnt lgkmcnt(4)
mm v[196:199],a[240:243],a[144:147],v[196:199]
tr a[240:241],v10,25088
mm v[160:163],a[216:219],a[168:171],v[160:163]
s_barrier
tr a[242:243],v10,27136
mm v[160:163],a[220:223],a[180:183],v[160:163]
s_add_u32 s50, s65, 262144
s_add_u32 s51, s65, 393216
mm v[164:167],a[220:223],a[184:187],v[164:167]
tr a[244:245],v10,29184
s_add_u32 m0, s43, 131072
mm v[164:167],a[216:219],a[172:175],v[164:167]
tr a[246:247],v10,31232
v_add_u32 v9, 65536, v9
mm v[168:171],a[216:219],a[176:179],v[168:171]
buffer_load_dwordx4 v1, s[20:23], s50 offen offset:0 lds
v_add_u32 v10, 65536, v10
mm v[168:171],a[220:223],a[188:191],v[168:171]
tr a[216:217],v9,0
mm v[180:183],a[228:231],a[188:191],v[180:183]
tr a[218:219],v9,2048
mm v[180:183],a[224:227],a[176:179],v[180:183]
tr a[220:221],v9,4096
mm v[176:179],a[224:227],a[172:175],v[176:179]
tr a[222:223],v9,6144
mm v[176:179],a[228:231],a[184:187],v[176:179]
buffer_load_dwordx4 v2, s[20:23], s50 offen offset:1024 lds
mm v[172:175],a[228:231],a[180:183],v[172:175]
s_waitcnt lgkmcnt(4)
mm v[172:175],a[224:227],a[168:171],v[172:175]
tr a[224:225],v10,0
mm v[184:187],a[232:235],a[168:171],v[184:187]
tr a[226:227],v10,2048
mm v[184:187],a[236:239],a[180:183],v[184:187]
tr a[228:229],v10,4096
mm v[188:191],a[236:239],a[184:187],v[188:191]
tr a[230:231],v10,6144
mm v[188:191],a[232:235],a[172:175],v[188:191]
mm v[192:195],a[232:235],a[176:179],v[192:195]
buffer_load_dwordx4 v3, s[20:23], s50 offen offset:2048 lds
tr a[232:233],v9,512
mm v[192:195],a[236:239],a[188:191],v[192:195]
tr a[234:235],v9,2560
mm v[204:207],a[244:247],a[188:191],v[204:207]
tr a[236:237],v9,4608
mm v[204:207],a[240:243],a[176:179],v[204:207]
tr a[238:239],v9,6656
mm v[200:203],a[240:243],a[172:175],v[200:203]
mm v[200:203],a[244:247],a[184:187],v[200:203]
mm v[196:199],a[244:247],a[180:183],v[196:199]
s_waitcnt lgkmcnt(4)
mm v[196:199],a[240:243],a[168:171],v[196:199]
buffer_load_dwordx4 v4, s[20:23], s50 offen offset:3072 lds
tr a[240:241],v10,512
mm v[112:115],a[216:219],a[0:3],0
tr a[242:243],v10,2560
mm v[112:115],a[220:223],a[12:15],v[112:115]
tr a[244:245],v10,4608
mm v[116:119],a[220:223],a[16:19],0
tr a[246:247],v10,6656
s_add_u32 s53, s71, 4096
mm v[116:119],a[216:219],a[4:7],v[116:119]
mm v[120:123],a[216:219],a[8:11],0
tr a[216:217],v9,8192
cv v160,v160,v161
mm v[120:123],a[220:223],a[20:23],v[120:123]
tr a[218:219],v9,10240
cv v161,v162,v163
mm v[132:135],a[228:231],a[20:23],0
tr a[220:221],v9,12288
s_add_u32 m0, s44, 131072
mm v[132:135],a[224:227],a[8:11],v[132:135]
tr a[222:223],v9,14336
buffer_load_dwordx4 v1, s[20:23], s51 offen offset:0 lds
mm v[128:131],a[224:227],a[4:7],0
cv v162,v164,v165
cv v163,v166,v167
mm v[128:131],a[228:231],a[16:19],v[128:131]
buffer_store_dwordx4 v[160:163], v244, s[24:27], s71 offen offset:0 sc1
mm v[124:127],a[228:231],a[12:15],0
s_waitcnt lgkmcnt(4)
cv v168,v168,v169
mm v[124:127],a[224:227],a[0:3],v[124:127]
tr a[224:225],v10,8192
cv v169,v170,v171
mm v[136:139],a[232:235],a[0:3],0
tr a[226:227],v10,10240
cv v170,v172,v173
mm v[136:139],a[236:239],a[12:15],v[136:139]
tr a[228:229],v10,12288
buffer_load_dwordx4 v2, s[20:23], s51 offen offset:1024 lds
mm v[140:143],a[236:239],a[16:19],0
tr a[230:231],v10,14336
cv v171,v174,v175
mm v[140:143],a[232:235],a[4:7],v[140:143]
buffer_store_dwordx4 v[168:171], v244, s[24:27], s71 offen offset:1024 sc1
mm v[144:147],a[232:235],a[8:11],0
tr a[232:233],v9,8704
cv v176,v176,v177
mm v[144:147],a[236:239],a[20:23],v[144:147]
tr a[234:235],v9,10752
cv v177,v178,v179
mm v[156:159],a[244:247],a[20:23],0
tr a[236:237],v9,12800
cv v178,v180,v181
mm v[156:159],a[240:243],a[8:11],v[156:159]
tr a[238:239],v9,14848
cv v179,v182,v183
mm v[152:155],a[240:243],a[4:7],0
buffer_load_dwordx4 v3, s[20:23], s51 offen offset:2048 lds
buffer_store_dwordx4 v[176:179], v244, s[24:27], s71 offen offset:2048 sc1
mm v[152:155],a[244:247],a[16:19],v[152:155]
mm v[148:151],a[244:247],a[12:15],0
s_waitcnt lgkmcnt(4)
s_waitcnt vmcnt(11)
mm v[148:151],a[240:243],a[0:3],v[148:151]
tr a[240:241],v10,8704
v_cmp_ne_u32 s[92:93], 1, v253
mm v[112:115],a[216:219],a[24:27],v[112:115]
tr a[242:243],v10,10752
cv v184,v184,v185
mm v[112:115],a[220:223],a[36:39],v[112:115]
tr a[244:245],v10,12800
cv v185,v186,v187
mm v[116:119],a[220:223],a[40:43],v[116:119]
tr a[246:247],v10,14848
s_and_b32 s55, s92, 2
mm v[116:119],a[216:219],a[28:31],v[116:119]
s_or_b32 s6, s6, s55
buffer_load_dwordx4 v4, s[20:23], s51 offen offset:3072 lds
mm v[120:123],a[216:219],a[32:35],v[120:123]
tr a[216:217],v9,16384
cv v186,v188,v189
mm v[120:123],a[220:223],a[44:47],v[120:123]
tr a[218:219],v9,18432
cv v187,v190,v191
mm v[132:135],a[228:231],a[44:47],v[132:135]
tr a[220:221],v9,20480
buffer_store_dwordx4 v[184:187], v244, s[24:27], s71 offen offset:3072 sc1
mm v[132:135],a[224:227],a[32:35],v[132:135]
tr a[222:223],v9,22528
cv v192,v192,v193
mm v[128:131],a[224:227],a[28:31],v[128:131]
cv v193,v194,v195
cv v194,v196,v197
mm v[128:131],a[228:231],a[40:43],v[128:131]
cv v195,v198,v199
mm v[124:127],a[228:231],a[36:39],v[124:127]
s_waitcnt lgkmcnt(4)
buffer_store_dwordx4 v[192:195], v244, s[24:27], s53 offen offset:0 sc1
mm v[124:127],a[224:227],a[24:27],v[124:127]
tr a[224:225],v10,16384
cv v200,v200,v201
mm v[136:139],a[232:235],a[24:27],v[136:139]
tr a[226:227],v10,18432
cv v201,v202,v203
mm v[136:139],a[236:239],a[36:39],v[136:139]
tr a[228:229],v10,20480
cv v202,v204,v205
mm v[140:143],a[236:239],a[40:43],v[140:143]
tr a[230:231],v10,22528
cv v203,v206,v207
mm v[140:143],a[232:235],a[28:31],v[140:143]
buffer_store_dwordx4 v[200:203], v244, s[24:27], s53 offen offset:1024 sc1
mm v[144:147],a[232:235],a[32:35],v[144:147]
tr a[232:233],v9,16896
mm v[144:147],a[236:239],a[44:47],v[144:147]
tr a[234:235],v9,18944
mm v[156:159],a[244:247],a[44:47],v[156:159]
tr a[236:237],v9,20992
mm v[156:159],a[240:243],a[32:35],v[156:159]
tr a[238:239],v9,23040
mm v[152:155],a[240:243],a[28:31],v[152:155]
s_bitcmp1_b32 s92, 1
s_cselect_b32 s4, s7, s77
mm v[152:155],a[244:247],a[40:43],v[152:155]
s_add_u32 s5, s4, 4096
mm v[148:151],a[244:247],a[36:39],v[148:151]
s_waitcnt lgkmcnt(4)
mm v[148:151],a[240:243],a[24:27],v[148:151]
tr a[240:241],v10,16896
mm v[112:115],a[216:219],a[48:51],v[112:115]
buffer_load_dwordx4 v[40:43], v244, s[24:27], s4 offen offset:0 sc1
tr a[242:243],v10,18944
mm v[112:115],a[220:223],a[60:63],v[112:115]
tr a[244:245],v10,20992
mm v[116:119],a[220:223],a[64:67],v[116:119]
tr a[246:247],v10,23040
mm v[116:119],a[216:219],a[52:55],v[116:119]
mm v[120:123],a[216:219],a[56:59],v[120:123]
tr a[216:217],v9,24576
mm v[120:123],a[220:223],a[68:71],v[120:123]
tr a[218:219],v9,26624
mm v[132:135],a[228:231],a[68:71],v[132:135]
tr a[220:221],v9,28672
mm v[132:135],a[224:227],a[56:59],v[132:135]
tr a[222:223],v9,30720
mm v[128:131],a[224:227],a[52:55],v[128:131]
mm v[128:131],a[228:231],a[64:67],v[128:131]
mm v[124:127],a[228:231],a[60:63],v[124:127]
s_waitcnt lgkmcnt(4)
mm v[124:127],a[224:227],a[48:51],v[124:127]
tr a[224:225],v10,24576
mm v[136:139],a[232:235],a[48:51],v[136:139]
buffer_load_dwordx4 v[44:47], v244, s[24:27], s4 offen offset:1024 sc1
tr a[226:227],v10,26624
mm v[136:139],a[236:239],a[60:63],v[136:139]
tr a[228:229],v10,28672
mm v[140:143],a[236:239],a[64:67],v[140:143]
tr a[230:231],v10,30720
mm v[140:143],a[232:235],a[52:55],v[140:143]
mm v[144:147],a[232:235],a[56:59],v[144:147]
tr a[232:233],v9,25088
mm v[144:147],a[236:239],a[68:71],v[144:147]
tr a[234:235],v9,27136
mm v[156:159],a[244:247],a[68:71],v[156:159]
tr a[236:237],v9,29184
mm v[156:159],a[240:243],a[56:59],v[156:159]
tr a[238:239],v9,31232
mm v[152:155],a[240:243],a[52:55],v[152:155]
mm v[152:155],a[244:247],a[64:67],v[152:155]
mm v[148:151],a[244:247],a[60:63],v[148:151]
s_waitcnt vmcnt(63)
s_waitcnt lgkmcnt(4)
mm v[148:151],a[240:243],a[48:51],v[148:151]
tr a[240:241],v10,25088
mm v[112:115],a[216:219],a[72:75],v[112:115]
s_barrier
buffer_load_dwordx4 v[48:51], v244, s[24:27], s4 offen offset:2048 sc1
mm v[112:115],a[220:223],a[84:87],v[112:115]
s_add_u32 s50, s66, 0
s_add_u32 s51, s66, 131072
mm v[116:119],a[220:223],a[88:91],v[116:119]
tr a[242:243],v10,27136
s_add_u32 m0, s43, 0
mm v[116:119],a[216:219],a[76:79],v[116:119]
tr a[244:245],v10,29184
buffer_load_dwordx4 v1, s[20:23], s50 offen offset:0 lds
mm v[120:123],a[216:219],a[80:83],v[120:123]
tr a[246:247],v10,31232
mm v[120:123],a[220:223],a[92:95],v[120:123]
tr a[216:217],v9,32768
mm v[132:135],a[228:231],a[92:95],v[132:135]
tr a[218:219],v9,34816
mm v[132:135],a[224:227],a[80:83],v[132:135]
tr a[220:221],v9,36864
mm v[128:131],a[224:227],a[76:79],v[128:131]
tr a[222:223],v9,38912
mm v[128:131],a[228:231],a[88:91],v[128:131]
buffer_load_dwordx4 v2, s[20:23], s50 offen offset:1024 lds
mm v[124:127],a[228:231],a[84:87],v[124:127]
s_waitcnt lgkmcnt(4)
mm v[124:127],a[224:227],a[72:75],v[124:127]
tr a[224:225],v10,32768
mm v[136:139],a[232:235],a[72:75],v[136:139]
tr a[226:227],v10,34816
mm v[136:139],a[236:239],a[84:87],v[136:139]
buffer_load_dwordx4 v[52:55], v244, s[24:27], s4 offen offset:3072 sc1
tr a[228:229],v10,36864
mm v[140:143],a[236:239],a[88:91],v[140:143]
tr a[230:231],v10,38912
mm v[140:143],a[232:235],a[76:79],v[140:143]
mm v[144:147],a[232:235],a[80:83],v[144:147]
buffer_load_dwordx4 v3, s[20:23], s50 offen offset:2048 lds
tr a[232:233],v9,33280
mm v[144:147],a[236:239],a[92:95],v[144:147]
tr a[234:235],v9,35328
mm v[156:159],a[244:247],a[92:95],v[156:159]
tr a[236:237],v9,37376
mm v[156:159],a[240:243],a[80:83],v[156:159]
tr a[238:239],v9,39424
mm v[152:155],a[240:243],a[76:79],v[152:155]
mm v[152:155],a[244:247],a[88:91],v[152:155]
mm v[148:151],a[244:247],a[84:87],v[148:151]
s_waitcnt lgkmcnt(4)
mm v[148:151],a[240:243],a[72:75],v[148:151]
buffer_load_dwordx4 v4, s[20:23], s50 offen offset:3072 lds
tr a[240:241],v10,33280
mm v[112:115],a[216:219],a[96:99],v[112:115]
tr a[242:243],v10,35328
mm v[112:115],a[220:223],a[108:111],v[112:115]
buffer_load_dwordx4 v[56:59], v244, s[24:27], s5 offen offset:0 sc1
tr a[244:245],v10,37376
mm v[116:119],a[220:223],a[112:115],v[116:119]
tr a[246:247],v10,39424
mm v[116:119],a[216:219],a[100:103],v[116:119]
mm v[120:123],a[216:219],a[104:107],v[120:123]
tr a[216:217],v9,40960
mm v[120:123],a[220:223],a[116:119],v[120:123]
tr a[218:219],v9,43008
mm v[132:135],a[228:231],a[116:119],v[132:135]
tr a[220:221],v9,45056
s_add_u32 m0, s44, 0
mm v[132:135],a[224:227],a[104:107],v[132:135]
tr a[222:223],v9,47104
buffer_load_dwordx4 v1, s[20:23], s51 offen offset:0 lds
mm v[128:131],a[224:227],a[100:103],v[128:131]
mm v[128:131],a[228:231],a[112:115],v[128:131]
mm v[124:127],a[228:231],a[108:111],v[124:127]
s_waitcnt lgkmcnt(4)
mm v[124:127],a[224:227],a[96:99],v[124:127]
tr a[224:225],v10,40960
mm v[136:139],a[232:235],a[96:99],v[136:139]
tr a[226:227],v10,43008
mm v[136:139],a[236:239],a[108:111],v[136:139]
buffer_load_dwordx4 v[60:63], v244, s[24:27], s5 offen offset:1024 sc1
tr a[228:229],v10,45056
mm v[140:143],a[236:239],a[112:115],v[140:143]
tr a[230:231],v10,47104
buffer_load_dwordx4 v2, s[20:23], s51 offen offset:1024 lds
mm v[140:143],a[232:235],a[100:103],v[140:143]
mm v[144:147],a[232:235],a[104:107],v[144:147]
tr a[232:233],v9,41472
mm v[144:147],a[236:239],a[116:119],v[144:147]
tr a[234:235],v9,43520
mm v[156:159],a[244:247],a[116:119],v[156:159]
tr a[236:237],v9,45568
mm v[156:159],a[240:243],a[104:107],v[156:159]
tr a[238:239],v9,47616
mm v[152:155],a[240:243],a[100:103],v[152:155]
buffer_load_dwordx4 v3, s[20:23], s51 offen offset:2048 lds
mm v[152:155],a[244:247],a[112:115],v[152:155]
mm v[148:151],a[244:247],a[108:111],v[148:151]
s_waitcnt lgkmcnt(4)
mm v[148:151],a[240:243],a[96:99],v[148:151]
tr a[240:241],v10,41472
mm v[112:115],a[216:219],a[120:123],v[112:115]
tr a[242:243],v10,43520
mm v[112:115],a[220:223],a[132:135],v[112:115]
tr a[244:245],v10,45568
mm v[116:119],a[220:223],a[136:139],v[116:119]
tr a[246:247],v10,47616
mm v[116:119],a[216:219],a[124:127],v[116:119]
buffer_load_dword v253, v255, s[28:31], s91 offen offset:0 sc1
buffer_load_dwordx4 v4, s[20:23], s51 offen offset:3072 lds
mm v[120:123],a[216:219],a[128:131],v[120:123]
tr a[216:217],v9,49152
mm v[120:123],a[220:223],a[140:143],v[120:123]
tr a[218:219],v9,51200
mm v[132:135],a[228:231],a[140:143],v[132:135]
tr a[220:221],v9,53248
mm v[132:135],a[224:227],a[128:131],v[132:135]
tr a[222:223],v9,55296
mm v[128:131],a[224:227],a[124:127],v[128:131]
mm v[128:131],a[228:231],a[136:139],v[128:131]
mm v[124:127],a[228:231],a[132:135],v[124:127]
s_waitcnt lgkmcnt(4)
mm v[124:127],a[224:227],a[120:123],v[124:127]
tr a[224:225],v10,49152
mm v[136:139],a[232:235],a[120:123],v[136:139]
tr a[226:227],v10,51200
mm v[136:139],a[236:239],a[132:135],v[136:139]
tr a[228:229],v10,53248
mm v[140:143],a[236:239],a[136:139],v[140:143]
tr a[230:231],v10,55296
L_pg26:
s_cbranch_execz L_tret3
mm v[140:143],a[232:235],a[124:127],v[140:143]
s_waitcnt vmcnt(15)
mm v[144:147],a[232:235],a[128:131],v[144:147]
buffer_store_dword v247, v245, s[28:31], s87 offen offset:0 sc1
tr a[232:233],v9,49664
mm v[144:147],a[236:239],a[140:143],v[144:147]
tr a[234:235],v9,51712
mm v[156:159],a[244:247],a[140:143],v[156:159]
tr a[236:237],v9,53760
mm v[156:159],a[240:243],a[128:131],v[156:159]
tr a[238:239],v9,55808
mm v[152:155],a[240:243],a[124:127],v[152:155]
mm v[152:155],a[244:247],a[136:139],v[152:155]
mm v[148:151],a[244:247],a[132:135],v[148:151]
s_waitcnt lgkmcnt(4)
mm v[148:151],a[240:243],a[120:123],v[148:151]
tr a[240:241],v10,49664
mm v[112:115],a[216:219],a[144:147],v[112:115]
tr a[242:243],v10,51712
mm v[112:115],a[220:223],a[156:159],v[112:115]
tr a[244:245],v10,53760
mm v[116:119],a[220:223],a[160:163],v[116:119]
tr a[246:247],v10,55808
mm v[116:119],a[216:219],a[148:151],v[116:119]
mm v[120:123],a[216:219],a[152:155],v[120:123]
tr a[216:217],v9,57344
mm v[120:123],a[220:223],a[164:167],v[120:123]
tr a[218:219],v9,59392
mm v[132:135],a[228:231],a[164:167],v[132:135]
tr a[220:221],v9,61440
mm v[132:135],a[224:227],a[152:155],v[132:135]
tr a[222:223],v9,63488
mm v[128:131],a[224:227],a[148:151],v[128:131]
mm v[128:131],a[228:231],a[160:163],v[128:131]
mm v[124:127],a[228:231],a[156:159],v[124:127]
s_waitcnt lgkmcnt(4)
mm v[124:127],a[224:227],a[144:147],v[124:127]
tr a[224:225],v10,57344
mm v[136:139],a[232:235],a[144:147],v[136:139]
tr a[226:227],v10,59392
mm v[136:139],a[236:239],a[156:159],v[136:139]
tr a[228:229],v10,61440
mm v[140:143],a[236:239],a[160:163],v[140:143]
tr a[230:231],v10,63488
mm v[140:143],a[232:235],a[148:151],v[140:143]
mm v[144:147],a[232:235],a[152:155],v[144:147]
tr a[232:233],v9,57856
mm v[144:147],a[236:239],a[164:167],v[144:147]
tr a[234:235],v9,59904
mm v[156:159],a[244:247],a[164:167],v[156:159]
tr a[236:237],v9,61952
mm v[156:159],a[240:243],a[152:155],v[156:159]
tr a[238:239],v9,64000
mm v[152:155],a[240:243],a[148:151],v[152:155]
mm v[152:155],a[244:247],a[160:163],v[152:155]
mm v[148:151],a[244:247],a[156:159],v[148:151]
s_waitcnt vmcnt(63)
s_waitcnt lgkmcnt(4)
mm v[148:151],a[240:243],a[144:147],v[148:151]
tr a[240:241],v10,57856
mm v[112:115],a[216:219],a[168:171],v[112:115]
s_barrier
tr a[242:243],v10,59904
mm v[112:115],a[220:223],a[180:183],v[112:115]
s_add_u32 s50, s66, 262144
s_add_u32 s51, s66, 393216
mm v[116:119],a[220:223],a[184:187],v[116:119]
tr a[244:245],v10,61952
s_add_u32 m0, s43, 65536
mm v[116:119],a[216:219],a[172:175],v[116:119]
tr a[246:247],v10,64000
v_add_u32 v9, 4294934528, v9
mm v[120:123],a[216:219],a[176:179],v[120:123]
buffer_load_dwordx4 v1, s[20:23], s50 offen offset:0 lds
v_add_u32 v10, 4294934528, v10
mm v[120:123],a[220:223],a[188:191],v[120:123]
tr a[216:217],v9,0
mm v[132:135],a[228:231],a[188:191],v[132:135]
tr a[218:219],v9,2048
mm v[132:135],a[224:227],a[176:179],v[132:135]
tr a[220:221],v9,4096
mm v[128:131],a[224:227],a[172:175],v[128:131]
tr a[222:223],v9,6144
mm v[128:131],a[228:231],a[184:187],v[128:131]
buffer_load_dwordx4 v2, s[20:23], s50 offen offset:1024 lds
mm v[124:127],a[228:231],a[180:183],v[124:127]
s_waitcnt lgkmcnt(4)
mm v[124:127],a[224:227],a[168:171],v[124:127]
tr a[224:225],v10,0
mm v[136:139],a[232:235],a[168:171],v[136:139]
tr a[226:227],v10,2048
mm v[136:139],a[236:239],a[180:183],v[136:139]
tr a[228:229],v10,4096
mm v[140:143],a[236:239],a[184:187],v[140:143]
tr a[230:231],v10,6144
mm v[140:143],a[232:235],a[172:175],v[140:143]
mm v[144:147],a[232:235],a[176:179],v[144:147]
buffer_load_dwordx4 v3, s[20:23], s50 offen offset:2048 lds
tr a[232:233],v9,512
mm v[144:147],a[236:239],a[188:191],v[144:147]
tr a[234:235],v9,2560
mm v[156:159],a[244:247],a[188:191],v[156:159]
tr a[236:237],v9,4608
mm v[156:159],a[240:243],a[176:179],v[156:159]
tr a[238:239],v9,6656
mm v[152:155],a[240:243],a[172:175],v[152:155]
mm v[152:155],a[244:247],a[184:187],v[152:155]
mm v[148:151],a[244:247],a[180:183],v[148:151]
s_waitcnt lgkmcnt(4)
mm v[148:151],a[240:243],a[168:171],v[148:151]
buffer_load_dwordx4 v4, s[20:23], s50 offen offset:3072 lds
tr a[240:241],v10,512
mm v[160:163],a[216:219],a[0:3],0
tr a[242:243],v10,2560
mm v[160:163],a[220:223],a[12:15],v[160:163]
tr a[244:245],v10,4608
mm v[164:167],a[220:223],a[16:19],0
tr a[246:247],v10,6656
s_add_u32 s53, s72, 4096
mm v[164:167],a[216:219],a[4:7],v[164:167]
mm v[168:171],a[216:219],a[8:11],0
tr a[216:217],v9,8192
cv v112,v112,v113
mm v[168:171],a[220:223],a[20:23],v[168:171]
tr a[218:219],v9,10240
cv v113,v114,v115
mm v[180:183],a[228:231],a[20:23],0
tr a[220:221],v9,12288
s_add_u32 m0, s44, 65536
mm v[180:183],a[224:227],a[8:11],v[180:183]
tr a[222:223],v9,14336
buffer_load_dwordx4 v1, s[20:23], s51 offen offset:0 lds
mm v[176:179],a[224:227],a[4:7],0
cv v114,v116,v117
cv v115,v118,v119
mm v[176:179],a[228:231],a[16:19],v[176:179]
buffer_store_dwordx4 v[112:115], v244, s[24:27], s72 offen offset:0 sc1
mm v[172:175],a[228:231],a[12:15],0
s_waitcnt lgkmcnt(4)
cv v120,v120,v121
mm v[172:175],a[224:227],a[0:3],v[172:175]
tr a[224:225],v10,8192
cv v121,v122,v123
mm v[184:187],a[232:235],a[0:3],0
tr a[226:227],v10,10240
cv v122,v124,v125
mm v[184:187],a[236:239],a[12:15],v[184:187]
tr a[228:229],v10,12288
buffer_load_dwordx4 v2, s[20:23], s51 offen offset:1024 lds
mm v[188:191],a[236:239],a[16:19],0
tr a[230:231],v10,14336
cv v123,v126,v127
mm v[188:191],a[232:235],a[4:7],v[188:191]
buffer_store_dwordx4 v[120:123], v244, s[24:27], s72 offen offset:1024 sc1
mm v[192:195],a[232:235],a[8:11],0
tr a[232:233],v9,8704
cv v128,v128,v129
mm v[192:195],a[236:239],a[20:23],v[192:195]
tr a[234:235],v9,10752
cv v129,v130,v131
mm v[204:207],a[244:247],a[20:23],0
tr a[236:237],v9,12800
cv v130,v132,v133
mm v[204:207],a[240:243],a[8:11],v[204:207]
tr a[238:239],v9,14848
cv v131,v134,v135
mm v[200:203],a[240:243],a[4:7],0
s_waitcnt vmcnt(10)
buffer_load_dwordx4 v3, s[20:23], s51 offen offset:2048 lds
mm v[200:203],a[244:247],a[16:19],v[200:203]
buffer_store_dwordx4 v[128:131], v244, s[24:27], s72 offen offset:2048 sc1
v_cmp_ne_u32 s[92:93], 1, v253
mm v[196:199],a[244:247],a[12:15],0
s_waitcnt lgkmcnt(4)
cv v136,v136,v137
mm v[196:199],a[240:243],a[0:3],v[196:199]
tr a[240:241],v10,8704
cv v137,v138,v139
mm v[160:163],a[216:219],a[24:27],v[160:163]
s_and_b32 s55, s92, 4
tr a[242:243],v10,10752
mm v[160:163],a[220:223],a[36:39],v[160:163]
tr a[244:245],v10,12800
s_or_b32 s6, s6, s55
mm v[164:167],a[220:223],a[40:43],v[164:167]
tr a[246:247],v10,14848
cv v138,v140,v141
mm v[164:167],a[216:219],a[28:31],v[164:167]
buffer_load_dwordx4 v4, s[20:23], s51 offen offset:3072 lds
cv v139,v142,v143
mm v[168:171],a[216:219],a[32:35],v[168:171]
tr a[216:217],v9,16384
buffer_store_dwordx4 v[136:139], v244, s[24:27], s72 offen offset:3072 sc1
mm v[168:171],a[220:223],a[44:47],v[168:171]
tr a[218:219],v9,18432
cv v144,v144,v145
mm v[180:183],a[228:231],a[44:47],v[180:183]
tr a[220:221],v9,20480
cv v145,v146,v147
mm v[180:183],a[224:227],a[32:35],v[180:183]
tr a[222:223],v9,22528
cv v146,v148,v149
mm v[176:179],a[224:227],a[28:31],v[176:179]
cv v147,v150,v151
mm v[176:179],a[228:231],a[40:43],v[176:179]
buffer_store_dwordx4 v[144:147], v244, s[24:27], s53 offen offset:0 sc1
mm v[172:175],a[228:231],a[36:39],v[172:175]
s_waitcnt lgkmcnt(4)
cv v152,v152,v153
mm v[172:175],a[224:227],a[24:27],v[172:175]
tr a[224:225],v10,16384
cv v153,v154,v155
mm v[184:187],a[232:235],a[24:27],v[184:187]
tr a[226:227],v10,18432
cv v154,v156,v157
mm v[184:187],a[236:239],a[36:39],v[184:187]
tr a[228:229],v10,20480
cv v155,v158,v159
mm v[188:191],a[236:239],a[40:43],v[188:191]
buffer_store_dwordx4 v[152:155], v244, s[24:27], s53 offen offset:1024 sc1
tr a[230:231],v10,22528
mm v[188:191],a[232:235],a[28:31],v[188:191]
mm v[192:195],a[232:235],a[32:35],v[192:195]
tr a[232:233],v9,16896
mm v[192:195],a[236:239],a[44:47],v[192:195]
tr a[234:235],v9,18944
mm v[204:207],a[244:247],a[44:47],v[204:207]
tr a[236:237],v9,20992
mm v[204:207],a[240:243],a[32:35],v[204:207]
tr a[238:239],v9,23040
mm v[200:203],a[240:243],a[28:31],v[200:203]
s_bitcmp1_b32 s92, 2
s_cselect_b32 s4, s7, s78
mm v[200:203],a[244:247],a[40:43],v[200:203]
s_add_u32 s5, s4, 4096
mm v[196:199],a[244:247],a[36:39],v[196:199]
s_waitcnt lgkmcnt(4)
mm v[196:199],a[240:243],a[24:27],v[196:199]
tr a[240:241],v10,16896
mm v[160:163],a[216:219],a[48:51],v[160:163]
buffer_load_dwordx4 v[64:67], v244, s[24:27], s4 offen offset:0 sc1
tr a[242:243],v10,18944
mm v[160:163],a[220:223],a[60:63],v[160:163]
tr a[244:245],v10,20992
mm v[164:167],a[220:223],a[64:67],v[164:167]
tr a[246:247],v10,23040
mm v[164:167],a[216:219],a[52:55],v[164:167]
mm v[168:171],a[216:219],a[56:59],v[168:171]
tr a[216:217],v9,24576
mm v[168:171],a[220:223],a[68:71],v[168:171]
tr a[218:219],v9,26624
mm v[180:183],a[228:231],a[68:71],v[180:183]
tr a[220:221],v9,28672
mm v[180:183],a[224:227],a[56:59],v[180:183]
tr a[222:223],v9,30720
mm v[176:179],a[224:227],a[52:55],v[176:179]
mm v[176:179],a[228:231],a[64:67],v[176:179]
mm v[172:175],a[228:231],a[60:63],v[172:175]
s_waitcnt lgkmcnt(4)
mm v[172:175],a[224:227],a[48:51],v[172:175]
tr a[224:225],v10,24576
mm v[184:187],a[232:235],a[48:51],v[184:187]
buffer_load_dwordx4 v[68:71], v244, s[24:27], s4 offen offset:1024 sc1
tr a[226:227],v10,26624
mm v[184:187],a[236:239],a[60:63],v[184:187]
tr a[228:229],v10,28672
mm v[188:191],a[236:239],a[64:67],v[188:191]
tr a[230:231],v10,30720
mm v[188:191],a[232:235],a[52:55],v[188:191]
mm v[192:195],a[232:235],a[56:59],v[192:195]
tr a[232:233],v9,25088
mm v[192:195],a[236:239],a[68:71],v[192:195]
tr a[234:235],v9,27136
mm v[204:207],a[244:247],a[68:71],v[204:207]
tr a[236:237],v9,29184
mm v[204:207],a[240:243],a[56:59],v[204:207]
tr a[238:239],v9,31232
mm v[200:203],a[240:243],a[52:55],v[200:203]
mm v[200:203],a[244:247],a[64:67],v[200:203]
mm v[196:199],a[244:247],a[60:63],v[196:199]
s_waitcnt vmcnt(63)
s_waitcnt lgkmcnt(4)
mm v[196:199],a[240:243],a[48:51],v[196:199]
tr a[240:241],v10,25088
mm v[160:163],a[216:219],a[72:75],v[160:163]
s_barrier
buffer_load_dwordx4 v[72:75], v244, s[24:27], s4 offen offset:2048 sc1
mm v[160:163],a[220:223],a[84:87],v[160:163]
s_add_u32 s50, s67, 0
s_add_u32 s51, s67, 131072
mm v[164:167],a[220:223],a[88:91],v[164:167]
tr a[242:243],v10,27136
s_add_u32 m0, s43, 98304
mm v[164:167],a[216:219],a[76:79],v[164:167]
tr a[244:245],v10,29184
buffer_load_dwordx4 v1, s[20:23], s50 offen offset:0 lds
mm v[168:171],a[216:219],a[80:83],v[168:171]
tr a[246:247],v10,31232
v_add_u32 v9, 98304, v9
v_add_u32 v10, 98304, v10
mm v[168:171],a[220:223],a[92:95],v[168:171]
tr a[216:217],v9,0
mm v[180:183],a[228:231],a[92:95],v[180:183]
tr a[218:219],v9,2048
mm v[180:183],a[224:227],a[80:83],v[180:183]
tr a[220:221],v9,4096
mm v[176:179],a[224:227],a[76:79],v[176:179]
tr a[222:223],v9,6144
mm v[176:179],a[228:231],a[88:91],v[176:179]
buffer_load_dwordx4 v2, s[20:23], s50 offen offset:1024 lds
mm v[172:175],a[228:231],a[84:87],v[172:175]
s_waitcnt lgkmcnt(4)
mm v[172:175],a[224:227],a[72:75],v[172:175]
tr a[224:225],v10,0
mm v[184:187],a[232:235],a[72:75],v[184:187]
buffer_load_dwordx4 v[76:79], v244, s[24:27], s4 offen offset:3072 sc1
tr a[226:227],v10,2048
mm v[184:187],a[236:239],a[84:87],v[184:187]
tr a[228:229],v10,4096
mm v[188:191],a[236:239],a[88:91],v[188:191]
tr a[230:231],v10,6144
mm v[188:191],a[232:235],a[76:79],v[188:191]
mm v[192:195],a[232:235],a[80:83],v[192:195]
buffer_load_dwordx4 v3, s[20:23], s50 offen offset:2048 lds
tr a[232:233],v9,512
mm v[192:195],a[236:239],a[92:95],v[192:195]
tr a[234:235],v9,2560
mm v[204:207],a[244:247],a[92:95],v[204:207]
tr a[236:237],v9,4608
mm v[204:207],a[240:243],a[80:83],v[204:207]
tr a[238:239],v9,6656
mm v[200:203],a[240:243],a[76:79],v[200:203]
mm v[200:203],a[244:247],a[88:91],v[200:203]
mm v[196:199],a[244:247],a[84:87],v[196:199]
s_waitcnt lgkmcnt(4)
mm v[196:199],a[240:243],a[72:75],v[196:199]
buffer_load_dwordx4 v4, s[20:23], s50 offen offset:3072 lds
tr a[240:241],v10,512
mm v[160:163],a[216:219],a[96:99],v[160:163]
buffer_load_dwordx4 v[80:83], v244, s[24:27], s5 offen offset:0 sc1
tr a[242:243],v10,2560
mm v[160:163],a[220:223],a[108:111],v[160:163]
tr a[244:245],v10,4608
mm v[164:167],a[220:223],a[112:115],v[164:167]
tr a[246:247],v10,6656
mm v[164:167],a[216:219],a[100:103],v[164:167]
mm v[168:171],a[216:219],a[104:107],v[168:171]
tr a[216:217],v9,8192
mm v[168:171],a[220:223],a[116:119],v[168:171]
tr a[218:219],v9,10240
mm v[180:183],a[228:231],a[116:119],v[180:183]
tr a[220:221],v9,12288
s_add_u32 m0, s44, 98304
mm v[180:183],a[224:227],a[104:107],v[180:183]
tr a[222:223],v9,14336
buffer_load_dwordx4 v1, s[20:23], s51 offen offset:0 lds
mm v[176:179],a[224:227],a[100:103],v[176:179]
mm v[176:179],a[228:231],a[112:115],v[176:179]
mm v[172:175],a[228:231],a[108:111],v[172:175]
s_waitcnt lgkmcnt(4)
mm v[172:175],a[224:227],a[96:99],v[172:175]
tr a[224:225],v10,8192
mm v[184:187],a[232:235],a[96:99],v[184:187]
buffer_load_dwordx4 v[84:87], v244, s[24:27], s5 offen offset:1024 sc1
tr a[226:227],v10,10240
mm v[184:187],a[236:239],a[108:111],v[184:187]
tr a[228:229],v10,12288
buffer_load_dwordx4 v2, s[20:23], s51 offen offset:1024 lds
mm v[188:191],a[236:239],a[112:115],v[188:191]
tr a[230:231],v10,14336
mm v[188:191],a[232:235],a[100:103],v[188:191]
mm v[192:195],a[232:235],a[104:107],v[192:195]
tr a[232:233],v9,8704
mm v[192:195],a[236:239],a[116:119],v[192:195]
tr a[234:235],v9,10752
mm v[204:207],a[244:247],a[116:119],v[204:207]
tr a[236:237],v9,12800
mm v[204:207],a[240:243],a[104:107],v[204:207]
tr a[238:239],v9,14848
mm v[200:203],a[240:243],a[100:103],v[200:203]
buffer_load_dwordx4 v3, s[20:23], s51 offen offset:2048 lds
mm v[200:203],a[244:247],a[112:115],v[200:203]
mm v[196:199],a[244:247],a[108:111],v[196:199]
s_waitcnt lgkmcnt(4)
mm v[196:199],a[240:243],a[96:99],v[196:199]
tr a[240:241],v10,8704
mm v[160:163],a[216:219],a[120:123],v[160:163]
tr a[242:243],v10,10752
mm v[160:163],a[220:223],a[132:135],v[160:163]
buffer_load_dword v253, v255, s[28:31], s91 offen offset:0 sc1
tr a[244:245],v10,12800
mm v[164:167],a[220:223],a[136:139],v[164:167]
tr a[246:247],v10,14848
mm v[164:167],a[216:219],a[124:127],v[164:167]
buffer_load_dwordx4 v4, s[20:23], s51 offen offset:3072 lds
mm v[168:171],a[216:219],a[128:131],v[168:171]
tr a[216:217],v9,16384
mm v[168:171],a[220:223],a[140:143],v[168:171]
tr a[218:219],v9,18432
mm v[180:183],a[228:231],a[140:143],v[180:183]
tr a[220:221],v9,20480
mm v[180:183],a[224:227],a[128:131],v[180:183]
tr a[222:223],v9,22528
mm v[176:179],a[224:227],a[124:127],v[176:179]
mm v[176:179],a[228:231],a[136:139],v[176:179]
mm v[172:175],a[228:231],a[132:135],v[172:175]
s_waitcnt lgkmcnt(4)
mm v[172:175],a[224:227],a[120:123],v[172:175]
tr a[224:225],v10,16384
mm v[184:187],a[232:235],a[120:123],v[184:187]
tr a[226:227],v10,18432
mm v[184:187],a[236:239],a[132:135],v[184:187]
tr a[228:229],v10,20480
mm v[188:191],a[236:239],a[136:139],v[188:191]
tr a[230:231],v10,22528
mm v[188:191],a[232:235],a[124:127],v[188:191]
s_waitcnt vmcnt(15)
mm v[192:195],a[232:235],a[128:131],v[192:195]
buffer_store_dword v247, v245, s[28:31], s88 offen offset:0 sc1
tr a[232:233],v9,16896
mm v[192:195],a[236:239],a[140:143],v[192:195]
tr a[234:235],v9,18944
mm v[204:207],a[244:247],a[140:143],v[204:207]
tr a[236:237],v9,20992
mm v[204:207],a[240:243],a[128:131],v[204:207]
tr a[238:239],v9,23040
mm v[200:203],a[240:243],a[124:127],v[200:203]
mm v[200:203],a[244:247],a[136:139],v[200:203]
mm v[196:199],a[244:247],a[132:135],v[196:199]
s_waitcnt lgkmcnt(4)
mm v[196:199],a[240:243],a[120:123],v[196:199]
tr a[240:241],v10,16896
mm v[160:163],a[216:219],a[144:147],v[160:163]
tr a[242:243],v10,18944
mm v[160:163],a[220:223],a[156:159],v[160:163]
tr a[244:245],v10,20992
mm v[164:167],a[220:223],a[160:163],v[164:167]
tr a[246:247],v10,23040
mm v[164:167],a[216:219],a[148:151],v[164:167]
mm v[168:171],a[216:219],a[152:155],v[168:171]
tr a[216:217],v9,24576
mm v[168:171],a[220:223],a[164:167],v[168:171]
tr a[218:219],v9,26624
mm v[180:183],a[228:231],a[164:167],v[180:183]
tr a[220:221],v9,28672
mm v[180:183],a[224:227],a[152:155],v[180:183]
tr a[222:223],v9,30720
mm v[176:179],a[224:227],a[148:151],v[176:179]
mm v[176:179],a[228:231],a[160:163],v[176:179]
mm v[172:175],a[228:231],a[156:159],v[172:175]
s_waitcnt lgkmcnt(4)
mm v[172:175],a[224:227],a[144:147],v[172:175]
tr a[224:225],v10,24576
mm v[184:187],a[232:235],a[144:147],v[184:187]
tr a[226:227],v10,26624
mm v[184:187],a[236:239],a[156:159],v[184:187]
tr a[228:229],v10,28672
mm v[188:191],a[236:239],a[160:163],v[188:191]
tr a[230:231],v10,30720
mm v[188:191],a[232:235],a[148:151],v[188:191]
mm v[192:195],a[232:235],a[152:155],v[192:195]
tr a[232:233],v9,25088
mm v[192:195],a[236:239],a[164:167],v[192:195]
tr a[234:235],v9,27136
mm v[204:207],a[244:247],a[164:167],v[204:207]
tr a[236:237],v9,29184
mm v[204:207],a[240:243],a[152:155],v[204:207]
tr a[238:239],v9,31232
mm v[200:203],a[240:243],a[148:151],v[200:203]
mm v[200:203],a[244:247],a[160:163],v[200:203]
mm v[196:199],a[244:247],a[156:159],v[196:199]
s_waitcnt vmcnt(63)
s_waitcnt lgkmcnt(4)
mm v[196:199],a[240:243],a[144:147],v[196:199]
tr a[240:241],v10,25088
mm v[160:163],a[216:219],a[168:171],v[160:163]
s_barrier
tr a[242:243],v10,27136
mm v[160:163],a[220:223],a[180:183],v[160:163]
s_add_u32 s50, s67, 262144
s_add_u32 s51, s67, 393216
mm v[164:167],a[220:223],a[184:187],v[164:167]
tr a[244:245],v10,29184
s_add_u32 m0, s43, 32768
mm v[164:167],a[216:219],a[172:175],v[164:167]
tr a[246:247],v10,31232
v_add_u32 v9, 4294836224, v9
mm v[168:171],a[216:219],a[176:179],v[168:171]
buffer_load_dwordx4 v1, s[20:23], s50 offen offset:0 lds
v_add_u32 v10, 4294836224, v10
mm v[168:171],a[220:223],a[188:191],v[168:171]
tr a[216:217],v9,0
mm v[180:183],a[228:231],a[188:191],v[180:183]
tr a[218:219],v9,2048
mm v[180:183],a[224:227],a[176:179],v[180:183]
tr a[220:221],v9,4096
mm v[176:179],a[224:227],a[172:175],v[176:179]
tr a[222:223],v9,6144
mm v[176:179],a[228:231],a[184:187],v[176:179]
buffer_load_dwordx4 v2, s[20:23], s50 offen offset:1024 lds
mm v[172:175],a[228:231],a[180:183],v[172:175]
s_waitcnt lgkmcnt(4)
mm v[172:175],a[224:227],a[168:171],v[172:175]
tr a[224:225],v10,0
mm v[184:187],a[232:235],a[168:171],v[184:187]
tr a[226:227],v10,2048
mm v[184:187],a[236:239],a[180:183],v[184:187]
tr a[228:229],v10,4096
mm v[188:191],a[236:239],a[184:187],v[188:191]
tr a[230:231],v10,6144
mm v[188:191],a[232:235],a[172:175],v[188:191]
mm v[192:195],a[232:235],a[176:179],v[192:195]
buffer_load_dwordx4 v3, s[20:23], s50 offen offset:2048 lds
tr a[232:233],v9,512
mm v[192:195],a[236:239],a[188:191],v[192:195]
tr a[234:235],v9,2560
mm v[204:207],a[244:247],a[188:191],v[204:207]
tr a[236:237],v9,4608
mm v[204:207],a[240:243],a[176:179],v[204:207]
tr a[238:239],v9,6656
mm v[200:203],a[240:243],a[172:175],v[200:203]
mm v[200:203],a[244:247],a[184:187],v[200:203]
mm v[196:199],a[244:247],a[180:183],v[196:199]
s_waitcnt lgkmcnt(4)
mm v[196:199],a[240:243],a[168:171],v[196:199]
buffer_load_dwordx4 v4, s[20:23], s50 offen offset:3072 lds
tr a[240:241],v10,512
mm v[112:115],a[216:219],a[0:3],0
tr a[242:243],v10,2560
L_pg27:
s_cbranch_execz L_tret3
mm v[112:115],a[220:223],a[12:15],v[112:115]
tr a[244:245],v10,4608
mm v[116:119],a[220:223],a[16:19],0
tr a[246:247],v10,6656
s_add_u32 s53, s73, 4096
mm v[116:119],a[216:219],a[4:7],v[116:119]
mm v[120:123],a[216:219],a[8:11],0
tr a[216:217],v9,8192
cv v160,v160,v161
mm v[120:123],a[220:223],a[20:23],v[120:123]
tr a[218:219],v9,10240
cv v161,v162,v163
mm v[132:135],a[228:231],a[20:23],0
tr a[220:221],v9,12288
s_add_u32 m0, s44, 32768
mm v[132:135],a[224:227],a[8:11],v[132:135]
tr a[222:223],v9,14336
buffer_load_dwordx4 v1, s[20:23], s51 offen offset:0 lds
mm v[128:131],a[224:227],a[4:7],0
cv v162,v164,v165
cv v163,v166,v167
mm v[128:131],a[228:231],a[16:19],v[128:131]
buffer_store_dwordx4 v[160:163], v244, s[24:27], s73 offen offset:0 sc1
mm v[124:127],a[228:231],a[12:15],0
s_waitcnt lgkmcnt(4)
cv v168,v168,v169
mm v[124:127],a[224:227],a[0:3],v[124:127]
tr a[224:225],v10,8192
cv v169,v170,v171
mm v[136:139],a[232:235],a[0:3],0
tr a[226:227],v10,10240
cv v170,v172,v173
mm v[136:139],a[236:239],a[12:15],v[136:139]
tr a[228:229],v10,12288
buffer_load_dwordx4 v2, s[20:23], s51 offen offset:1024 lds
mm v[140:143],a[236:239],a[16:19],0
tr a[230:231],v10,14336
cv v171,v174,v175
mm v[140:143],a[232:235],a[4:7],v[140:143]
buffer_store_dwordx4 v[168:171], v244, s[24:27], s73 offen offset:1024 sc1
mm v[144:147],a[232:235],a[8:11],0
tr a[232:233],v9,8704
cv v176,v176,v177
mm v[144:147],a[236:239],a[20:23],v[144:147]
tr a[234:235],v9,10752
cv v177,v178,v179
mm v[156:159],a[244:247],a[20:23],0
s_waitcnt vmcnt(10)
tr a[236:237],v9,12800
mm v[156:159],a[240:243],a[8:11],v[156:159]
tr a[238:239],v9,14848
v_cmp_ne_u32 s[92:93], 1, v253
mm v[152:155],a[240:243],a[4:7],0
buffer_load_dwordx4 v3, s[20:23], s51 offen offset:2048 lds
cv v178,v180,v181
mm v[152:155],a[244:247],a[16:19],v[152:155]
cv v179,v182,v183
mm v[148:151],a[244:247],a[12:15],0
s_waitcnt lgkmcnt(4)
s_and_b32 s55, s92, 8
mm v[148:151],a[240:243],a[0:3],v[148:151]
s_or_b32 s6, s6, s55
tr a[240:241],v10,8704
mm v[112:115],a[216:219],a[24:27],v[112:115]
tr a[242:243],v10,10752
buffer_store_dwordx4 v[176:179], v244, s[24:27], s73 offen offset:2048 sc1
mm v[112:115],a[220:223],a[36:39],v[112:115]
tr a[244:245],v10,12800
cv v184,v184,v185
mm v[116:119],a[220:223],a[40:43],v[116:119]
tr a[246:247],v10,14848
cv v185,v186,v187
mm v[116:119],a[216:219],a[28:31],v[116:119]
buffer_load_dwordx4 v4, s[20:23], s51 offen offset:3072 lds
cv v186,v188,v189
mm v[120:123],a[216:219],a[32:35],v[120:123]
tr a[216:217],v9,16384
cv v187,v190,v191
mm v[120:123],a[220:223],a[44:47],v[120:123]
tr a[218:219],v9,18432
buffer_store_dwordx4 v[184:187], v244, s[24:27], s73 offen offset:3072 sc1
mm v[132:135],a[228:231],a[44:47],v[132:135]
tr a[220:221],v9,20480
cv v192,v192,v193
mm v[132:135],a[224:227],a[32:35],v[132:135]
tr a[222:223],v9,22528
cv v193,v194,v195
mm v[128:131],a[224:227],a[28:31],v[128:131]
cv v194,v196,v197
cv v195,v198,v199
mm v[128:131],a[228:231],a[40:43],v[128:131]
buffer_store_dwordx4 v[192:195], v244, s[24:27], s53 offen offset:0 sc1
mm v[124:127],a[228:231],a[36:39],v[124:127]
s_waitcnt lgkmcnt(4)
cv v200,v200,v201
mm v[124:127],a[224:227],a[24:27],v[124:127]
tr a[224:225],v10,16384
cv v201,v202,v203
mm v[136:139],a[232:235],a[24:27],v[136:139]
tr a[226:227],v10,18432
cv v202,v204,v205
mm v[136:139],a[236:239],a[36:39],v[136:139]
tr a[228:229],v10,20480
cv v203,v206,v207
mm v[140:143],a[236:239],a[40:43],v[140:143]
buffer_store_dwordx4 v[200:203], v244, s[24:27], s53 offen offset:1024 sc1
tr a[230:231],v10,22528
mm v[140:143],a[232:235],a[28:31],v[140:143]
mm v[144:147],a[232:235],a[32:35],v[144:147]
tr a[232:233],v9,16896
mm v[144:147],a[236:239],a[44:47],v[144:147]
tr a[234:235],v9,18944
mm v[156:159],a[244:247],a[44:47],v[156:159]
tr a[236:237],v9,20992
mm v[156:159],a[240:243],a[32:35],v[156:159]
tr a[238:239],v9,23040
mm v[152:155],a[240:243],a[28:31],v[152:155]
s_bitcmp1_b32 s92, 3
s_cselect_b32 s4, s7, s79
mm v[152:155],a[244:247],a[40:43],v[152:155]
s_add_u32 s5, s4, 4096
mm v[148:151],a[244:247],a[36:39],v[148:151]
s_waitcnt lgkmcnt(4)
mm v[148:151],a[240:243],a[24:27],v[148:151]
tr a[240:241],v10,16896
mm v[112:115],a[216:219],a[48:51],v[112:115]
buffer_load_dwordx4 v[88:91], v244, s[24:27], s4 offen offset:0 sc1
tr a[242:243],v10,18944
mm v[112:115],a[220:223],a[60:63],v[112:115]
tr a[244:245],v10,20992
mm v[116:119],a[220:223],a[64:67],v[116:119]
tr a[246:247],v10,23040
mm v[116:119],a[216:219],a[52:55],v[116:119]
mm v[120:123],a[216:219],a[56:59],v[120:123]
tr a[216:217],v9,24576
mm v[120:123],a[220:223],a[68:71],v[120:123]
tr a[218:219],v9,26624
mm v[132:135],a[228:231],a[68:71],v[132:135]
tr a[220:221],v9,28672
mm v[132:135],a[224:227],a[56:59],v[132:135]
tr a[222:223],v9,30720
mm v[128:131],a[224:227],a[52:55],v[128:131]
mm v[128:131],a[228:231],a[64:67],v[128:131]
mm v[124:127],a[228:231],a[60:63],v[124:127]
s_waitcnt lgkmcnt(4)
mm v[124:127],a[224:227],a[48:51],v[124:127]
tr a[224:225],v10,24576
mm v[136:139],a[232:235],a[48:51],v[136:139]
tr a[226:227],v10,26624
mm v[136:139],a[236:239],a[60:63],v[136:139]
tr a[228:229],v10,28672
mm v[140:143],a[236:239],a[64:67],v[140:143]
tr a[230:231],v10,30720
mm v[140:143],a[232:235],a[52:55],v[140:143]
mm v[144:147],a[232:235],a[56:59],v[144:147]
buffer_load_dwordx4 v[92:95], v244, s[24:27], s4 offen offset:1024 sc1
tr a[232:233],v9,25088
mm v[144:147],a[236:239],a[68:71],v[144:147]
tr a[234:235],v9,27136
mm v[156:159],a[244:247],a[68:71],v[156:159]
tr a[236:237],v9,29184
mm v[156:159],a[240:243],a[56:59],v[156:159]
tr a[238:239],v9,31232
mm v[152:155],a[240:243],a[52:55],v[152:155]
mm v[152:155],a[244:247],a[64:67],v[152:155]
mm v[148:151],a[244:247],a[60:63],v[148:151]
s_waitcnt vmcnt(63)
s_waitcnt lgkmcnt(4)
mm v[148:151],a[240:243],a[48:51],v[148:151]
tr a[240:241],v10,25088
mm v[112:115],a[216:219],a[72:75],v[112:115]
s_barrier
tr a[242:243],v10,27136
mm v[112:115],a[220:223],a[84:87],v[112:115]
tr a[244:245],v10,29184
mm v[116:119],a[220:223],a[88:91],v[116:119]
tr a[246:247],v10,31232
v_add_u32 v9, 65536, v9
mm v[116:119],a[216:219],a[76:79],v[116:119]
v_add_u32 v10, 65536, v10
mm v[120:123],a[216:219],a[80:83],v[120:123]
tr a[216:217],v9,0
mm v[120:123],a[220:223],a[92:95],v[120:123]
tr a[218:219],v9,2048
mm v[132:135],a[228:231],a[92:95],v[132:135]
tr a[220:221],v9,4096
mm v[132:135],a[224:227],a[80:83],v[132:135]
tr a[222:223],v9,6144
mm v[128:131],a[224:227],a[76:79],v[128:131]
mm v[128:131],a[228:231],a[88:91],v[128:131]
buffer_load_dwordx4 v[96:99], v244, s[24:27], s4 offen offset:2048 sc1
mm v[124:127],a[228:231],a[84:87],v[124:127]
s_waitcnt lgkmcnt(4)
mm v[124:127],a[224:227],a[72:75],v[124:127]
tr a[224:225],v10,0
mm v[136:139],a[232:235],a[72:75],v[136:139]
tr a[226:227],v10,2048
mm v[136:139],a[236:239],a[84:87],v[136:139]
tr a[228:229],v10,4096
mm v[140:143],a[236:239],a[88:91],v[140:143]
tr a[230:231],v10,6144
mm v[140:143],a[232:235],a[76:79],v[140:143]
mm v[144:147],a[232:235],a[80:83],v[144:147]
tr a[232:233],v9,512
mm v[144:147],a[236:239],a[92:95],v[144:147]
tr a[234:235],v9,2560
mm v[156:159],a[244:247],a[92:95],v[156:159]
tr a[236:237],v9,4608
mm v[156:159],a[240:243],a[80:83],v[156:159]
tr a[238:239],v9,6656
mm v[152:155],a[240:243],a[76:79],v[152:155]
mm v[152:155],a[244:247],a[88:91],v[152:155]
mm v[148:151],a[244:247],a[84:87],v[148:151]
s_waitcnt lgkmcnt(4)
mm v[148:151],a[240:243],a[72:75],v[148:151]
tr a[240:241],v10,512
mm v[112:115],a[216:219],a[96:99],v[112:115]
tr a[242:243],v10,2560
mm v[112:115],a[220:223],a[108:111],v[112:115]
tr a[244:245],v10,4608
mm v[116:119],a[220:223],a[112:115],v[116:119]
tr a[246:247],v10,6656
buffer_load_dwordx4 v[100:103], v244, s[24:27], s4 offen offset:3072 sc1
mm v[116:119],a[216:219],a[100:103],v[116:119]
mm v[120:123],a[216:219],a[104:107],v[120:123]
tr a[216:217],v9,8192
mm v[120:123],a[220:223],a[116:119],v[120:123]
tr a[218:219],v9,10240
mm v[132:135],a[228:231],a[116:119],v[132:135]
tr a[220:221],v9,12288
mm v[132:135],a[224:227],a[104:107],v[132:135]
tr a[222:223],v9,14336
mm v[128:131],a[224:227],a[100:103],v[128:131]
mm v[128:131],a[228:231],a[112:115],v[128:131]
mm v[124:127],a[228:231],a[108:111],v[124:127]
s_waitcnt lgkmcnt(4)
mm v[124:127],a[224:227],a[96:99],v[124:127]
tr a[224:225],v10,8192
mm v[136:139],a[232:235],a[96:99],v[136:139]
tr a[226:227],v10,10240
mm v[136:139],a[236:239],a[108:111],v[136:139]
tr a[228:229],v10,12288
mm v[140:143],a[236:239],a[112:115],v[140:143]
tr a[230:231],v10,14336
mm v[140:143],a[232:235],a[100:103],v[140:143]
mm v[144:147],a[232:235],a[104:107],v[144:147]
tr a[232:233],v9,8704
mm v[144:147],a[236:239],a[116:119],v[144:147]
tr a[234:235],v9,10752
mm v[156:159],a[244:247],a[116:119],v[156:159]
buffer_load_dwordx4 v[104:107], v244, s[24:27], s5 offen offset:0 sc1
tr a[236:237],v9,12800
mm v[156:159],a[240:243],a[104:107],v[156:159]
tr a[238:239],v9,14848
mm v[152:155],a[240:243],a[100:103],v[152:155]
mm v[152:155],a[244:247],a[112:115],v[152:155]
mm v[148:151],a[244:247],a[108:111],v[148:151]
s_waitcnt lgkmcnt(4)
mm v[148:151],a[240:243],a[96:99],v[148:151]
tr a[240:241],v10,8704
mm v[112:115],a[216:219],a[120:123],v[112:115]
tr a[242:243],v10,10752
mm v[112:115],a[220:223],a[132:135],v[112:115]
tr a[244:245],v10,12800
mm v[116:119],a[220:223],a[136:139],v[116:119]
tr a[246:247],v10,14848
mm v[116:119],a[216:219],a[124:127],v[116:119]
mm v[120:123],a[216:219],a[128:131],v[120:123]
tr a[216:217],v9,16384
mm v[120:123],a[220:223],a[140:143],v[120:123]
tr a[218:219],v9,18432
mm v[132:135],a[228:231],a[140:143],v[132:135]
tr a[220:221],v9,20480
mm v[132:135],a[224:227],a[128:131],v[132:135]
tr a[222:223],v9,22528
mm v[128:131],a[224:227],a[124:127],v[128:131]
mm v[128:131],a[228:231],a[136:139],v[128:131]
mm v[124:127],a[228:231],a[132:135],v[124:127]
s_waitcnt lgkmcnt(4)
mm v[124:127],a[224:227],a[120:123],v[124:127]
buffer_load_dwordx4 v[108:111], v244, s[24:27], s5 offen offset:1024 sc1
tr a[224:225],v10,16384
mm v[136:139],a[232:235],a[120:123],v[136:139]
tr a[226:227],v10,18432
mm v[136:139],a[236:239],a[132:135],v[136:139]
tr a[228:229],v10,20480
mm v[140:143],a[236:239],a[136:139],v[140:143]
tr a[230:231],v10,22528
mm v[140:143],a[232:235],a[124:127],v[140:143]
s_waitcnt vmcnt(6)
mm v[144:147],a[232:235],a[128:131],v[144:147]
buffer_store_dword v247, v245, s[28:31], s89 offen offset:0 sc1
tr a[232:233],v9,16896
mm v[144:147],a[236:239],a[140:143],v[144:147]
tr a[234:235],v9,18944
mm v[156:159],a[244:247],a[140:143],v[156:159]
tr a[236:237],v9,20992
mm v[156:159],a[240:243],a[128:131],v[156:159]
tr a[238:239],v9,23040
mm v[152:155],a[240:243],a[124:127],v[152:155]
mm v[152:155],a[244:247],a[136:139],v[152:155]
mm v[148:151],a[244:247],a[132:135],v[148:151]
s_waitcnt lgkmcnt(4)
mm v[148:151],a[240:243],a[120:123],v[148:151]
tr a[240:241],v10,16896
mm v[112:115],a[216:219],a[144:147],v[112:115]
tr a[242:243],v10,18944
mm v[112:115],a[220:223],a[156:159],v[112:115]
tr a[244:245],v10,20992
mm v[116:119],a[220:223],a[160:163],v[116:119]
tr a[246:247],v10,23040
mm v[116:119],a[216:219],a[148:151],v[116:119]
mm v[120:123],a[216:219],a[152:155],v[120:123]
tr a[216:217],v9,24576
mm v[120:123],a[220:223],a[164:167],v[120:123]
tr a[218:219],v9,26624
mm v[132:135],a[228:231],a[164:167],v[132:135]
tr a[220:221],v9,28672
mm v[132:135],a[224:227],a[152:155],v[132:135]
tr a[222:223],v9,30720
mm v[128:131],a[224:227],a[148:151],v[128:131]
mm v[128:131],a[228:231],a[160:163],v[128:131]
mm v[124:127],a[228:231],a[156:159],v[124:127]
s_waitcnt lgkmcnt(4)
mm v[124:127],a[224:227],a[144:147],v[124:127]
tr a[224:225],v10,24576
mm v[136:139],a[232:235],a[144:147],v[136:139]
tr a[226:227],v10,26624
mm v[136:139],a[236:239],a[156:159],v[136:139]
tr a[228:229],v10,28672
mm v[140:143],a[236:239],a[160:163],v[140:143]
tr a[230:231],v10,30720
mm v[140:143],a[232:235],a[148:151],v[140:143]
mm v[144:147],a[232:235],a[152:155],v[144:147]
tr a[232:233],v9,25088
mm v[144:147],a[236:239],a[164:167],v[144:147]
tr a[234:235],v9,27136
mm v[156:159],a[244:247],a[164:167],v[156:159]
tr a[236:237],v9,29184
mm v[156:159],a[240:243],a[152:155],v[156:159]
tr a[238:239],v9,31232
mm v[152:155],a[240:243],a[148:151],v[152:155]
mm v[152:155],a[244:247],a[160:163],v[152:155]
mm v[148:151],a[244:247],a[156:159],v[148:151]
s_waitcnt vmcnt(63)
s_waitcnt lgkmcnt(4)
mm v[148:151],a[240:243],a[144:147],v[148:151]
tr a[240:241],v10,25088
mm v[112:115],a[216:219],a[168:171],v[112:115]
s_barrier
tr a[242:243],v10,27136
mm v[112:115],a[220:223],a[180:183],v[112:115]
tr a[244:245],v10,29184
mm v[116:119],a[220:223],a[184:187],v[116:119]
tr a[246:247],v10,31232
mm v[116:119],a[216:219],a[172:175],v[116:119]
mm v[120:123],a[216:219],a[176:179],v[120:123]
tr a[216:217],v9,32768
mm v[120:123],a[220:223],a[188:191],v[120:123]
tr a[218:219],v9,34816
mm v[132:135],a[228:231],a[188:191],v[132:135]
tr a[220:221],v9,36864
mm v[132:135],a[224:227],a[176:179],v[132:135]
tr a[222:223],v9,38912
mm v[128:131],a[224:227],a[172:175],v[128:131]
mm v[128:131],a[228:231],a[184:187],v[128:131]
mm v[124:127],a[228:231],a[180:183],v[124:127]
s_waitcnt lgkmcnt(4)
mm v[124:127],a[224:227],a[168:171],v[124:127]
tr a[224:225],v10,32768
mm v[136:139],a[232:235],a[168:171],v[136:139]
tr a[226:227],v10,34816
mm v[136:139],a[236:239],a[180:183],v[136:139]
tr a[228:229],v10,36864
mm v[140:143],a[236:239],a[184:187],v[140:143]
tr a[230:231],v10,38912
mm v[140:143],a[232:235],a[172:175],v[140:143]
mm v[144:147],a[232:235],a[176:179],v[144:147]
tr a[232:233],v9,33280
mm v[144:147],a[236:239],a[188:191],v[144:147]
tr a[234:235],v9,35328
mm v[156:159],a[244:247],a[188:191],v[156:159]
tr a[236:237],v9,37376
mm v[156:159],a[240:243],a[176:179],v[156:159]
tr a[238:239],v9,39424
mm v[152:155],a[240:243],a[172:175],v[152:155]
mm v[152:155],a[244:247],a[184:187],v[152:155]
mm v[148:151],a[244:247],a[180:183],v[148:151]
s_waitcnt lgkmcnt(4)
mm v[148:151],a[240:243],a[168:171],v[148:151]
tr a[240:241],v10,33280
mm v[160:163],a[216:219],a[0:3],0
tr a[242:243],v10,35328
mm v[160:163],a[220:223],a[12:15],v[160:163]
tr a[244:245],v10,37376
mm v[164:167],a[220:223],a[16:19],0
tr a[246:247],v10,39424
s_add_u32 s53, s74, 4096
mm v[164:167],a[216:219],a[4:7],v[164:167]
mm v[168:171],a[216:219],a[8:11],0
tr a[216:217],v9,40960
cv v112,v112,v113
mm v[168:171],a[220:223],a[20:23],v[168:171]
tr a[218:219],v9,43008
cv v113,v114,v115
mm v[180:183],a[228:231],a[20:23],0
tr a[220:221],v9,45056
cv v114,v116,v117
mm v[180:183],a[224:227],a[8:11],v[180:183]
tr a[222:223],v9,47104
cv v115,v118,v119
mm v[176:179],a[224:227],a[4:7],0
buffer_store_dwordx4 v[112:115], v244, s[24:27], s74 offen offset:0 sc1
cv v120,v120,v121
mm v[176:179],a[228:231],a[16:19],v[176:179]
cv v121,v122,v123
cv v122,v124,v125
mm v[172:175],a[228:231],a[12:15],0
s_waitcnt lgkmcnt(4)
cv v123,v126,v127
mm v[172:175],a[224:227],a[0:3],v[172:175]
tr a[224:225],v10,40960
buffer_store_dwordx4 v[120:123], v244, s[24:27], s74 offen offset:1024 sc1
mm v[184:187],a[232:235],a[0:3],0
tr a[226:227],v10,43008
cv v128,v128,v129
mm v[184:187],a[236:239],a[12:15],v[184:187]
tr a[228:229],v10,45056
cv v129,v130,v131
mm v[188:191],a[236:239],a[16:19],0
tr a[230:231],v10,47104
cv v130,v132,v133
mm v[188:191],a[232:235],a[4:7],v[188:191]
cv v131,v134,v135
mm v[192:195],a[232:235],a[8:11],0
tr a[232:233],v9,41472
buffer_store_dwordx4 v[128:131], v244, s[24:27], s74 offen offset:2048 sc1
mm v[192:195],a[236:239],a[20:23],v[192:195]
tr a[234:235],v9,43520
cv v136,v136,v137
mm v[204:207],a[244:247],a[20:23],0
tr a[236:237],v9,45568
cv v137,v138,v139
mm v[204:207],a[240:243],a[8:11],v[204:207]
tr a[238:239],v9,47616
cv v138,v140,v141
mm v[200:203],a[240:243],a[4:7],0
cv v139,v142,v143
mm v[200:203],a[244:247],a[16:19],v[200:203]
buffer_store_dwordx4 v[136:139], v244, s[24:27], s74 offen offset:3072 sc1
cv v144,v144,v145
mm v[196:199],a[244:247],a[12:15],0
s_waitcnt lgkmcnt(4)
cv v145,v146,v147
mm v[196:199],a[240:243],a[0:3],v[196:199]
tr a[240:241],v10,41472
cv v146,v148,v149
mm v[160:163],a[216:219],a[24:27],v[160:163]
tr a[242:243],v10,43520
cv v147,v150,v151
buffer_store_dwordx4 v[144:147], v244, s[24:27], s53 offen offset:0 sc1
cv v152,v152,v153
cv v153,v154,v155
cv v154,v156,v157
cv v155,v158,v159
buffer_store_dwordx4 v[152:155], v244, s[24:27], s53 offen offset:1024 sc1
mm v[160:163],a[220:223],a[36:39],v[160:163]
tr a[244:245],v10,45568
mm v[164:167],a[220:223],a[40:43],v[164:167]
tr a[246:247],v10,47616
mm v[164:167],a[216:219],a[28:31],v[164:167]
mm v[168:171],a[216:219],a[32:35],v[168:171]
buffer_load_dword v253, v255, s[28:31], s91 offen offset:0 sc1
tr a[216:217],v9,49152
mm v[168:171],a[220:223],a[44:47],v[168:171]
tr a[218:219],v9,51200
mm v[180:183],a[228:231],a[44:47],v[180:183]
tr a[220:221],v9,53248
s_mul_i32 s48, s42, 6912
mm v[180:183],a[224:227],a[32:35],v[180:183]
tr a[222:223],v9,55296
mm v[176:179],a[224:227],a[28:31],v[176:179]
mm v[176:179],a[228:231],a[40:43],v[176:179]
mm v[172:175],a[228:231],a[36:39],v[172:175]
s_waitcnt lgkmcnt(4)
s_add_u32 s48, s48, 65536
mm v[172:175],a[224:227],a[24:27],v[172:175]
tr a[224:225],v10,49152
mm v[184:187],a[232:235],a[24:27],v[184:187]
tr a[226:227],v10,51200
mm v[184:187],a[236:239],a[36:39],v[184:187]
tr a[228:229],v10,53248
mm v[188:191],a[236:239],a[40:43],v[188:191]
tr a[230:231],v10,55296
v_and_b32 v248, 15, v0
mm v[188:191],a[232:235],a[28:31],v[188:191]
mm v[192:195],a[232:235],a[32:35],v[192:195]
tr a[232:233],v9,49664
mm v[192:195],a[236:239],a[44:47],v[192:195]
tr a[234:235],v9,51712
mm v[204:207],a[244:247],a[44:47],v[204:207]
tr a[236:237],v9,53760
v_mul_u32_u24 v248, 144, v248
mm v[204:207],a[240:243],a[32:35],v[204:207]
tr a[238:239],v9,55808
mm v[200:203],a[240:243],a[28:31],v[200:203]
mm v[200:203],a[244:247],a[40:43],v[200:203]
mm v[196:199],a[244:247],a[36:39],v[196:199]
s_waitcnt lgkmcnt(4)
v_bfe_u32 v249, v0, 5, 1
mm v[196:199],a[240:243],a[24:27],v[196:199]
tr a[240:241],v10,49664
mm v[160:163],a[216:219],a[48:51],v[160:163]
tr a[242:243],v10,51712
mm v[160:163],a[220:223],a[60:63],v[160:163]
tr a[244:245],v10,53760
mm v[164:167],a[220:223],a[64:67],v[164:167]
tr a[246:247],v10,55808
v_lshl_add_u32 v248, v249, 5, v248
mm v[164:167],a[216:219],a[52:55],v[164:167]
mm v[168:171],a[216:219],a[56:59],v[168:171]
tr a[216:217],v9,57344
mm v[168:171],a[220:223],a[68:71],v[168:171]
tr a[218:219],v9,59392
mm v[180:183],a[228:231],a[68:71],v[180:183]
tr a[220:221],v9,61440
v_bfe_u32 v249, v0, 4, 1
L_pg28:
s_cbranch_execz L_tret3
mm v[180:183],a[224:227],a[56:59],v[180:183]
tr a[222:223],v9,63488
mm v[176:179],a[224:227],a[52:55],v[176:179]
mm v[176:179],a[228:231],a[64:67],v[176:179]
mm v[172:175],a[228:231],a[60:63],v[172:175]
s_waitcnt lgkmcnt(4)
v_lshl_add_u32 v248, v249, 3, v248
mm v[172:175],a[224:227],a[48:51],v[172:175]
tr a[224:225],v10,57344
mm v[184:187],a[232:235],a[48:51],v[184:187]
tr a[226:227],v10,59392
mm v[184:187],a[236:239],a[60:63],v[184:187]
tr a[228:229],v10,61440
mm v[188:191],a[236:239],a[64:67],v[188:191]
tr a[230:231],v10,63488
v_add_u32 v248, s48, v248
mm v[188:191],a[232:235],a[52:55],v[188:191]
mm v[192:195],a[232:235],a[56:59],v[192:195]
tr a[232:233],v9,57856
mm v[192:195],a[236:239],a[68:71],v[192:195]
tr a[234:235],v9,59904
mm v[204:207],a[244:247],a[68:71],v[204:207]
tr a[236:237],v9,61952
mm v[204:207],a[240:243],a[56:59],v[204:207]
tr a[238:239],v9,64000
v_lshrrev_b32 v249, 3, v0
mm v[200:203],a[240:243],a[52:55],v[200:203]
mm v[200:203],a[244:247],a[64:67],v[200:203]
mm v[196:199],a[244:247],a[60:63],v[196:199]
s_waitcnt vmcnt(63)
s_waitcnt lgkmcnt(4)
mm v[196:199],a[240:243],a[48:51],v[196:199]
tr a[240:241],v10,57856
v_and_b32 v250, 7, v0
mm v[160:163],a[216:219],a[72:75],v[160:163]
s_barrier
tr a[242:243],v10,59904
mm v[160:163],a[220:223],a[84:87],v[160:163]
tr a[244:245],v10,61952
mm v[164:167],a[220:223],a[88:91],v[164:167]
tr a[246:247],v10,64000
v_add_u32 v9, 4294934528, v9
mm v[164:167],a[216:219],a[76:79],v[164:167]
v_add_u32 v10, 4294934528, v10
v_lshlrev_b32 v250, 4, v250
mm v[168:171],a[216:219],a[80:83],v[168:171]
tr a[216:217],v9,0
mm v[168:171],a[220:223],a[92:95],v[168:171]
tr a[218:219],v9,2048
mm v[180:183],a[228:231],a[92:95],v[180:183]
tr a[220:221],v9,4096
mm v[180:183],a[224:227],a[80:83],v[180:183]
tr a[222:223],v9,6144
v_lshl_add_u32 v246, v249, 10, v250
mm v[176:179],a[224:227],a[76:79],v[176:179]
mm v[176:179],a[228:231],a[88:91],v[176:179]
mm v[172:175],a[228:231],a[84:87],v[172:175]
s_waitcnt lgkmcnt(4)
mm v[172:175],a[224:227],a[72:75],v[172:175]
tr a[224:225],v10,0
v_mul_u32_u24 v249, 144, v249
mm v[184:187],a[232:235],a[72:75],v[184:187]
tr a[226:227],v10,2048
mm v[184:187],a[236:239],a[84:87],v[184:187]
tr a[228:229],v10,4096
mm v[188:191],a[236:239],a[88:91],v[188:191]
tr a[230:231],v10,6144
mm v[188:191],a[232:235],a[76:79],v[188:191]
v_add3_u32 v249, v249, v250, s48
mm v[192:195],a[232:235],a[80:83],v[192:195]
tr a[232:233],v9,512
mm v[192:195],a[236:239],a[92:95],v[192:195]
tr a[234:235],v9,2560
mm v[204:207],a[244:247],a[92:95],v[204:207]
tr a[236:237],v9,4608
mm v[204:207],a[240:243],a[80:83],v[204:207]
tr a[238:239],v9,6656
s_mul_i32 s48, s42, 49152
mm v[200:203],a[240:243],a[76:79],v[200:203]
mm v[200:203],a[244:247],a[88:91],v[200:203]
mm v[196:199],a[244:247],a[84:87],v[196:199]
s_waitcnt lgkmcnt(4)
mm v[196:199],a[240:243],a[72:75],v[196:199]
tr a[240:241],v10,512
v_add_u32 v246, s48, v246
mm v[160:163],a[216:219],a[96:99],v[160:163]
tr a[242:243],v10,2560
mm v[160:163],a[220:223],a[108:111],v[160:163]
tr a[244:245],v10,4608
mm v[164:167],a[220:223],a[112:115],v[164:167]
tr a[246:247],v10,6656
mm v[164:167],a[216:219],a[100:103],v[164:167]
mm v[168:171],a[216:219],a[104:107],v[168:171]
tr a[216:217],v9,8192
mm v[168:171],a[220:223],a[116:119],v[168:171]
tr a[218:219],v9,10240
mm v[180:183],a[228:231],a[116:119],v[180:183]
tr a[220:221],v9,12288
mm v[180:183],a[224:227],a[104:107],v[180:183]
tr a[222:223],v9,14336
mm v[176:179],a[224:227],a[100:103],v[176:179]
mm v[176:179],a[228:231],a[112:115],v[176:179]
mm v[172:175],a[228:231],a[108:111],v[172:175]
s_waitcnt lgkmcnt(4)
mm v[172:175],a[224:227],a[96:99],v[172:175]
tr a[224:225],v10,8192
mm v[184:187],a[232:235],a[96:99],v[184:187]
s_waitcnt vmcnt(0)
tr a[226:227],v10,10240
mm v[184:187],a[236:239],a[108:111],v[184:187]
tr a[228:229],v10,12288
v_cmp_ne_u32 s[92:93], 1, v253
mm v[188:191],a[236:239],a[112:115],v[188:191]
tr a[230:231],v10,14336
mm v[188:191],a[232:235],a[100:103],v[188:191]
mm v[192:195],a[232:235],a[104:107],v[192:195]
s_and_b32 s55, s92, 48
s_or_b32 s6, s6, s55
mm v[192:195],a[236:239],a[116:119],v[192:195]
tr a[232:233],v9,8704
mm v[204:207],a[244:247],a[116:119],v[204:207]
tr a[234:235],v9,10752
mm v[204:207],a[240:243],a[104:107],v[204:207]
s_waitcnt vmcnt(63)
tr a[236:237],v9,12800
mm v[200:203],a[240:243],a[100:103],v[200:203]
buffer_store_dword v247, v245, s[28:31], s90 offen offset:0 sc1
tr a[238:239],v9,14848
mm v[200:203],a[244:247],a[112:115],v[200:203]
s_bitcmp1_b32 s92, 4
s_cselect_b32 s4, s7, s80
mm v[196:199],a[244:247],a[108:111],v[196:199]
s_waitcnt lgkmcnt(4)
s_add_u32 s5, s4, 4096
mm v[196:199],a[240:243],a[96:99],v[196:199]
tr a[240:241],v10,8704
mm v[160:163],a[216:219],a[120:123],v[160:163]
tr a[242:243],v10,10752
mm v[160:163],a[220:223],a[132:135],v[160:163]
buffer_load_dwordx4 v[208:211], v244, s[24:27], s4 offen offset:0 sc1
tr a[244:245],v10,12800
mm v[164:167],a[220:223],a[136:139],v[164:167]
tr a[246:247],v10,14848
mm v[164:167],a[216:219],a[124:127],v[164:167]
mm v[168:171],a[216:219],a[128:131],v[168:171]
tr a[216:217],v9,16384
mm v[168:171],a[220:223],a[140:143],v[168:171]
tr a[218:219],v9,18432
mm v[180:183],a[228:231],a[140:143],v[180:183]
buffer_load_dwordx4 v[212:215], v244, s[24:27], s4 offen offset:1024 sc1
tr a[220:221],v9,20480
mm v[180:183],a[224:227],a[128:131],v[180:183]
tr a[222:223],v9,22528
mm v[176:179],a[224:227],a[124:127],v[176:179]
mm v[176:179],a[228:231],a[136:139],v[176:179]
mm v[172:175],a[228:231],a[132:135],v[172:175]
s_waitcnt lgkmcnt(4)
mm v[172:175],a[224:227],a[120:123],v[172:175]
buffer_load_dwordx4 v[216:219], v244, s[24:27], s4 offen offset:2048 sc1
tr a[224:225],v10,16384
mm v[184:187],a[232:235],a[120:123],v[184:187]
tr a[226:227],v10,18432
mm v[184:187],a[236:239],a[132:135],v[184:187]
tr a[228:229],v10,20480
mm v[188:191],a[236:239],a[136:139],v[188:191]
tr a[230:231],v10,22528
mm v[188:191],a[232:235],a[124:127],v[188:191]
mm v[192:195],a[232:235],a[128:131],v[192:195]
buffer_load_dwordx4 v[220:223], v244, s[24:27], s4 offen offset:3072 sc1
tr a[232:233],v9,16896
mm v[192:195],a[236:239],a[140:143],v[192:195]
tr a[234:235],v9,18944
mm v[204:207],a[244:247],a[140:143],v[204:207]
tr a[236:237],v9,20992
mm v[204:207],a[240:243],a[128:131],v[204:207]
tr a[238:239],v9,23040
mm v[200:203],a[240:243],a[124:127],v[200:203]
mm v[200:203],a[244:247],a[136:139],v[200:203]
buffer_load_dwordx4 v[224:227], v244, s[24:27], s5 offen offset:0 sc1
mm v[196:199],a[244:247],a[132:135],v[196:199]
s_waitcnt lgkmcnt(4)
mm v[196:199],a[240:243],a[120:123],v[196:199]
tr a[240:241],v10,16896
mm v[160:163],a[216:219],a[144:147],v[160:163]
tr a[242:243],v10,18944
mm v[160:163],a[220:223],a[156:159],v[160:163]
tr a[244:245],v10,20992
mm v[164:167],a[220:223],a[160:163],v[164:167]
tr a[246:247],v10,23040
buffer_load_dwordx4 v[228:231], v244, s[24:27], s5 offen offset:1024 sc1
mm v[164:167],a[216:219],a[148:151],v[164:167]
mm v[168:171],a[216:219],a[152:155],v[168:171]
s_bitcmp1_b32 s92, 5
s_cselect_b32 s4, s7, s81
mm v[168:171],a[220:223],a[164:167],v[168:171]
s_add_u32 s5, s4, 4096
tr a[216:217],v9,24576
mm v[180:183],a[228:231],a[164:167],v[180:183]
tr a[218:219],v9,26624
mm v[180:183],a[224:227],a[152:155],v[180:183]
tr a[220:221],v9,28672
mm v[176:179],a[224:227],a[148:151],v[176:179]
tr a[222:223],v9,30720
buffer_load_dwordx4 v[112:115], v244, s[24:27], s4 offen offset:0 sc1
mm v[176:179],a[228:231],a[160:163],v[176:179]
mm v[172:175],a[228:231],a[156:159],v[172:175]
s_waitcnt lgkmcnt(4)
mm v[172:175],a[224:227],a[144:147],v[172:175]
tr a[224:225],v10,24576
mm v[184:187],a[232:235],a[144:147],v[184:187]
tr a[226:227],v10,26624
mm v[184:187],a[236:239],a[156:159],v[184:187]
buffer_load_dwordx4 v[116:119], v244, s[24:27], s4 offen offset:1024 sc1
tr a[228:229],v10,28672
mm v[188:191],a[236:239],a[160:163],v[188:191]
tr a[230:231],v10,30720
mm v[188:191],a[232:235],a[148:151],v[188:191]
mm v[192:195],a[232:235],a[152:155],v[192:195]
tr a[232:233],v9,25088
mm v[192:195],a[236:239],a[164:167],v[192:195]
tr a[234:235],v9,27136
mm v[204:207],a[244:247],a[164:167],v[204:207]
tr a[236:237],v9,29184
mm v[204:207],a[240:243],a[152:155],v[204:207]
buffer_load_dwordx4 v[120:123], v244, s[24:27], s4 offen offset:2048 sc1
tr a[238:239],v9,31232
mm v[200:203],a[240:243],a[148:151],v[200:203]
mm v[200:203],a[244:247],a[160:163],v[200:203]
buffer_load_dword v254, v255, s[28:31], s91 offen offset:0 sc1
mm v[196:199],a[244:247],a[156:159],v[196:199]
s_waitcnt lgkmcnt(4)
mm v[196:199],a[240:243],a[144:147],v[196:199]
tr a[240:241],v10,25088
mm v[160:163],a[216:219],a[168:171],v[160:163]
tr a[242:243],v10,27136
mm v[160:163],a[220:223],a[180:183],v[160:163]
buffer_load_dwordx4 v[124:127], v244, s[24:27], s4 offen offset:3072 sc1
tr a[244:245],v10,29184
mm v[164:167],a[220:223],a[184:187],v[164:167]
tr a[246:247],v10,31232
mm v[164:167],a[216:219],a[172:175],v[164:167]
mm v[168:171],a[216:219],a[176:179],v[168:171]
mm v[168:171],a[220:223],a[188:191],v[168:171]
mm v[180:183],a[228:231],a[188:191],v[180:183]
buffer_load_dwordx4 v[128:131], v244, s[24:27], s5 offen offset:0 sc1
mm v[180:183],a[224:227],a[176:179],v[180:183]
mm v[176:179],a[224:227],a[172:175],v[176:179]
mm v[176:179],a[228:231],a[184:187],v[176:179]
mm v[172:175],a[228:231],a[180:183],v[172:175]
s_waitcnt lgkmcnt(0)
mm v[172:175],a[224:227],a[168:171],v[172:175]
mm v[184:187],a[232:235],a[168:171],v[184:187]
buffer_load_dwordx4 v[132:135], v244, s[24:27], s5 offen offset:1024 sc1
mm v[184:187],a[236:239],a[180:183],v[184:187]
mm v[188:191],a[236:239],a[184:187],v[188:191]
mm v[188:191],a[232:235],a[172:175],v[188:191]
mm v[192:195],a[232:235],a[176:179],v[192:195]
mm v[192:195],a[236:239],a[188:191],v[192:195]
mm v[204:207],a[244:247],a[188:191],v[204:207]
mm v[204:207],a[240:243],a[176:179],v[204:207]
mm v[200:203],a[240:243],a[172:175],v[200:203]
mm v[200:203],a[244:247],a[184:187],v[200:203]
mm v[196:199],a[244:247],a[180:183],v[196:199]
mm v[196:199],a[240:243],a[168:171],v[196:199]
s_mov_b32 s55, 0x00003f80
s_mov_b32 s56, 0x3f800000
s_waitcnt vmcnt(63)
v_dot2_f32_bf16 v160, v16, s55, v160
v_dot2_f32_bf16 v161, v16, s56, v161
v_dot2_f32_bf16 v162, v17, s55, v162
v_dot2_f32_bf16 v163, v17, s56, v163
v_dot2_f32_bf16 v164, v18, s55, v164
v_dot2_f32_bf16 v165, v18, s56, v165
v_dot2_f32_bf16 v166, v19, s55, v166
v_dot2_f32_bf16 v167, v19, s56, v167
v_dot2_f32_bf16 v168, v20, s55, v168
v_dot2_f32_bf16 v169, v20, s56, v169
v_dot2_f32_bf16 v170, v21, s55, v170
v_dot2_f32_bf16 v171, v21, s56, v171
v_dot2_f32_bf16 v172, v22, s55, v172
v_dot2_f32_bf16 v173, v22, s56, v173
v_dot2_f32_bf16 v174, v23, s55, v174
v_dot2_f32_bf16 v175, v23, s56, v175
v_dot2_f32_bf16 v176, v24, s55, v176
v_dot2_f32_bf16 v177, v24, s56, v177
v_dot2_f32_bf16 v178, v25, s55, v178
v_dot2_f32_bf16 v179, v25, s56, v179
v_dot2_f32_bf16 v180, v26, s55, v180
v_dot2_f32_bf16 v181, v26, s56, v181
v_dot2_f32_bf16 v182, v27, s55, v182
v_dot2_f32_bf16 v183, v27, s56, v183
v_dot2_f32_bf16 v184, v28, s55, v184
v_dot2_f32_bf16 v185, v28, s56, v185
v_dot2_f32_bf16 v186, v29, s55, v186
v_dot2_f32_bf16 v187, v29, s56, v187
v_dot2_f32_bf16 v188, v30, s55, v188
v_dot2_f32_bf16 v189, v30, s56, v189
v_dot2_f32_bf16 v190, v31, s55, v190
v_dot2_f32_bf16 v191, v31, s56, v191
v_dot2_f32_bf16 v192, v32, s55, v192
v_dot2_f32_bf16 v193, v32, s56, v193
v_dot2_f32_bf16 v194, v33, s55, v194
v_dot2_f32_bf16 v195, v33, s56, v195
v_dot2_f32_bf16 v196, v34, s55, v196
v_dot2_f32_bf16 v197, v34, s56, v197
v_dot2_f32_bf16 v198, v35, s55, v198
v_dot2_f32_bf16 v199, v35, s56, v199
v_dot2_f32_bf16 v200, v36, s55, v200
v_dot2_f32_bf16 v201, v36, s56, v201
v_dot2_f32_bf16 v202, v37, s55, v202
v_dot2_f32_bf16 v203, v37, s56, v203
v_dot2_f32_bf16 v204, v38, s55, v204
v_dot2_f32_bf16 v205, v38, s56, v205
v_dot2_f32_bf16 v206, v39, s55, v206
v_dot2_f32_bf16 v207, v39, s56, v207
s_waitcnt vmcnt(63)
v_dot2_f32_bf16 v160, v40, s55, v160
v_dot2_f32_bf16 v161, v40, s56, v161
v_dot2_f32_bf16 v162, v41, s55, v162
v_dot2_f32_bf16 v163, v41, s56, v163
v_dot2_f32_bf16 v164, v42, s55, v164
v_dot2_f32_bf16 v165, v42, s56, v165
v_dot2_f32_bf16 v166, v43, s55, v166
v_dot2_f32_bf16 v167, v43, s56, v167
v_dot2_f32_bf16 v168, v44, s55, v168
v_dot2_f32_bf16 v169, v44, s56, v169
v_dot2_f32_bf16 v170, v45, s55, v170
v_dot2_f32_bf16 v171, v45, s56, v171
v_dot2_f32_bf16 v172, v46, s55, v172
v_dot2_f32_bf16 v173, v46, s56, v173
v_dot2_f32_bf16 v174, v47, s55, v174
v_dot2_f32_bf16 v175, v47, s56, v175
v_dot2_f32_bf16 v176, v48, s55, v176
v_dot2_f32_bf16 v177, v48, s56, v177
v_dot2_f32_bf16 v178, v49, s55, v178
v_dot2_f32_bf16 v179, v49, s56, v179
v_dot2_f32_bf16 v180, v50, s55, v180
v_dot2_f32_bf16 v181, v50, s56, v181
v_dot2_f32_bf16 v182, v51, s55, v182
v_dot2_f32_bf16 v183, v51, s56, v183
v_dot2_f32_bf16 v184, v52, s55, v184
v_dot2_f32_bf16 v185, v52, s56, v185
v_dot2_f32_bf16 v186, v53, s55, v186
v_dot2_f32_bf16 v187, v53, s56, v187
v_dot2_f32_bf16 v188, v54, s55, v188
v_dot2_f32_bf16 v189, v54, s56, v189
v_dot2_f32_bf16 v190, v55, s55, v190
v_dot2_f32_bf16 v191, v55, s56, v191
v_dot2_f32_bf16 v192, v56, s55, v192
v_dot2_f32_bf16 v193, v56, s56, v193
v_dot2_f32_bf16 v194, v57, s55, v194
v_dot2_f32_bf16 v195, v57, s56, v195
v_dot2_f32_bf16 v196, v58, s55, v196
v_dot2_f32_bf16 v197, v58, s56, v197
v_dot2_f32_bf16 v198, v59, s55, v198
v_dot2_f32_bf16 v199, v59, s56, v199
v_dot2_f32_bf16 v200, v60, s55, v200
v_dot2_f32_bf16 v201, v60, s56, v201
v_dot2_f32_bf16 v202, v61, s55, v202
v_dot2_f32_bf16 v203, v61, s56, v203
v_dot2_f32_bf16 v204, v62, s55, v204
v_dot2_f32_bf16 v205, v62, s56, v205
v_dot2_f32_bf16 v206, v63, s55, v206
v_dot2_f32_bf16 v207, v63, s56, v207
s_waitcnt vmcnt(63)
v_dot2_f32_bf16 v160, v64, s55, v160
v_dot2_f32_bf16 v161, v64, s56, v161
v_dot2_f32_bf16 v162, v65, s55, v162
v_dot2_f32_bf16 v163, v65, s56, v163
v_dot2_f32_bf16 v164, v66, s55, v164
v_dot2_f32_bf16 v165, v66, s56, v165
v_dot2_f32_bf16 v166, v67, s55, v166
v_dot2_f32_bf16 v167, v67, s56, v167
v_dot2_f32_bf16 v168, v68, s55, v168
v_dot2_f32_bf16 v169, v68, s56, v169
v_dot2_f32_bf16 v170, v69, s55, v170
v_dot2_f32_bf16 v171, v69, s56, v171
v_dot2_f32_bf16 v172, v70, s55, v172
v_dot2_f32_bf16 v173, v70, s56, v173
v_dot2_f32_bf16 v174, v71, s55, v174
v_dot2_f32_bf16 v175, v71, s56, v175
v_dot2_f32_bf16 v176, v72, s55, v176
v_dot2_f32_bf16 v177, v72, s56, v177
v_dot2_f32_bf16 v178, v73, s55, v178
v_dot2_f32_bf16 v179, v73, s56, v179
v_dot2_f32_bf16 v180, v74, s55, v180
v_dot2_f32_bf16 v181, v74, s56, v181
v_dot2_f32_bf16 v182, v75, s55, v182
v_dot2_f32_bf16 v183, v75, s56, v183
v_dot2_f32_bf16 v184, v76, s55, v184
v_dot2_f32_bf16 v185, v76, s56, v185
v_dot2_f32_bf16 v186, v77, s55, v186
v_dot2_f32_bf16 v187, v77, s56, v187
v_dot2_f32_bf16 v188, v78, s55, v188
v_dot2_f32_bf16 v189, v78, s56, v189
v_dot2_f32_bf16 v190, v79, s55, v190
v_dot2_f32_bf16 v191, v79, s56, v191
v_dot2_f32_bf16 v192, v80, s55, v192
v_dot2_f32_bf16 v193, v80, s56, v193
v_dot2_f32_bf16 v194, v81, s55, v194
v_dot2_f32_bf16 v195, v81, s56, v195
v_dot2_f32_bf16 v196, v82, s55, v196
v_dot2_f32_bf16 v197, v82, s56, v197
v_dot2_f32_bf16 v198, v83, s55, v198
v_dot2_f32_bf16 v199, v83, s56, v199
v_dot2_f32_bf16 v200, v84, s55, v200
v_dot2_f32_bf16 v201, v84, s56, v201
v_dot2_f32_bf16 v202, v85, s55, v202
v_dot2_f32_bf16 v203, v85, s56, v203
v_dot2_f32_bf16 v204, v86, s55, v204
v_dot2_f32_bf16 v205, v86, s56, v205
v_dot2_f32_bf16 v206, v87, s55, v206
v_dot2_f32_bf16 v207, v87, s56, v207
s_waitcnt vmcnt(3)
v_cmp_ne_u32 vcc, 1, v254
s_nop 4
s_cbranch_vccnz L_spin6
L_spun6:
s_cmp_lg_u32 s6, 0
s_cbranch_scc1 L_late
L_late_back:
s_add_u32 s53, s82, 4096
buffer_load_dwordx4 v[136:139], v244, s[24:27], s82 offen offset:0 sc1
buffer_load_dwordx4 v[140:143], v244, s[24:27], s82 offen offset:1024 sc1
buffer_load_dwordx4 v[144:147], v244, s[24:27], s82 offen offset:2048 sc1
buffer_load_dwordx4 v[148:151], v244, s[24:27], s82 offen offset:3072 sc1
buffer_load_dwordx4 v[152:155], v244, s[24:27], s53 offen offset:0 sc1
buffer_load_dwordx4 v[156:159], v244, s[24:27], s53 offen offset:1024 sc1
s_waitcnt vmcnt(63)
v_dot2_f32_bf16 v160, v88, s55, v160
v_dot2_f32_bf16 v161, v88, s56, v161
v_dot2_f32_bf16 v162, v89, s55, v162
v_dot2_f32_bf16 v163, v89, s56, v163
v_dot2_f32_bf16 v164, v90, s55, v164
v_dot2_f32_bf16 v165, v90, s56, v165
v_dot2_f32_bf16 v166, v91, s55, v166
v_dot2_f32_bf16 v167, v91, s56, v167
v_dot2_f32_bf16 v168, v92, s55, v168
v_dot2_f32_bf16 v169, v92, s56, v169
v_dot2_f32_bf16 v170, v93, s55, v170
v_dot2_f32_bf16 v171, v93, s56, v171
v_dot2_f32_bf16 v172, v94, s55, v172
v_dot2_f32_bf16 v173, v94, s56, v173
v_dot2_f32_bf16 v174, v95, s55, v174
v_dot2_f32_bf16 v175, v95, s56, v175
v_dot2_f32_bf16 v176, v96, s55, v176
v_dot2_f32_bf16 v177, v96, s56, v177
v_dot2_f32_bf16 v178, v97, s55, v178
v_dot2_f32_bf16 v179, v97, s56, v179
v_dot2_f32_bf16 v180, v98, s55, v180
v_dot2_f32_bf16 v181, v98, s56, v181
v_dot2_f32_bf16 v182, v99, s55, v182
v_dot2_f32_bf16 v183, v99, s56, v183
v_dot2_f32_bf16 v184, v100, s55, v184
v_dot2_f32_bf16 v185, v100, s56, v185
v_dot2_f32_bf16 v186, v101, s55, v186
v_dot2_f32_bf16 v187, v101, s56, v187
v_dot2_f32_bf16 v188, v102, s55, v188
v_dot2_f32_bf16 v189, v102, s56, v189
v_dot2_f32_bf16 v190, v103, s55, v190
v_dot2_f32_bf16 v191, v103, s56, v191
v_dot2_f32_bf16 v192, v104, s55, v192
v_dot2_f32_bf16 v193, v104, s56, v193
v_dot2_f32_bf16 v194, v105, s55, v194
v_dot2_f32_bf16 v195, v105, s56, v195
v_dot2_f32_bf16 v196, v106, s55, v196
v_dot2_f32_bf16 v197, v106, s56, v197
v_dot2_f32_bf16 v198, v107, s55, v198
v_dot2_f32_bf16 v199, v107, s56, v199
v_dot2_f32_bf16 v200, v108, s55, v200
v_dot2_f32_bf16 v201, v108, s56, v201
v_dot2_f32_bf16 v202, v109, s55, v202
v_dot2_f32_bf16 v203, v109, s56, v203
v_dot2_f32_bf16 v204, v110, s55, v204
v_dot2_f32_bf16 v205, v110, s56, v205
v_dot2_f32_bf16 v206, v111, s55, v206
v_dot2_f32_bf16 v207, v111, s56, v207
s_waitcnt vmcnt(63)
v_dot2_f32_bf16 v160, v208, s55, v160
v_dot2_f32_bf16 v161, v208, s56, v161
v_dot2_f32_bf16 v162, v209, s55, v162
v_dot2_f32_bf16 v163, v209, s56, v163
v_dot2_f32_bf16 v164, v210, s55, v164
v_dot2_f32_bf16 v165, v210, s56, v165
v_dot2_f32_bf16 v166, v211, s55, v166
v_dot2_f32_bf16 v167, v211, s56, v167
v_dot2_f32_bf16 v168, v212, s55, v168
v_dot2_f32_bf16 v169, v212, s56, v169
v_dot2_f32_bf16 v170, v213, s55, v170
v_dot2_f32_bf16 v171, v213, s56, v171
v_dot2_f32_bf16 v172, v214, s55, v172
v_dot2_f32_bf16 v173, v214, s56, v173
v_dot2_f32_bf16 v174, v215, s55, v174
v_dot2_f32_bf16 v175, v215, s56, v175
v_dot2_f32_bf16 v176, v216, s55, v176
v_dot2_f32_bf16 v177, v216, s56, v177
v_dot2_f32_bf16 v178, v217, s55, v178
v_dot2_f32_bf16 v179, v217, s56, v179
v_dot2_f32_bf16 v180, v218, s55, v180
v_dot2_f32_bf16 v181, v218, s56, v181
v_dot2_f32_bf16 v182, v219, s55, v182
v_dot2_f32_bf16 v183, v219, s56, v183
v_dot2_f32_bf16 v184, v220, s55, v184
v_dot2_f32_bf16 v185, v220, s56, v185
v_dot2_f32_bf16 v186, v221, s55, v186
v_dot2_f32_bf16 v187, v221, s56, v187
v_dot2_f32_bf16 v188, v222, s55, v188
v_dot2_f32_bf16 v189, v222, s56, v189
v_dot2_f32_bf16 v190, v223, s55, v190
v_dot2_f32_bf16 v191, v223, s56, v191
v_dot2_f32_bf16 v192, v224, s55, v192
v_dot2_f32_bf16 v193, v224, s56, v193
v_dot2_f32_bf16 v194, v225, s55, v194
v_dot2_f32_bf16 v195, v225, s56, v195
v_dot2_f32_bf16 v196, v226, s55, v196
v_dot2_f32_bf16 v197, v226, s56, v197
v_dot2_f32_bf16 v198, v227, s55, v198
v_dot2_f32_bf16 v199, v227, s56, v199
v_dot2_f32_bf16 v200, v228, s55, v200
v_dot2_f32_bf16 v201, v228, s56, v201
v_dot2_f32_bf16 v202, v229, s55, v202
v_dot2_f32_bf16 v203, v229, s56, v203
v_dot2_f32_bf16 v204, v230, s55, v204
v_dot2_f32_bf16 v205, v230, s56, v205
v_dot2_f32_bf16 v206, v231, s55, v206
v_dot2_f32_bf16 v207, v231, s56, v207
s_waitcnt vmcnt(6)
v_dot2_f32_bf16 v160, v112, s55, v160
v_dot2_f32_bf16 v161, v112, s56, v161
v_dot2_f32_bf16 v162, v113, s55, v162
v_dot2_f32_bf16 v163, v113, s56, v163
v_dot2_f32_bf16 v164, v114, s55, v164
v_dot2_f32_bf16 v165, v114, s56, v165
L_pg29:
s_cbranch_execz L_tret3
v_dot2_f32_bf16 v166, v115, s55, v166
v_dot2_f32_bf16 v167, v115, s56, v167
v_dot2_f32_bf16 v168, v116, s55, v168
v_dot2_f32_bf16 v169, v116, s56, v169
v_dot2_f32_bf16 v170, v117, s55, v170
v_dot2_f32_bf16 v171, v117, s56, v171
v_dot2_f32_bf16 v172, v118, s55, v172
v_dot2_f32_bf16 v173, v118, s56, v173
v_dot2_f32_bf16 v174, v119, s55, v174
v_dot2_f32_bf16 v175, v119, s56, v175
v_dot2_f32_bf16 v176, v120, s55, v176
v_dot2_f32_bf16 v177, v120, s56, v177
v_dot2_f32_bf16 v178, v121, s55, v178
v_dot2_f32_bf16 v179, v121, s56, v179
v_dot2_f32_bf16 v180, v122, s55, v180
v_dot2_f32_bf16 v181, v122, s56, v181
v_dot2_f32_bf16 v182, v123, s55, v182
v_dot2_f32_bf16 v183, v123, s56, v183
v_dot2_f32_bf16 v184, v124, s55, v184
v_dot2_f32_bf16 v185, v124, s56, v185
v_dot2_f32_bf16 v186, v125, s55, v186
v_dot2_f32_bf16 v187, v125, s56, v187
v_dot2_f32_bf16 v188, v126, s55, v188
v_dot2_f32_bf16 v189, v126, s56, v189
v_dot2_f32_bf16 v190, v127, s55, v190
v_dot2_f32_bf16 v191, v127, s56, v191
v_dot2_f32_bf16 v192, v128, s55, v192
v_dot2_f32_bf16 v193, v128, s56, v193
v_dot2_f32_bf16 v194, v129, s55, v194
v_dot2_f32_bf16 v195, v129, s56, v195
v_dot2_f32_bf16 v196, v130, s55, v196
v_dot2_f32_bf16 v197, v130, s56, v197
v_dot2_f32_bf16 v198, v131, s55, v198
v_dot2_f32_bf16 v199, v131, s56, v199
v_dot2_f32_bf16 v200, v132, s55, v200
v_dot2_f32_bf16 v201, v132, s56, v201
v_dot2_f32_bf16 v202, v133, s55, v202
v_dot2_f32_bf16 v203, v133, s56, v203
v_dot2_f32_bf16 v204, v134, s55, v204
v_dot2_f32_bf16 v205, v134, s56, v205
v_dot2_f32_bf16 v206, v135, s55, v206
v_dot2_f32_bf16 v207, v135, s56, v207
s_waitcnt vmcnt(0)
v_dot2_f32_bf16 v160, v136, s55, v160
v_dot2_f32_bf16 v161, v136, s56, v161
v_dot2_f32_bf16 v162, v137, s55, v162
v_dot2_f32_bf16 v163, v137, s56, v163
v_dot2_f32_bf16 v164, v138, s55, v164
v_dot2_f32_bf16 v165, v138, s56, v165
v_dot2_f32_bf16 v166, v139, s55, v166
v_dot2_f32_bf16 v167, v139, s56, v167
v_dot2_f32_bf16 v168, v140, s55, v168
v_dot2_f32_bf16 v169, v140, s56, v169
v_dot2_f32_bf16 v170, v141, s55, v170
v_dot2_f32_bf16 v171, v141, s56, v171
v_dot2_f32_bf16 v172, v142, s55, v172
v_dot2_f32_bf16 v173, v142, s56, v173
v_dot2_f32_bf16 v174, v143, s55, v174
v_dot2_f32_bf16 v175, v143, s56, v175
v_dot2_f32_bf16 v176, v144, s55, v176
v_dot2_f32_bf16 v177, v144, s56, v177
v_dot2_f32_bf16 v178, v145, s55, v178
v_dot2_f32_bf16 v179, v145, s56, v179
v_dot2_f32_bf16 v180, v146, s55, v180
v_dot2_f32_bf16 v181, v146, s56, v181
v_dot2_f32_bf16 v182, v147, s55, v182
v_dot2_f32_bf16 v183, v147, s56, v183
v_dot2_f32_bf16 v184, v148, s55, v184
v_dot2_f32_bf16 v185, v148, s56, v185
v_dot2_f32_bf16 v186, v149, s55, v186
v_dot2_f32_bf16 v187, v149, s56, v187
v_dot2_f32_bf16 v188, v150, s55, v188
v_dot2_f32_bf16 v189, v150, s56, v189
v_dot2_f32_bf16 v190, v151, s55, v190
v_dot2_f32_bf16 v191, v151, s56, v191
v_dot2_f32_bf16 v192, v152, s55, v192
v_dot2_f32_bf16 v193, v152, s56, v193
v_dot2_f32_bf16 v194, v153, s55, v194
v_dot2_f32_bf16 v195, v153, s56, v195
v_dot2_f32_bf16 v196, v154, s55, v196
v_dot2_f32_bf16 v197, v154, s56, v197
v_dot2_f32_bf16 v198, v155, s55, v198
v_dot2_f32_bf16 v199, v155, s56, v199
v_dot2_f32_bf16 v200, v156, s55, v200
v_dot2_f32_bf16 v201, v156, s56, v201
v_dot2_f32_bf16 v202, v157, s55, v202
v_dot2_f32_bf16 v203, v157, s56, v203
v_dot2_f32_bf16 v204, v158, s55, v204
v_dot2_f32_bf16 v205, v158, s56, v205
v_dot2_f32_bf16 v206, v159, s55, v206
v_dot2_f32_bf16 v207, v159, s56, v207
s_nop 2
cv v16,v160,v161
cv v17,v162,v163
cv v18,v172,v173
cv v19,v174,v175
cv v20,v184,v185
cv v21,v186,v187
cv v22,v196,v197
cv v23,v198,v199
ds_write_b64 v248, v[16:17] offset:0
ds_write_b64 v248, v[18:19] offset:16
ds_write_b64 v248, v[20:21] offset:64
ds_write_b64 v248, v[22:23] offset:80
cv v24,v164,v165
cv v25,v166,v167
cv v26,v176,v177
cv v27,v178,v179
cv v28,v188,v189
cv v29,v190,v191
cv v30,v200,v201
cv v31,v202,v203
ds_write_b64 v248, v[24:25] offset:2304
ds_write_b64 v248, v[26:27] offset:2320
ds_write_b64 v248, v[28:29] offset:2368
ds_write_b64 v248, v[30:31] offset:2384
cv v32,v168,v169
cv v33,v170,v171
cv v34,v180,v181
cv v35,v182,v183
cv v36,v192,v193
cv v37,v194,v195
cv v38,v204,v205
cv v39,v206,v207
ds_write_b64 v248, v[32:33] offset:4608
ds_write_b64 v248, v[34:35] offset:4624
ds_write_b64 v248, v[36:37] offset:4672
ds_write_b64 v248, v[38:39] offset:4688
s_waitcnt lgkmcnt(0)
lq v[40:43],v249,0
lq v[44:47],v249,1152
lq v[48:51],v249,2304
lq v[52:55],v249,3456
lq v[56:59],v249,4608
lq v[60:63],v249,5760
s_waitcnt lgkmcnt(5)
buffer_store_dwordx4 v[40:43], v246, s[36:39], s67 offen offset:0 sc1
s_add_u32 s55, s67, 8192
s_waitcnt lgkmcnt(4)
buffer_store_dwordx4 v[44:47], v246, s[36:39], s55 offen offset:0 sc1
s_add_u32 s54, s67, 16384
s_waitcnt lgkmcnt(3)
buffer_store_dwordx4 v[48:51], v246, s[36:39], s54 offen offset:0 sc1
s_add_u32 s55, s67, 24576
s_waitcnt lgkmcnt(2)
buffer_store_dwordx4 v[52:55], v246, s[36:39], s55 offen offset:0 sc1
s_add_u32 s54, s67, 32768
s_waitcnt lgkmcnt(1)
buffer_store_dwordx4 v[56:59], v246, s[36:39], s54 offen offset:0 sc1
s_add_u32 s55, s67, 40960
s_waitcnt lgkmcnt(0)
buffer_store_dwordx4 v[60:63], v246, s[36:39], s55 offen offset:0 sc1
L_end:
s_endpgm
L_spin6:
s_mov_b32 s54, 0
L_spin6_l:
buffer_load_dword v253, v255, s[28:31], s91 offen sc1
s_add_u32 s54, s54, 1
s_waitcnt vmcnt(0)
v_cmp_ne_u32 vcc, 1, v253
s_cmp_gt_u32 s54, 200000
s_cbranch_scc1 L_spun6
s_nop 2
s_cbranch_vccnz L_spin6_l
s_branch L_spun6
L_late:
s_waitcnt vmcnt(0)
s_bitcmp1_b32 s6, 0
s_cbranch_scc0 L_late_l0
s_add_u32 s54, s76, 4096
buffer_load_dwordx4 v[16:19], v244, s[24:27], s76 offen offset:0 sc1
buffer_load_dwordx4 v[20:23], v244, s[24:27], s76 offen offset:1024 sc1
buffer_load_dwordx4 v[24:27], v244, s[24:27], s76 offen offset:2048 sc1
buffer_load_dwordx4 v[28:31], v244, s[24:27], s76 offen offset:3072 sc1
buffer_load_dwordx4 v[32:35], v244, s[24:27], s54 offen offset:0 sc1
buffer_load_dwordx4 v[36:39], v244, s[24:27], s54 offen offset:1024 sc1
L_late_l0:
s_bitcmp1_b32 s6, 1
s_cbranch_scc0 L_late_l1
s_add_u32 s54, s77, 4096
buffer_load_dwordx4 v[40:43], v244, s[24:27], s77 offen offset:0 sc1
buffer_load_dwordx4 v[44:47], v244, s[24:27], s77 offen offset:1024 sc1
buffer_load_dwordx4 v[48:51], v244, s[24:27], s77 offen offset:2048 sc1
buffer_load_dwordx4 v[52:55], v244, s[24:27], s77 offen offset:3072 sc1
buffer_load_dwordx4 v[56:59], v244, s[24:27], s54 offen offset:0 sc1
buffer_load_dwordx4 v[60:63], v244, s[24:27], s54 offen offset:1024 sc1
L_late_l1:
s_bitcmp1_b32 s6, 2
s_cbranch_scc0 L_late_l2
s_add_u32 s54, s78, 4096
buffer_load_dwordx4 v[64:67], v244, s[24:27], s78 offen offset:0 sc1
buffer_load_dwordx4 v[68:71], v244, s[24:27], s78 offen offset:1024 sc1
buffer_load_dwordx4 v[72:75], v244, s[24:27], s78 offen offset:2048 sc1
buffer_load_dwordx4 v[76:79], v244, s[24:27], s78 offen offset:3072 sc1
buffer_load_dwordx4 v[80:83], v244, s[24:27], s54 offen offset:0 sc1
buffer_load_dwordx4 v[84:87], v244, s[24:27], s54 offen offset:1024 sc1
L_late_l2:
s_bitcmp1_b32 s6, 3
s_cbranch_scc0 L_late_l3
s_add_u32 s54, s79, 4096
buffer_load_dwordx4 v[88:91], v244, s[24:27], s79 offen offset:0 sc1
buffer_load_dwordx4 v[92:95], v244, s[24:27], s79 offen offset:1024 sc1
buffer_load_dwordx4 v[96:99], v244, s[24:27], s79 offen offset:2048 sc1
buffer_load_dwordx4 v[100:103], v244, s[24:27], s79 offen offset:3072 sc1
buffer_load_dwordx4 v[104:107], v244, s[24:27], s54 offen offset:0 sc1
buffer_load_dwordx4 v[108:111], v244, s[24:27], s54 offen offset:1024 sc1
L_late_l3:
s_bitcmp1_b32 s6, 4
s_cbranch_scc0 L_late_l4
s_add_u32 s54, s80, 4096
buffer_load_dwordx4 v[208:211], v244, s[24:27], s80 offen offset:0 sc1
buffer_load_dwordx4 v[212:215], v244, s[24:27], s80 offen offset:1024 sc1
buffer_load_dwordx4 v[216:219], v244, s[24:27], s80 offen offset:2048 sc1
buffer_load_dwordx4 v[220:223], v244, s[24:27], s80 offen offset:3072 sc1
buffer_load_dwordx4 v[224:227], v244, s[24:27], s54 offen offset:0 sc1
buffer_load_dwordx4 v[228:231], v244, s[24:27], s54 offen offset:1024 sc1
L_late_l4:
s_bitcmp1_b32 s6, 5
s_cbranch_scc0 L_late_l5
s_add_u32 s54, s81, 4096
buffer_load_dwordx4 v[112:115], v244, s[24:27], s81 offen offset:0 sc1
buffer_load_dwordx4 v[116:119], v244, s[24:27], s81 offen offset:1024 sc1
buffer_load_dwordx4 v[120:123], v244, s[24:27], s81 offen offset:2048 sc1
buffer_load_dwordx4 v[124:127], v244, s[24:27], s81 offen offset:3072 sc1
buffer_load_dwordx4 v[128:131], v244, s[24:27], s54 offen offset:0 sc1
buffer_load_dwordx4 v[132:135], v244, s[24:27], s54 offen offset:1024 sc1
L_late_l5:
s_waitcnt vmcnt(0)
s_bitcmp1_b32 s6, 0
s_cbranch_scc0 L_late_d0
v_dot2_f32_bf16 v160, v16, s55, v160
v_dot2_f32_bf16 v161, v16, s56, v161
v_dot2_f32_bf16 v162, v17, s55, v162
v_dot2_f32_bf16 v163, v17, s56, v163
v_dot2_f32_bf16 v164, v18, s55, v164
v_dot2_f32_bf16 v165, v18, s56, v165
v_dot2_f32_bf16 v166, v19, s55, v166
v_dot2_f32_bf16 v167, v19, s56, v167
v_dot2_f32_bf16 v168, v20, s55, v168
v_dot2_f32_bf16 v169, v20, s56, v169
v_dot2_f32_bf16 v170, v21, s55, v170
v_dot2_f32_bf16 v171, v21, s56, v171
v_dot2_f32_bf16 v172, v22, s55, v172
v_dot2_f32_bf16 v173, v22, s56, v173
v_dot2_f32_bf16 v174, v23, s55, v174
v_dot2_f32_bf16 v175, v23, s56, v175
v_dot2_f32_bf16 v176, v24, s55, v176
v_dot2_f32_bf16 v177, v24, s56, v177
v_dot2_f32_bf16 v178, v25, s55, v178
v_dot2_f32_bf16 v179, v25, s56, v179
v_dot2_f32_bf16 v180, v26, s55, v180
v_dot2_f32_bf16 v181, v26, s56, v181
v_dot2_f32_bf16 v182, v27, s55, v182
v_dot2_f32_bf16 v183, v27, s56, v183
v_dot2_f32_bf16 v184, v28, s55, v184
v_dot2_f32_bf16 v185, v28, s56, v185
v_dot2_f32_bf16 v186, v29, s55, v186
v_dot2_f32_bf16 v187, v29, s56, v187
v_dot2_f32_bf16 v188, v30, s55, v188
v_dot2_f32_bf16 v189, v30, s56, v189
v_dot2_f32_bf16 v190, v31, s55, v190
v_dot2_f32_bf16 v191, v31, s56, v191
v_dot2_f32_bf16 v192, v32, s55, v192
v_dot2_f32_bf16 v193, v32, s56, v193
v_dot2_f32_bf16 v194, v33, s55, v194
v_dot2_f32_bf16 v195, v33, s56, v195
v_dot2_f32_bf16 v196, v34, s55, v196
v_dot2_f32_bf16 v197, v34, s56, v197
v_dot2_f32_bf16 v198, v35, s55, v198
v_dot2_f32_bf16 v199, v35, s56, v199
v_dot2_f32_bf16 v200, v36, s55, v200
v_dot2_f32_bf16 v201, v36, s56, v201
v_dot2_f32_bf16 v202, v37, s55, v202
v_dot2_f32_bf16 v203, v37, s56, v203
v_dot2_f32_bf16 v204, v38, s55, v204
v_dot2_f32_bf16 v205, v38, s56, v205
v_dot2_f32_bf16 v206, v39, s55, v206
v_dot2_f32_bf16 v207, v39, s56, v207
L_late_d0:
s_bitcmp1_b32 s6, 1
s_cbranch_scc0 L_late_d1
v_dot2_f32_bf16 v160, v40, s55, v160
v_dot2_f32_bf16 v161, v40, s56, v161
v_dot2_f32_bf16 v162, v41, s55, v162
v_dot2_f32_bf16 v163, v41, s56, v163
v_dot2_f32_bf16 v164, v42, s55, v164
v_dot2_f32_bf16 v165, v42, s56, v165
v_dot2_f32_bf16 v166, v43, s55, v166
v_dot2_f32_bf16 v167, v43, s56, v167
v_dot2_f32_bf16 v168, v44, s55, v168
v_dot2_f32_bf16 v169, v44, s56, v169
v_dot2_f32_bf16 v170, v45, s55, v170
v_dot2_f32_bf16 v171, v45, s56, v171
v_dot2_f32_bf16 v172, v46, s55, v172
v_dot2_f32_bf16 v173, v46, s56, v173
v_dot2_f32_bf16 v174, v47, s55, v174
v_dot2_f32_bf16 v175, v47, s56, v175
v_dot2_f32_bf16 v176, v48, s55, v176
v_dot2_f32_bf16 v177, v48, s56, v177
v_dot2_f32_bf16 v178, v49, s55, v178
v_dot2_f32_bf16 v179, v49, s56, v179
v_dot2_f32_bf16 v180, v50, s55, v180
v_dot2_f32_bf16 v181, v50, s56, v181
v_dot2_f32_bf16 v182, v51, s55, v182
v_dot2_f32_bf16 v183, v51, s56, v183
v_dot2_f32_bf16 v184, v52, s55, v184
v_dot2_f32_bf16 v185, v52, s56, v185
v_dot2_f32_bf16 v186, v53, s55, v186
v_dot2_f32_bf16 v187, v53, s56, v187
v_dot2_f32_bf16 v188, v54, s55, v188
v_dot2_f32_bf16 v189, v54, s56, v189
v_dot2_f32_bf16 v190, v55, s55, v190
v_dot2_f32_bf16 v191, v55, s56, v191
v_dot2_f32_bf16 v192, v56, s55, v192
v_dot2_f32_bf16 v193, v56, s56, v193
v_dot2_f32_bf16 v194, v57, s55, v194
v_dot2_f32_bf16 v195, v57, s56, v195
v_dot2_f32_bf16 v196, v58, s55, v196
v_dot2_f32_bf16 v197, v58, s56, v197
v_dot2_f32_bf16 v198, v59, s55, v198
v_dot2_f32_bf16 v199, v59, s56, v199
v_dot2_f32_bf16 v200, v60, s55, v200
v_dot2_f32_bf16 v201, v60, s56, v201
v_dot2_f32_bf16 v202, v61, s55, v202
v_dot2_f32_bf16 v203, v61, s56, v203
v_dot2_f32_bf16 v204, v62, s55, v204
v_dot2_f32_bf16 v205, v62, s56, v205
v_dot2_f32_bf16 v206, v63, s55, v206
v_dot2_f32_bf16 v207, v63, s56, v207
L_late_d1:
s_bitcmp1_b32 s6, 2
s_cbranch_scc0 L_late_d2
v_dot2_f32_bf16 v160, v64, s55, v160
v_dot2_f32_bf16 v161, v64, s56, v161
v_dot2_f32_bf16 v162, v65, s55, v162
v_dot2_f32_bf16 v163, v65, s56, v163
v_dot2_f32_bf16 v164, v66, s55, v164
v_dot2_f32_bf16 v165, v66, s56, v165
v_dot2_f32_bf16 v166, v67, s55, v166
v_dot2_f32_bf16 v167, v67, s56, v167
v_dot2_f32_bf16 v168, v68, s55, v168
v_dot2_f32_bf16 v169, v68, s56, v169
v_dot2_f32_bf16 v170, v69, s55, v170
v_dot2_f32_bf16 v171, v69, s56, v171
v_dot2_f32_bf16 v172, v70, s55, v172
v_dot2_f32_bf16 v173, v70, s56, v173
v_dot2_f32_bf16 v174, v71, s55, v174
v_dot2_f32_bf16 v175, v71, s56, v175
v_dot2_f32_bf16 v176, v72, s55, v176
v_dot2_f32_bf16 v177, v72, s56, v177
v_dot2_f32_bf16 v178, v73, s55, v178
v_dot2_f32_bf16 v179, v73, s56, v179
v_dot2_f32_bf16 v180, v74, s55, v180
v_dot2_f32_bf16 v181, v74, s56, v181
v_dot2_f32_bf16 v182, v75, s55, v182
v_dot2_f32_bf16 v183, v75, s56, v183
v_dot2_f32_bf16 v184, v76, s55, v184
v_dot2_f32_bf16 v185, v76, s56, v185
v_dot2_f32_bf16 v186, v77, s55, v186
v_dot2_f32_bf16 v187, v77, s56, v187
v_dot2_f32_bf16 v188, v78, s55, v188
v_dot2_f32_bf16 v189, v78, s56, v189
v_dot2_f32_bf16 v190, v79, s55, v190
v_dot2_f32_bf16 v191, v79, s56, v191
v_dot2_f32_bf16 v192, v80, s55, v192
v_dot2_f32_bf16 v193, v80, s56, v193
v_dot2_f32_bf16 v194, v81, s55, v194
v_dot2_f32_bf16 v195, v81, s56, v195
v_dot2_f32_bf16 v196, v82, s55, v196
v_dot2_f32_bf16 v197, v82, s56, v197
v_dot2_f32_bf16 v198, v83, s55, v198
v_dot2_f32_bf16 v199, v83, s56, v199
v_dot2_f32_bf16 v200, v84, s55, v200
v_dot2_f32_bf16 v201, v84, s56, v201
v_dot2_f32_bf16 v202, v85, s55, v202
v_dot2_f32_bf16 v203, v85, s56, v203
v_dot2_f32_bf16 v204, v86, s55, v204
v_dot2_f32_bf16 v205, v86, s56, v205
v_dot2_f32_bf16 v206, v87, s55, v206
v_dot2_f32_bf16 v207, v87, s56, v207
L_late_d2:
s_branch L_late_back
L_slow0:
s_lshl_b32 s95, s2, 2
s_add_u32 s95, s95, s42
s_mul_i32 s95, s95, 16384
s_add_u32 s95, s95, 1048576
v_lshlrev_b32 v244, 4, v0
s_nop 7
buffer_store_dwordx4 v[112:115], v244, s[28:31], s95 offen
v_add_u32 v244, 1024, v244
buffer_store_dwordx4 v[116:119], v244, s[28:31], s95 offen
v_add_u32 v244, 1024, v244
buffer_store_dwordx4 v[120:123], v244, s[28:31], s95 offen
v_add_u32 v244, 1024, v244
buffer_store_dwordx4 v[124:127], v244, s[28:31], s95 offen
v_add_u32 v244, 1024, v244
buffer_store_dwordx4 v[128:131], v244, s[28:31], s95 offen
v_add_u32 v244, 1024, v244
buffer_store_dwordx4 v[132:135], v244, s[28:31], s95 offen
v_add_u32 v244, 1024, v244
buffer_store_dwordx4 v[136:139], v244, s[28:31], s95 offen
v_add_u32 v244, 1024, v244
buffer_store_dwordx4 v[140:143], v244, s[28:31], s95 offen
v_add_u32 v244, 1024, v244
buffer_store_dwordx4 v[144:147], v244, s[28:31], s95 offen
v_add_u32 v244, 1024, v244
buffer_store_dwordx4 v[148:151], v244, s[28:31], s95 offen
v_add_u32 v244, 1024, v244
buffer_store_dwordx4 v[152:155], v244, s[28:31], s95 offen
v_add_u32 v244, 1024, v244
buffer_store_dwordx4 v[156:159], v244, s[28:31], s95 offen
v_add_u32 v244, 1024, v244
buffer_store_dwordx4 v[160:163], v244, s[28:31], s95 offen
v_add_u32 v244, 1024, v244
buffer_store_dwordx4 v[164:167], v244, s[28:31], s95 offen
v_add_u32 v244, 1024, v244
buffer_store_dwordx4 v[168:171], v244, s[28:31], s95 offen
v_add_u32 v244, 1024, v244
buffer_store_dwordx4 v[172:175], v244, s[28:31], s95 offen
v_add_u32 v244, 1024, v244
s_waitcnt vmcnt(0)
v_and_b32 v173, 15, v0
v_lshrrev_b32 v174, 4, v0
v_lshlrev_b32 v171, 8, v173
v_lshl_add_u32 v171, v174, 4, v171
v_lshlrev_b32 v172, 1, v173
v_lshl_add_u32 v172, v174, 10, v172
v_mov_b32 v168, 0xff800000
v_mov_b32 v169, 0xff800000
v_mov_b32 v170, 0xff800000
s_mov_b32 s93, 0
s_mov_b32 s92, 0
L_s1_0:
buffer_load_dwordx4 v[112:115], v171, s[8:11], s93 offen offset:0
buffer_load_dwordx4 v[116:119], v171, s[8:11], s93 offen offset:64
buffer_load_dwordx4 v[120:123], v171, s[8:11], s93 offen offset:128
buffer_load_dwordx4 v[124:127], v171, s[8:11], s93 offen offset:192
s_waitcnt vmcnt(0)
mm v[128:131],v[112:115],a[0:3],0
mm v[128:131],v[116:119],a[12:15],v[128:131]
mm v[128:131],v[120:123],a[24:27],v[128:131]
mm v[128:131],v[124:127],a[36:39],v[128:131]
mm v[132:135],v[112:115],a[4:7],0
mm v[132:135],v[116:119],a[16:19],v[132:135]
mm v[132:135],v[120:123],a[28:31],v[132:135]
mm v[132:135],v[124:127],a[40:43],v[132:135]
mm v[136:139],v[112:115],a[8:11],0
mm v[136:139],v[116:119],a[20:23],v[136:139]
mm v[136:139],v[120:123],a[32:35],v[136:139]
mm v[136:139],v[124:127],a[44:47],v[136:139]
s_nop 9
v_max3_f32 v168, v128, v129, v168
v_max3_f32 v168, v130, v131, v168
v_max3_f32 v169, v132, v133, v169
v_max3_f32 v169, v134, v135, v169
v_max3_f32 v170, v136, v137, v170
v_max3_f32 v170, v138, v139, v170
s_add_u32 s93, s93, 4096
s_add_u32 s92, s92, 1
s_cmp_lt_u32 s92, 32
s_cbranch_scc1 L_s1_0
v_mov_b32 v173, v168
v_mov_b32 v174, v168
s_nop 1
v_permlane16_swap_b32 v173, v174
s_nop 1
v_max_f32 v168, v173, v174
v_mov_b32 v173, v168
v_mov_b32 v174, v168
s_nop 1
v_permlane32_swap_b32 v173, v174
s_nop 1
v_max_f32 v168, v173, v174
v_mov_b32 v173, v169
v_mov_b32 v174, v169
s_nop 1
v_permlane16_swap_b32 v173, v174
s_nop 1
v_max_f32 v169, v173, v174
v_mov_b32 v173, v169
v_mov_b32 v174, v169
s_nop 1
v_permlane32_swap_b32 v173, v174
s_nop 1
v_max_f32 v169, v173, v174
v_mov_b32 v173, v170
v_mov_b32 v174, v170
s_nop 1
v_permlane16_swap_b32 v173, v174
s_nop 1
v_max_f32 v170, v173, v174
v_mov_b32 v173, v170
v_mov_b32 v174, v170
s_nop 1
v_permlane32_swap_b32 v173, v174
s_nop 1
v_max_f32 v170, v173, v174
v_mov_b32 v16, 0
v_mov_b32 v17, 0
v_mov_b32 v18, 0
v_mov_b32 v19, 0
v_mov_b32 v20, 0
v_mov_b32 v21, 0
v_mov_b32 v22, 0
v_mov_b32 v23, 0
v_mov_b32 v24, 0
v_mov_b32 v25, 0
v_mov_b32 v26, 0
v_mov_b32 v27, 0
v_mov_b32 v28, 0
v_mov_b32 v29, 0
v_mov_b32 v30, 0
v_mov_b32 v31, 0
v_mov_b32 v32, 0
v_mov_b32 v33, 0
v_mov_b32 v34, 0
v_mov_b32 v35, 0
v_mov_b32 v36, 0
v_mov_b32 v37, 0
v_mov_b32 v38, 0
v_mov_b32 v39, 0
v_mov_b32 v40, 0
v_mov_b32 v41, 0
v_mov_b32 v42, 0
v_mov_b32 v43, 0
v_mov_b32 v44, 0
v_mov_b32 v45, 0
v_mov_b32 v46, 0
v_mov_b32 v47, 0
v_mov_b32 v48, 0
v_mov_b32 v49, 0
v_mov_b32 v50, 0
v_mov_b32 v51, 0
v_mov_b32 v52, 0
v_mov_b32 v53, 0
v_mov_b32 v54, 0
v_mov_b32 v55, 0
v_mov_b32 v56, 0
v_mov_b32 v57, 0
v_mov_b32 v58, 0
v_mov_b32 v59, 0
v_mov_b32 v60, 0
v_mov_b32 v61, 0
v_mov_b32 v62, 0
v_mov_b32 v63, 0
v_mov_b32 v64, 0
v_mov_b32 v65, 0
v_mov_b32 v66, 0
v_mov_b32 v67, 0
v_mov_b32 v68, 0
v_mov_b32 v69, 0
v_mov_b32 v70, 0
v_mov_b32 v71, 0
v_mov_b32 v72, 0
v_mov_b32 v73, 0
v_mov_b32 v74, 0
v_mov_b32 v75, 0
v_mov_b32 v76, 0
v_mov_b32 v77, 0
v_mov_b32 v78, 0
v_mov_b32 v79, 0
v_mov_b32 v80, 0
v_mov_b32 v81, 0
v_mov_b32 v82, 0
v_mov_b32 v83, 0
v_mov_b32 v84, 0
v_mov_b32 v85, 0
v_mov_b32 v86, 0
v_mov_b32 v87, 0
v_mov_b32 v88, 0
v_mov_b32 v89, 0
v_mov_b32 v90, 0
v_mov_b32 v91, 0
v_mov_b32 v92, 0
v_mov_b32 v93, 0
v_mov_b32 v94, 0
v_mov_b32 v95, 0
v_mov_b32 v96, 0
v_mov_b32 v97, 0
v_mov_b32 v98, 0
v_mov_b32 v99, 0
v_mov_b32 v100, 0
v_mov_b32 v101, 0
v_mov_b32 v102, 0
v_mov_b32 v103, 0
v_mov_b32 v104, 0
v_mov_b32 v105, 0
v_mov_b32 v106, 0
v_mov_b32 v107, 0
v_mov_b32 v108, 0
v_mov_b32 v109, 0
v_mov_b32 v110, 0
v_mov_b32 v111, 0
v_mov_b32 v208, 0
v_mov_b32 v209, 0
v_mov_b32 v210, 0
v_mov_b32 v211, 0
v_mov_b32 v212, 0
v_mov_b32 v213, 0
v_mov_b32 v214, 0
v_mov_b32 v215, 0
v_mov_b32 v216, 0
v_mov_b32 v217, 0
v_mov_b32 v218, 0
v_mov_b32 v219, 0
s_mov_b32 s93, 0
s_mov_b32 s92, 0
L_s2_0:
s_mov_b32 s95, s93
buffer_load_dwordx4 v[112:115], v171, s[8:11], s93 offen offset:0
buffer_load_dwordx4 v[116:119], v171, s[8:11], s93 offen offset:64
buffer_load_dwordx4 v[120:123], v171, s[8:11], s93 offen offset:128
buffer_load_dwordx4 v[124:127], v171, s[8:11], s93 offen offset:192
s_waitcnt vmcnt(0)
mm v[128:131],v[112:115],a[0:3],0
mm v[128:131],v[116:119],a[12:15],v[128:131]
mm v[128:131],v[120:123],a[24:27],v[128:131]
mm v[128:131],v[124:127],a[36:39],v[128:131]
mm v[132:135],v[112:115],a[4:7],0
mm v[132:135],v[116:119],a[16:19],v[132:135]
mm v[132:135],v[120:123],a[28:31],v[132:135]
mm v[132:135],v[124:127],a[40:43],v[132:135]
mm v[136:139],v[112:115],a[8:11],0
mm v[136:139],v[116:119],a[20:23],v[136:139]
mm v[136:139],v[120:123],a[32:35],v[136:139]
mm v[136:139],v[124:127],a[44:47],v[136:139]
s_nop 9
v_sub_f32 v128, v128, v168
v_sub_f32 v129, v129, v168
v_sub_f32 v130, v130, v168
v_sub_f32 v131, v131, v168
v_exp_f32 v128, v128
v_exp_f32 v129, v129
v_exp_f32 v130, v130
v_exp_f32 v131, v131
s_nop 0
cv v140,v128,v129
cv v141,v130,v131
v_sub_f32 v132, v132, v169
v_sub_f32 v133, v133, v169
v_sub_f32 v134, v134, v169
v_sub_f32 v135, v135, v169
v_exp_f32 v132, v132
v_exp_f32 v133, v133
v_exp_f32 v134, v134
v_exp_f32 v135, v135
s_nop 0
cv v144,v132,v133
cv v145,v134,v135
v_sub_f32 v136, v136, v170
v_sub_f32 v137, v137, v170
v_sub_f32 v138, v138, v170
v_sub_f32 v139, v139, v170
v_exp_f32 v136, v136
v_exp_f32 v137, v137
v_exp_f32 v138, v138
v_exp_f32 v139, v139
s_nop 0
cv v148,v136,v137
cv v149,v138,v139
s_add_u32 s93, s93, 4096
buffer_load_dwordx4 v[112:115], v171, s[8:11], s93 offen offset:0
buffer_load_dwordx4 v[116:119], v171, s[8:11], s93 offen offset:64
buffer_load_dwordx4 v[120:123], v171, s[8:11], s93 offen offset:128
buffer_load_dwordx4 v[124:127], v171, s[8:11], s93 offen offset:192
s_waitcnt vmcnt(0)
mm v[128:131],v[112:115],a[0:3],0
mm v[128:131],v[116:119],a[12:15],v[128:131]
mm v[128:131],v[120:123],a[24:27],v[128:131]
mm v[128:131],v[124:127],a[36:39],v[128:131]
mm v[132:135],v[112:115],a[4:7],0
mm v[132:135],v[116:119],a[16:19],v[132:135]
mm v[132:135],v[120:123],a[28:31],v[132:135]
mm v[132:135],v[124:127],a[40:43],v[132:135]
mm v[136:139],v[112:115],a[8:11],0
mm v[136:139],v[116:119],a[20:23],v[136:139]
mm v[136:139],v[120:123],a[32:35],v[136:139]
mm v[136:139],v[124:127],a[44:47],v[136:139]
s_nop 9
v_sub_f32 v128, v128, v168
v_sub_f32 v129, v129, v168
v_sub_f32 v130, v130, v168
v_sub_f32 v131, v131, v168
v_exp_f32 v128, v128
v_exp_f32 v129, v129
v_exp_f32 v130, v130
v_exp_f32 v131, v131
s_nop 0
cv v142,v128,v129
cv v143,v130,v131
v_sub_f32 v132, v132, v169
v_sub_f32 v133, v133, v169
v_sub_f32 v134, v134, v169
v_sub_f32 v135, v135, v169
v_exp_f32 v132, v132
v_exp_f32 v133, v133
v_exp_f32 v134, v134
v_exp_f32 v135, v135
s_nop 0
cv v146,v132,v133
cv v147,v134,v135
v_sub_f32 v136, v136, v170
v_sub_f32 v137, v137, v170
v_sub_f32 v138, v138, v170
v_sub_f32 v139, v139, v170
v_exp_f32 v136, v136
v_exp_f32 v137, v137
v_exp_f32 v138, v138
v_exp_f32 v139, v139
s_nop 0
cv v150,v136,v137
cv v151,v138,v139
s_add_u32 s93, s93, 4096
s_add_u32 s94, s95, 4096
s_nop 1
mm v[208:211],v[220:223],v[140:143],v[208:211]
mm v[212:215],v[220:223],v[144:147],v[212:215]
mm v[216:219],v[220:223],v[148:151],v[216:219]
buffer_load_ushort v152, v172, s[12:15], s95 offen offset:0
buffer_load_ushort v153, v172, s[12:15], s95 offen offset:256
buffer_load_ushort v154, v172, s[12:15], s95 offen offset:512
buffer_load_ushort v155, v172, s[12:15], s95 offen offset:768
buffer_load_ushort v156, v172, s[12:15], s94 offen offset:0
buffer_load_ushort v157, v172, s[12:15], s94 offen offset:256
buffer_load_ushort v158, v172, s[12:15], s94 offen offset:512
buffer_load_ushort v159, v172, s[12:15], s94 offen offset:768
buffer_load_ushort v160, v172, s[12:15], s95 offen offset:32
buffer_load_ushort v161, v172, s[12:15], s95 offen offset:288
buffer_load_ushort v162, v172, s[12:15], s95 offen offset:544
buffer_load_ushort v163, v172, s[12:15], s95 offen offset:800
buffer_load_ushort v164, v172, s[12:15], s94 offen offset:32
buffer_load_ushort v165, v172, s[12:15], s94 offen offset:288
buffer_load_ushort v166, v172, s[12:15], s94 offen offset:544
buffer_load_ushort v167, v172, s[12:15], s94 offen offset:800
s_waitcnt vmcnt(0)
v_lshl_or_b32 v152, v153, 16, v152
v_lshl_or_b32 v153, v155, 16, v154
v_lshl_or_b32 v154, v157, 16, v156
v_lshl_or_b32 v155, v159, 16, v158
v_lshl_or_b32 v160, v161, 16, v160
v_lshl_or_b32 v161, v163, 16, v162
v_lshl_or_b32 v162, v165, 16, v164
v_lshl_or_b32 v163, v167, 16, v166
s_nop 1
mm v[16:19],v[152:155],v[140:143],v[16:19]
mm v[20:23],v[152:155],v[144:147],v[20:23]
mm v[24:27],v[152:155],v[148:151],v[24:27]
mm v[28:31],v[160:163],v[140:143],v[28:31]
mm v[32:35],v[160:163],v[144:147],v[32:35]
mm v[36:39],v[160:163],v[148:151],v[36:39]
s_nop 7
buffer_load_ushort v152, v172, s[12:15], s95 offen offset:64
buffer_load_ushort v153, v172, s[12:15], s95 offen offset:320
buffer_load_ushort v154, v172, s[12:15], s95 offen offset:576
buffer_load_ushort v155, v172, s[12:15], s95 offen offset:832
buffer_load_ushort v156, v172, s[12:15], s94 offen offset:64
buffer_load_ushort v157, v172, s[12:15], s94 offen offset:320
buffer_load_ushort v158, v172, s[12:15], s94 offen offset:576
buffer_load_ushort v159, v172, s[12:15], s94 offen offset:832
buffer_load_ushort v160, v172, s[12:15], s95 offen offset:96
buffer_load_ushort v161, v172, s[12:15], s95 offen offset:352
buffer_load_ushort v162, v172, s[12:15], s95 offen offset:608
buffer_load_ushort v163, v172, s[12:15], s95 offen offset:864
buffer_load_ushort v164, v172, s[12:15], s94 offen offset:96
buffer_load_ushort v165, v172, s[12:15], s94 offen offset:352
buffer_load_ushort v166, v172, s[12:15], s94 offen offset:608
buffer_load_ushort v167, v172, s[12:15], s94 offen offset:864
s_waitcnt vmcnt(0)
v_lshl_or_b32 v152, v153, 16, v152
v_lshl_or_b32 v153, v155, 16, v154
v_lshl_or_b32 v154, v157, 16, v156
v_lshl_or_b32 v155, v159, 16, v158
v_lshl_or_b32 v160, v161, 16, v160
v_lshl_or_b32 v161, v163, 16, v162
v_lshl_or_b32 v162, v165, 16, v164
v_lshl_or_b32 v163, v167, 16, v166
s_nop 1
mm v[40:43],v[152:155],v[140:143],v[40:43]
mm v[44:47],v[152:155],v[144:147],v[44:47]
mm v[48:51],v[152:155],v[148:151],v[48:51]
mm v[52:55],v[160:163],v[140:143],v[52:55]
mm v[56:59],v[160:163],v[144:147],v[56:59]
mm v[60:63],v[160:163],v[148:151],v[60:63]
s_nop 7
buffer_load_ushort v152, v172, s[12:15], s95 offen offset:128
buffer_load_ushort v153, v172, s[12:15], s95 offen offset:384
buffer_load_ushort v154, v172, s[12:15], s95 offen offset:640
buffer_load_ushort v155, v172, s[12:15], s95 offen offset:896
buffer_load_ushort v156, v172, s[12:15], s94 offen offset:128
buffer_load_ushort v157, v172, s[12:15], s94 offen offset:384
buffer_load_ushort v158, v172, s[12:15], s94 offen offset:640
buffer_load_ushort v159, v172, s[12:15], s94 offen offset:896
buffer_load_ushort v160, v172, s[12:15], s95 offen offset:160
buffer_load_ushort v161, v172, s[12:15], s95 offen offset:416
buffer_load_ushort v162, v172, s[12:15], s95 offen offset:672
buffer_load_ushort v163, v172, s[12:15], s95 offen offset:928
buffer_load_ushort v164, v172, s[12:15], s94 offen offset:160
buffer_load_ushort v165, v172, s[12:15], s94 offen offset:416
buffer_load_ushort v166, v172, s[12:15], s94 offen offset:672
buffer_load_ushort v167, v172, s[12:15], s94 offen offset:928
s_waitcnt vmcnt(0)
v_lshl_or_b32 v152, v153, 16, v152
v_lshl_or_b32 v153, v155, 16, v154
v_lshl_or_b32 v154, v157, 16, v156
v_lshl_or_b32 v155, v159, 16, v158
v_lshl_or_b32 v160, v161, 16, v160
v_lshl_or_b32 v161, v163, 16, v162
v_lshl_or_b32 v162, v165, 16, v164
v_lshl_or_b32 v163, v167, 16, v166
s_nop 1
mm v[64:67],v[152:155],v[140:143],v[64:67]
mm v[68:71],v[152:155],v[144:147],v[68:71]
mm v[72:75],v[152:155],v[148:151],v[72:75]
mm v[76:79],v[160:163],v[140:143],v[76:79]
mm v[80:83],v[160:163],v[144:147],v[80:83]
mm v[84:87],v[160:163],v[148:151],v[84:87]
s_nop 7
buffer_load_ushort v152, v172, s[12:15], s95 offen offset:192
buffer_load_ushort v153, v172, s[12:15], s95 offen offset:448
buffer_load_ushort v154, v172, s[12:15], s95 offen offset:704
buffer_load_ushort v155, v172, s[12:15], s95 offen offset:960
buffer_load_ushort v156, v172, s[12:15], s94 offen offset:192
buffer_load_ushort v157, v172, s[12:15], s94 offen offset:448
buffer_load_ushort v158, v172, s[12:15], s94 offen offset:704
buffer_load_ushort v159, v172, s[12:15], s94 offen offset:960
buffer_load_ushort v160, v172, s[12:15], s95 offen offset:224
buffer_load_ushort v161, v172, s[12:15], s95 offen offset:480
buffer_load_ushort v162, v172, s[12:15], s95 offen offset:736
buffer_load_ushort v163, v172, s[12:15], s95 offen offset:992
buffer_load_ushort v164, v172, s[12:15], s94 offen offset:224
buffer_load_ushort v165, v172, s[12:15], s94 offen offset:480
buffer_load_ushort v166, v172, s[12:15], s94 offen offset:736
buffer_load_ushort v167, v172, s[12:15], s94 offen offset:992
s_waitcnt vmcnt(0)
v_lshl_or_b32 v152, v153, 16, v152
v_lshl_or_b32 v153, v155, 16, v154
v_lshl_or_b32 v154, v157, 16, v156
v_lshl_or_b32 v155, v159, 16, v158
v_lshl_or_b32 v160, v161, 16, v160
v_lshl_or_b32 v161, v163, 16, v162
v_lshl_or_b32 v162, v165, 16, v164
v_lshl_or_b32 v163, v167, 16, v166
s_nop 1
mm v[88:91],v[152:155],v[140:143],v[88:91]
mm v[92:95],v[152:155],v[144:147],v[92:95]
mm v[96:99],v[152:155],v[148:151],v[96:99]
mm v[100:103],v[160:163],v[140:143],v[100:103]
mm v[104:107],v[160:163],v[144:147],v[104:107]
mm v[108:111],v[160:163],v[148:151],v[108:111]
s_nop 7
s_add_u32 s92, s92, 1
s_cmp_lt_u32 s92, 16
s_cbranch_scc1 L_s2_0
s_nop 9
s_lshl_b32 s95, s2, 2
s_add_u32 s95, s95, s42
s_mul_i32 s95, s95, 16384
s_add_u32 s95, s95, 1048576
v_lshlrev_b32 v244, 4, v0
buffer_load_dwordx4 v[112:115], v244, s[28:31], s95 offen sc1
v_add_u32 v244, 1024, v244
buffer_load_dwordx4 v[116:119], v244, s[28:31], s95 offen sc1
v_add_u32 v244, 1024, v244
buffer_load_dwordx4 v[120:123], v244, s[28:31], s95 offen sc1
v_add_u32 v244, 1024, v244
buffer_load_dwordx4 v[124:127], v244, s[28:31], s95 offen sc1
v_add_u32 v244, 1024, v244
buffer_load_dwordx4 v[128:131], v244, s[28:31], s95 offen sc1
v_add_u32 v244, 1024, v244
buffer_load_dwordx4 v[132:135], v244, s[28:31], s95 offen sc1
v_add_u32 v244, 1024, v244
buffer_load_dwordx4 v[136:139], v244, s[28:31], s95 offen sc1
v_add_u32 v244, 1024, v244
buffer_load_dwordx4 v[140:143], v244, s[28:31], s95 offen sc1
v_add_u32 v244, 1024, v244
buffer_load_dwordx4 v[144:147], v244, s[28:31], s95 offen sc1
v_add_u32 v244, 1024, v244
buffer_load_dwordx4 v[148:151], v244, s[28:31], s95 offen sc1
v_add_u32 v244, 1024, v244
buffer_load_dwordx4 v[152:155], v244, s[28:31], s95 offen sc1
v_add_u32 v244, 1024, v244
buffer_load_dwordx4 v[156:159], v244, s[28:31], s95 offen sc1
v_add_u32 v244, 1024, v244
buffer_load_dwordx4 v[160:163], v244, s[28:31], s95 offen sc1
v_add_u32 v244, 1024, v244
buffer_load_dwordx4 v[164:167], v244, s[28:31], s95 offen sc1
v_add_u32 v244, 1024, v244
buffer_load_dwordx4 v[168:171], v244, s[28:31], s95 offen sc1
v_add_u32 v244, 1024, v244
buffer_load_dwordx4 v[172:175], v244, s[28:31], s95 offen sc1
v_add_u32 v244, 1024, v244
v_rcp_f32 v240, v208
v_rcp_f32 v241, v212
v_rcp_f32 v242, v216
s_waitcnt vmcnt(0)
s_branch L_back0
L_slow1:
s_lshl_b32 s95, s2, 2
s_add_u32 s95, s95, s42
s_mul_i32 s95, s95, 16384
s_add_u32 s95, s95, 1048576
v_lshlrev_b32 v244, 4, v0
s_nop 7
buffer_store_dwordx4 v[112:115], v244, s[28:31], s95 offen
v_add_u32 v244, 1024, v244
buffer_store_dwordx4 v[116:119], v244, s[28:31], s95 offen
v_add_u32 v244, 1024, v244
buffer_store_dwordx4 v[120:123], v244, s[28:31], s95 offen
v_add_u32 v244, 1024, v244
buffer_store_dwordx4 v[124:127], v244, s[28:31], s95 offen
v_add_u32 v244, 1024, v244
buffer_store_dwordx4 v[128:131], v244, s[28:31], s95 offen
v_add_u32 v244, 1024, v244
buffer_store_dwordx4 v[132:135], v244, s[28:31], s95 offen
v_add_u32 v244, 1024, v244
buffer_store_dwordx4 v[136:139], v244, s[28:31], s95 offen
v_add_u32 v244, 1024, v244
buffer_store_dwordx4 v[140:143], v244, s[28:31], s95 offen
v_add_u32 v244, 1024, v244
buffer_store_dwordx4 v[144:147], v244, s[28:31], s95 offen
v_add_u32 v244, 1024, v244
buffer_store_dwordx4 v[148:151], v244, s[28:31], s95 offen
v_add_u32 v244, 1024, v244
buffer_store_dwordx4 v[152:155], v244, s[28:31], s95 offen
v_add_u32 v244, 1024, v244
buffer_store_dwordx4 v[156:159], v244, s[28:31], s95 offen
v_add_u32 v244, 1024, v244
buffer_store_dwordx4 v[160:163], v244, s[28:31], s95 offen
v_add_u32 v244, 1024, v244
buffer_store_dwordx4 v[164:167], v244, s[28:31], s95 offen
v_add_u32 v244, 1024, v244
buffer_store_dwordx4 v[168:171], v244, s[28:31], s95 offen
v_add_u32 v244, 1024, v244
buffer_store_dwordx4 v[172:175], v244, s[28:31], s95 offen
v_add_u32 v244, 1024, v244
s_waitcnt vmcnt(0)
v_and_b32 v173, 15, v0
v_lshrrev_b32 v174, 4, v0
v_lshlrev_b32 v171, 8, v173
v_lshl_add_u32 v171, v174, 4, v171
v_lshlrev_b32 v172, 1, v173
v_lshl_add_u32 v172, v174, 10, v172
v_mov_b32 v168, 0xff800000
v_mov_b32 v169, 0xff800000
v_mov_b32 v170, 0xff800000
s_mov_b32 s93, 131072
s_mov_b32 s92, 0
L_s1_1:
buffer_load_dwordx4 v[112:115], v171, s[8:11], s93 offen offset:0
buffer_load_dwordx4 v[116:119], v171, s[8:11], s93 offen offset:64
buffer_load_dwordx4 v[120:123], v171, s[8:11], s93 offen offset:128
buffer_load_dwordx4 v[124:127], v171, s[8:11], s93 offen offset:192
s_waitcnt vmcnt(0)
mm v[128:131],v[112:115],a[48:51],0
mm v[128:131],v[116:119],a[60:63],v[128:131]
mm v[128:131],v[120:123],a[72:75],v[128:131]
mm v[128:131],v[124:127],a[84:87],v[128:131]
mm v[132:135],v[112:115],a[52:55],0
mm v[132:135],v[116:119],a[64:67],v[132:135]
mm v[132:135],v[120:123],a[76:79],v[132:135]
mm v[132:135],v[124:127],a[88:91],v[132:135]
mm v[136:139],v[112:115],a[56:59],0
mm v[136:139],v[116:119],a[68:71],v[136:139]
mm v[136:139],v[120:123],a[80:83],v[136:139]
mm v[136:139],v[124:127],a[92:95],v[136:139]
s_nop 9
v_max3_f32 v168, v128, v129, v168
v_max3_f32 v168, v130, v131, v168
v_max3_f32 v169, v132, v133, v169
v_max3_f32 v169, v134, v135, v169
v_max3_f32 v170, v136, v137, v170
v_max3_f32 v170, v138, v139, v170
s_add_u32 s93, s93, 4096
s_add_u32 s92, s92, 1
s_cmp_lt_u32 s92, 32
s_cbranch_scc1 L_s1_1
v_mov_b32 v173, v168
v_mov_b32 v174, v168
s_nop 1
v_permlane16_swap_b32 v173, v174
s_nop 1
v_max_f32 v168, v173, v174
v_mov_b32 v173, v168
v_mov_b32 v174, v168
s_nop 1
v_permlane32_swap_b32 v173, v174
s_nop 1
v_max_f32 v168, v173, v174
v_mov_b32 v173, v169
v_mov_b32 v174, v169
s_nop 1
v_permlane16_swap_b32 v173, v174
s_nop 1
v_max_f32 v169, v173, v174
v_mov_b32 v173, v169
v_mov_b32 v174, v169
s_nop 1
v_permlane32_swap_b32 v173, v174
s_nop 1
v_max_f32 v169, v173, v174
v_mov_b32 v173, v170
v_mov_b32 v174, v170
s_nop 1
v_permlane16_swap_b32 v173, v174
s_nop 1
v_max_f32 v170, v173, v174
v_mov_b32 v173, v170
v_mov_b32 v174, v170
s_nop 1
v_permlane32_swap_b32 v173, v174
s_nop 1
v_max_f32 v170, v173, v174
v_mov_b32 v16, 0
v_mov_b32 v17, 0
v_mov_b32 v18, 0
v_mov_b32 v19, 0
v_mov_b32 v20, 0
v_mov_b32 v21, 0
v_mov_b32 v22, 0
v_mov_b32 v23, 0
v_mov_b32 v24, 0
v_mov_b32 v25, 0
v_mov_b32 v26, 0
v_mov_b32 v27, 0
v_mov_b32 v28, 0
v_mov_b32 v29, 0
v_mov_b32 v30, 0
v_mov_b32 v31, 0
v_mov_b32 v32, 0
v_mov_b32 v33, 0
v_mov_b32 v34, 0
v_mov_b32 v35, 0
v_mov_b32 v36, 0
v_mov_b32 v37, 0
v_mov_b32 v38, 0
v_mov_b32 v39, 0
v_mov_b32 v40, 0
v_mov_b32 v41, 0
v_mov_b32 v42, 0
v_mov_b32 v43, 0
v_mov_b32 v44, 0
v_mov_b32 v45, 0
v_mov_b32 v46, 0
v_mov_b32 v47, 0
v_mov_b32 v48, 0
v_mov_b32 v49, 0
v_mov_b32 v50, 0
v_mov_b32 v51, 0
v_mov_b32 v52, 0
v_mov_b32 v53, 0
v_mov_b32 v54, 0
v_mov_b32 v55, 0
v_mov_b32 v56, 0
v_mov_b32 v57, 0
v_mov_b32 v58, 0
v_mov_b32 v59, 0
v_mov_b32 v60, 0
v_mov_b32 v61, 0
v_mov_b32 v62, 0
v_mov_b32 v63, 0
v_mov_b32 v64, 0
v_mov_b32 v65, 0
v_mov_b32 v66, 0
v_mov_b32 v67, 0
v_mov_b32 v68, 0
v_mov_b32 v69, 0
v_mov_b32 v70, 0
v_mov_b32 v71, 0
v_mov_b32 v72, 0
v_mov_b32 v73, 0
v_mov_b32 v74, 0
v_mov_b32 v75, 0
v_mov_b32 v76, 0
v_mov_b32 v77, 0
v_mov_b32 v78, 0
v_mov_b32 v79, 0
v_mov_b32 v80, 0
v_mov_b32 v81, 0
v_mov_b32 v82, 0
v_mov_b32 v83, 0
v_mov_b32 v84, 0
v_mov_b32 v85, 0
v_mov_b32 v86, 0
v_mov_b32 v87, 0
v_mov_b32 v88, 0
v_mov_b32 v89, 0
v_mov_b32 v90, 0
v_mov_b32 v91, 0
v_mov_b32 v92, 0
v_mov_b32 v93, 0
v_mov_b32 v94, 0
v_mov_b32 v95, 0
v_mov_b32 v96, 0
v_mov_b32 v97, 0
v_mov_b32 v98, 0
v_mov_b32 v99, 0
v_mov_b32 v100, 0
v_mov_b32 v101, 0
v_mov_b32 v102, 0
v_mov_b32 v103, 0
v_mov_b32 v104, 0
v_mov_b32 v105, 0
v_mov_b32 v106, 0
v_mov_b32 v107, 0
v_mov_b32 v108, 0
v_mov_b32 v109, 0
v_mov_b32 v110, 0
v_mov_b32 v111, 0
v_mov_b32 v208, 0
v_mov_b32 v209, 0
v_mov_b32 v210, 0
v_mov_b32 v211, 0
v_mov_b32 v212, 0
v_mov_b32 v213, 0
v_mov_b32 v214, 0
v_mov_b32 v215, 0
v_mov_b32 v216, 0
v_mov_b32 v217, 0
v_mov_b32 v218, 0
v_mov_b32 v219, 0
s_mov_b32 s93, 131072
s_mov_b32 s92, 0
L_s2_1:
s_mov_b32 s95, s93
buffer_load_dwordx4 v[112:115], v171, s[8:11], s93 offen offset:0
buffer_load_dwordx4 v[116:119], v171, s[8:11], s93 offen offset:64
buffer_load_dwordx4 v[120:123], v171, s[8:11], s93 offen offset:128
buffer_load_dwordx4 v[124:127], v171, s[8:11], s93 offen offset:192
s_waitcnt vmcnt(0)
mm v[128:131],v[112:115],a[48:51],0
mm v[128:131],v[116:119],a[60:63],v[128:131]
mm v[128:131],v[120:123],a[72:75],v[128:131]
mm v[128:131],v[124:127],a[84:87],v[128:131]
mm v[132:135],v[112:115],a[52:55],0
mm v[132:135],v[116:119],a[64:67],v[132:135]
mm v[132:135],v[120:123],a[76:79],v[132:135]
mm v[132:135],v[124:127],a[88:91],v[132:135]
mm v[136:139],v[112:115],a[56:59],0
mm v[136:139],v[116:119],a[68:71],v[136:139]
mm v[136:139],v[120:123],a[80:83],v[136:139]
mm v[136:139],v[124:127],a[92:95],v[136:139]
s_nop 9
v_sub_f32 v128, v128, v168
v_sub_f32 v129, v129, v168
v_sub_f32 v130, v130, v168
v_sub_f32 v131, v131, v168
v_exp_f32 v128, v128
v_exp_f32 v129, v129
v_exp_f32 v130, v130
v_exp_f32 v131, v131
s_nop 0
cv v140,v128,v129
cv v141,v130,v131
v_sub_f32 v132, v132, v169
v_sub_f32 v133, v133, v169
v_sub_f32 v134, v134, v169
v_sub_f32 v135, v135, v169
v_exp_f32 v132, v132
v_exp_f32 v133, v133
v_exp_f32 v134, v134
v_exp_f32 v135, v135
s_nop 0
cv v144,v132,v133
cv v145,v134,v135
v_sub_f32 v136, v136, v170
v_sub_f32 v137, v137, v170
v_sub_f32 v138, v138, v170
v_sub_f32 v139, v139, v170
v_exp_f32 v136, v136
v_exp_f32 v137, v137
v_exp_f32 v138, v138
v_exp_f32 v139, v139
s_nop 0
cv v148,v136,v137
cv v149,v138,v139
s_add_u32 s93, s93, 4096
buffer_load_dwordx4 v[112:115], v171, s[8:11], s93 offen offset:0
buffer_load_dwordx4 v[116:119], v171, s[8:11], s93 offen offset:64
buffer_load_dwordx4 v[120:123], v171, s[8:11], s93 offen offset:128
buffer_load_dwordx4 v[124:127], v171, s[8:11], s93 offen offset:192
s_waitcnt vmcnt(0)
mm v[128:131],v[112:115],a[48:51],0
mm v[128:131],v[116:119],a[60:63],v[128:131]
mm v[128:131],v[120:123],a[72:75],v[128:131]
mm v[128:131],v[124:127],a[84:87],v[128:131]
mm v[132:135],v[112:115],a[52:55],0
mm v[132:135],v[116:119],a[64:67],v[132:135]
mm v[132:135],v[120:123],a[76:79],v[132:135]
mm v[132:135],v[124:127],a[88:91],v[132:135]
mm v[136:139],v[112:115],a[56:59],0
mm v[136:139],v[116:119],a[68:71],v[136:139]
mm v[136:139],v[120:123],a[80:83],v[136:139]
mm v[136:139],v[124:127],a[92:95],v[136:139]
s_nop 9
v_sub_f32 v128, v128, v168
v_sub_f32 v129, v129, v168
v_sub_f32 v130, v130, v168
v_sub_f32 v131, v131, v168
v_exp_f32 v128, v128
v_exp_f32 v129, v129
v_exp_f32 v130, v130
v_exp_f32 v131, v131
s_nop 0
cv v142,v128,v129
cv v143,v130,v131
v_sub_f32 v132, v132, v169
v_sub_f32 v133, v133, v169
v_sub_f32 v134, v134, v169
v_sub_f32 v135, v135, v169
v_exp_f32 v132, v132
v_exp_f32 v133, v133
v_exp_f32 v134, v134
v_exp_f32 v135, v135
s_nop 0
cv v146,v132,v133
cv v147,v134,v135
v_sub_f32 v136, v136, v170
v_sub_f32 v137, v137, v170
v_sub_f32 v138, v138, v170
v_sub_f32 v139, v139, v170
v_exp_f32 v136, v136
v_exp_f32 v137, v137
v_exp_f32 v138, v138
v_exp_f32 v139, v139
s_nop 0
cv v150,v136,v137
cv v151,v138,v139
s_add_u32 s93, s93, 4096
s_add_u32 s94, s95, 4096
s_nop 1
mm v[208:211],v[220:223],v[140:143],v[208:211]
mm v[212:215],v[220:223],v[144:147],v[212:215]
mm v[216:219],v[220:223],v[148:151],v[216:219]
buffer_load_ushort v152, v172, s[12:15], s95 offen offset:0
buffer_load_ushort v153, v172, s[12:15], s95 offen offset:256
buffer_load_ushort v154, v172, s[12:15], s95 offen offset:512
buffer_load_ushort v155, v172, s[12:15], s95 offen offset:768
buffer_load_ushort v156, v172, s[12:15], s94 offen offset:0
buffer_load_ushort v157, v172, s[12:15], s94 offen offset:256
buffer_load_ushort v158, v172, s[12:15], s94 offen offset:512
buffer_load_ushort v159, v172, s[12:15], s94 offen offset:768
buffer_load_ushort v160, v172, s[12:15], s95 offen offset:32
buffer_load_ushort v161, v172, s[12:15], s95 offen offset:288
buffer_load_ushort v162, v172, s[12:15], s95 offen offset:544
buffer_load_ushort v163, v172, s[12:15], s95 offen offset:800
buffer_load_ushort v164, v172, s[12:15], s94 offen offset:32
buffer_load_ushort v165, v172, s[12:15], s94 offen offset:288
buffer_load_ushort v166, v172, s[12:15], s94 offen offset:544
buffer_load_ushort v167, v172, s[12:15], s94 offen offset:800
s_waitcnt vmcnt(0)
v_lshl_or_b32 v152, v153, 16, v152
v_lshl_or_b32 v153, v155, 16, v154
v_lshl_or_b32 v154, v157, 16, v156
v_lshl_or_b32 v155, v159, 16, v158
v_lshl_or_b32 v160, v161, 16, v160
v_lshl_or_b32 v161, v163, 16, v162
v_lshl_or_b32 v162, v165, 16, v164
v_lshl_or_b32 v163, v167, 16, v166
s_nop 1
mm v[16:19],v[152:155],v[140:143],v[16:19]
mm v[20:23],v[152:155],v[144:147],v[20:23]
mm v[24:27],v[152:155],v[148:151],v[24:27]
mm v[28:31],v[160:163],v[140:143],v[28:31]
mm v[32:35],v[160:163],v[144:147],v[32:35]
mm v[36:39],v[160:163],v[148:151],v[36:39]
s_nop 7
buffer_load_ushort v152, v172, s[12:15], s95 offen offset:64
buffer_load_ushort v153, v172, s[12:15], s95 offen offset:320
buffer_load_ushort v154, v172, s[12:15], s95 offen offset:576
buffer_load_ushort v155, v172, s[12:15], s95 offen offset:832
buffer_load_ushort v156, v172, s[12:15], s94 offen offset:64
buffer_load_ushort v157, v172, s[12:15], s94 offen offset:320
buffer_load_ushort v158, v172, s[12:15], s94 offen offset:576
buffer_load_ushort v159, v172, s[12:15], s94 offen offset:832
buffer_load_ushort v160, v172, s[12:15], s95 offen offset:96
buffer_load_ushort v161, v172, s[12:15], s95 offen offset:352
buffer_load_ushort v162, v172, s[12:15], s95 offen offset:608
buffer_load_ushort v163, v172, s[12:15], s95 offen offset:864
buffer_load_ushort v164, v172, s[12:15], s94 offen offset:96
buffer_load_ushort v165, v172, s[12:15], s94 offen offset:352
buffer_load_ushort v166, v172, s[12:15], s94 offen offset:608
buffer_load_ushort v167, v172, s[12:15], s94 offen offset:864
s_waitcnt vmcnt(0)
v_lshl_or_b32 v152, v153, 16, v152
v_lshl_or_b32 v153, v155, 16, v154
v_lshl_or_b32 v154, v157, 16, v156
v_lshl_or_b32 v155, v159, 16, v158
v_lshl_or_b32 v160, v161, 16, v160
v_lshl_or_b32 v161, v163, 16, v162
v_lshl_or_b32 v162, v165, 16, v164
v_lshl_or_b32 v163, v167, 16, v166
s_nop 1
mm v[40:43],v[152:155],v[140:143],v[40:43]
mm v[44:47],v[152:155],v[144:147],v[44:47]
mm v[48:51],v[152:155],v[148:151],v[48:51]
mm v[52:55],v[160:163],v[140:143],v[52:55]
mm v[56:59],v[160:163],v[144:147],v[56:59]
mm v[60:63],v[160:163],v[148:151],v[60:63]
s_nop 7
buffer_load_ushort v152, v172, s[12:15], s95 offen offset:128
buffer_load_ushort v153, v172, s[12:15], s95 offen offset:384
buffer_load_ushort v154, v172, s[12:15], s95 offen offset:640
buffer_load_ushort v155, v172, s[12:15], s95 offen offset:896
buffer_load_ushort v156, v172, s[12:15], s94 offen offset:128
buffer_load_ushort v157, v172, s[12:15], s94 offen offset:384
buffer_load_ushort v158, v172, s[12:15], s94 offen offset:640
buffer_load_ushort v159, v172, s[12:15], s94 offen offset:896
buffer_load_ushort v160, v172, s[12:15], s95 offen offset:160
buffer_load_ushort v161, v172, s[12:15], s95 offen offset:416
buffer_load_ushort v162, v172, s[12:15], s95 offen offset:672
buffer_load_ushort v163, v172, s[12:15], s95 offen offset:928
buffer_load_ushort v164, v172, s[12:15], s94 offen offset:160
buffer_load_ushort v165, v172, s[12:15], s94 offen offset:416
buffer_load_ushort v166, v172, s[12:15], s94 offen offset:672
buffer_load_ushort v167, v172, s[12:15], s94 offen offset:928
s_waitcnt vmcnt(0)
v_lshl_or_b32 v152, v153, 16, v152
v_lshl_or_b32 v153, v155, 16, v154
v_lshl_or_b32 v154, v157, 16, v156
v_lshl_or_b32 v155, v159, 16, v158
v_lshl_or_b32 v160, v161, 16, v160
v_lshl_or_b32 v161, v163, 16, v162
v_lshl_or_b32 v162, v165, 16, v164
v_lshl_or_b32 v163, v167, 16, v166
s_nop 1
mm v[64:67],v[152:155],v[140:143],v[64:67]
mm v[68:71],v[152:155],v[144:147],v[68:71]
mm v[72:75],v[152:155],v[148:151],v[72:75]
mm v[76:79],v[160:163],v[140:143],v[76:79]
mm v[80:83],v[160:163],v[144:147],v[80:83]
mm v[84:87],v[160:163],v[148:151],v[84:87]
s_nop 7
buffer_load_ushort v152, v172, s[12:15], s95 offen offset:192
buffer_load_ushort v153, v172, s[12:15], s95 offen offset:448
buffer_load_ushort v154, v172, s[12:15], s95 offen offset:704
buffer_load_ushort v155, v172, s[12:15], s95 offen offset:960
buffer_load_ushort v156, v172, s[12:15], s94 offen offset:192
buffer_load_ushort v157, v172, s[12:15], s94 offen offset:448
buffer_load_ushort v158, v172, s[12:15], s94 offen offset:704
buffer_load_ushort v159, v172, s[12:15], s94 offen offset:960
buffer_load_ushort v160, v172, s[12:15], s95 offen offset:224
buffer_load_ushort v161, v172, s[12:15], s95 offen offset:480
buffer_load_ushort v162, v172, s[12:15], s95 offen offset:736
buffer_load_ushort v163, v172, s[12:15], s95 offen offset:992
buffer_load_ushort v164, v172, s[12:15], s94 offen offset:224
buffer_load_ushort v165, v172, s[12:15], s94 offen offset:480
buffer_load_ushort v166, v172, s[12:15], s94 offen offset:736
buffer_load_ushort v167, v172, s[12:15], s94 offen offset:992
s_waitcnt vmcnt(0)
v_lshl_or_b32 v152, v153, 16, v152
v_lshl_or_b32 v153, v155, 16, v154
v_lshl_or_b32 v154, v157, 16, v156
v_lshl_or_b32 v155, v159, 16, v158
v_lshl_or_b32 v160, v161, 16, v160
v_lshl_or_b32 v161, v163, 16, v162
v_lshl_or_b32 v162, v165, 16, v164
v_lshl_or_b32 v163, v167, 16, v166
s_nop 1
mm v[88:91],v[152:155],v[140:143],v[88:91]
mm v[92:95],v[152:155],v[144:147],v[92:95]
mm v[96:99],v[152:155],v[148:151],v[96:99]
mm v[100:103],v[160:163],v[140:143],v[100:103]
mm v[104:107],v[160:163],v[144:147],v[104:107]
mm v[108:111],v[160:163],v[148:151],v[108:111]
s_nop 7
s_add_u32 s92, s92, 1
s_cmp_lt_u32 s92, 16
s_cbranch_scc1 L_s2_1
s_nop 9
s_lshl_b32 s95, s2, 2
s_add_u32 s95, s95, s42
s_mul_i32 s95, s95, 16384
s_add_u32 s95, s95, 1048576
v_lshlrev_b32 v244, 4, v0
buffer_load_dwordx4 v[112:115], v244, s[28:31], s95 offen sc1
v_add_u32 v244, 1024, v244
buffer_load_dwordx4 v[116:119], v244, s[28:31], s95 offen sc1
v_add_u32 v244, 1024, v244
buffer_load_dwordx4 v[120:123], v244, s[28:31], s95 offen sc1
v_add_u32 v244, 1024, v244
buffer_load_dwordx4 v[124:127], v244, s[28:31], s95 offen sc1
v_add_u32 v244, 1024, v244
buffer_load_dwordx4 v[128:131], v244, s[28:31], s95 offen sc1
v_add_u32 v244, 1024, v244
buffer_load_dwordx4 v[132:135], v244, s[28:31], s95 offen sc1
v_add_u32 v244, 1024, v244
buffer_load_dwordx4 v[136:139], v244, s[28:31], s95 offen sc1
v_add_u32 v244, 1024, v244
buffer_load_dwordx4 v[140:143], v244, s[28:31], s95 offen sc1
v_add_u32 v244, 1024, v244
buffer_load_dwordx4 v[144:147], v244, s[28:31], s95 offen sc1
v_add_u32 v244, 1024, v244
buffer_load_dwordx4 v[148:151], v244, s[28:31], s95 offen sc1
v_add_u32 v244, 1024, v244
buffer_load_dwordx4 v[152:155], v244, s[28:31], s95 offen sc1
v_add_u32 v244, 1024, v244
buffer_load_dwordx4 v[156:159], v244, s[28:31], s95 offen sc1
v_add_u32 v244, 1024, v244
buffer_load_dwordx4 v[160:163], v244, s[28:31], s95 offen sc1
v_add_u32 v244, 1024, v244
buffer_load_dwordx4 v[164:167], v244, s[28:31], s95 offen sc1
v_add_u32 v244, 1024, v244
buffer_load_dwordx4 v[168:171], v244, s[28:31], s95 offen sc1
v_add_u32 v244, 1024, v244
buffer_load_dwordx4 v[172:175], v244, s[28:31], s95 offen sc1
v_add_u32 v244, 1024, v244
v_rcp_f32 v240, v208
v_rcp_f32 v241, v212
v_rcp_f32 v242, v216
s_waitcnt vmcnt(0)
s_branch L_back1
L_slow2:
s_lshl_b32 s95, s2, 2
s_add_u32 s95, s95, s42
s_mul_i32 s95, s95, 16384
s_add_u32 s95, s95, 1048576
v_lshlrev_b32 v244, 4, v0
s_nop 7
buffer_store_dwordx4 v[112:115], v244, s[28:31], s95 offen
v_add_u32 v244, 1024, v244
buffer_store_dwordx4 v[116:119], v244, s[28:31], s95 offen
v_add_u32 v244, 1024, v244
buffer_store_dwordx4 v[120:123], v244, s[28:31], s95 offen
v_add_u32 v244, 1024, v244
buffer_store_dwordx4 v[124:127], v244, s[28:31], s95 offen
v_add_u32 v244, 1024, v244
buffer_store_dwordx4 v[128:131], v244, s[28:31], s95 offen
v_add_u32 v244, 1024, v244
buffer_store_dwordx4 v[132:135], v244, s[28:31], s95 offen
v_add_u32 v244, 1024, v244
buffer_store_dwordx4 v[136:139], v244, s[28:31], s95 offen
v_add_u32 v244, 1024, v244
buffer_store_dwordx4 v[140:143], v244, s[28:31], s95 offen
v_add_u32 v244, 1024, v244
buffer_store_dwordx4 v[144:147], v244, s[28:31], s95 offen
v_add_u32 v244, 1024, v244
buffer_store_dwordx4 v[148:151], v244, s[28:31], s95 offen
v_add_u32 v244, 1024, v244
buffer_store_dwordx4 v[152:155], v244, s[28:31], s95 offen
v_add_u32 v244, 1024, v244
buffer_store_dwordx4 v[156:159], v244, s[28:31], s95 offen
v_add_u32 v244, 1024, v244
buffer_store_dwordx4 v[160:163], v244, s[28:31], s95 offen
v_add_u32 v244, 1024, v244
buffer_store_dwordx4 v[164:167], v244, s[28:31], s95 offen
v_add_u32 v244, 1024, v244
buffer_store_dwordx4 v[168:171], v244, s[28:31], s95 offen
v_add_u32 v244, 1024, v244
buffer_store_dwordx4 v[172:175], v244, s[28:31], s95 offen
v_add_u32 v244, 1024, v244
s_waitcnt vmcnt(0)
v_and_b32 v173, 15, v0
v_lshrrev_b32 v174, 4, v0
v_lshlrev_b32 v171, 8, v173
v_lshl_add_u32 v171, v174, 4, v171
v_lshlrev_b32 v172, 1, v173
v_lshl_add_u32 v172, v174, 10, v172
v_mov_b32 v168, 0xff800000
v_mov_b32 v169, 0xff800000
v_mov_b32 v170, 0xff800000
s_mov_b32 s93, 262144
s_mov_b32 s92, 0
L_s1_2:
buffer_load_dwordx4 v[112:115], v171, s[8:11], s93 offen offset:0
buffer_load_dwordx4 v[116:119], v171, s[8:11], s93 offen offset:64
buffer_load_dwordx4 v[120:123], v171, s[8:11], s93 offen offset:128
buffer_load_dwordx4 v[124:127], v171, s[8:11], s93 offen offset:192
s_waitcnt vmcnt(0)
mm v[128:131],v[112:115],a[96:99],0
mm v[128:131],v[116:119],a[108:111],v[128:131]
mm v[128:131],v[120:123],a[120:123],v[128:131]
mm v[128:131],v[124:127],a[132:135],v[128:131]
mm v[132:135],v[112:115],a[100:103],0
mm v[132:135],v[116:119],a[112:115],v[132:135]
mm v[132:135],v[120:123],a[124:127],v[132:135]
mm v[132:135],v[124:127],a[136:139],v[132:135]
mm v[136:139],v[112:115],a[104:107],0
mm v[136:139],v[116:119],a[116:119],v[136:139]
mm v[136:139],v[120:123],a[128:131],v[136:139]
mm v[136:139],v[124:127],a[140:143],v[136:139]
s_nop 9
v_max3_f32 v168, v128, v129, v168
v_max3_f32 v168, v130, v131, v168
v_max3_f32 v169, v132, v133, v169
v_max3_f32 v169, v134, v135, v169
v_max3_f32 v170, v136, v137, v170
v_max3_f32 v170, v138, v139, v170
s_add_u32 s93, s93, 4096
s_add_u32 s92, s92, 1
s_cmp_lt_u32 s92, 32
s_cbranch_scc1 L_s1_2
v_mov_b32 v173, v168
v_mov_b32 v174, v168
s_nop 1
v_permlane16_swap_b32 v173, v174
s_nop 1
v_max_f32 v168, v173, v174
v_mov_b32 v173, v168
v_mov_b32 v174, v168
s_nop 1
v_permlane32_swap_b32 v173, v174
s_nop 1
v_max_f32 v168, v173, v174
v_mov_b32 v173, v169
v_mov_b32 v174, v169
s_nop 1
v_permlane16_swap_b32 v173, v174
s_nop 1
v_max_f32 v169, v173, v174
v_mov_b32 v173, v169
v_mov_b32 v174, v169
s_nop 1
v_permlane32_swap_b32 v173, v174
s_nop 1
v_max_f32 v169, v173, v174
v_mov_b32 v173, v170
v_mov_b32 v174, v170
s_nop 1
v_permlane16_swap_b32 v173, v174
s_nop 1
v_max_f32 v170, v173, v174
v_mov_b32 v173, v170
v_mov_b32 v174, v170
s_nop 1
v_permlane32_swap_b32 v173, v174
s_nop 1
v_max_f32 v170, v173, v174
v_mov_b32 v16, 0
v_mov_b32 v17, 0
v_mov_b32 v18, 0
v_mov_b32 v19, 0
v_mov_b32 v20, 0
v_mov_b32 v21, 0
v_mov_b32 v22, 0
v_mov_b32 v23, 0
v_mov_b32 v24, 0
v_mov_b32 v25, 0
v_mov_b32 v26, 0
v_mov_b32 v27, 0
v_mov_b32 v28, 0
v_mov_b32 v29, 0
v_mov_b32 v30, 0
v_mov_b32 v31, 0
v_mov_b32 v32, 0
v_mov_b32 v33, 0
v_mov_b32 v34, 0
v_mov_b32 v35, 0
v_mov_b32 v36, 0
v_mov_b32 v37, 0
v_mov_b32 v38, 0
v_mov_b32 v39, 0
v_mov_b32 v40, 0
v_mov_b32 v41, 0
v_mov_b32 v42, 0
v_mov_b32 v43, 0
v_mov_b32 v44, 0
v_mov_b32 v45, 0
v_mov_b32 v46, 0
v_mov_b32 v47, 0
v_mov_b32 v48, 0
v_mov_b32 v49, 0
v_mov_b32 v50, 0
v_mov_b32 v51, 0
v_mov_b32 v52, 0
v_mov_b32 v53, 0
v_mov_b32 v54, 0
v_mov_b32 v55, 0
v_mov_b32 v56, 0
v_mov_b32 v57, 0
v_mov_b32 v58, 0
v_mov_b32 v59, 0
v_mov_b32 v60, 0
v_mov_b32 v61, 0
v_mov_b32 v62, 0
v_mov_b32 v63, 0
v_mov_b32 v64, 0
v_mov_b32 v65, 0
v_mov_b32 v66, 0
v_mov_b32 v67, 0
v_mov_b32 v68, 0
v_mov_b32 v69, 0
v_mov_b32 v70, 0
v_mov_b32 v71, 0
v_mov_b32 v72, 0
v_mov_b32 v73, 0
v_mov_b32 v74, 0
v_mov_b32 v75, 0
v_mov_b32 v76, 0
v_mov_b32 v77, 0
v_mov_b32 v78, 0
v_mov_b32 v79, 0
v_mov_b32 v80, 0
v_mov_b32 v81, 0
v_mov_b32 v82, 0
v_mov_b32 v83, 0
v_mov_b32 v84, 0
v_mov_b32 v85, 0
v_mov_b32 v86, 0
v_mov_b32 v87, 0
v_mov_b32 v88, 0
v_mov_b32 v89, 0
v_mov_b32 v90, 0
v_mov_b32 v91, 0
v_mov_b32 v92, 0
v_mov_b32 v93, 0
v_mov_b32 v94, 0
v_mov_b32 v95, 0
v_mov_b32 v96, 0
v_mov_b32 v97, 0
v_mov_b32 v98, 0
v_mov_b32 v99, 0
v_mov_b32 v100, 0
v_mov_b32 v101, 0
v_mov_b32 v102, 0
v_mov_b32 v103, 0
v_mov_b32 v104, 0
v_mov_b32 v105, 0
v_mov_b32 v106, 0
v_mov_b32 v107, 0
v_mov_b32 v108, 0
v_mov_b32 v109, 0
v_mov_b32 v110, 0
v_mov_b32 v111, 0
v_mov_b32 v208, 0
v_mov_b32 v209, 0
v_mov_b32 v210, 0
v_mov_b32 v211, 0
v_mov_b32 v212, 0
v_mov_b32 v213, 0
v_mov_b32 v214, 0
v_mov_b32 v215, 0
v_mov_b32 v216, 0
v_mov_b32 v217, 0
v_mov_b32 v218, 0
v_mov_b32 v219, 0
s_mov_b32 s93, 262144
s_mov_b32 s92, 0
L_s2_2:
s_mov_b32 s95, s93
buffer_load_dwordx4 v[112:115], v171, s[8:11], s93 offen offset:0
buffer_load_dwordx4 v[116:119], v171, s[8:11], s93 offen offset:64
buffer_load_dwordx4 v[120:123], v171, s[8:11], s93 offen offset:128
buffer_load_dwordx4 v[124:127], v171, s[8:11], s93 offen offset:192
s_waitcnt vmcnt(0)
mm v[128:131],v[112:115],a[96:99],0
mm v[128:131],v[116:119],a[108:111],v[128:131]
mm v[128:131],v[120:123],a[120:123],v[128:131]
mm v[128:131],v[124:127],a[132:135],v[128:131]
mm v[132:135],v[112:115],a[100:103],0
mm v[132:135],v[116:119],a[112:115],v[132:135]
mm v[132:135],v[120:123],a[124:127],v[132:135]
mm v[132:135],v[124:127],a[136:139],v[132:135]
mm v[136:139],v[112:115],a[104:107],0
mm v[136:139],v[116:119],a[116:119],v[136:139]
mm v[136:139],v[120:123],a[128:131],v[136:139]
mm v[136:139],v[124:127],a[140:143],v[136:139]
s_nop 9
v_sub_f32 v128, v128, v168
v_sub_f32 v129, v129, v168
v_sub_f32 v130, v130, v168
v_sub_f32 v131, v131, v168
v_exp_f32 v128, v128
v_exp_f32 v129, v129
v_exp_f32 v130, v130
v_exp_f32 v131, v131
s_nop 0
cv v140,v128,v129
cv v141,v130,v131
v_sub_f32 v132, v132, v169
v_sub_f32 v133, v133, v169
v_sub_f32 v134, v134, v169
v_sub_f32 v135, v135, v169
v_exp_f32 v132, v132
v_exp_f32 v133, v133
v_exp_f32 v134, v134
v_exp_f32 v135, v135
s_nop 0
cv v144,v132,v133
cv v145,v134,v135
v_sub_f32 v136, v136, v170
v_sub_f32 v137, v137, v170
v_sub_f32 v138, v138, v170
v_sub_f32 v139, v139, v170
v_exp_f32 v136, v136
v_exp_f32 v137, v137
v_exp_f32 v138, v138
v_exp_f32 v139, v139
s_nop 0
cv v148,v136,v137
cv v149,v138,v139
s_add_u32 s93, s93, 4096
buffer_load_dwordx4 v[112:115], v171, s[8:11], s93 offen offset:0
buffer_load_dwordx4 v[116:119], v171, s[8:11], s93 offen offset:64
buffer_load_dwordx4 v[120:123], v171, s[8:11], s93 offen offset:128
buffer_load_dwordx4 v[124:127], v171, s[8:11], s93 offen offset:192
s_waitcnt vmcnt(0)
mm v[128:131],v[112:115],a[96:99],0
mm v[128:131],v[116:119],a[108:111],v[128:131]
mm v[128:131],v[120:123],a[120:123],v[128:131]
mm v[128:131],v[124:127],a[132:135],v[128:131]
mm v[132:135],v[112:115],a[100:103],0
mm v[132:135],v[116:119],a[112:115],v[132:135]
mm v[132:135],v[120:123],a[124:127],v[132:135]
mm v[132:135],v[124:127],a[136:139],v[132:135]
mm v[136:139],v[112:115],a[104:107],0
mm v[136:139],v[116:119],a[116:119],v[136:139]
mm v[136:139],v[120:123],a[128:131],v[136:139]
mm v[136:139],v[124:127],a[140:143],v[136:139]
s_nop 9
v_sub_f32 v128, v128, v168
v_sub_f32 v129, v129, v168
v_sub_f32 v130, v130, v168
v_sub_f32 v131, v131, v168
v_exp_f32 v128, v128
v_exp_f32 v129, v129
v_exp_f32 v130, v130
v_exp_f32 v131, v131
s_nop 0
cv v142,v128,v129
cv v143,v130,v131
v_sub_f32 v132, v132, v169
v_sub_f32 v133, v133, v169
v_sub_f32 v134, v134, v169
v_sub_f32 v135, v135, v169
v_exp_f32 v132, v132
v_exp_f32 v133, v133
v_exp_f32 v134, v134
v_exp_f32 v135, v135
s_nop 0
cv v146,v132,v133
cv v147,v134,v135
v_sub_f32 v136, v136, v170
v_sub_f32 v137, v137, v170
v_sub_f32 v138, v138, v170
v_sub_f32 v139, v139, v170
v_exp_f32 v136, v136
v_exp_f32 v137, v137
v_exp_f32 v138, v138
v_exp_f32 v139, v139
s_nop 0
cv v150,v136,v137
cv v151,v138,v139
s_add_u32 s93, s93, 4096
s_add_u32 s94, s95, 4096
s_nop 1
mm v[208:211],v[220:223],v[140:143],v[208:211]
mm v[212:215],v[220:223],v[144:147],v[212:215]
mm v[216:219],v[220:223],v[148:151],v[216:219]
buffer_load_ushort v152, v172, s[12:15], s95 offen offset:0
buffer_load_ushort v153, v172, s[12:15], s95 offen offset:256
buffer_load_ushort v154, v172, s[12:15], s95 offen offset:512
buffer_load_ushort v155, v172, s[12:15], s95 offen offset:768
buffer_load_ushort v156, v172, s[12:15], s94 offen offset:0
buffer_load_ushort v157, v172, s[12:15], s94 offen offset:256
buffer_load_ushort v158, v172, s[12:15], s94 offen offset:512
buffer_load_ushort v159, v172, s[12:15], s94 offen offset:768
buffer_load_ushort v160, v172, s[12:15], s95 offen offset:32
buffer_load_ushort v161, v172, s[12:15], s95 offen offset:288
buffer_load_ushort v162, v172, s[12:15], s95 offen offset:544
buffer_load_ushort v163, v172, s[12:15], s95 offen offset:800
buffer_load_ushort v164, v172, s[12:15], s94 offen offset:32
buffer_load_ushort v165, v172, s[12:15], s94 offen offset:288
buffer_load_ushort v166, v172, s[12:15], s94 offen offset:544
buffer_load_ushort v167, v172, s[12:15], s94 offen offset:800
s_waitcnt vmcnt(0)
v_lshl_or_b32 v152, v153, 16, v152
v_lshl_or_b32 v153, v155, 16, v154
v_lshl_or_b32 v154, v157, 16, v156
v_lshl_or_b32 v155, v159, 16, v158
v_lshl_or_b32 v160, v161, 16, v160
v_lshl_or_b32 v161, v163, 16, v162
v_lshl_or_b32 v162, v165, 16, v164
v_lshl_or_b32 v163, v167, 16, v166
s_nop 1
mm v[16:19],v[152:155],v[140:143],v[16:19]
mm v[20:23],v[152:155],v[144:147],v[20:23]
mm v[24:27],v[152:155],v[148:151],v[24:27]
mm v[28:31],v[160:163],v[140:143],v[28:31]
mm v[32:35],v[160:163],v[144:147],v[32:35]
mm v[36:39],v[160:163],v[148:151],v[36:39]
s_nop 7
buffer_load_ushort v152, v172, s[12:15], s95 offen offset:64
buffer_load_ushort v153, v172, s[12:15], s95 offen offset:320
buffer_load_ushort v154, v172, s[12:15], s95 offen offset:576
buffer_load_ushort v155, v172, s[12:15], s95 offen offset:832
buffer_load_ushort v156, v172, s[12:15], s94 offen offset:64
buffer_load_ushort v157, v172, s[12:15], s94 offen offset:320
buffer_load_ushort v158, v172, s[12:15], s94 offen offset:576
buffer_load_ushort v159, v172, s[12:15], s94 offen offset:832
buffer_load_ushort v160, v172, s[12:15], s95 offen offset:96
buffer_load_ushort v161, v172, s[12:15], s95 offen offset:352
buffer_load_ushort v162, v172, s[12:15], s95 offen offset:608
buffer_load_ushort v163, v172, s[12:15], s95 offen offset:864
buffer_load_ushort v164, v172, s[12:15], s94 offen offset:96
buffer_load_ushort v165, v172, s[12:15], s94 offen offset:352
buffer_load_ushort v166, v172, s[12:15], s94 offen offset:608
buffer_load_ushort v167, v172, s[12:15], s94 offen offset:864
s_waitcnt vmcnt(0)
v_lshl_or_b32 v152, v153, 16, v152
v_lshl_or_b32 v153, v155, 16, v154
v_lshl_or_b32 v154, v157, 16, v156
v_lshl_or_b32 v155, v159, 16, v158
v_lshl_or_b32 v160, v161, 16, v160
v_lshl_or_b32 v161, v163, 16, v162
v_lshl_or_b32 v162, v165, 16, v164
v_lshl_or_b32 v163, v167, 16, v166
s_nop 1
mm v[40:43],v[152:155],v[140:143],v[40:43]
mm v[44:47],v[152:155],v[144:147],v[44:47]
mm v[48:51],v[152:155],v[148:151],v[48:51]
mm v[52:55],v[160:163],v[140:143],v[52:55]
mm v[56:59],v[160:163],v[144:147],v[56:59]
mm v[60:63],v[160:163],v[148:151],v[60:63]
s_nop 7
buffer_load_ushort v152, v172, s[12:15], s95 offen offset:128
buffer_load_ushort v153, v172, s[12:15], s95 offen offset:384
buffer_load_ushort v154, v172, s[12:15], s95 offen offset:640
buffer_load_ushort v155, v172, s[12:15], s95 offen offset:896
buffer_load_ushort v156, v172, s[12:15], s94 offen offset:128
buffer_load_ushort v157, v172, s[12:15], s94 offen offset:384
buffer_load_ushort v158, v172, s[12:15], s94 offen offset:640
buffer_load_ushort v159, v172, s[12:15], s94 offen offset:896
buffer_load_ushort v160, v172, s[12:15], s95 offen offset:160
buffer_load_ushort v161, v172, s[12:15], s95 offen offset:416
buffer_load_ushort v162, v172, s[12:15], s95 offen offset:672
buffer_load_ushort v163, v172, s[12:15], s95 offen offset:928
buffer_load_ushort v164, v172, s[12:15], s94 offen offset:160
buffer_load_ushort v165, v172, s[12:15], s94 offen offset:416
buffer_load_ushort v166, v172, s[12:15], s94 offen offset:672
buffer_load_ushort v167, v172, s[12:15], s94 offen offset:928
s_waitcnt vmcnt(0)
v_lshl_or_b32 v152, v153, 16, v152
v_lshl_or_b32 v153, v155, 16, v154
v_lshl_or_b32 v154, v157, 16, v156
v_lshl_or_b32 v155, v159, 16, v158
v_lshl_or_b32 v160, v161, 16, v160
v_lshl_or_b32 v161, v163, 16, v162
v_lshl_or_b32 v162, v165, 16, v164
v_lshl_or_b32 v163, v167, 16, v166
s_nop 1
mm v[64:67],v[152:155],v[140:143],v[64:67]
mm v[68:71],v[152:155],v[144:147],v[68:71]
mm v[72:75],v[152:155],v[148:151],v[72:75]
mm v[76:79],v[160:163],v[140:143],v[76:79]
mm v[80:83],v[160:163],v[144:147],v[80:83]
mm v[84:87],v[160:163],v[148:151],v[84:87]
s_nop 7
buffer_load_ushort v152, v172, s[12:15], s95 offen offset:192
buffer_load_ushort v153, v172, s[12:15], s95 offen offset:448
buffer_load_ushort v154, v172, s[12:15], s95 offen offset:704
buffer_load_ushort v155, v172, s[12:15], s95 offen offset:960
buffer_load_ushort v156, v172, s[12:15], s94 offen offset:192
buffer_load_ushort v157, v172, s[12:15], s94 offen offset:448
buffer_load_ushort v158, v172, s[12:15], s94 offen offset:704
buffer_load_ushort v159, v172, s[12:15], s94 offen offset:960
buffer_load_ushort v160, v172, s[12:15], s95 offen offset:224
buffer_load_ushort v161, v172, s[12:15], s95 offen offset:480
buffer_load_ushort v162, v172, s[12:15], s95 offen offset:736
buffer_load_ushort v163, v172, s[12:15], s95 offen offset:992
buffer_load_ushort v164, v172, s[12:15], s94 offen offset:224
buffer_load_ushort v165, v172, s[12:15], s94 offen offset:480
buffer_load_ushort v166, v172, s[12:15], s94 offen offset:736
buffer_load_ushort v167, v172, s[12:15], s94 offen offset:992
s_waitcnt vmcnt(0)
v_lshl_or_b32 v152, v153, 16, v152
v_lshl_or_b32 v153, v155, 16, v154
v_lshl_or_b32 v154, v157, 16, v156
v_lshl_or_b32 v155, v159, 16, v158
v_lshl_or_b32 v160, v161, 16, v160
v_lshl_or_b32 v161, v163, 16, v162
v_lshl_or_b32 v162, v165, 16, v164
v_lshl_or_b32 v163, v167, 16, v166
s_nop 1
mm v[88:91],v[152:155],v[140:143],v[88:91]
mm v[92:95],v[152:155],v[144:147],v[92:95]
mm v[96:99],v[152:155],v[148:151],v[96:99]
mm v[100:103],v[160:163],v[140:143],v[100:103]
mm v[104:107],v[160:163],v[144:147],v[104:107]
mm v[108:111],v[160:163],v[148:151],v[108:111]
s_nop 7
s_add_u32 s92, s92, 1
s_cmp_lt_u32 s92, 16
s_cbranch_scc1 L_s2_2
s_nop 9
s_lshl_b32 s95, s2, 2
s_add_u32 s95, s95, s42
s_mul_i32 s95, s95, 16384
s_add_u32 s95, s95, 1048576
v_lshlrev_b32 v244, 4, v0
buffer_load_dwordx4 v[112:115], v244, s[28:31], s95 offen sc1
v_add_u32 v244, 1024, v244
buffer_load_dwordx4 v[116:119], v244, s[28:31], s95 offen sc1
v_add_u32 v244, 1024, v244
buffer_load_dwordx4 v[120:123], v244, s[28:31], s95 offen sc1
v_add_u32 v244, 1024, v244
buffer_load_dwordx4 v[124:127], v244, s[28:31], s95 offen sc1
v_add_u32 v244, 1024, v244
buffer_load_dwordx4 v[128:131], v244, s[28:31], s95 offen sc1
v_add_u32 v244, 1024, v244
buffer_load_dwordx4 v[132:135], v244, s[28:31], s95 offen sc1
v_add_u32 v244, 1024, v244
buffer_load_dwordx4 v[136:139], v244, s[28:31], s95 offen sc1
v_add_u32 v244, 1024, v244
buffer_load_dwordx4 v[140:143], v244, s[28:31], s95 offen sc1
v_add_u32 v244, 1024, v244
buffer_load_dwordx4 v[144:147], v244, s[28:31], s95 offen sc1
v_add_u32 v244, 1024, v244
buffer_load_dwordx4 v[148:151], v244, s[28:31], s95 offen sc1
v_add_u32 v244, 1024, v244
buffer_load_dwordx4 v[152:155], v244, s[28:31], s95 offen sc1
v_add_u32 v244, 1024, v244
buffer_load_dwordx4 v[156:159], v244, s[28:31], s95 offen sc1
v_add_u32 v244, 1024, v244
buffer_load_dwordx4 v[160:163], v244, s[28:31], s95 offen sc1
v_add_u32 v244, 1024, v244
buffer_load_dwordx4 v[164:167], v244, s[28:31], s95 offen sc1
v_add_u32 v244, 1024, v244
buffer_load_dwordx4 v[168:171], v244, s[28:31], s95 offen sc1
v_add_u32 v244, 1024, v244
buffer_load_dwordx4 v[172:175], v244, s[28:31], s95 offen sc1
v_add_u32 v244, 1024, v244
v_rcp_f32 v240, v208
v_rcp_f32 v241, v212
v_rcp_f32 v242, v216
s_waitcnt vmcnt(0)
s_branch L_back2
L_slow3:
s_lshl_b32 s95, s2, 2
s_add_u32 s95, s95, s42
s_mul_i32 s95, s95, 16384
s_add_u32 s95, s95, 1048576
v_lshlrev_b32 v244, 4, v0
s_nop 7
buffer_store_dwordx4 v[112:115], v244, s[28:31], s95 offen
v_add_u32 v244, 1024, v244
buffer_store_dwordx4 v[116:119], v244, s[28:31], s95 offen
v_add_u32 v244, 1024, v244
buffer_store_dwordx4 v[120:123], v244, s[28:31], s95 offen
v_add_u32 v244, 1024, v244
buffer_store_dwordx4 v[124:127], v244, s[28:31], s95 offen
v_add_u32 v244, 1024, v244
buffer_store_dwordx4 v[128:131], v244, s[28:31], s95 offen
v_add_u32 v244, 1024, v244
buffer_store_dwordx4 v[132:135], v244, s[28:31], s95 offen
v_add_u32 v244, 1024, v244
buffer_store_dwordx4 v[136:139], v244, s[28:31], s95 offen
v_add_u32 v244, 1024, v244
buffer_store_dwordx4 v[140:143], v244, s[28:31], s95 offen
v_add_u32 v244, 1024, v244
buffer_store_dwordx4 v[144:147], v244, s[28:31], s95 offen
v_add_u32 v244, 1024, v244
buffer_store_dwordx4 v[148:151], v244, s[28:31], s95 offen
v_add_u32 v244, 1024, v244
buffer_store_dwordx4 v[152:155], v244, s[28:31], s95 offen
v_add_u32 v244, 1024, v244
buffer_store_dwordx4 v[156:159], v244, s[28:31], s95 offen
v_add_u32 v244, 1024, v244
buffer_store_dwordx4 v[160:163], v244, s[28:31], s95 offen
v_add_u32 v244, 1024, v244
buffer_store_dwordx4 v[164:167], v244, s[28:31], s95 offen
v_add_u32 v244, 1024, v244
buffer_store_dwordx4 v[168:171], v244, s[28:31], s95 offen
v_add_u32 v244, 1024, v244
buffer_store_dwordx4 v[172:175], v244, s[28:31], s95 offen
v_add_u32 v244, 1024, v244
s_waitcnt vmcnt(0)
v_and_b32 v173, 15, v0
v_lshrrev_b32 v174, 4, v0
v_lshlrev_b32 v171, 8, v173
v_lshl_add_u32 v171, v174, 4, v171
v_lshlrev_b32 v172, 1, v173
v_lshl_add_u32 v172, v174, 10, v172
v_mov_b32 v168, 0xff800000
v_mov_b32 v169, 0xff800000
v_mov_b32 v170, 0xff800000
s_mov_b32 s93, 393216
s_mov_b32 s92, 0
L_s1_3:
buffer_load_dwordx4 v[112:115], v171, s[8:11], s93 offen offset:0
buffer_load_dwordx4 v[116:119], v171, s[8:11], s93 offen offset:64
buffer_load_dwordx4 v[120:123], v171, s[8:11], s93 offen offset:128
buffer_load_dwordx4 v[124:127], v171, s[8:11], s93 offen offset:192
s_waitcnt vmcnt(0)
mm v[128:131],v[112:115],a[144:147],0
mm v[128:131],v[116:119],a[156:159],v[128:131]
mm v[128:131],v[120:123],a[168:171],v[128:131]
mm v[128:131],v[124:127],a[180:183],v[128:131]
mm v[132:135],v[112:115],a[148:151],0
mm v[132:135],v[116:119],a[160:163],v[132:135]
mm v[132:135],v[120:123],a[172:175],v[132:135]
mm v[132:135],v[124:127],a[184:187],v[132:135]
mm v[136:139],v[112:115],a[152:155],0
mm v[136:139],v[116:119],a[164:167],v[136:139]
mm v[136:139],v[120:123],a[176:179],v[136:139]
mm v[136:139],v[124:127],a[188:191],v[136:139]
s_nop 9
v_max3_f32 v168, v128, v129, v168
v_max3_f32 v168, v130, v131, v168
v_max3_f32 v169, v132, v133, v169
v_max3_f32 v169, v134, v135, v169
v_max3_f32 v170, v136, v137, v170
v_max3_f32 v170, v138, v139, v170
s_add_u32 s93, s93, 4096
s_add_u32 s92, s92, 1
s_cmp_lt_u32 s92, 32
s_cbranch_scc1 L_s1_3
v_mov_b32 v173, v168
v_mov_b32 v174, v168
s_nop 1
v_permlane16_swap_b32 v173, v174
s_nop 1
v_max_f32 v168, v173, v174
v_mov_b32 v173, v168
v_mov_b32 v174, v168
s_nop 1
v_permlane32_swap_b32 v173, v174
s_nop 1
v_max_f32 v168, v173, v174
v_mov_b32 v173, v169
v_mov_b32 v174, v169
s_nop 1
v_permlane16_swap_b32 v173, v174
s_nop 1
v_max_f32 v169, v173, v174
v_mov_b32 v173, v169
v_mov_b32 v174, v169
s_nop 1
v_permlane32_swap_b32 v173, v174
s_nop 1
v_max_f32 v169, v173, v174
v_mov_b32 v173, v170
v_mov_b32 v174, v170
s_nop 1
v_permlane16_swap_b32 v173, v174
s_nop 1
v_max_f32 v170, v173, v174
v_mov_b32 v173, v170
v_mov_b32 v174, v170
s_nop 1
v_permlane32_swap_b32 v173, v174
s_nop 1
v_max_f32 v170, v173, v174
v_mov_b32 v16, 0
v_mov_b32 v17, 0
v_mov_b32 v18, 0
v_mov_b32 v19, 0
v_mov_b32 v20, 0
v_mov_b32 v21, 0
v_mov_b32 v22, 0
v_mov_b32 v23, 0
v_mov_b32 v24, 0
v_mov_b32 v25, 0
v_mov_b32 v26, 0
v_mov_b32 v27, 0
v_mov_b32 v28, 0
v_mov_b32 v29, 0
v_mov_b32 v30, 0
v_mov_b32 v31, 0
v_mov_b32 v32, 0
v_mov_b32 v33, 0
v_mov_b32 v34, 0
v_mov_b32 v35, 0
v_mov_b32 v36, 0
v_mov_b32 v37, 0
v_mov_b32 v38, 0
v_mov_b32 v39, 0
v_mov_b32 v40, 0
v_mov_b32 v41, 0
v_mov_b32 v42, 0
v_mov_b32 v43, 0
v_mov_b32 v44, 0
v_mov_b32 v45, 0
v_mov_b32 v46, 0
v_mov_b32 v47, 0
v_mov_b32 v48, 0
v_mov_b32 v49, 0
v_mov_b32 v50, 0
v_mov_b32 v51, 0
v_mov_b32 v52, 0
v_mov_b32 v53, 0
v_mov_b32 v54, 0
v_mov_b32 v55, 0
v_mov_b32 v56, 0
v_mov_b32 v57, 0
v_mov_b32 v58, 0
v_mov_b32 v59, 0
v_mov_b32 v60, 0
v_mov_b32 v61, 0
v_mov_b32 v62, 0
v_mov_b32 v63, 0
v_mov_b32 v64, 0
v_mov_b32 v65, 0
v_mov_b32 v66, 0
v_mov_b32 v67, 0
v_mov_b32 v68, 0
v_mov_b32 v69, 0
v_mov_b32 v70, 0
v_mov_b32 v71, 0
v_mov_b32 v72, 0
v_mov_b32 v73, 0
v_mov_b32 v74, 0
v_mov_b32 v75, 0
v_mov_b32 v76, 0
v_mov_b32 v77, 0
v_mov_b32 v78, 0
v_mov_b32 v79, 0
v_mov_b32 v80, 0
v_mov_b32 v81, 0
v_mov_b32 v82, 0
v_mov_b32 v83, 0
v_mov_b32 v84, 0
v_mov_b32 v85, 0
v_mov_b32 v86, 0
v_mov_b32 v87, 0
v_mov_b32 v88, 0
v_mov_b32 v89, 0
v_mov_b32 v90, 0
v_mov_b32 v91, 0
v_mov_b32 v92, 0
v_mov_b32 v93, 0
v_mov_b32 v94, 0
v_mov_b32 v95, 0
v_mov_b32 v96, 0
v_mov_b32 v97, 0
v_mov_b32 v98, 0
v_mov_b32 v99, 0
v_mov_b32 v100, 0
v_mov_b32 v101, 0
v_mov_b32 v102, 0
v_mov_b32 v103, 0
v_mov_b32 v104, 0
v_mov_b32 v105, 0
v_mov_b32 v106, 0
v_mov_b32 v107, 0
v_mov_b32 v108, 0
v_mov_b32 v109, 0
v_mov_b32 v110, 0
v_mov_b32 v111, 0
v_mov_b32 v208, 0
v_mov_b32 v209, 0
v_mov_b32 v210, 0
v_mov_b32 v211, 0
v_mov_b32 v212, 0
v_mov_b32 v213, 0
v_mov_b32 v214, 0
v_mov_b32 v215, 0
v_mov_b32 v216, 0
v_mov_b32 v217, 0
v_mov_b32 v218, 0
v_mov_b32 v219, 0
s_mov_b32 s93, 393216
s_mov_b32 s92, 0
L_s2_3:
s_mov_b32 s95, s93
buffer_load_dwordx4 v[112:115], v171, s[8:11], s93 offen offset:0
buffer_load_dwordx4 v[116:119], v171, s[8:11], s93 offen offset:64
buffer_load_dwordx4 v[120:123], v171, s[8:11], s93 offen offset:128
buffer_load_dwordx4 v[124:127], v171, s[8:11], s93 offen offset:192
s_waitcnt vmcnt(0)
mm v[128:131],v[112:115],a[144:147],0
mm v[128:131],v[116:119],a[156:159],v[128:131]
mm v[128:131],v[120:123],a[168:171],v[128:131]
mm v[128:131],v[124:127],a[180:183],v[128:131]
mm v[132:135],v[112:115],a[148:151],0
mm v[132:135],v[116:119],a[160:163],v[132:135]
mm v[132:135],v[120:123],a[172:175],v[132:135]
mm v[132:135],v[124:127],a[184:187],v[132:135]
mm v[136:139],v[112:115],a[152:155],0
mm v[136:139],v[116:119],a[164:167],v[136:139]
mm v[136:139],v[120:123],a[176:179],v[136:139]
mm v[136:139],v[124:127],a[188:191],v[136:139]
s_nop 9
v_sub_f32 v128, v128, v168
v_sub_f32 v129, v129, v168
v_sub_f32 v130, v130, v168
v_sub_f32 v131, v131, v168
v_exp_f32 v128, v128
v_exp_f32 v129, v129
v_exp_f32 v130, v130
v_exp_f32 v131, v131
s_nop 0
cv v140,v128,v129
cv v141,v130,v131
v_sub_f32 v132, v132, v169
v_sub_f32 v133, v133, v169
v_sub_f32 v134, v134, v169
v_sub_f32 v135, v135, v169
v_exp_f32 v132, v132
v_exp_f32 v133, v133
v_exp_f32 v134, v134
v_exp_f32 v135, v135
s_nop 0
cv v144,v132,v133
cv v145,v134,v135
v_sub_f32 v136, v136, v170
v_sub_f32 v137, v137, v170
v_sub_f32 v138, v138, v170
v_sub_f32 v139, v139, v170
v_exp_f32 v136, v136
v_exp_f32 v137, v137
v_exp_f32 v138, v138
v_exp_f32 v139, v139
s_nop 0
cv v148,v136,v137
cv v149,v138,v139
s_add_u32 s93, s93, 4096
buffer_load_dwordx4 v[112:115], v171, s[8:11], s93 offen offset:0
buffer_load_dwordx4 v[116:119], v171, s[8:11], s93 offen offset:64
buffer_load_dwordx4 v[120:123], v171, s[8:11], s93 offen offset:128
buffer_load_dwordx4 v[124:127], v171, s[8:11], s93 offen offset:192
s_waitcnt vmcnt(0)
mm v[128:131],v[112:115],a[144:147],0
mm v[128:131],v[116:119],a[156:159],v[128:131]
mm v[128:131],v[120:123],a[168:171],v[128:131]
mm v[128:131],v[124:127],a[180:183],v[128:131]
mm v[132:135],v[112:115],a[148:151],0
mm v[132:135],v[116:119],a[160:163],v[132:135]
mm v[132:135],v[120:123],a[172:175],v[132:135]
mm v[132:135],v[124:127],a[184:187],v[132:135]
mm v[136:139],v[112:115],a[152:155],0
mm v[136:139],v[116:119],a[164:167],v[136:139]
mm v[136:139],v[120:123],a[176:179],v[136:139]
mm v[136:139],v[124:127],a[188:191],v[136:139]
s_nop 9
v_sub_f32 v128, v128, v168
v_sub_f32 v129, v129, v168
v_sub_f32 v130, v130, v168
v_sub_f32 v131, v131, v168
v_exp_f32 v128, v128
v_exp_f32 v129, v129
v_exp_f32 v130, v130
v_exp_f32 v131, v131
s_nop 0
cv v142,v128,v129
cv v143,v130,v131
v_sub_f32 v132, v132, v169
v_sub_f32 v133, v133, v169
v_sub_f32 v134, v134, v169
v_sub_f32 v135, v135, v169
v_exp_f32 v132, v132
v_exp_f32 v133, v133
v_exp_f32 v134, v134
v_exp_f32 v135, v135
s_nop 0
cv v146,v132,v133
cv v147,v134,v135
v_sub_f32 v136, v136, v170
v_sub_f32 v137, v137, v170
v_sub_f32 v138, v138, v170
v_sub_f32 v139, v139, v170
v_exp_f32 v136, v136
v_exp_f32 v137, v137
v_exp_f32 v138, v138
v_exp_f32 v139, v139
s_nop 0
cv v150,v136,v137
cv v151,v138,v139
s_add_u32 s93, s93, 4096
s_add_u32 s94, s95, 4096
s_nop 1
mm v[208:211],v[220:223],v[140:143],v[208:211]
mm v[212:215],v[220:223],v[144:147],v[212:215]
mm v[216:219],v[220:223],v[148:151],v[216:219]
buffer_load_ushort v152, v172, s[12:15], s95 offen offset:0
buffer_load_ushort v153, v172, s[12:15], s95 offen offset:256
buffer_load_ushort v154, v172, s[12:15], s95 offen offset:512
buffer_load_ushort v155, v172, s[12:15], s95 offen offset:768
buffer_load_ushort v156, v172, s[12:15], s94 offen offset:0
buffer_load_ushort v157, v172, s[12:15], s94 offen offset:256
buffer_load_ushort v158, v172, s[12:15], s94 offen offset:512
buffer_load_ushort v159, v172, s[12:15], s94 offen offset:768
buffer_load_ushort v160, v172, s[12:15], s95 offen offset:32
buffer_load_ushort v161, v172, s[12:15], s95 offen offset:288
buffer_load_ushort v162, v172, s[12:15], s95 offen offset:544
buffer_load_ushort v163, v172, s[12:15], s95 offen offset:800
buffer_load_ushort v164, v172, s[12:15], s94 offen offset:32
buffer_load_ushort v165, v172, s[12:15], s94 offen offset:288
buffer_load_ushort v166, v172, s[12:15], s94 offen offset:544
buffer_load_ushort v167, v172, s[12:15], s94 offen offset:800
s_waitcnt vmcnt(0)
v_lshl_or_b32 v152, v153, 16, v152
v_lshl_or_b32 v153, v155, 16, v154
v_lshl_or_b32 v154, v157, 16, v156
v_lshl_or_b32 v155, v159, 16, v158
v_lshl_or_b32 v160, v161, 16, v160
v_lshl_or_b32 v161, v163, 16, v162
v_lshl_or_b32 v162, v165, 16, v164
v_lshl_or_b32 v163, v167, 16, v166
s_nop 1
mm v[16:19],v[152:155],v[140:143],v[16:19]
mm v[20:23],v[152:155],v[144:147],v[20:23]
mm v[24:27],v[152:155],v[148:151],v[24:27]
mm v[28:31],v[160:163],v[140:143],v[28:31]
mm v[32:35],v[160:163],v[144:147],v[32:35]
mm v[36:39],v[160:163],v[148:151],v[36:39]
s_nop 7
buffer_load_ushort v152, v172, s[12:15], s95 offen offset:64
buffer_load_ushort v153, v172, s[12:15], s95 offen offset:320
buffer_load_ushort v154, v172, s[12:15], s95 offen offset:576
buffer_load_ushort v155, v172, s[12:15], s95 offen offset:832
buffer_load_ushort v156, v172, s[12:15], s94 offen offset:64
buffer_load_ushort v157, v172, s[12:15], s94 offen offset:320
buffer_load_ushort v158, v172, s[12:15], s94 offen offset:576
buffer_load_ushort v159, v172, s[12:15], s94 offen offset:832
buffer_load_ushort v160, v172, s[12:15], s95 offen offset:96
buffer_load_ushort v161, v172, s[12:15], s95 offen offset:352
buffer_load_ushort v162, v172, s[12:15], s95 offen offset:608
buffer_load_ushort v163, v172, s[12:15], s95 offen offset:864
buffer_load_ushort v164, v172, s[12:15], s94 offen offset:96
buffer_load_ushort v165, v172, s[12:15], s94 offen offset:352
buffer_load_ushort v166, v172, s[12:15], s94 offen offset:608
buffer_load_ushort v167, v172, s[12:15], s94 offen offset:864
s_waitcnt vmcnt(0)
v_lshl_or_b32 v152, v153, 16, v152
v_lshl_or_b32 v153, v155, 16, v154
v_lshl_or_b32 v154, v157, 16, v156
v_lshl_or_b32 v155, v159, 16, v158
v_lshl_or_b32 v160, v161, 16, v160
v_lshl_or_b32 v161, v163, 16, v162
v_lshl_or_b32 v162, v165, 16, v164
v_lshl_or_b32 v163, v167, 16, v166
s_nop 1
mm v[40:43],v[152:155],v[140:143],v[40:43]
mm v[44:47],v[152:155],v[144:147],v[44:47]
mm v[48:51],v[152:155],v[148:151],v[48:51]
mm v[52:55],v[160:163],v[140:143],v[52:55]
mm v[56:59],v[160:163],v[144:147],v[56:59]
mm v[60:63],v[160:163],v[148:151],v[60:63]
s_nop 7
buffer_load_ushort v152, v172, s[12:15], s95 offen offset:128
buffer_load_ushort v153, v172, s[12:15], s95 offen offset:384
buffer_load_ushort v154, v172, s[12:15], s95 offen offset:640
buffer_load_ushort v155, v172, s[12:15], s95 offen offset:896
buffer_load_ushort v156, v172, s[12:15], s94 offen offset:128
buffer_load_ushort v157, v172, s[12:15], s94 offen offset:384
buffer_load_ushort v158, v172, s[12:15], s94 offen offset:640
buffer_load_ushort v159, v172, s[12:15], s94 offen offset:896
buffer_load_ushort v160, v172, s[12:15], s95 offen offset:160
buffer_load_ushort v161, v172, s[12:15], s95 offen offset:416
buffer_load_ushort v162, v172, s[12:15], s95 offen offset:672
buffer_load_ushort v163, v172, s[12:15], s95 offen offset:928
buffer_load_ushort v164, v172, s[12:15], s94 offen offset:160
buffer_load_ushort v165, v172, s[12:15], s94 offen offset:416
buffer_load_ushort v166, v172, s[12:15], s94 offen offset:672
buffer_load_ushort v167, v172, s[12:15], s94 offen offset:928
s_waitcnt vmcnt(0)
v_lshl_or_b32 v152, v153, 16, v152
v_lshl_or_b32 v153, v155, 16, v154
v_lshl_or_b32 v154, v157, 16, v156
v_lshl_or_b32 v155, v159, 16, v158
v_lshl_or_b32 v160, v161, 16, v160
v_lshl_or_b32 v161, v163, 16, v162
v_lshl_or_b32 v162, v165, 16, v164
v_lshl_or_b32 v163, v167, 16, v166
s_nop 1
mm v[64:67],v[152:155],v[140:143],v[64:67]
mm v[68:71],v[152:155],v[144:147],v[68:71]
mm v[72:75],v[152:155],v[148:151],v[72:75]
mm v[76:79],v[160:163],v[140:143],v[76:79]
mm v[80:83],v[160:163],v[144:147],v[80:83]
mm v[84:87],v[160:163],v[148:151],v[84:87]
s_nop 7
buffer_load_ushort v152, v172, s[12:15], s95 offen offset:192
buffer_load_ushort v153, v172, s[12:15], s95 offen offset:448
buffer_load_ushort v154, v172, s[12:15], s95 offen offset:704
buffer_load_ushort v155, v172, s[12:15], s95 offen offset:960
buffer_load_ushort v156, v172, s[12:15], s94 offen offset:192
buffer_load_ushort v157, v172, s[12:15], s94 offen offset:448
buffer_load_ushort v158, v172, s[12:15], s94 offen offset:704
buffer_load_ushort v159, v172, s[12:15], s94 offen offset:960
buffer_load_ushort v160, v172, s[12:15], s95 offen offset:224
buffer_load_ushort v161, v172, s[12:15], s95 offen offset:480
buffer_load_ushort v162, v172, s[12:15], s95 offen offset:736
buffer_load_ushort v163, v172, s[12:15], s95 offen offset:992
buffer_load_ushort v164, v172, s[12:15], s94 offen offset:224
buffer_load_ushort v165, v172, s[12:15], s94 offen offset:480
buffer_load_ushort v166, v172, s[12:15], s94 offen offset:736
buffer_load_ushort v167, v172, s[12:15], s94 offen offset:992
s_waitcnt vmcnt(0)
v_lshl_or_b32 v152, v153, 16, v152
v_lshl_or_b32 v153, v155, 16, v154
v_lshl_or_b32 v154, v157, 16, v156
v_lshl_or_b32 v155, v159, 16, v158
v_lshl_or_b32 v160, v161, 16, v160
v_lshl_or_b32 v161, v163, 16, v162
v_lshl_or_b32 v162, v165, 16, v164
v_lshl_or_b32 v163, v167, 16, v166
s_nop 1
mm v[88:91],v[152:155],v[140:143],v[88:91]
mm v[92:95],v[152:155],v[144:147],v[92:95]
mm v[96:99],v[152:155],v[148:151],v[96:99]
mm v[100:103],v[160:163],v[140:143],v[100:103]
mm v[104:107],v[160:163],v[144:147],v[104:107]
mm v[108:111],v[160:163],v[148:151],v[108:111]
s_nop 7
s_add_u32 s92, s92, 1
s_cmp_lt_u32 s92, 16
s_cbranch_scc1 L_s2_3
s_nop 9
s_lshl_b32 s95, s2, 2
s_add_u32 s95, s95, s42
s_mul_i32 s95, s95, 16384
s_add_u32 s95, s95, 1048576
v_lshlrev_b32 v244, 4, v0
buffer_load_dwordx4 v[112:115], v244, s[28:31], s95 offen sc1
v_add_u32 v244, 1024, v244
buffer_load_dwordx4 v[116:119], v244, s[28:31], s95 offen sc1
v_add_u32 v244, 1024, v244
buffer_load_dwordx4 v[120:123], v244, s[28:31], s95 offen sc1
v_add_u32 v244, 1024, v244
buffer_load_dwordx4 v[124:127], v244, s[28:31], s95 offen sc1
v_add_u32 v244, 1024, v244
buffer_load_dwordx4 v[128:131], v244, s[28:31], s95 offen sc1
v_add_u32 v244, 1024, v244
buffer_load_dwordx4 v[132:135], v244, s[28:31], s95 offen sc1
v_add_u32 v244, 1024, v244
buffer_load_dwordx4 v[136:139], v244, s[28:31], s95 offen sc1
v_add_u32 v244, 1024, v244
buffer_load_dwordx4 v[140:143], v244, s[28:31], s95 offen sc1
v_add_u32 v244, 1024, v244
buffer_load_dwordx4 v[144:147], v244, s[28:31], s95 offen sc1
v_add_u32 v244, 1024, v244
buffer_load_dwordx4 v[148:151], v244, s[28:31], s95 offen sc1
v_add_u32 v244, 1024, v244
buffer_load_dwordx4 v[152:155], v244, s[28:31], s95 offen sc1
v_add_u32 v244, 1024, v244
buffer_load_dwordx4 v[156:159], v244, s[28:31], s95 offen sc1
v_add_u32 v244, 1024, v244
buffer_load_dwordx4 v[160:163], v244, s[28:31], s95 offen sc1
v_add_u32 v244, 1024, v244
buffer_load_dwordx4 v[164:167], v244, s[28:31], s95 offen sc1
v_add_u32 v244, 1024, v244
buffer_load_dwordx4 v[168:171], v244, s[28:31], s95 offen sc1
v_add_u32 v244, 1024, v244
buffer_load_dwordx4 v[172:175], v244, s[28:31], s95 offen sc1
v_add_u32 v244, 1024, v244
v_rcp_f32 v240, v208
v_rcp_f32 v241, v212
v_rcp_f32 v242, v216
s_waitcnt vmcnt(0)
s_branch L_back3
L_notready:
s_mov_b32 s55, 0
s_lshl_b32 s54, s40, 3
L_nr_loop:
buffer_load_dword v252, v251, s[32:35], s54 offen offset:4 sc1
s_add_u32 s55, s55, 1
s_waitcnt vmcnt(0)
v_cmp_ne_u32 vcc, 0xff, v252
s_cmp_gt_u32 s55, 200000
s_cbranch_scc1 L_ready
s_nop 2
s_cbranch_vccnz L_nr_loop
s_branch L_ready
.fill 64, 4, 0xbf810000
.section .rodata,"a"
.p2align 6
.amdhsa_kernel standalone__mha_block_cached__near_ridge_kernel
  .amdhsa_next_free_vgpr 512
  .amdhsa_next_free_sgpr 102
  .amdhsa_accum_offset 256
  .amdhsa_group_segment_fixed_size 0
  .amdhsa_kernarg_size 64
  .amdhsa_user_sgpr_count 2
  .amdhsa_user_sgpr_kernarg_segment_ptr 1
  .amdhsa_system_sgpr_workgroup_id_x 1
.end_amdhsa_kernel
```
